```python
import torch

def _softmax(x, axis=-1):
    return torch.softmax(x, dim=axis)

def _gelu(x):
    return torch.nn.functional.gelu(x, approximate='tanh')

def _silu(x):
    return torch.nn.functional.silu(x)

def _sigmoid(x):
    return torch.sigmoid(x)

def _layernorm(x, axis=-1, eps=1e-05):
    m = x.mean(dim=axis, keepdim=True)
    v = x.var(dim=axis, keepdim=True, unbiased=False)
    return (x - m) / torch.sqrt(v + eps)

def _scatter_add(tgt, idx, src, axis=0):
    return tgt.clone().index_add_(axis, idx, src)

def _segment_sum(src, seg, n):
    out = torch.zeros((n,) + src.shape[1:], dtype=src.dtype)
    return out.index_add_(0, seg, src)

def _pad(x, pw):
    flat = tuple((v for pair in reversed(pw) for v in pair))
    return torch.nn.functional.pad(x, flat)
kernel_name = 'concat_heads__spectral_gfnet__memory_aug_recurrent_mem_tr__prompt'

def setup_inputs():

    _w = lambda a: (lambda t: t.to(torch.bfloat16) if t.is_floating_point() else t)(torch.as_tensor(a))

    def _A_setup():
        B, S, D = (1, 2048, 512)
        Df = D // 2 + 1
        return {'x': _w((lambda *s: torch.randn(*s, dtype=torch.bfloat16) * 0.05)(B, S, D)), 'w_r': _w((lambda *s: torch.randn(*s, dtype=torch.bfloat16) * 3.2)(S, Df) * 0.02), 'w_i': _w((lambda *s: torch.randn(*s, dtype=torch.bfloat16) * 3.2)(S, Df) * 0.02)}
    _A_in = _A_setup()

    def _B_setup():
        B, S, Dm = (1, 2048, 512)
        H, Dh = (32, 128)
        M, seg = (8, 32)
        seg = min(seg, S)
        S = S // seg * seg
        return {'x': _w((lambda *s: torch.randn(*s, dtype=torch.bfloat16) * 0.05)(B, S, Dm)), 'mem0': _w((lambda *s: torch.randn(*s, dtype=torch.bfloat16) * 0.4)(B, M, Dm)), 'Wq': _w((lambda *s: torch.randn(*s, dtype=torch.bfloat16) * 6.4)(Dm, H, Dh) * Dm ** (-0.5)), 'Wk': _w((lambda *s: torch.randn(*s, dtype=torch.bfloat16) * 6.4)(Dm, H, Dh) * Dm ** (-0.5)), 'Wv': _w((lambda *s: torch.randn(*s, dtype=torch.bfloat16) * 0.4)(Dm, H, Dh) * Dm ** (-0.5)), 'Wo': _w((lambda *s: torch.randn(*s, dtype=torch.bfloat16) * 0.4)(H, Dh, Dm) * (H * Dh) ** (-0.5)), 'seg_len': seg}
    _B_in = _B_setup()
    return {'A_x': _A_in['x'], 'A_w_r': _A_in['w_r'], 'A_w_i': _A_in['w_i'], 'B_x': _B_in['x'], 'B_mem0': _B_in['mem0'], 'B_Wq': _B_in['Wq'], 'B_Wk': _B_in['Wk'], 'B_Wv': _B_in['Wv'], 'B_Wo': _B_in['Wo'], 'B_seg_len': _B_in['seg_len']}

def reference(A_x, A_w_r, A_w_i, B_x, B_mem0, B_Wq, B_Wk, B_Wv, B_Wo, B_seg_len):

    def _A_ref(x, w_r, w_i):
        B, S, D = x.shape
        X = (lambda x, axes=(-2, -1): torch.fft.rfft2(x.float(), dim=axes))(x, axes=(-2, -1))
        W = w_r + 1j * w_i
        X = X * W
        y = (lambda x, s, axes=(-2, -1): torch.fft.irfft2(x, s=s, dim=axes).to(torch.bfloat16))(X, (S, D), axes=(-2, -1))
        return y

    def _B_ref(x, mem0, Wq, Wk, Wv, Wo, seg_len):
        B, S, Dm = x.shape
        H, Dh = (Wq.shape[1], Wq.shape[2])
        M = mem0.shape[1]
        scale = Dh ** (-0.5)
        n_seg = S // seg_len
        L = M + seg_len
        idx = torch.arange(L)
        mask = (idx[:, None] < M) | (idx[:, None] >= idx[None, :])
        mem = mem0
        outs = []
        for s in range(n_seg):
            xs = x[:, s * seg_len:(s + 1) * seg_len, :].clone()
            h = torch.concatenate([mem, xs], axis=1)
            q = torch.einsum('btd,dhe->bhte', h, Wq)
            k = torch.einsum('btd,dhe->bhte', h, Wk)
            v = torch.einsum('btd,dhe->bhte', h, Wv)
            scores = torch.einsum('bhqe,bhke->bhqk', q, k) * scale
            scores = torch.where(mask[None, None], scores, -1000000000.0)
            p = _softmax(scores, axis=-1)
            o = torch.einsum('bhqk,bhke->bhqe', p, v)
            o = torch.einsum('bhte,hed->btd', o, Wo)
            mem = o[:, :M, :].clone()
            outs.append(o[:, M:, :])
        return torch.concatenate(outs, axis=1)
    a = _A_ref(A_x, A_w_r, A_w_i)
    b = _B_ref(B_x, B_mem0, B_Wq, B_Wk, B_Wv, B_Wo, B_seg_len)
    return torch.concatenate([a, b], axis=-1)
```

```asm
; @launch grid=(256,1,1) block=(256,1,1) lds=163840
.amdgcn_target "amdgcn-amd-amdhsa--gfx950"
.text
.globl concat_heads__spectral_gfnet__memory_aug_recurrent_mem_tr__prompt_kernel
.p2align 8
.type concat_heads__spectral_gfnet__memory_aug_recurrent_mem_tr__prompt_kernel,@function
concat_heads__spectral_gfnet__memory_aug_recurrent_mem_tr__prompt_kernel:
s_cmp_ge_u32 s2, 256
s_cbranch_scc1 L_end
s_load_dwordx16 s[64:79], s[0:1], 0
s_load_dwordx2 s[80:81], s[0:1], 64
s_load_dwordx4 s[4:7], s[0:1], 80
s_load_dwordx2 s[8:9], s[0:1], 96
s_getreg_b32 s3, hwreg(HW_REG_XCC_ID)
s_and_b32 s3, s3, 7
s_mov_b32 s10, 268435456
s_mov_b32 s11, 0x20000
s_mov_b32 s30, 0
v_lshrrev_b32 v1, 6, v0
s_nop 0
v_readfirstlane_b32 s17, v1
s_waitcnt lgkmcnt(0)
s_getreg_b32 s21, hwreg(HW_REG_HW_ID, 13, 2)
s_getreg_b32 s22, hwreg(HW_REG_HW_ID, 8, 3)
s_lshl3_add_u32 s22, s21, s22
s_lshl_b32 s82, s3, 5
s_add_u32 s82, s82, s22
s_mov_b32 s83, 0
s_lshl_b32 s100, 1, s22
s_mov_b32 s101, s100
s_cmp_lg_u32 s17, 0
s_cbranch_scc1 L_go
s_cmp_lt_u32 s82, 32
s_cbranch_scc1 L_go
s_lshl_b32 s20, s3, 2
s_atomic_or s100, s[6:7], s20 glc
L_go:
s_cmp_ge_u32 s82, 32
s_cbranch_scc1 L_work
s_xor_b32 s16, s82, 0
v_mbcnt_lo_u32_b32 v51, -1, 0
v_mbcnt_hi_u32_b32 v51, -1, v51
s_lshl_b32 s28, s17, 6
v_add_u32 v51, s28, v51
v_mov_b32 v70, v51
v_bfe_u32 v50, v51, 1, 3
v_bfe_u32 v49, v51, 4, 2
v_xor_b32 v50, v50, v49
v_lshlrev_b32 v50, 5, v50
v_and_b32 v49, 1, v51
v_lshl_add_u32 v48, v49, 4, v50
s_lshl_b32 s28, s16, 8
v_bfe_u32 v124, v51, 4, 1
v_lshlrev_b32 v124, 13, v124
v_bfe_u32 v50, v51, 5, 1
v_lshl_add_u32 v124, v50, 16, v124
v_bfe_u32 v50, v51, 6, 1
v_lshl_add_u32 v124, v50, 14, v124
v_bfe_u32 v50, v51, 7, 1
v_lshl_add_u32 v124, v50, 18, v124
v_add_u32 v124, s28, v124
v_add_u32 v124, v124, v48
v_xor_b32 v125, 128, v124
s_lshl_b32 s28, s16, 17
v_bfe_u32 v126, v51, 5, 1
v_lshlrev_b32 v126, 15, v126
v_bfe_u32 v50, v51, 4, 1
v_lshl_add_u32 v126, v50, 10, v126
v_bfe_u32 v50, v51, 6, 2
v_lshl_add_u32 v126, v50, 8, v126
v_add_u32 v126, s28, v126
v_add_u32 v126, v126, v48
v_xor_b32 v127, 128, v126
s_or_b32 s28, s83, s17
s_cbranch_scc1 L_vc_1
s_atomic_or s100, s[6:7], 160 glc
L_vc_1:
s_mul_i32 s36, s17, 36864
s_add_u32 s36, s36, 16384
s_mov_b32 s14, 0x400000
s_mov_b32 s15, 0x20000
s_mov_b32 s12, s74
s_mov_b32 s13, s75
s_add_u32 m0, s36, 0
s_mov_b32 s28, 1048576
buffer_load_dwordx4 v124, s[12:15], s28 offen  lds
s_add_u32 m0, s36, 1024
s_mov_b32 s28, 1081344
buffer_load_dwordx4 v125, s[12:15], s28 offen  lds
s_add_u32 m0, s36, 2048
s_mov_b32 s28, 1179648
buffer_load_dwordx4 v124, s[12:15], s28 offen  lds
s_add_u32 m0, s36, 3072
s_mov_b32 s28, 1212416
buffer_load_dwordx4 v125, s[12:15], s28 offen  lds
s_add_u32 m0, s36, 4096
s_mov_b32 s28, 1572864
buffer_load_dwordx4 v124, s[12:15], s28 offen  lds
s_add_u32 m0, s36, 5120
s_mov_b32 s28, 1605632
buffer_load_dwordx4 v125, s[12:15], s28 offen  lds
s_add_u32 m0, s36, 6144
s_mov_b32 s28, 1703936
buffer_load_dwordx4 v124, s[12:15], s28 offen  lds
s_add_u32 m0, s36, 7168
s_mov_b32 s28, 1736704
buffer_load_dwordx4 v125, s[12:15], s28 offen  lds
s_add_u32 m0, s36, 8192
s_mov_b32 s28, 2097152
buffer_load_dwordx4 v124, s[12:15], s28 offen  lds
s_add_u32 m0, s36, 9216
s_mov_b32 s28, 2129920
buffer_load_dwordx4 v125, s[12:15], s28 offen  lds
s_add_u32 m0, s36, 10240
s_mov_b32 s28, 2228224
buffer_load_dwordx4 v124, s[12:15], s28 offen  lds
s_add_u32 m0, s36, 11264
s_mov_b32 s28, 2260992
buffer_load_dwordx4 v125, s[12:15], s28 offen  lds
s_add_u32 m0, s36, 12288
s_mov_b32 s28, 2621440
buffer_load_dwordx4 v124, s[12:15], s28 offen  lds
s_add_u32 m0, s36, 13312
s_mov_b32 s28, 2654208
buffer_load_dwordx4 v125, s[12:15], s28 offen  lds
s_add_u32 m0, s36, 14336
s_mov_b32 s28, 2752512
buffer_load_dwordx4 v124, s[12:15], s28 offen  lds
s_add_u32 m0, s36, 15360
s_mov_b32 s28, 2785280
buffer_load_dwordx4 v125, s[12:15], s28 offen  lds
v_bfe_u32 v50, v51, 2, 3
v_bfe_u32 v49, v51, 6, 2
v_lshlrev_b32 v49, 1, v49
v_xor_b32 v48, v50, v49
v_bfe_u32 v49, v51, 2, 4
v_lshlrev_b32 v49, 8, v49
v_bfe_u32 v50, v51, 0, 2
v_lshl_add_u32 v49, v50, 3, v49
v_lshl_add_u32 v49, v48, 5, v49
v_add_u32 v100, 16384, v49
v_xor_b32 v101, 32, v100
v_add_u32 v102, 53248, v49
v_xor_b32 v103, 32, v102
v_add_u32 v104, 90112, v49
v_xor_b32 v105, 32, v104
v_add_u32 v106, 126976, v49
v_xor_b32 v107, 32, v106
v_bfe_u32 v48, v51, 6, 2
v_lshlrev_b32 v48, 1, v48
v_bfe_u32 v50, v51, 3, 1
v_lshl_add_u32 v48, v50, 0, v48
v_bfe_u32 v49, v51, 4, 1
v_lshlrev_b32 v49, 2, v49
v_bfe_u32 v50, v51, 2, 1
v_lshl_add_u32 v49, v50, 0, v49
v_xor_b32 v48, v48, v49
v_bfe_u32 v49, v51, 4, 2
v_lshlrev_b32 v49, 10, v49
v_bfe_u32 v50, v51, 2, 1
v_lshl_add_u32 v49, v50, 8, v49
v_bfe_u32 v50, v51, 0, 2
v_lshl_add_u32 v49, v50, 3, v49
v_lshl_add_u32 v49, v48, 5, v49
v_add_u32 v108, 16384, v49
v_xor_b32 v109, 576, v108
v_add_u32 v110, 53248, v49
v_xor_b32 v111, 576, v110
v_add_u32 v112, 90112, v49
v_xor_b32 v113, 576, v112
v_add_u32 v114, 126976, v49
v_xor_b32 v115, 576, v114
v_bfe_u32 v0, v51, 0, 6
v_lshlrev_b32 v0, 4, v0
v_bfe_u32 v1, v51, 0, 6
v_lshlrev_b32 v1, 4, v1
v_bfe_u32 v50, v51, 6, 2
v_mul_u32_u24 v50, 36864, v50
v_add_u32 v1, v50, v1
v_add_u32 v1, 16384, v1
s_lshl_b32 s28, s16, 7
v_bfe_u32 v2, v51, 4, 4
v_lshlrev_b32 v2, 14, v2
v_bfe_u32 v50, v51, 0, 4
v_lshl_add_u32 v2, v50, 3, v2
v_add_u32 v2, s28, v2
v_bfe_u32 v49, v51, 4, 2
v_bfe_u32 v50, v51, 2, 2
v_lshl_add_u32 v49, v50, 0, v49
v_and_b32 v49, 3, v49
v_bfe_u32 v7, v51, 6, 2
v_lshlrev_b32 v7, 9, v7
v_bfe_u32 v50, v51, 0, 4
v_lshl_add_u32 v7, v50, 5, v7
v_lshl_add_u32 v7, v49, 3, v7
v_bfe_u32 v6, v51, 6, 2
v_lshlrev_b32 v6, 9, v6
v_bfe_u32 v50, v51, 0, 4
v_lshl_add_u32 v6, v50, 4, v6
v_bfe_u32 v50, v51, 4, 2
v_lshl_add_u32 v6, v50, 2, v6
v_add_u32 v6, 8192, v6
v_bfe_u32 v8, v51, 2, 4
v_lshlrev_b32 v8, 4, v8
v_bfe_u32 v50, v51, 0, 1
v_lshl_add_u32 v8, v50, 3, v8
v_bfe_u32 v10, v51, 6, 2
v_mul_u32_u24 v10, 1152, v10
v_bfe_u32 v50, v51, 1, 3
v_mul_u32_u24 v50, 136, v50
v_add_u32 v10, v50, v10
v_bfe_u32 v50, v51, 0, 1
v_lshl_add_u32 v10, v50, 6, v10
v_bfe_u32 v50, v51, 4, 2
v_lshl_add_u32 v10, v50, 3, v10
v_add_u32 v10, 8192, v10
v_bfe_u32 v48, v51, 2, 4
v_lshlrev_b32 v48, 5, v48
v_bfe_u32 v49, v51, 4, 2
v_bfe_u32 v50, v51, 0, 2
v_lshl_add_u32 v49, v50, 0, v49
v_and_b32 v49, 3, v49
v_lshl_add_u32 v9, v49, 3, v48
v_bfe_u32 v11, v51, 4, 1
v_mul_u32_u24 v11, 1152, v11
v_bfe_u32 v50, v51, 5, 1
v_mul_u32_u24 v50, 272, v50
v_add_u32 v11, v50, v11
v_bfe_u32 v50, v51, 2, 1
v_lshl_add_u32 v11, v50, 6, v11
v_bfe_u32 v50, v51, 3, 1
v_lshl_add_u32 v11, v50, 5, v11
v_bfe_u32 v50, v51, 0, 2
v_lshl_add_u32 v11, v50, 3, v11
v_bfe_u32 v12, v51, 6, 2
v_lshlrev_b32 v12, 8, v12
v_bfe_u32 v50, v51, 0, 4
v_lshl_add_u32 v12, v50, 4, v12
v_bfe_u32 v50, v51, 4, 2
v_lshl_add_u32 v12, v50, 2, v12
v_bfe_u32 v14, v51, 3, 1
v_mul_u32_u24 v14, 43690, v14
v_lshlrev_b32 v14, 16, v14
v_bfe_u32 v49, v51, 1, 1
v_mul_u32_u24 v49, 43690, v49
v_add_u32 v49, 1145324612, v49
v_add_u32 v14, v14, v49
v_mov_b32 v48, 0x3f80
v_bfe_u32 v49, v51, 2, 1
v_lshlrev_b32 v49, 4, v49
v_lshlrev_b32 v48, v49, v48
v_bfe_u32 v49, v51, 0, 2
v_lshlrev_b32 v49, 1, v49
v_bfe_u32 v50, v51, 3, 1
v_lshl_add_u32 v49, v50, 0, v49
v_cmp_eq_u32 vcc, 0, v49
s_nop 1
v_cndmask_b32 v20, 0, v48, vcc
v_cmp_eq_u32 vcc, 1, v49
s_nop 1
v_cndmask_b32 v21, 0, v48, vcc
v_cmp_eq_u32 vcc, 2, v49
s_nop 1
v_cndmask_b32 v22, 0, v48, vcc
v_cmp_eq_u32 vcc, 3, v49
s_nop 1
v_cndmask_b32 v23, 0, v48, vcc
ds_write_b128 v0, v[20:23] offset:14848
v_mov_b32 v123, 0
v_mov_b32 v118, 0x3f803f80
v_mov_b32 v119, 0x3f803f80
v_mov_b32 v120, 0x3f803f80
v_mov_b32 v121, 0x3f803f80
v_bfe_u32 v16, v51, 2, 2
v_lshlrev_b32 v16, 11, v16
v_bfe_u32 v50, v51, 0, 1
v_lshl_add_u32 v16, v50, 10, v16
v_bfe_u32 v50, v51, 4, 2
v_lshl_add_u32 v16, v50, 5, v16
v_bfe_u32 v50, v51, 1, 1
v_lshl_add_u32 v16, v50, 4, v16
v_bfe_u32 v50, v51, 6, 2
v_lshl_add_u32 v16, v50, 8, v16
s_and_b32 s28, s16, 1
s_lshl_b32 s28, s28, 11
s_and_b32 s29, s16, 30
s_lshl_b32 s29, s29, 6
s_add_u32 s28, s28, s29
v_bfe_u32 v3, v51, 6, 1
v_lshlrev_b32 v3, 12, v3
v_bfe_u32 v50, v51, 5, 1
v_lshl_add_u32 v3, v50, 6, v3
v_bfe_u32 v50, v51, 2, 1
v_lshl_add_u32 v3, v50, 5, v3
v_bfe_u32 v50, v51, 4, 1
v_lshl_add_u32 v3, v50, 4, v3
v_bfe_u32 v50, v51, 0, 2
v_lshl_add_u32 v3, v50, 2, v3
v_bfe_u32 v50, v51, 3, 1
v_lshl_add_u32 v3, v50, 30, v3
v_add_u32 v3, s28, v3
v_bfe_u32 v4, v51, 0, 6
v_lshlrev_b32 v4, 6, v4
v_bfe_u32 v50, v51, 1, 4
v_lshl_add_u32 v4, v50, 2, v4
s_lshl_b32 s28, s16, 1
s_add_u32 s28, s28, s17
s_and_b32 s28, s28, 7
s_lshl_b32 s28, s28, 7
v_bfe_u32 v76, v51, 0, 5
v_lshlrev_b32 v76, 2, v76
v_add_u32 v76, 1114112, v76
v_add_u32 v76, s28, v76
s_lshl_b32 s28, s16, 2
v_bfe_u32 v77, v51, 0, 3
v_lshlrev_b32 v77, 7, v77
v_bfe_u32 v50, v51, 3, 3
v_lshl_add_u32 v77, v50, 28, v77
v_add_u32 v77, 1114112, v77
v_add_u32 v77, s28, v77
s_lshl_b32 s28, s16, 7
s_add_u32 s28, s28, 1122304
v_and_b32 v50, 63, v51
v_min_u32 v50, 3, v50
v_lshl_add_u32 v78, v50, 2, s28
s_cmp_lt_u32 s17, 2
s_cbranch_scc1 Lc_ra_2
v_mov_b32 v3, v4
v_mov_b32 v4, v78
Lc_ra_2:
v_bfe_u32 v19, v51, 0, 4
v_lshlrev_b32 v19, 7, v19
v_bfe_u32 v50, v51, 4, 2
v_lshl_add_u32 v19, v50, 28, v19
v_bfe_u32 v52, v51, 0, 6
v_lshlrev_b32 v52, 6, v52
v_bfe_u32 v50, v51, 6, 1
v_lshl_add_u32 v52, v50, 12, v52
v_bfe_u32 v50, v51, 7, 1
v_lshl_add_u32 v52, v50, 18, v52
s_mov_b32 s27, 2141552549
s_mov_b32 s26, 1040356334
s_mov_b32 s31, 1468006400
s_mov_b32 s30, 0
s_mov_b32 s18, 0
s_mov_b32 s34, 0
s_mov_b32 s40, 63
s_mov_b32 s32, 0
s_mov_b32 s44, 0
s_mov_b32 s45, 0
s_mov_b32 s46, 0
s_mov_b32 s47, 0
s_lshl_b32 s28, s16, 13
s_and_b32 s29, s17, 1
s_lshl_b32 s29, s29, 12
s_add_u32 s21, s28, s29
s_lshl_b32 s37, s17, 11
s_add_u32 s37, s37, s28
s_mov_b32 s22, 1048576
s_mov_b32 s23, 1056768
s_mov_b32 s33, 1073152
s_add_u32 s24, s37, 16777216
s_add_u32 s25, s37, 17039360
s_mov_b32 s35, 1572864
s_waitcnt vmcnt(12)
s_barrier
s_cmp_lg_u32 s83, 0
s_cbranch_scc1 L_vf_3
v_mov_b32 v60, 15920
s_cmp_lg_u32 s17, 0
s_cbranch_scc1 L_vg_4
s_waitcnt lgkmcnt(0)
s_and_b32 s100, s100, s101
v_mov_b32 v61, s100
ds_write_b32 v60, v61
L_vg_4:
s_waitcnt lgkmcnt(0)
s_barrier
ds_read_b32 v61, v60
s_waitcnt lgkmcnt(0)
v_cmp_ne_u32 vcc, 0, v61
s_cbranch_vccnz L_redo
L_vf_3:
s_add_u32 s28, s16, 128
v_mov_b32 v15, s28
s_add_u32 s29, s3, 1
v_mov_b32 v18, s29
s_cmp_lg_u32 s17, 1
s_cbranch_scc1 Lc_rg_5
s_mov_b64 exec, 1
global_store_byte v15, v18, s[6:7] sc1
s_mov_b64 exec, -1
Lc_rg_5:
s_add_u32 m0, s36, 16384
s_mov_b32 s28, 3670016
buffer_load_dwordx4 v124, s[12:15], s28 offen  lds
s_add_u32 m0, s36, 17408
s_mov_b32 s28, 3702784
buffer_load_dwordx4 v125, s[12:15], s28 offen  lds
s_add_u32 m0, s36, 18432
s_mov_b32 s28, 3801088
buffer_load_dwordx4 v124, s[12:15], s28 offen  lds
s_add_u32 m0, s36, 19456
s_mov_b32 s28, 3833856
buffer_load_dwordx4 v125, s[12:15], s28 offen  lds
ds_read_b64_tr_b16 a[0:1], v100 offset:0
ds_read_b64_tr_b16 a[2:3], v102 offset:0
ds_read_b64_tr_b16 a[4:5], v104 offset:0
ds_read_b64_tr_b16 a[6:7], v106 offset:0
ds_read_b64_tr_b16 a[8:9], v101 offset:0
ds_read_b64_tr_b16 a[10:11], v103 offset:0
ds_read_b64_tr_b16 a[12:13], v105 offset:0
ds_read_b64_tr_b16 a[14:15], v107 offset:0
s_waitcnt lgkmcnt(0)
s_waitcnt vmcnt(12)
s_barrier
s_mov_b32 s48, s72
s_mov_b32 s49, s73
s_mov_b32 s50, 8192
s_mov_b32 s51, 0x20000
buffer_load_dwordx4 v[136:139], v16, s[48:51], 0 offen offset:0
buffer_load_dwordx4 v[140:143], v16, s[48:51], 0 offen offset:128
v_lshrrev_b32 v13, 2, v0
s_mov_b32 s48, 0
s_mov_b32 s49, 8192
s_mov_b32 s50, 4096
s_mov_b32 s51, 12288
s_mov_b32 s12, s76
s_mov_b32 s13, s77
s_add_u32 m0, s36, 20480
s_mov_b32 s28, 0
buffer_load_dwordx4 v124, s[12:15], s28 offen  lds
s_add_u32 m0, s36, 21504
s_mov_b32 s28, 32768
buffer_load_dwordx4 v125, s[12:15], s28 offen  lds
s_add_u32 m0, s36, 22528
s_mov_b32 s28, 131072
buffer_load_dwordx4 v124, s[12:15], s28 offen  lds
s_add_u32 m0, s36, 23552
s_mov_b32 s28, 163840
buffer_load_dwordx4 v125, s[12:15], s28 offen  lds
ds_read_b64_tr_b16 a[16:17], v100 offset:4096
ds_read_b64_tr_b16 a[18:19], v102 offset:4096
ds_read_b64_tr_b16 a[20:21], v104 offset:4096
ds_read_b64_tr_b16 a[22:23], v106 offset:4096
ds_read_b64_tr_b16 a[24:25], v101 offset:4096
ds_read_b64_tr_b16 a[26:27], v103 offset:4096
ds_read_b64_tr_b16 a[28:29], v105 offset:4096
ds_read_b64_tr_b16 a[30:31], v107 offset:4096
s_waitcnt lgkmcnt(0)
s_waitcnt vmcnt(14)
s_barrier
s_add_u32 m0, s36, 24576
s_mov_b32 s28, 524288
buffer_load_dwordx4 v124, s[12:15], s28 offen  lds
s_add_u32 m0, s36, 25600
s_mov_b32 s28, 557056
buffer_load_dwordx4 v125, s[12:15], s28 offen  lds
s_add_u32 m0, s36, 26624
s_mov_b32 s28, 655360
buffer_load_dwordx4 v124, s[12:15], s28 offen  lds
s_add_u32 m0, s36, 27648
s_mov_b32 s28, 688128
buffer_load_dwordx4 v125, s[12:15], s28 offen  lds
ds_read_b64_tr_b16 a[32:33], v100 offset:8192
ds_read_b64_tr_b16 a[34:35], v102 offset:8192
ds_read_b64_tr_b16 a[36:37], v104 offset:8192
ds_read_b64_tr_b16 a[38:39], v106 offset:8192
ds_read_b64_tr_b16 a[40:41], v101 offset:8192
ds_read_b64_tr_b16 a[42:43], v103 offset:8192
ds_read_b64_tr_b16 a[44:45], v105 offset:8192
ds_read_b64_tr_b16 a[46:47], v107 offset:8192
s_waitcnt lgkmcnt(0)
s_waitcnt vmcnt(14)
s_barrier
s_add_u32 m0, s36, 28672
s_mov_b32 s28, 1048576
buffer_load_dwordx4 v124, s[12:15], s28 offen  lds
s_add_u32 m0, s36, 29696
s_mov_b32 s28, 1081344
buffer_load_dwordx4 v125, s[12:15], s28 offen  lds
s_add_u32 m0, s36, 30720
s_mov_b32 s28, 1179648
buffer_load_dwordx4 v124, s[12:15], s28 offen  lds
s_add_u32 m0, s36, 31744
s_mov_b32 s28, 1212416
buffer_load_dwordx4 v125, s[12:15], s28 offen  lds
ds_read_b64_tr_b16 a[48:49], v100 offset:12288
ds_read_b64_tr_b16 a[50:51], v102 offset:12288
ds_read_b64_tr_b16 a[52:53], v104 offset:12288
ds_read_b64_tr_b16 a[54:55], v106 offset:12288
ds_read_b64_tr_b16 a[56:57], v101 offset:12288
ds_read_b64_tr_b16 a[58:59], v103 offset:12288
ds_read_b64_tr_b16 a[60:61], v105 offset:12288
ds_read_b64_tr_b16 a[62:63], v107 offset:12288
s_waitcnt lgkmcnt(0)
s_waitcnt vmcnt(14)
s_barrier
s_add_u32 m0, s36, 32768
s_mov_b32 s28, 2097152
buffer_load_dwordx4 v124, s[12:15], s28 offen  lds
s_add_u32 m0, s36, 33792
s_mov_b32 s28, 2129920
buffer_load_dwordx4 v125, s[12:15], s28 offen  lds
s_add_u32 m0, s36, 34816
s_mov_b32 s28, 2228224
buffer_load_dwordx4 v124, s[12:15], s28 offen  lds
s_add_u32 m0, s36, 35840
s_mov_b32 s28, 2260992
buffer_load_dwordx4 v125, s[12:15], s28 offen  lds
ds_read_b64_tr_b16 a[64:65], v100 offset:16384
ds_read_b64_tr_b16 a[66:67], v102 offset:16384
ds_read_b64_tr_b16 a[68:69], v104 offset:16384
ds_read_b64_tr_b16 a[70:71], v106 offset:16384
ds_read_b64_tr_b16 a[72:73], v101 offset:16384
ds_read_b64_tr_b16 a[74:75], v103 offset:16384
ds_read_b64_tr_b16 a[76:77], v105 offset:16384
ds_read_b64_tr_b16 a[78:79], v107 offset:16384
s_waitcnt lgkmcnt(0)
s_waitcnt vmcnt(12)
s_barrier
s_add_u32 m0, s36, 0
s_mov_b32 s28, 2621440
buffer_load_dwordx4 v124, s[12:15], s28 offen  lds
s_add_u32 m0, s36, 1024
s_mov_b32 s28, 2654208
buffer_load_dwordx4 v125, s[12:15], s28 offen  lds
s_add_u32 m0, s36, 2048
s_mov_b32 s28, 2752512
buffer_load_dwordx4 v124, s[12:15], s28 offen  lds
s_add_u32 m0, s36, 3072
s_mov_b32 s28, 2785280
buffer_load_dwordx4 v125, s[12:15], s28 offen  lds
ds_read_b64_tr_b16 a[80:81], v100 offset:20480
ds_read_b64_tr_b16 a[82:83], v102 offset:20480
ds_read_b64_tr_b16 a[84:85], v104 offset:20480
ds_read_b64_tr_b16 a[86:87], v106 offset:20480
ds_read_b64_tr_b16 a[88:89], v101 offset:20480
ds_read_b64_tr_b16 a[90:91], v103 offset:20480
ds_read_b64_tr_b16 a[92:93], v105 offset:20480
ds_read_b64_tr_b16 a[94:95], v107 offset:20480
s_waitcnt lgkmcnt(0)
s_waitcnt vmcnt(12)
s_barrier
s_add_u32 m0, s36, 4096
s_mov_b32 s28, 3145728
buffer_load_dwordx4 v124, s[12:15], s28 offen  lds
s_add_u32 m0, s36, 5120
s_mov_b32 s28, 3178496
buffer_load_dwordx4 v125, s[12:15], s28 offen  lds
s_add_u32 m0, s36, 6144
s_mov_b32 s28, 3276800
buffer_load_dwordx4 v124, s[12:15], s28 offen  lds
s_add_u32 m0, s36, 7168
s_mov_b32 s28, 3309568
buffer_load_dwordx4 v125, s[12:15], s28 offen  lds
ds_read_b64_tr_b16 a[96:97], v100 offset:24576
ds_read_b64_tr_b16 a[98:99], v102 offset:24576
ds_read_b64_tr_b16 a[100:101], v104 offset:24576
ds_read_b64_tr_b16 a[102:103], v106 offset:24576
ds_read_b64_tr_b16 a[104:105], v101 offset:24576
ds_read_b64_tr_b16 a[106:107], v103 offset:24576
ds_read_b64_tr_b16 a[108:109], v105 offset:24576
ds_read_b64_tr_b16 a[110:111], v107 offset:24576
s_waitcnt lgkmcnt(0)
s_waitcnt vmcnt(12)
s_barrier
s_mov_b32 s12, s78
s_mov_b32 s13, s79
s_add_u32 m0, s36, 8192
s_mov_b32 s28, 0
buffer_load_dwordx4 v124, s[12:15], s28 offen  lds
s_add_u32 m0, s36, 9216
s_mov_b32 s28, 32768
buffer_load_dwordx4 v125, s[12:15], s28 offen  lds
s_add_u32 m0, s36, 10240
s_mov_b32 s28, 131072
buffer_load_dwordx4 v124, s[12:15], s28 offen  lds
s_add_u32 m0, s36, 11264
s_mov_b32 s28, 163840
buffer_load_dwordx4 v125, s[12:15], s28 offen  lds
ds_read_b64_tr_b16 a[112:113], v100 offset:28672
ds_read_b64_tr_b16 a[114:115], v102 offset:28672
ds_read_b64_tr_b16 a[116:117], v104 offset:28672
ds_read_b64_tr_b16 a[118:119], v106 offset:28672
ds_read_b64_tr_b16 a[120:121], v101 offset:28672
ds_read_b64_tr_b16 a[122:123], v103 offset:28672
ds_read_b64_tr_b16 a[124:125], v105 offset:28672
ds_read_b64_tr_b16 a[126:127], v107 offset:28672
s_waitcnt lgkmcnt(0)
s_waitcnt vmcnt(12)
s_barrier
s_add_u32 m0, s36, 12288
s_mov_b32 s28, 524288
buffer_load_dwordx4 v124, s[12:15], s28 offen  lds
s_add_u32 m0, s36, 13312
s_mov_b32 s28, 557056
buffer_load_dwordx4 v125, s[12:15], s28 offen  lds
s_add_u32 m0, s36, 14336
s_mov_b32 s28, 655360
buffer_load_dwordx4 v124, s[12:15], s28 offen  lds
s_add_u32 m0, s36, 15360
s_mov_b32 s28, 688128
buffer_load_dwordx4 v125, s[12:15], s28 offen  lds
ds_read_b64_tr_b16 a[128:129], v100 offset:32768
ds_read_b64_tr_b16 a[130:131], v102 offset:32768
ds_read_b64_tr_b16 a[132:133], v104 offset:32768
ds_read_b64_tr_b16 a[134:135], v106 offset:32768
ds_read_b64_tr_b16 a[136:137], v101 offset:32768
ds_read_b64_tr_b16 a[138:139], v103 offset:32768
ds_read_b64_tr_b16 a[140:141], v105 offset:32768
ds_read_b64_tr_b16 a[142:143], v107 offset:32768
s_waitcnt lgkmcnt(0)
s_waitcnt vmcnt(12)
s_barrier
s_add_u32 m0, s36, 16384
s_mov_b32 s28, 1048576
buffer_load_dwordx4 v124, s[12:15], s28 offen  lds
s_add_u32 m0, s36, 17408
s_mov_b32 s28, 1081344
buffer_load_dwordx4 v125, s[12:15], s28 offen  lds
s_add_u32 m0, s36, 18432
s_mov_b32 s28, 1179648
buffer_load_dwordx4 v124, s[12:15], s28 offen  lds
s_add_u32 m0, s36, 19456
s_mov_b32 s28, 1212416
buffer_load_dwordx4 v125, s[12:15], s28 offen  lds
ds_read_b64_tr_b16 a[144:145], v100 offset:0
ds_read_b64_tr_b16 a[146:147], v102 offset:0
ds_read_b64_tr_b16 a[148:149], v104 offset:0
ds_read_b64_tr_b16 a[150:151], v106 offset:0
ds_read_b64_tr_b16 a[152:153], v101 offset:0
ds_read_b64_tr_b16 a[154:155], v103 offset:0
ds_read_b64_tr_b16 a[156:157], v105 offset:0
ds_read_b64_tr_b16 a[158:159], v107 offset:0
s_waitcnt lgkmcnt(0)
s_waitcnt vmcnt(12)
s_barrier
v_mov_b32 v17, 2145746917
v_cmp_eq_u32 vcc, s27, v136
s_nop 1
v_cndmask_b32 v136, v136, v17, vcc
v_cmp_eq_u32 vcc, s27, v137
s_nop 1
v_cndmask_b32 v137, v137, v17, vcc
v_cmp_eq_u32 vcc, s27, v138
s_nop 1
v_cndmask_b32 v138, v138, v17, vcc
v_cmp_eq_u32 vcc, s27, v139
s_nop 1
v_cndmask_b32 v139, v139, v17, vcc
v_cmp_eq_u32 vcc, s27, v140
s_nop 1
v_cndmask_b32 v140, v140, v17, vcc
v_cmp_eq_u32 vcc, s27, v141
s_nop 1
v_cndmask_b32 v141, v141, v17, vcc
v_cmp_eq_u32 vcc, s27, v142
s_nop 1
v_cndmask_b32 v142, v142, v17, vcc
v_cmp_eq_u32 vcc, s27, v143
s_nop 1
v_cndmask_b32 v143, v143, v17, vcc
s_lshl_b32 s28, s17, 11
v_add_u32 v16, s28, v0
ds_write_b128 v16, v[136:139] offset:0
ds_write_b128 v16, v[140:143] offset:1024
s_add_u32 m0, s36, 20480
s_mov_b32 s28, 1572864
buffer_load_dwordx4 v124, s[12:15], s28 offen  lds
s_add_u32 m0, s36, 21504
s_mov_b32 s28, 1605632
buffer_load_dwordx4 v125, s[12:15], s28 offen  lds
s_add_u32 m0, s36, 22528
s_mov_b32 s28, 1703936
buffer_load_dwordx4 v124, s[12:15], s28 offen  lds
s_add_u32 m0, s36, 23552
s_mov_b32 s28, 1736704
buffer_load_dwordx4 v125, s[12:15], s28 offen  lds
ds_read_b64_tr_b16 a[160:161], v100 offset:4096
ds_read_b64_tr_b16 a[162:163], v102 offset:4096
ds_read_b64_tr_b16 a[164:165], v104 offset:4096
ds_read_b64_tr_b16 a[166:167], v106 offset:4096
ds_read_b64_tr_b16 a[168:169], v101 offset:4096
ds_read_b64_tr_b16 a[170:171], v103 offset:4096
ds_read_b64_tr_b16 a[172:173], v105 offset:4096
ds_read_b64_tr_b16 a[174:175], v107 offset:4096
s_waitcnt lgkmcnt(0)
s_waitcnt vmcnt(12)
s_barrier
s_add_u32 m0, s36, 24576
s_mov_b32 s28, 2097152
buffer_load_dwordx4 v124, s[12:15], s28 offen  lds
s_add_u32 m0, s36, 25600
s_mov_b32 s28, 2129920
buffer_load_dwordx4 v125, s[12:15], s28 offen  lds
s_add_u32 m0, s36, 26624
s_mov_b32 s28, 2228224
buffer_load_dwordx4 v124, s[12:15], s28 offen  lds
s_add_u32 m0, s36, 27648
s_mov_b32 s28, 2260992
buffer_load_dwordx4 v125, s[12:15], s28 offen  lds
ds_read_b64_tr_b16 a[176:177], v100 offset:8192
ds_read_b64_tr_b16 a[178:179], v102 offset:8192
ds_read_b64_tr_b16 a[180:181], v104 offset:8192
ds_read_b64_tr_b16 a[182:183], v106 offset:8192
ds_read_b64_tr_b16 a[184:185], v101 offset:8192
ds_read_b64_tr_b16 a[186:187], v103 offset:8192
ds_read_b64_tr_b16 a[188:189], v105 offset:8192
ds_read_b64_tr_b16 a[190:191], v107 offset:8192
s_waitcnt lgkmcnt(0)
s_waitcnt vmcnt(12)
s_barrier
s_add_u32 m0, s36, 28672
s_mov_b32 s28, 2621440
buffer_load_dwordx4 v124, s[12:15], s28 offen  lds
s_add_u32 m0, s36, 29696
s_mov_b32 s28, 2654208
buffer_load_dwordx4 v125, s[12:15], s28 offen  lds
s_add_u32 m0, s36, 30720
s_mov_b32 s28, 2752512
buffer_load_dwordx4 v124, s[12:15], s28 offen  lds
s_add_u32 m0, s36, 31744
s_mov_b32 s28, 2785280
buffer_load_dwordx4 v125, s[12:15], s28 offen  lds
ds_read_b64_tr_b16 a[192:193], v100 offset:12288
ds_read_b64_tr_b16 a[194:195], v102 offset:12288
ds_read_b64_tr_b16 a[196:197], v104 offset:12288
ds_read_b64_tr_b16 a[198:199], v106 offset:12288
ds_read_b64_tr_b16 a[200:201], v101 offset:12288
ds_read_b64_tr_b16 a[202:203], v103 offset:12288
ds_read_b64_tr_b16 a[204:205], v105 offset:12288
ds_read_b64_tr_b16 a[206:207], v107 offset:12288
s_waitcnt lgkmcnt(0)
s_waitcnt vmcnt(12)
s_barrier
s_add_u32 m0, s36, 32768
s_mov_b32 s28, 3145728
buffer_load_dwordx4 v124, s[12:15], s28 offen  lds
s_add_u32 m0, s36, 33792
s_mov_b32 s28, 3178496
buffer_load_dwordx4 v125, s[12:15], s28 offen  lds
s_add_u32 m0, s36, 34816
s_mov_b32 s28, 3276800
buffer_load_dwordx4 v124, s[12:15], s28 offen  lds
s_add_u32 m0, s36, 35840
s_mov_b32 s28, 3309568
buffer_load_dwordx4 v125, s[12:15], s28 offen  lds
ds_read_b64_tr_b16 a[208:209], v100 offset:16384
ds_read_b64_tr_b16 a[210:211], v102 offset:16384
ds_read_b64_tr_b16 a[212:213], v104 offset:16384
ds_read_b64_tr_b16 a[214:215], v106 offset:16384
ds_read_b64_tr_b16 a[216:217], v101 offset:16384
ds_read_b64_tr_b16 a[218:219], v103 offset:16384
ds_read_b64_tr_b16 a[220:221], v105 offset:16384
ds_read_b64_tr_b16 a[222:223], v107 offset:16384
s_waitcnt lgkmcnt(0)
s_waitcnt vmcnt(12)
s_barrier
s_add_u32 m0, s36, 0
s_mov_b32 s28, 3670016
buffer_load_dwordx4 v124, s[12:15], s28 offen  lds
s_add_u32 m0, s36, 1024
s_mov_b32 s28, 3702784
buffer_load_dwordx4 v125, s[12:15], s28 offen  lds
s_add_u32 m0, s36, 2048
s_mov_b32 s28, 3801088
buffer_load_dwordx4 v124, s[12:15], s28 offen  lds
s_add_u32 m0, s36, 3072
s_mov_b32 s28, 3833856
buffer_load_dwordx4 v125, s[12:15], s28 offen  lds
ds_read_b64_tr_b16 a[224:225], v100 offset:20480
ds_read_b64_tr_b16 a[226:227], v102 offset:20480
ds_read_b64_tr_b16 a[228:229], v104 offset:20480
ds_read_b64_tr_b16 a[230:231], v106 offset:20480
ds_read_b64_tr_b16 a[232:233], v101 offset:20480
ds_read_b64_tr_b16 a[234:235], v103 offset:20480
ds_read_b64_tr_b16 a[236:237], v105 offset:20480
ds_read_b64_tr_b16 a[238:239], v107 offset:20480
s_waitcnt lgkmcnt(0)
s_waitcnt vmcnt(12)
s_barrier
s_mov_b32 s12, s80
s_mov_b32 s13, s81
s_add_u32 m0, s36, 4096
s_mov_b32 s28, 0
buffer_load_dwordx4 v126, s[12:15], s28 offen  lds
s_add_u32 m0, s36, 5120
s_mov_b32 s28, 16384
buffer_load_dwordx4 v127, s[12:15], s28 offen  lds
s_add_u32 m0, s36, 6144
s_mov_b32 s28, 4096
buffer_load_dwordx4 v126, s[12:15], s28 offen  lds
s_add_u32 m0, s36, 7168
s_mov_b32 s28, 20480
buffer_load_dwordx4 v127, s[12:15], s28 offen  lds
ds_read_b64_tr_b16 a[240:241], v100 offset:24576
ds_read_b64_tr_b16 a[242:243], v102 offset:24576
ds_read_b64_tr_b16 a[244:245], v104 offset:24576
ds_read_b64_tr_b16 a[246:247], v106 offset:24576
ds_read_b64_tr_b16 a[248:249], v101 offset:24576
ds_read_b64_tr_b16 a[250:251], v103 offset:24576
ds_read_b64_tr_b16 a[252:253], v105 offset:24576
ds_read_b64_tr_b16 a[254:255], v107 offset:24576
s_waitcnt lgkmcnt(0)
s_waitcnt vmcnt(12)
s_barrier
v_mov_b32 v56, 164
global_load_dword v57, v56, s[6:7] sc1
s_add_u32 m0, s36, 8192
s_mov_b32 s28, 2048
buffer_load_dwordx4 v126, s[12:15], s28 offen  lds
s_add_u32 m0, s36, 9216
s_mov_b32 s28, 18432
buffer_load_dwordx4 v127, s[12:15], s28 offen  lds
s_add_u32 m0, s36, 10240
s_mov_b32 s28, 6144
buffer_load_dwordx4 v126, s[12:15], s28 offen  lds
s_add_u32 m0, s36, 11264
s_mov_b32 s28, 22528
buffer_load_dwordx4 v127, s[12:15], s28 offen  lds
ds_read_b64_tr_b16 v[144:145], v100 offset:28672
ds_read_b64_tr_b16 v[146:147], v102 offset:28672
ds_read_b64_tr_b16 v[148:149], v104 offset:28672
ds_read_b64_tr_b16 v[150:151], v106 offset:28672
ds_read_b64_tr_b16 v[152:153], v101 offset:28672
ds_read_b64_tr_b16 v[154:155], v103 offset:28672
ds_read_b64_tr_b16 v[156:157], v105 offset:28672
ds_read_b64_tr_b16 v[158:159], v107 offset:28672
s_waitcnt lgkmcnt(0)
s_waitcnt vmcnt(13)
s_barrier
s_add_u32 m0, s36, 12288
s_mov_b32 s28, 8192
buffer_load_dwordx4 v126, s[12:15], s28 offen  lds
s_add_u32 m0, s36, 13312
s_mov_b32 s28, 24576
buffer_load_dwordx4 v127, s[12:15], s28 offen  lds
s_add_u32 m0, s36, 14336
s_mov_b32 s28, 12288
buffer_load_dwordx4 v126, s[12:15], s28 offen  lds
s_add_u32 m0, s36, 15360
s_mov_b32 s28, 28672
buffer_load_dwordx4 v127, s[12:15], s28 offen  lds
ds_read_b64_tr_b16 v[160:161], v100 offset:32768
ds_read_b64_tr_b16 v[162:163], v102 offset:32768
ds_read_b64_tr_b16 v[164:165], v104 offset:32768
ds_read_b64_tr_b16 v[166:167], v106 offset:32768
ds_read_b64_tr_b16 v[168:169], v101 offset:32768
ds_read_b64_tr_b16 v[170:171], v103 offset:32768
ds_read_b64_tr_b16 v[172:173], v105 offset:32768
ds_read_b64_tr_b16 v[174:175], v107 offset:32768
s_waitcnt lgkmcnt(0)
s_waitcnt vmcnt(13)
s_barrier
s_add_u32 m0, s36, 16384
s_mov_b32 s28, 10240
buffer_load_dwordx4 v126, s[12:15], s28 offen  lds
s_add_u32 m0, s36, 17408
s_mov_b32 s28, 26624
buffer_load_dwordx4 v127, s[12:15], s28 offen  lds
s_add_u32 m0, s36, 18432
s_mov_b32 s28, 14336
buffer_load_dwordx4 v126, s[12:15], s28 offen  lds
s_add_u32 m0, s36, 19456
s_mov_b32 s28, 30720
buffer_load_dwordx4 v127, s[12:15], s28 offen  lds
ds_read_b64_tr_b16 v[176:177], v100 offset:0
ds_read_b64_tr_b16 v[178:179], v102 offset:0
ds_read_b64_tr_b16 v[180:181], v104 offset:0
ds_read_b64_tr_b16 v[182:183], v106 offset:0
ds_read_b64_tr_b16 v[184:185], v101 offset:0
ds_read_b64_tr_b16 v[186:187], v103 offset:0
ds_read_b64_tr_b16 v[188:189], v105 offset:0
ds_read_b64_tr_b16 v[190:191], v107 offset:0
s_waitcnt lgkmcnt(0)
s_waitcnt vmcnt(13)
s_barrier
s_add_u32 m0, s36, 20480
s_mov_b32 s28, 65536
buffer_load_dwordx4 v126, s[12:15], s28 offen  lds
s_add_u32 m0, s36, 21504
s_mov_b32 s28, 81920
buffer_load_dwordx4 v127, s[12:15], s28 offen  lds
s_add_u32 m0, s36, 22528
s_mov_b32 s28, 69632
buffer_load_dwordx4 v126, s[12:15], s28 offen  lds
s_add_u32 m0, s36, 23552
s_mov_b32 s28, 86016
buffer_load_dwordx4 v127, s[12:15], s28 offen  lds
ds_read_b64_tr_b16 v[84:85], v108 offset:4096
ds_read_b64_tr_b16 v[208:209], v110 offset:4096
ds_read_b64_tr_b16 v[224:225], v112 offset:4096
ds_read_b64_tr_b16 v[240:241], v114 offset:4096
ds_read_b64_tr_b16 v[92:93], v109 offset:4096
ds_read_b64_tr_b16 v[216:217], v111 offset:4096
ds_read_b64_tr_b16 v[232:233], v113 offset:4096
ds_read_b64_tr_b16 v[248:249], v115 offset:4096
s_waitcnt lgkmcnt(0)
s_waitcnt vmcnt(12)
s_barrier
s_add_u32 m0, s36, 24576
s_mov_b32 s28, 67584
buffer_load_dwordx4 v126, s[12:15], s28 offen  lds
s_add_u32 m0, s36, 25600
s_mov_b32 s28, 83968
buffer_load_dwordx4 v127, s[12:15], s28 offen  lds
s_add_u32 m0, s36, 26624
s_mov_b32 s28, 71680
buffer_load_dwordx4 v126, s[12:15], s28 offen  lds
s_add_u32 m0, s36, 27648
s_mov_b32 s28, 88064
buffer_load_dwordx4 v127, s[12:15], s28 offen  lds
ds_read_b64_tr_b16 v[86:87], v108 offset:8192
ds_read_b64_tr_b16 v[210:211], v110 offset:8192
ds_read_b64_tr_b16 v[226:227], v112 offset:8192
ds_read_b64_tr_b16 v[242:243], v114 offset:8192
ds_read_b64_tr_b16 v[94:95], v109 offset:8192
ds_read_b64_tr_b16 v[218:219], v111 offset:8192
ds_read_b64_tr_b16 v[234:235], v113 offset:8192
ds_read_b64_tr_b16 v[250:251], v115 offset:8192
s_waitcnt lgkmcnt(0)
s_waitcnt vmcnt(12)
s_barrier
s_add_u32 m0, s36, 28672
s_mov_b32 s28, 73728
buffer_load_dwordx4 v126, s[12:15], s28 offen  lds
s_add_u32 m0, s36, 29696
s_mov_b32 s28, 90112
buffer_load_dwordx4 v127, s[12:15], s28 offen  lds
s_add_u32 m0, s36, 30720
s_mov_b32 s28, 77824
buffer_load_dwordx4 v126, s[12:15], s28 offen  lds
s_add_u32 m0, s36, 31744
s_mov_b32 s28, 94208
buffer_load_dwordx4 v127, s[12:15], s28 offen  lds
ds_read_b64_tr_b16 v[88:89], v108 offset:12288
ds_read_b64_tr_b16 v[212:213], v110 offset:12288
ds_read_b64_tr_b16 v[228:229], v112 offset:12288
ds_read_b64_tr_b16 v[244:245], v114 offset:12288
ds_read_b64_tr_b16 v[96:97], v109 offset:12288
ds_read_b64_tr_b16 v[220:221], v111 offset:12288
ds_read_b64_tr_b16 v[236:237], v113 offset:12288
ds_read_b64_tr_b16 v[252:253], v115 offset:12288
s_waitcnt lgkmcnt(0)
s_waitcnt vmcnt(12)
s_barrier
s_add_u32 m0, s36, 32768
s_mov_b32 s28, 75776
buffer_load_dwordx4 v126, s[12:15], s28 offen  lds
s_add_u32 m0, s36, 33792
s_mov_b32 s28, 92160
buffer_load_dwordx4 v127, s[12:15], s28 offen  lds
s_add_u32 m0, s36, 34816
s_mov_b32 s28, 79872
buffer_load_dwordx4 v126, s[12:15], s28 offen  lds
s_add_u32 m0, s36, 35840
s_mov_b32 s28, 96256
buffer_load_dwordx4 v127, s[12:15], s28 offen  lds
ds_read_b64_tr_b16 v[90:91], v108 offset:16384
ds_read_b64_tr_b16 v[214:215], v110 offset:16384
ds_read_b64_tr_b16 v[230:231], v112 offset:16384
ds_read_b64_tr_b16 v[246:247], v114 offset:16384
ds_read_b64_tr_b16 v[98:99], v109 offset:16384
ds_read_b64_tr_b16 v[222:223], v111 offset:16384
ds_read_b64_tr_b16 v[238:239], v113 offset:16384
ds_read_b64_tr_b16 v[254:255], v115 offset:16384
s_waitcnt lgkmcnt(0)
s_waitcnt vmcnt(12)
s_barrier
s_mov_b32 s12, s74
s_mov_b32 s13, s75
s_add_u32 m0, s36, 0
s_mov_b32 s28, 0
buffer_load_dwordx4 v124, s[12:15], s28 offen  lds
s_add_u32 m0, s36, 1024
s_mov_b32 s28, 32768
buffer_load_dwordx4 v125, s[12:15], s28 offen  lds
s_add_u32 m0, s36, 2048
s_mov_b32 s28, 131072
buffer_load_dwordx4 v124, s[12:15], s28 offen  lds
s_add_u32 m0, s36, 3072
s_mov_b32 s28, 163840
buffer_load_dwordx4 v125, s[12:15], s28 offen  lds
ds_read_b64_tr_b16 v[192:193], v108 offset:20480
ds_read_b64_tr_b16 v[128:129], v110 offset:20480
ds_read_b64_tr_b16 v[20:21], v112 offset:20480
ds_read_b64_tr_b16 v[36:37], v114 offset:20480
ds_read_b64_tr_b16 v[200:201], v109 offset:20480
ds_read_b64_tr_b16 v[136:137], v111 offset:20480
ds_read_b64_tr_b16 v[28:29], v113 offset:20480
ds_read_b64_tr_b16 v[44:45], v115 offset:20480
s_waitcnt lgkmcnt(0)
s_waitcnt vmcnt(12)
s_barrier
s_add_u32 m0, s36, 4096
s_mov_b32 s28, 524288
buffer_load_dwordx4 v124, s[12:15], s28 offen  lds
s_add_u32 m0, s36, 5120
s_mov_b32 s28, 557056
buffer_load_dwordx4 v125, s[12:15], s28 offen  lds
s_add_u32 m0, s36, 6144
s_mov_b32 s28, 655360
buffer_load_dwordx4 v124, s[12:15], s28 offen  lds
s_add_u32 m0, s36, 7168
s_mov_b32 s28, 688128
buffer_load_dwordx4 v125, s[12:15], s28 offen  lds
ds_read_b64_tr_b16 v[194:195], v108 offset:24576
ds_read_b64_tr_b16 v[130:131], v110 offset:24576
ds_read_b64_tr_b16 v[22:23], v112 offset:24576
ds_read_b64_tr_b16 v[38:39], v114 offset:24576
ds_read_b64_tr_b16 v[202:203], v109 offset:24576
ds_read_b64_tr_b16 v[138:139], v111 offset:24576
ds_read_b64_tr_b16 v[30:31], v113 offset:24576
ds_read_b64_tr_b16 v[46:47], v115 offset:24576
s_waitcnt lgkmcnt(0)
s_waitcnt vmcnt(12)
s_barrier
s_add_u32 m0, s36, 8192
s_mov_b32 s28, 3145728
buffer_load_dwordx4 v124, s[12:15], s28 offen  lds
s_add_u32 m0, s36, 9216
s_mov_b32 s28, 3178496
buffer_load_dwordx4 v125, s[12:15], s28 offen  lds
s_add_u32 m0, s36, 10240
s_mov_b32 s28, 3276800
buffer_load_dwordx4 v124, s[12:15], s28 offen  lds
s_add_u32 m0, s36, 11264
s_mov_b32 s28, 3309568
buffer_load_dwordx4 v125, s[12:15], s28 offen  lds
ds_read_b64_tr_b16 v[196:197], v108 offset:28672
ds_read_b64_tr_b16 v[132:133], v110 offset:28672
ds_read_b64_tr_b16 v[24:25], v112 offset:28672
ds_read_b64_tr_b16 v[40:41], v114 offset:28672
ds_read_b64_tr_b16 v[204:205], v109 offset:28672
ds_read_b64_tr_b16 v[140:141], v111 offset:28672
ds_read_b64_tr_b16 v[32:33], v113 offset:28672
ds_read_b64_tr_b16 v[48:49], v115 offset:28672
s_waitcnt lgkmcnt(0)
s_waitcnt vmcnt(12)
s_barrier
s_mov_b32 s12, s76
s_mov_b32 s13, s77
s_add_u32 m0, s36, 12288
s_mov_b32 s28, 1572864
buffer_load_dwordx4 v124, s[12:15], s28 offen  lds
s_add_u32 m0, s36, 13312
s_mov_b32 s28, 1605632
buffer_load_dwordx4 v125, s[12:15], s28 offen  lds
s_add_u32 m0, s36, 14336
s_mov_b32 s28, 1703936
buffer_load_dwordx4 v124, s[12:15], s28 offen  lds
s_add_u32 m0, s36, 15360
s_mov_b32 s28, 1736704
buffer_load_dwordx4 v125, s[12:15], s28 offen  lds
ds_read_b64_tr_b16 v[198:199], v108 offset:32768
ds_read_b64_tr_b16 v[134:135], v110 offset:32768
ds_read_b64_tr_b16 v[26:27], v112 offset:32768
ds_read_b64_tr_b16 v[42:43], v114 offset:32768
ds_read_b64_tr_b16 v[206:207], v109 offset:32768
ds_read_b64_tr_b16 v[142:143], v111 offset:32768
ds_read_b64_tr_b16 v[34:35], v113 offset:32768
ds_read_b64_tr_b16 v[50:51], v115 offset:32768
s_waitcnt lgkmcnt(0)
s_waitcnt vmcnt(12)
s_barrier
s_add_u32 m0, s36, 16384
s_mov_b32 s28, 3670016
buffer_load_dwordx4 v124, s[12:15], s28 offen  lds
s_add_u32 m0, s36, 17408
s_mov_b32 s28, 3702784
buffer_load_dwordx4 v125, s[12:15], s28 offen  lds
s_add_u32 m0, s36, 18432
s_mov_b32 s28, 3801088
buffer_load_dwordx4 v124, s[12:15], s28 offen  lds
s_add_u32 m0, s36, 19456
s_mov_b32 s28, 3833856
buffer_load_dwordx4 v125, s[12:15], s28 offen  lds
ds_write_b128 v1, v[20:23] offset:28672
ds_write_b128 v1, v[24:27] offset:29696
ds_write_b128 v1, v[28:31] offset:30720
ds_write_b128 v1, v[32:35] offset:31744
s_waitcnt lgkmcnt(0)
ds_write_b128 v1, v[36:39] offset:32768
ds_write_b128 v1, v[40:43] offset:33792
ds_write_b128 v1, v[44:47] offset:34816
ds_write_b128 v1, v[48:51] offset:35840
s_waitcnt lgkmcnt(0)
ds_write_b128 v1, v[84:87] offset:20480
ds_write_b128 v1, v[88:91] offset:21504
ds_write_b128 v1, v[92:95] offset:22528
ds_write_b128 v1, v[96:99] offset:23552
s_waitcnt lgkmcnt(0)
ds_write_b128 v1, v[128:131] offset:24576
ds_write_b128 v1, v[132:135] offset:25600
ds_write_b128 v1, v[136:139] offset:26624
ds_write_b128 v1, v[140:143] offset:27648
s_waitcnt lgkmcnt(0)
ds_read_b64_tr_b16 v[36:37], v100 offset:0
ds_read_b64_tr_b16 v[38:39], v102 offset:0
ds_read_b64_tr_b16 v[40:41], v104 offset:0
ds_read_b64_tr_b16 v[42:43], v106 offset:0
ds_read_b64_tr_b16 v[44:45], v101 offset:0
ds_read_b64_tr_b16 v[46:47], v103 offset:0
ds_read_b64_tr_b16 v[48:49], v105 offset:0
ds_read_b64_tr_b16 v[50:51], v107 offset:0
s_waitcnt lgkmcnt(0)
s_waitcnt vmcnt(12)
s_barrier
Lc_in_6:
v_cmp_gt_u32 vcc, 64, v57
s_cbranch_vccz Lc_io_7
global_load_dword v57, v56, s[6:7] sc1
s_add_u32 s30, s30, 1
s_cmp_gt_u32 s30, 1000000
s_cbranch_scc1 Lc_abort
s_waitcnt vmcnt(0)
s_branch Lc_in_6
Lc_io_7:
s_lshl_b32 s28, s16, 13
buffer_load_dword v53, v52, s[8:11], s28 offen sc1
s_lshr_b32 s28, s37, 3
s_add_u32 s28, s28, 1048576
buffer_load_dword v54, v13, s[8:11], s28 offen sc1
buffer_load_dword v55, v76, s[8:11], 0 offen sc1
v_bfe_u32 v58, v70, 0, 5
v_lshlrev_b32 v58, 21, v58
v_bfe_u32 v59, v70, 5, 3
v_lshl_add_u32 v58, v59, 28, v58
v_add_u32 v58, 17563648, v58
buffer_load_dword v59, v58, s[8:11], 0 offen sc1
ds_write_b128 v1, v[36:39] offset:0
ds_write_b128 v1, v[40:43] offset:1024
ds_write_b128 v1, v[44:47] offset:2048
ds_write_b128 v1, v[48:51] offset:3072
ds_read_b64_tr_b16 v[20:21], v100 offset:4096
ds_read_b64_tr_b16 v[22:23], v102 offset:4096
ds_read_b64_tr_b16 v[24:25], v104 offset:4096
ds_read_b64_tr_b16 v[26:27], v106 offset:4096
ds_read_b64_tr_b16 v[28:29], v101 offset:4096
ds_read_b64_tr_b16 v[30:31], v103 offset:4096
ds_read_b64_tr_b16 v[32:33], v105 offset:4096
ds_read_b64_tr_b16 v[34:35], v107 offset:4096
s_waitcnt lgkmcnt(0)
s_waitcnt vmcnt(12)
s_barrier
ds_write_b128 v1, v[20:23] offset:4096
ds_write_b128 v1, v[24:27] offset:5120
ds_write_b128 v1, v[28:31] offset:6144
ds_write_b128 v1, v[32:35] offset:7168
ds_read_b64_tr_b16 v[36:37], v100 offset:8192
ds_read_b64_tr_b16 v[38:39], v102 offset:8192
ds_read_b64_tr_b16 v[40:41], v104 offset:8192
ds_read_b64_tr_b16 v[42:43], v106 offset:8192
ds_read_b64_tr_b16 v[44:45], v101 offset:8192
ds_read_b64_tr_b16 v[46:47], v103 offset:8192
ds_read_b64_tr_b16 v[48:49], v105 offset:8192
ds_read_b64_tr_b16 v[50:51], v107 offset:8192
s_waitcnt lgkmcnt(0)
s_waitcnt vmcnt(8)
s_barrier
v_and_b32 v16, 31, v70
v_add_u32 v16, 128, v16
global_load_ubyte v17, v16, s[6:7] sc1
buffer_load_dword v15, v78, s[8:11], 0 offen sc1
ds_write_b128 v1, v[36:39] offset:8192
ds_write_b128 v1, v[40:43] offset:9216
ds_write_b128 v1, v[44:47] offset:10240
ds_write_b128 v1, v[48:51] offset:11264
ds_read_b64_tr_b16 v[20:21], v100 offset:12288
ds_read_b64_tr_b16 v[22:23], v102 offset:12288
ds_read_b64_tr_b16 v[24:25], v104 offset:12288
ds_read_b64_tr_b16 v[26:27], v106 offset:12288
ds_read_b64_tr_b16 v[28:29], v101 offset:12288
ds_read_b64_tr_b16 v[30:31], v103 offset:12288
ds_read_b64_tr_b16 v[32:33], v105 offset:12288
ds_read_b64_tr_b16 v[34:35], v107 offset:12288
s_waitcnt lgkmcnt(0)
s_waitcnt vmcnt(6)
s_barrier
ds_write_b128 v1, v[20:23] offset:12288
ds_write_b128 v1, v[24:27] offset:13312
ds_write_b128 v1, v[28:31] offset:14336
ds_write_b128 v1, v[32:35] offset:15360
ds_read_b64_tr_b16 v[36:37], v100 offset:16384
ds_read_b64_tr_b16 v[38:39], v102 offset:16384
ds_read_b64_tr_b16 v[40:41], v104 offset:16384
ds_read_b64_tr_b16 v[42:43], v106 offset:16384
ds_read_b64_tr_b16 v[44:45], v101 offset:16384
ds_read_b64_tr_b16 v[46:47], v103 offset:16384
ds_read_b64_tr_b16 v[48:49], v105 offset:16384
ds_read_b64_tr_b16 v[50:51], v107 offset:16384
s_waitcnt lgkmcnt(0)
s_barrier
ds_write_b128 v1, v[36:39] offset:16384
ds_write_b128 v1, v[40:43] offset:17408
ds_write_b128 v1, v[44:47] offset:18432
ds_write_b128 v1, v[48:51] offset:19456
s_waitcnt lgkmcnt(0)
s_branch Lc_tx
Lc_tw:
global_load_ubyte v17, v16, s[6:7] sc1
buffer_load_dword v15, v78, s[8:11], 0 offen sc1
s_add_u32 s30, s30, 1
s_cmp_gt_u32 s30, 1000000
s_cbranch_scc1 Lc_abort
Lc_tx:
s_waitcnt vmcnt(0) lgkmcnt(0)
v_cmp_eq_u32 vcc, 0, v17
s_cbranch_vccnz Lc_tw
v_cmp_ge_u32 vcc, 1, v15
s_cbranch_vccnz Lc_tw
buffer_load_dwordx4 v[100:103], v0, s[8:11], s24 offen offset:0 sc1
buffer_load_dwordx4 v[104:107], v0, s[8:11], s24 offen offset:1024 sc1
buffer_load_dwordx4 v[108:111], v0, s[8:11], s25 offen offset:0 sc1
v_cmp_ne_u32 s[38:39], v18, v17
s_and_b32 s28, s17, 1
s_lshl_b32 s28, s28, 12
s_add_u32 m0, s28, 0
s_mov_b32 s28, 1
v_mov_b32 v18, v76
s_cmp_lg_u32 s17, 2
s_cbranch_scc1 Lc_c_8
s_min_u32 s28, s28, 63
s_mul_i32 s36, s28, 1048576
s_lshl_b32 s29, s16, 13
s_add_u32 s36, s36, s29
s_add_u32 s36, s36, 16777216
s_and_b32 s29, s16, 3
s_lshl_b32 s29, s29, 11
s_add_u32 s19, s36, s29
s_xor_b32 s20, s19, 2048
s_xor_b32 s80, s19, 4096
s_xor_b32 s81, s19, 6144
Lc_c_8:
s_cmp_lg_u32 s17, 3
s_cbranch_scc1 Lc_d_9
v_mov_b32 v13, 1
v_mov_b32 v18, v77
v_mov_b32 v4, v76
s_min_u32 s28, s28, 63
s_mul_i32 s36, s28, 1048576
s_lshl_b32 s29, s16, 13
s_add_u32 s36, s36, s29
s_add_u32 s36, s36, 17039360
s_and_b32 s29, s16, 3
s_lshl_b32 s29, s29, 11
s_add_u32 s19, s36, s29
s_xor_b32 s20, s19, 2048
s_xor_b32 s80, s19, 4096
s_xor_b32 s81, s19, 6144
Lc_d_9:
s_cmp_ge_u32 s17, 2
s_cbranch_scc1 Lc_e_10
v_and_b32 v15, 0x1fff, v3
ds_read_b32 v13, v15 offset:0
v_mov_b32 v15, s27
Lc_e_10:
v_mfma_f32_32x32x1_2b_f32 v[52:83], v123, v123, 0
ds_read_b128 v[84:87], v1 offset:0
ds_read_b128 v[88:91], v1 offset:1024
ds_read_b128 v[92:95], v1 offset:2048
ds_read_b128 v[96:99], v1 offset:3072
ds_read_b128 v[128:131], v1 offset:4096
ds_read_b128 v[132:135], v1 offset:5120
ds_read_b128 v[136:139], v1 offset:6144
ds_read_b128 v[140:143], v1 offset:7168
s_waitcnt lgkmcnt(0)
s_cmp_lg_u64 s[38:39], 0
s_cbranch_scc1 Lc_m1
Lc_m0:
s_cmp_eq_u32 s17, 1
s_cbranch_scc1 Lc_m0_r1_entry
s_cmp_eq_u32 s17, 2
s_cbranch_scc1 Lc_m0_r2_entry
s_cmp_eq_u32 s17, 3
s_cbranch_scc1 Lc_m0_r3_entry
s_branch Lc_m0_r0_entry
Lc_m0_r0_entry:
.p2align 6
s_nop 0
s_nop 0
s_nop 0
s_nop 0
s_nop 0
s_nop 0
s_nop 0
s_nop 0
s_nop 0
s_nop 0
s_nop 0
s_nop 0
s_nop 0
s_nop 0
s_nop 0
Lc_m0_r0_head:
s_waitcnt vmcnt(7)
s_barrier
ds_read_b32 v16, v4 offset:0
ds_read_b128 v[20:23], v0 offset:0
ds_read_b128 v[24:27], v0 offset:1024
ds_read_b128 v[28:31], v0 offset:2048
ds_read_b128 v[32:35], v0 offset:3072
buffer_load_dwordx4 v[112:115], v0, s[8:11], s25 offen offset:1024 sc1
s_waitcnt lgkmcnt(4)
v_cmp_eq_u32 vcc, s27, v16
Lc_m0_r0_q0:
s_waitcnt lgkmcnt(3)
v_smfmac_f32_16x16x64_bf16 v[52:55], v[20:23], v[84:91], v14
v_smfmac_f32_16x16x64_bf16 v[56:59], v[20:23], v[92:99], v14
s_waitcnt lgkmcnt(2)
s_cbranch_vccnz Lc_m0_r0_y0
Lc_m0_r0_y0r:
v_smfmac_f32_16x16x64_bf16 v[52:55], v[24:27], v[128:135], v14
ds_read_b128 v[128:131], v1 offset:8192
v_smfmac_f32_16x16x64_bf16 v[56:59], v[24:27], v[136:143], v14
s_waitcnt lgkmcnt(2)
ds_read_b128 v[132:135], v1 offset:9216
v_smfmac_f32_16x16x64_bf16 v[52:55], v[28:31], a[0:7], v14
s_barrier
ds_read_b32 v17, v4 offset:4096
v_smfmac_f32_16x16x64_bf16 v[56:59], v[28:31], a[8:15], v14
s_waitcnt lgkmcnt(3)
ds_read_b128 v[36:39], v0 offset:4096
v_smfmac_f32_16x16x64_bf16 v[52:55], v[32:35], a[16:23], v14
ds_read_b128 v[40:43], v0 offset:5120
v_smfmac_f32_16x16x64_bf16 v[56:59], v[32:35], a[24:31], v14
s_waitcnt lgkmcnt(2)
v_cmp_eq_u32 vcc, s27, v17
v_smfmac_f32_16x16x64_bf16 v[60:63], v[20:23], a[80:87], v14
ds_read_b128 v[44:47], v0 offset:6144
v_smfmac_f32_16x16x64_bf16 v[60:63], v[24:27], a[96:103], v14
s_waitcnt lgkmcnt(2)
s_cbranch_vccnz Lc_m0_r0_y1
Lc_m0_r0_y1r:
ds_read_b128 v[48:51], v0 offset:7168
ds_read_b128 v[136:139], v1 offset:10240
v_smfmac_f32_16x16x64_bf16 v[52:55], v[36:39], a[32:39], v14
s_waitcnt lgkmcnt(3)
ds_read_b128 v[140:143], v1 offset:11264
v_mov_b32 v118, v119
v_smfmac_f32_16x16x64_bf16 v[52:55], v[40:43], a[48:55], v14
s_waitcnt lgkmcnt(3)
buffer_store_dword v13, v3, s[8:11], s35 offen sc1
v_mov_b32 v118, v119
v_smfmac_f32_16x16x64_bf16 v[52:55], v[44:47], v[128:135], v14
s_waitcnt lgkmcnt(2)
ds_read_b128 v[128:131], v1 offset:12288
v_mov_b32 v118, v119
v_smfmac_f32_16x16x64_bf16 v[52:55], v[48:51], a[64:71], v14
ds_read_b128 v[132:135], v1 offset:13312
v_mov_b32 v118, v119
v_smfmac_f32_16x16x64_bf16 v[56:59], v[36:39], a[40:47], v14
buffer_store_dword v15, v3, s[8:11], s33 offen
v_mov_b32 v118, v119
v_smfmac_f32_16x16x64_bf16 v[56:59], v[40:43], a[56:63], v14
s_waitcnt lgkmcnt(2)
v_add_f32 v52, v52, v54
v_smfmac_f32_16x16x64_bf16 v[56:59], v[44:47], v[136:143], v14
ds_read_b128 v[136:139], v1 offset:16384
v_add_f32 v53, v53, v55
v_smfmac_f32_16x16x64_bf16 v[56:59], v[48:51], a[72:79], v14
ds_read_b128 v[140:143], v1 offset:17408
v_cvt_pk_bf16_f32 v54, v52, v53
v_smfmac_f32_16x16x64_bf16 v[60:63], v[28:31], a[112:119], v14
s_waitcnt lgkmcnt(2)
ds_write2_b32 v10, v54, v54 offset0:0 offset1:1
v_mov_b32 v118, v119
v_smfmac_f32_16x16x64_bf16 v[60:63], v[32:35], v[128:135], v14
ds_read_b128 v[128:131], v1 offset:14336
v_add_f32 v56, v56, v58
v_smfmac_f32_16x16x64_bf16 v[60:63], v[36:39], a[128:135], v14
v_add_f32 v57, v57, v59
v_smfmac_f32_16x16x64_bf16 v[60:63], v[40:43], a[144:151], v14
ds_read_b128 v[132:135], v1 offset:15360
v_cvt_pk_bf16_f32 v58, v56, v57
v_smfmac_f32_16x16x64_bf16 v[60:63], v[44:47], a[160:167], v14
s_waitcnt lgkmcnt(3)
ds_write2_b32 v10, v58, v58 offset0:8 offset1:9
v_mov_b32 v118, v119
v_smfmac_f32_16x16x64_bf16 v[60:63], v[48:51], v[136:143], v14
ds_read_b128 v[136:139], v1 offset:18432
v_mov_b32 v118, v119
v_smfmac_f32_16x16x64_bf16 v[64:67], v[20:23], a[88:95], v14
ds_read_b128 v[140:143], v1 offset:19456
v_mov_b32 v118, v119
v_smfmac_f32_16x16x64_bf16 v[64:67], v[24:27], a[104:111], v14
v_add_f32 v60, v60, v62
v_smfmac_f32_16x16x64_bf16 v[64:67], v[28:31], a[120:127], v14
s_waitcnt vmcnt(2) lgkmcnt(2)
s_barrier
ds_read_b64_tr_b16 v[84:85], v11 offset:8192
ds_read_b64_tr_b16 v[86:87], v11 offset:8328
v_add_f32 v61, v61, v63
v_smfmac_f32_16x16x64_bf16 v[64:67], v[32:35], v[128:135], v14
ds_read_b64_tr_b16 v[88:89], v11 offset:8736
ds_read_b64_tr_b16 v[90:91], v11 offset:8872
v_cvt_pk_bf16_f32 v62, v60, v61
v_smfmac_f32_16x16x64_bf16 v[64:67], v[36:39], a[136:143], v14
ds_read_b64_tr_b16 v[92:93], v11 offset:10496
ds_read_b64_tr_b16 v[94:95], v11 offset:10632
v_mov_b32 v52, 0
v_smfmac_f32_16x16x64_bf16 v[64:67], v[40:43], a[152:159], v14
ds_read_b64_tr_b16 v[96:97], v11 offset:11040
ds_read_b64_tr_b16 v[98:99], v11 offset:11176
v_mov_b32 v53, 0
v_smfmac_f32_16x16x64_bf16 v[64:67], v[44:47], a[168:175], v14
s_waitcnt lgkmcnt(8)
v_mov_b32 v54, 0
v_smfmac_f32_16x16x64_bf16 v[64:67], v[48:51], v[136:143], v14
s_waitcnt lgkmcnt(4)
v_mov_b32 v55, 0
v_smfmac_f32_16x16x64_bf16 v[76:79], v[100:103], v[84:91], v14
s_waitcnt lgkmcnt(0)
v_smfmac_f32_16x16x64_bf16 v[76:79], v[104:107], v[92:99], v14
v_add_f32 v64, v64, v66
v_add_f32 v65, v65, v67
v_cvt_pk_bf16_f32 v63, v64, v65
v_smfmac_f32_16x16x64_bf16 v[68:71], v[20:23], a[176:183], v14
ds_write_b64 v7, v[62:63] offset:12800
v_smfmac_f32_16x16x64_bf16 v[68:71], v[24:27], a[192:199], v14
v_add_f32 v76, v76, v78
v_add_f32 v77, v77, v79
v_smfmac_f32_16x16x64_bf16 v[68:71], v[28:31], a[208:215], v14
ds_read_b128 v[136:139], v1 offset:22528
v_exp_f32 v78, v76
v_smfmac_f32_16x16x64_bf16 v[68:71], v[32:35], a[224:231], v14
ds_read_b128 v[140:143], v1 offset:23552
v_exp_f32 v79, v77
v_smfmac_f32_16x16x64_bf16 v[68:71], v[36:39], a[240:247], v14
s_waitcnt lgkmcnt(2)
s_barrier
ds_read_b64_tr_b16 v[100:101], v9 offset:12800
v_cvt_pk_bf16_f32 v78, v78, v79
v_smfmac_f32_16x16x64_bf16 v[68:71], v[40:43], v[144:151], v14
ds_write_b32 v12, v78 offset:0
ds_read_b64_tr_b16 v[102:103], v9 offset:13312
v_smfmac_f32_16x16x64_bf16 v[68:71], v[44:47], v[160:167], v14
ds_read_b64_tr_b16 v[104:105], v9 offset:13824
v_smfmac_f32_16x16x64_bf16 v[68:71], v[48:51], v[176:183], v14
ds_read_b64_tr_b16 v[106:107], v9 offset:14336
v_smfmac_f32_16x16x64_bf16 v[72:75], v[20:23], a[184:191], v14
v_smfmac_f32_16x16x64_bf16 v[72:75], v[24:27], a[200:207], v14
s_waitcnt lgkmcnt(3)
s_barrier
ds_read_b128 v[124:127], v0 offset:0
v_smfmac_f32_16x16x64_bf16 v[72:75], v[28:31], a[216:223], v14
s_waitcnt lgkmcnt(3)
ds_read_b128 v[128:131], v1 offset:20480
v_add_f32 v68, v68, v70
v_smfmac_f32_16x16x64_bf16 v[80:83], v[100:103], v[84:91], v14
s_waitcnt lgkmcnt(2)
v_add_f32 v69, v69, v71
v_smfmac_f32_16x16x64_bf16 v[80:83], v[104:107], v[92:99], v14
v_cvt_pk_bf16_f32 v116, v68, v69
v_smfmac_f32_16x16x64_bf16 v[72:75], v[32:35], a[232:239], v14
ds_read_b128 v[132:135], v1 offset:21504
v_smfmac_f32_16x16x64_bf16 v[72:75], v[36:39], a[248:255], v14
v_mul_f32 v80, s26, v80
v_mul_f32 v81, s26, v81
v_fmac_f32 v80, s26, v82
v_smfmac_f32_16x16x64_bf16 v[72:75], v[40:43], v[152:159], v14
ds_read_b128 v[100:103], v1 offset:32768
v_fmac_f32 v81, s26, v83
v_smfmac_f32_16x16x64_bf16 v[72:75], v[44:47], v[168:175], v14
s_waitcnt lgkmcnt(3)
ds_read_b128 v[104:107], v1 offset:33792
v_exp_f32 v82, v80
v_mfma_f32_16x16x32_bf16 v[60:63], v[124:127], v[118:121], 0
v_exp_f32 v83, v81
v_smfmac_f32_16x16x64_bf16 v[72:75], v[48:51], v[184:191], v14
v_cvt_pk_bf16_f32 v122, v82, v83
v_smfmac_f32_16x16x64_bf16 v[52:55], v[124:127], v[108:115], v14
s_nop 0
v_mfma_f32_16x16x16_bf16 v[60:63], v[122:123], v[118:119], v[60:63]
v_add_f32 v72, v72, v74
v_add_f32 v73, v73, v75
v_cvt_pk_bf16_f32 v117, v72, v73
s_nop 1
v_smfmac_f32_16x16x32_bf16 v[52:55], v[122:123], v[116:119], v14
v_rcp_f32 v62, v60
v_rcp_f32 v63, v61
v_maximum3_f32 v16, v60, v61, v62
s_nop 1
v_mul_f32 v52, v52, v62
v_mul_f32 v53, v53, v63
v_mul_f32 v54, v54, v62
v_mul_f32 v55, v55, v63
v_cvt_pk_bf16_f32 v52, v52, v53
v_cvt_pk_bf16_f32 v53, v54, v55
ds_write2_b32 v6, v52, v53 offset0:0 offset1:64
v_maximum3_f32 v16, v16, v63, v63
v_cmp_nge_f32 vcc, s31, v16
s_cbranch_vccnz Lc_m0_r0_sl
Lc_m0_r0_slr:
v_mfma_f32_16x16x1_4b_f32 v[20:35], v123, v123, 0
s_waitcnt lgkmcnt(0)
s_barrier
ds_read_b64_tr_b16 v[84:85], v8 offset:8192
ds_read_b64_tr_b16 v[86:87], v8 offset:8448
ds_read_b64_tr_b16 v[88:89], v8 offset:8704
ds_read_b64_tr_b16 v[90:91], v8 offset:8960
ds_read_b64_tr_b16 v[92:93], v8 offset:9216
ds_read_b64_tr_b16 v[94:95], v8 offset:9472
ds_read_b64_tr_b16 v[96:97], v8 offset:9728
ds_read_b64_tr_b16 v[98:99], v8 offset:9984
s_waitcnt lgkmcnt(6)
v_smfmac_f32_16x16x64_bf16 v[20:23], v[84:87], v[128:135], v14 abid:1
s_waitcnt lgkmcnt(4)
ds_read_b128 v[36:39], v1 offset:24576
v_smfmac_f32_16x16x64_bf16 v[20:23], v[88:91], v[136:143], v14 abid:1
s_waitcnt lgkmcnt(3)
ds_read_b128 v[40:43], v1 offset:25600
v_smfmac_f32_16x16x64_bf16 v[20:23], v[92:95], v[192:199], v14 abid:1
s_waitcnt lgkmcnt(2)
ds_read_b128 v[44:47], v1 offset:26624
ds_read_b128 v[48:51], v1 offset:27648
v_smfmac_f32_16x16x64_bf16 v[20:23], v[96:99], v[200:207], v14 abid:1
v_smfmac_f32_16x16x64_bf16 v[24:27], v[84:87], v[208:215], v14 abid:1
ds_read_b128 v[128:131], v1 offset:28672
v_smfmac_f32_16x16x64_bf16 v[24:27], v[88:91], v[216:223], v14 abid:1
s_waitcnt lgkmcnt(3)
ds_read_b128 v[132:135], v1 offset:29696
v_cvt_pk_bf16_f32 v52, v20, v21
v_cvt_pk_bf16_f32 v53, v22, v23
v_smfmac_f32_16x16x64_bf16 v[24:27], v[92:95], v[36:43], v14 abid:1
s_waitcnt lgkmcnt(2)
ds_read_b128 v[136:139], v1 offset:30720
v_and_or_b32 v52, v52, -2, s32
v_smfmac_f32_16x16x64_bf16 v[24:27], v[96:99], v[44:51], v14 abid:1
ds_read_b128 v[140:143], v1 offset:31744
buffer_store_dwordx2 v[52:53], v2, s[8:11], s48 offen
v_smfmac_f32_16x16x64_bf16 v[28:31], v[84:87], v[224:231], v14 abid:1
v_smfmac_f32_16x16x64_bf16 v[28:31], v[88:91], v[232:239], v14 abid:1
s_waitcnt lgkmcnt(2)
ds_read_b128 v[36:39], v1 offset:34816
v_cvt_pk_bf16_f32 v54, v24, v25
v_cvt_pk_bf16_f32 v55, v26, v27
v_smfmac_f32_16x16x64_bf16 v[28:31], v[92:95], v[128:135], v14 abid:1
s_waitcnt lgkmcnt(1)
ds_read_b128 v[40:43], v1 offset:35840
v_and_or_b32 v54, v54, -2, s32
v_smfmac_f32_16x16x64_bf16 v[28:31], v[96:99], v[136:143], v14 abid:1
buffer_store_dwordx2 v[54:55], v2, s[8:11], s49 offen
v_smfmac_f32_16x16x64_bf16 v[32:35], v[84:87], v[240:247], v14 abid:1
v_smfmac_f32_16x16x64_bf16 v[32:35], v[88:91], v[248:255], v14 abid:1
v_cvt_pk_bf16_f32 v56, v28, v29
v_cvt_pk_bf16_f32 v57, v30, v31
v_smfmac_f32_16x16x64_bf16 v[32:35], v[92:95], v[100:107], v14 abid:1
s_waitcnt lgkmcnt(0)
ds_read_b128 v[68:71], v0 offset:14848
v_and_or_b32 v56, v56, -2, s32
v_smfmac_f32_16x16x64_bf16 v[32:35], v[96:99], v[36:43], v14 abid:1
buffer_store_dwordx2 v[56:57], v2, s[8:11], s50 offen
s_nop 5
s_nop 0
v_cvt_pk_bf16_f32 v58, v32, v33
v_cvt_pk_bf16_f32 v59, v34, v35
v_and_or_b32 v58, v58, -2, s32
buffer_store_dwordx2 v[58:59], v2, s[8:11], s51 offen
s_waitcnt lgkmcnt(0)
s_barrier
buffer_load_dwordx4 v[20:23], v0, s[8:11], s21 offen offset:0 sc1
buffer_load_dwordx4 v[24:27], v0, s[8:11], s21 offen offset:1024 sc1
buffer_load_dwordx4 v[28:31], v0, s[8:11], s21 offen offset:2048 sc1
buffer_load_dwordx4 v[32:35], v0, s[8:11], s21 offen offset:3072 sc1
ds_read_b128 v[84:87], v1 offset:0
ds_read_b128 v[88:91], v1 offset:1024
ds_read_b128 v[92:95], v1 offset:2048
ds_read_b128 v[96:99], v1 offset:3072
ds_read_b128 v[128:131], v1 offset:4096
ds_read_b128 v[132:135], v1 offset:5120
ds_read_b128 v[136:139], v1 offset:6144
ds_read_b128 v[140:143], v1 offset:7168
s_waitcnt vmcnt(3)
v_mfma_f32_16x16x32_bf16 v[72:75], v[68:71], v[20:23], 0
v_bitop3_b32 v16, v20, v22, s32 bitop3:0x7e
s_waitcnt vmcnt(2)
v_mfma_f32_16x16x32_bf16 v[72:75], v[68:71], v[24:27], v[72:75]
v_bitop3_b32 v17, v24, v26, s32 bitop3:0x7e
v_or_b32 v16, v16, v17
s_waitcnt vmcnt(1)
v_mfma_f32_16x16x32_bf16 v[72:75], v[68:71], v[28:31], v[72:75]
v_bitop3_b32 v17, v28, v30, s32 bitop3:0x7e
v_or_b32 v16, v16, v17
s_waitcnt vmcnt(0)
v_mfma_f32_16x16x32_bf16 v[72:75], v[68:71], v[32:35], v[72:75]
v_bitop3_b32 v17, v32, v34, s32 bitop3:0x7e
v_bitop3_b32 v16, v16, v17, 1 bitop3:0xa8
v_cmp_ne_u32 vcc, 0, v16
s_nop 3
v_add_f32_dpp v74, v72, v72 row_ror:8 row_mask:0xf bank_mask:0xf
v_add_f32_dpp v75, v73, v73 row_ror:8 row_mask:0xf bank_mask:0xf
v_cvt_pk_bf16_f32 v13, v74, v75
s_cbranch_vccnz Lc_m0_r0_r1
buffer_store_dword v13, v3, s[8:11], s23 offen
Lc_m0_r0_pu3:
v_mfma_f32_32x32x1_2b_f32 v[52:83], v123, v123, 0
s_add_u32 s18, s18, 1
s_bfe_u32 s32, s18, 0x10001
s_xor_b32 s48, s48, 0x40000
s_xor_b32 s49, s49, 0x40000
s_xor_b32 s50, s50, 0x40000
s_xor_b32 s51, s51, 0x40000
s_xor_b32 s21, s21, 0x40000
s_add_u32 s35, s35, 8192
s_add_u32 s24, s24, 1048576
s_add_u32 s25, s25, 1048576
s_cmp_eq_u32 s18, s40
s_cbranch_scc0 Lc_m0_r0_more
buffer_store_dword v13, v3, s[8:11], s35 offen sc1
s_branch Lc_m0_r0_exit
Lc_m0_r0_more:
s_add_u32 s22, s23, 0
s_add_u32 s23, s23, 0x2000
s_and_b32 s23, s23, 1081343
s_xor_b32 s33, s23, 0x4000
s_nop 15
s_nop 15
s_nop 0
buffer_load_dwordx4 v0, s[8:11], s22 offen offset:0 sc1 lds
buffer_load_dwordx4 v0, s[8:11], s22 offen offset:1024 sc1 lds
buffer_load_dwordx4 v0, s[8:11], s22 offen offset:2048 sc1 lds
buffer_load_dwordx4 v0, s[8:11], s22 offen offset:3072 sc1 lds
s_barrier
buffer_load_dwordx4 v[100:103], v0, s[8:11], s24 offen offset:0 sc1
buffer_load_dwordx4 v[104:107], v0, s[8:11], s24 offen offset:1024 sc1
buffer_load_dwordx4 v[108:111], v0, s[8:11], s25 offen offset:0 sc1
s_nop 3
buffer_load_dwordx4 v0, s[8:11], s22 offen offset:0 sc1 lds
buffer_load_dwordx4 v0, s[8:11], s22 offen offset:1024 sc1 lds
buffer_load_dwordx4 v0, s[8:11], s22 offen offset:2048 sc1 lds
buffer_load_dwordx4 v0, s[8:11], s22 offen offset:3072 sc1 lds
s_waitcnt lgkmcnt(0)
s_branch Lc_m0_r0_head
Lc_m0_r0_y0:
s_cmp_eq_u32 s18, s34
s_cbranch_scc1 Lc_m0_r0_y0r
Lc_m0_r0_y0l:
ds_read_b32 v16, v4 offset:0
ds_read_b128 v[20:23], v0 offset:0
ds_read_b128 v[24:27], v0 offset:1024
ds_read_b128 v[28:31], v0 offset:2048
ds_read_b128 v[32:35], v0 offset:3072
buffer_load_dwordx4 v0, s[8:11], s22 offen offset:0 sc1 lds
buffer_load_dwordx4 v0, s[8:11], s22 offen offset:1024 sc1 lds
buffer_load_dwordx4 v0, s[8:11], s22 offen offset:2048 sc1 lds
buffer_load_dwordx4 v0, s[8:11], s22 offen offset:3072 sc1 lds
s_waitcnt vmcnt(16)
s_add_u32 s46, s46, 1
s_waitcnt lgkmcnt(4)
v_cmp_eq_u32 vcc, s27, v16
s_cbranch_vccz Lc_m0_r0_y0k
ds_read_b32 v16, v4 offset:0
ds_read_b128 v[20:23], v0 offset:0
ds_read_b128 v[24:27], v0 offset:1024
ds_read_b128 v[28:31], v0 offset:2048
ds_read_b128 v[32:35], v0 offset:3072
s_add_u32 s46, s46, 1
s_waitcnt lgkmcnt(4)
v_cmp_eq_u32 vcc, s27, v16
s_cbranch_vccz Lc_m0_r0_y0k
s_add_u32 s30, s30, 1
s_cmp_gt_u32 s30, 1000000
s_cbranch_scc1 Lc_m0_abort
s_branch Lc_m0_r0_y0l
Lc_m0_r0_y0k:
v_mov_b32 v52, 0
v_mov_b32 v53, 0
v_mov_b32 v54, 0
v_mov_b32 v55, 0
v_mov_b32 v56, 0
v_mov_b32 v57, 0
v_mov_b32 v58, 0
v_mov_b32 v59, 0
s_waitcnt lgkmcnt(3)
v_smfmac_f32_16x16x64_bf16 v[52:55], v[20:23], v[84:91], v14
v_smfmac_f32_16x16x64_bf16 v[56:59], v[20:23], v[92:99], v14
s_waitcnt lgkmcnt(0)
s_branch Lc_m0_r0_y0r
Lc_m0_r0_y1:
s_cmp_eq_u32 s18, s34
s_cbranch_scc1 Lc_m0_r0_y1r
Lc_m0_r0_y1l:
ds_read_b32 v17, v4 offset:4096
ds_read_b128 v[36:39], v0 offset:4096
ds_read_b128 v[40:43], v0 offset:5120
ds_read_b128 v[44:47], v0 offset:6144
ds_read_b128 v[48:51], v0 offset:7168
s_add_u32 s47, s47, 1
s_waitcnt lgkmcnt(4)
v_cmp_eq_u32 vcc, s27, v17
s_cbranch_vccz Lc_m0_r0_y1k
ds_read_b32 v17, v4 offset:4096
ds_read_b128 v[36:39], v0 offset:4096
ds_read_b128 v[40:43], v0 offset:5120
ds_read_b128 v[44:47], v0 offset:6144
ds_read_b128 v[48:51], v0 offset:7168
s_add_u32 s47, s47, 1
s_waitcnt lgkmcnt(4)
v_cmp_eq_u32 vcc, s27, v17
s_cbranch_vccz Lc_m0_r0_y1k
s_add_u32 s30, s30, 1
s_cmp_gt_u32 s30, 1000000
s_cbranch_scc1 Lc_m0_abort
s_branch Lc_m0_r0_y1l
Lc_m0_r0_y1k:
s_waitcnt lgkmcnt(0)
s_branch Lc_m0_r0_y1r
Lc_m0_r0_r1:
buffer_load_dwordx4 v[20:23], v0, s[8:11], s21 offen offset:0 sc1
buffer_load_dwordx4 v[24:27], v0, s[8:11], s21 offen offset:1024 sc1
buffer_load_dwordx4 v[28:31], v0, s[8:11], s21 offen offset:2048 sc1
buffer_load_dwordx4 v[32:35], v0, s[8:11], s21 offen offset:3072 sc1
s_nop 15
s_nop 11
Lc_m0_r0_r2:
buffer_load_dwordx4 v[36:39], v0, s[8:11], s21 offen offset:0 sc1
buffer_load_dwordx4 v[40:43], v0, s[8:11], s21 offen offset:1024 sc1
buffer_load_dwordx4 v[44:47], v0, s[8:11], s21 offen offset:2048 sc1
buffer_load_dwordx4 v[48:51], v0, s[8:11], s21 offen offset:3072 sc1
s_add_u32 s45, s45, 1
s_waitcnt vmcnt(7)
v_mfma_f32_16x16x32_bf16 v[72:75], v[68:71], v[20:23], 0
v_bitop3_b32 v16, v20, v22, s32 bitop3:0x7e
s_waitcnt vmcnt(6)
v_mfma_f32_16x16x32_bf16 v[72:75], v[68:71], v[24:27], v[72:75]
v_bitop3_b32 v17, v24, v26, s32 bitop3:0x7e
v_or_b32 v16, v16, v17
s_waitcnt vmcnt(5)
v_mfma_f32_16x16x32_bf16 v[72:75], v[68:71], v[28:31], v[72:75]
v_bitop3_b32 v17, v28, v30, s32 bitop3:0x7e
v_or_b32 v16, v16, v17
s_waitcnt vmcnt(4)
v_mfma_f32_16x16x32_bf16 v[72:75], v[68:71], v[32:35], v[72:75]
v_bitop3_b32 v17, v32, v34, s32 bitop3:0x7e
v_bitop3_b32 v16, v16, v17, 1 bitop3:0xa8
v_cmp_ne_u32 vcc, 0, v16
s_nop 3
v_add_f32_dpp v74, v72, v72 row_ror:8 row_mask:0xf bank_mask:0xf
v_add_f32_dpp v75, v73, v73 row_ror:8 row_mask:0xf bank_mask:0xf
v_cvt_pk_bf16_f32 v13, v74, v75
s_cbranch_vccz Lc_m0_r0_pu2
Lc_m0_r0_r3:
buffer_load_dwordx4 v[20:23], v0, s[8:11], s21 offen offset:0 sc1
buffer_load_dwordx4 v[24:27], v0, s[8:11], s21 offen offset:1024 sc1
buffer_load_dwordx4 v[28:31], v0, s[8:11], s21 offen offset:2048 sc1
buffer_load_dwordx4 v[32:35], v0, s[8:11], s21 offen offset:3072 sc1
s_add_u32 s45, s45, 1
s_waitcnt vmcnt(7)
v_mfma_f32_16x16x32_bf16 v[72:75], v[68:71], v[36:39], 0
v_bitop3_b32 v16, v36, v38, s32 bitop3:0x7e
s_waitcnt vmcnt(6)
v_mfma_f32_16x16x32_bf16 v[72:75], v[68:71], v[40:43], v[72:75]
v_bitop3_b32 v17, v40, v42, s32 bitop3:0x7e
v_or_b32 v16, v16, v17
s_waitcnt vmcnt(5)
v_mfma_f32_16x16x32_bf16 v[72:75], v[68:71], v[44:47], v[72:75]
v_bitop3_b32 v17, v44, v46, s32 bitop3:0x7e
v_or_b32 v16, v16, v17
s_waitcnt vmcnt(4)
v_mfma_f32_16x16x32_bf16 v[72:75], v[68:71], v[48:51], v[72:75]
v_bitop3_b32 v17, v48, v50, s32 bitop3:0x7e
v_bitop3_b32 v16, v16, v17, 1 bitop3:0xa8
v_cmp_ne_u32 vcc, 0, v16
s_nop 3
v_add_f32_dpp v74, v72, v72 row_ror:8 row_mask:0xf bank_mask:0xf
v_add_f32_dpp v75, v73, v73 row_ror:8 row_mask:0xf bank_mask:0xf
v_cvt_pk_bf16_f32 v13, v74, v75
s_cbranch_vccz Lc_m0_r0_pu2
s_add_u32 s30, s30, 1
s_cmp_gt_u32 s30, 1000000
s_cbranch_scc1 Lc_m0_abort
s_branch Lc_m0_r0_r2
Lc_m0_r0_pu2:
buffer_store_dword v13, v3, s[8:11], s23 offen
s_branch Lc_m0_r0_pu3
Lc_m0_r0_sl:
v_max3_f32 v16, v76, v77, v80
v_max_f32 v16, v16, v81
v_lshrrev_b32 v61, 2, v0
ds_write_b32 v61, v16 offset:1024
v_and_b32 v61, 63, v61
v_add_u32 v61, 1024, v61
s_mov_b64 s[38:39], 0
v_cmp_eq_u32 vcc, s27, v20
s_or_b64 s[38:39], s[38:39], vcc
v_cmp_eq_u32 vcc, s27, v21
s_or_b64 s[38:39], s[38:39], vcc
v_cmp_eq_u32 vcc, s27, v22
s_or_b64 s[38:39], s[38:39], vcc
v_cmp_eq_u32 vcc, s27, v23
s_or_b64 s[38:39], s[38:39], vcc
v_cmp_eq_u32 vcc, s27, v24
s_or_b64 s[38:39], s[38:39], vcc
v_cmp_eq_u32 vcc, s27, v25
s_or_b64 s[38:39], s[38:39], vcc
v_cmp_eq_u32 vcc, s27, v26
s_or_b64 s[38:39], s[38:39], vcc
v_cmp_eq_u32 vcc, s27, v27
s_or_b64 s[38:39], s[38:39], vcc
v_cmp_eq_u32 vcc, s27, v28
s_or_b64 s[38:39], s[38:39], vcc
v_cmp_eq_u32 vcc, s27, v29
s_or_b64 s[38:39], s[38:39], vcc
v_cmp_eq_u32 vcc, s27, v30
s_or_b64 s[38:39], s[38:39], vcc
v_cmp_eq_u32 vcc, s27, v31
s_or_b64 s[38:39], s[38:39], vcc
v_cmp_eq_u32 vcc, s27, v32
s_or_b64 s[38:39], s[38:39], vcc
v_cmp_eq_u32 vcc, s27, v33
s_or_b64 s[38:39], s[38:39], vcc
v_cmp_eq_u32 vcc, s27, v34
s_or_b64 s[38:39], s[38:39], vcc
v_cmp_eq_u32 vcc, s27, v35
s_or_b64 s[38:39], s[38:39], vcc
v_cmp_eq_u32 vcc, s27, v36
s_or_b64 s[38:39], s[38:39], vcc
v_cmp_eq_u32 vcc, s27, v37
s_or_b64 s[38:39], s[38:39], vcc
v_cmp_eq_u32 vcc, s27, v38
s_or_b64 s[38:39], s[38:39], vcc
v_cmp_eq_u32 vcc, s27, v39
s_or_b64 s[38:39], s[38:39], vcc
v_cmp_eq_u32 vcc, s27, v40
s_or_b64 s[38:39], s[38:39], vcc
v_cmp_eq_u32 vcc, s27, v41
s_or_b64 s[38:39], s[38:39], vcc
v_cmp_eq_u32 vcc, s27, v42
s_or_b64 s[38:39], s[38:39], vcc
v_cmp_eq_u32 vcc, s27, v43
s_or_b64 s[38:39], s[38:39], vcc
v_cmp_eq_u32 vcc, s27, v44
s_or_b64 s[38:39], s[38:39], vcc
v_cmp_eq_u32 vcc, s27, v45
s_or_b64 s[38:39], s[38:39], vcc
v_cmp_eq_u32 vcc, s27, v46
s_or_b64 s[38:39], s[38:39], vcc
v_cmp_eq_u32 vcc, s27, v47
s_or_b64 s[38:39], s[38:39], vcc
v_cmp_eq_u32 vcc, s27, v48
s_or_b64 s[38:39], s[38:39], vcc
v_cmp_eq_u32 vcc, s27, v49
s_or_b64 s[38:39], s[38:39], vcc
v_cmp_eq_u32 vcc, s27, v50
s_or_b64 s[38:39], s[38:39], vcc
v_cmp_eq_u32 vcc, s27, v51
s_or_b64 s[38:39], s[38:39], vcc
s_cselect_b32 s36, 1, 0
v_mov_b32 v60, s36
ds_write_b32 v123, v60 offset:2048
s_waitcnt lgkmcnt(0)
s_barrier
ds_read_b128 v[84:87], v123 offset:2048
s_waitcnt lgkmcnt(0)
v_or3_b32 v84, v84, v85, v86
v_or_b32 v84, v84, v87
v_cmp_ne_u32 vcc, 0, v84
s_cbranch_vccnz Lc_m0_r0_x
ds_read2_b32 v[84:85], v61 offset0:0 offset1:16
ds_read2_b32 v[86:87], v61 offset0:32 offset1:48
ds_read2_b32 v[88:89], v61 offset0:64 offset1:80
ds_read2_b32 v[90:91], v61 offset0:96 offset1:112
ds_read2_b32 v[92:93], v61 offset0:128 offset1:144
ds_read2_b32 v[94:95], v61 offset0:160 offset1:176
ds_read2_b32 v[96:97], v61 offset0:192 offset1:208
ds_read2_b32 v[98:99], v61 offset0:224 offset1:240
s_waitcnt lgkmcnt(0)
v_max3_f32 v16, v16, v84, v85
v_max3_f32 v16, v16, v86, v87
v_max3_f32 v16, v16, v88, v89
v_max3_f32 v16, v16, v90, v91
v_max3_f32 v16, v16, v92, v93
v_max3_f32 v16, v16, v94, v95
v_max3_f32 v16, v16, v96, v97
v_max3_f32 v16, v16, v98, v99
v_sub_f32 v78, v76, v16
v_sub_f32 v79, v77, v16
v_exp_f32 v78, v78
v_exp_f32 v79, v79
v_sub_f32 v82, v80, v16
v_sub_f32 v83, v81, v16
v_exp_f32 v82, v82
v_exp_f32 v83, v83
v_cvt_pk_bf16_f32 v78, v78, v79
ds_write_b32 v12, v78 offset:0
v_cvt_pk_bf16_f32 v122, v82, v83
v_mov_b32 v52, 0
v_mov_b32 v53, 0
v_mov_b32 v54, 0
v_mov_b32 v55, 0
s_waitcnt lgkmcnt(0)
s_barrier
ds_read_b128 v[124:127], v0 offset:0
s_waitcnt lgkmcnt(0)
v_mfma_f32_16x16x32_bf16 v[60:63], v[124:127], v[118:121], 0
v_smfmac_f32_16x16x64_bf16 v[52:55], v[124:127], v[108:115], v14
v_mfma_f32_16x16x16_bf16 v[60:63], v[122:123], v[118:119], v[60:63]
v_smfmac_f32_16x16x32_bf16 v[52:55], v[122:123], v[116:119], v14
s_nop 2
s_nop 0
v_rcp_f32 v62, v60
v_rcp_f32 v63, v61
v_maximum3_f32 v16, v60, v61, v62
v_mul_f32 v52, v52, v62
v_mul_f32 v53, v53, v63
v_mul_f32 v54, v54, v62
v_mul_f32 v55, v55, v63
v_cvt_pk_bf16_f32 v52, v52, v53
v_cvt_pk_bf16_f32 v53, v54, v55
ds_write2_b32 v6, v52, v53 offset0:0 offset1:64
s_branch Lc_m0_r0_slr
Lc_m0_r0_x:
s_add_u32 s44, s44, 1
s_add_u32 s30, s30, 1
s_cmp_gt_u32 s30, 1000000
s_cbranch_scc1 Lc_m0_abort
s_waitcnt vmcnt(0) lgkmcnt(0)
s_barrier
buffer_load_dwordx4 v0, s[8:11], s22 offen offset:0 sc1 lds
buffer_load_dwordx4 v0, s[8:11], s22 offen offset:1024 sc1 lds
buffer_load_dwordx4 v0, s[8:11], s22 offen offset:2048 sc1 lds
buffer_load_dwordx4 v0, s[8:11], s22 offen offset:3072 sc1 lds
buffer_load_dwordx4 v[100:103], v0, s[8:11], s24 offen offset:0 sc1
buffer_load_dwordx4 v[104:107], v0, s[8:11], s24 offen offset:1024 sc1
buffer_load_dwordx4 v[108:111], v0, s[8:11], s25 offen offset:0 sc1
v_mfma_f32_32x32x1_2b_f32 v[52:83], v123, v123, 0
ds_read_b128 v[84:87], v1 offset:0
ds_read_b128 v[88:91], v1 offset:1024
ds_read_b128 v[92:95], v1 offset:2048
ds_read_b128 v[96:99], v1 offset:3072
ds_read_b128 v[128:131], v1 offset:4096
ds_read_b128 v[132:135], v1 offset:5120
ds_read_b128 v[136:139], v1 offset:6144
ds_read_b128 v[140:143], v1 offset:7168
s_waitcnt vmcnt(0) lgkmcnt(0)
s_branch Lc_m0_r0_head
Lc_m0_r0_exit:
s_branch Lc_m0_done
Lc_m0_r1_entry:
.p2align 6
s_nop 0
s_nop 0
s_nop 0
s_nop 0
s_nop 0
s_nop 0
s_nop 0
s_nop 0
s_nop 0
s_nop 0
s_nop 0
s_nop 0
s_nop 0
s_nop 0
s_nop 0
Lc_m0_r1_head:
s_waitcnt vmcnt(8)
s_barrier
ds_read_b32 v16, v4 offset:0
ds_read_b128 v[20:23], v0 offset:0
ds_read_b128 v[24:27], v0 offset:1024
ds_read_b128 v[28:31], v0 offset:2048
ds_read_b128 v[32:35], v0 offset:3072
buffer_load_dwordx4 v[112:115], v0, s[8:11], s25 offen offset:1024 sc1
s_waitcnt lgkmcnt(4)
v_cmp_eq_u32 vcc, s27, v16
Lc_m0_r1_q0:
s_waitcnt lgkmcnt(3)
v_smfmac_f32_16x16x64_bf16 v[52:55], v[20:23], v[84:91], v14
v_smfmac_f32_16x16x64_bf16 v[56:59], v[20:23], v[92:99], v14
s_waitcnt lgkmcnt(2)
s_cbranch_vccnz Lc_m0_r1_y0
Lc_m0_r1_y0r:
v_smfmac_f32_16x16x64_bf16 v[52:55], v[24:27], v[128:135], v14
ds_read_b128 v[128:131], v1 offset:8192
v_smfmac_f32_16x16x64_bf16 v[56:59], v[24:27], v[136:143], v14
s_waitcnt lgkmcnt(2)
ds_read_b128 v[132:135], v1 offset:9216
v_smfmac_f32_16x16x64_bf16 v[52:55], v[28:31], a[0:7], v14
s_waitcnt vmcnt(4)
s_barrier
ds_read_b32 v17, v4 offset:4096
v_smfmac_f32_16x16x64_bf16 v[56:59], v[28:31], a[8:15], v14
s_waitcnt lgkmcnt(3)
ds_read_b128 v[36:39], v0 offset:4096
v_smfmac_f32_16x16x64_bf16 v[52:55], v[32:35], a[16:23], v14
ds_read_b128 v[40:43], v0 offset:5120
v_smfmac_f32_16x16x64_bf16 v[56:59], v[32:35], a[24:31], v14
s_waitcnt lgkmcnt(2)
v_cmp_eq_u32 vcc, s27, v17
v_smfmac_f32_16x16x64_bf16 v[60:63], v[20:23], a[80:87], v14
ds_read_b128 v[44:47], v0 offset:6144
v_smfmac_f32_16x16x64_bf16 v[60:63], v[24:27], a[96:103], v14
s_waitcnt lgkmcnt(2)
s_cbranch_vccnz Lc_m0_r1_y1
Lc_m0_r1_y1r:
ds_read_b128 v[48:51], v0 offset:7168
ds_read_b128 v[136:139], v1 offset:10240
v_smfmac_f32_16x16x64_bf16 v[52:55], v[36:39], a[32:39], v14
s_waitcnt lgkmcnt(3)
ds_read_b128 v[140:143], v1 offset:11264
v_mov_b32 v118, v119
v_smfmac_f32_16x16x64_bf16 v[52:55], v[40:43], a[48:55], v14
s_waitcnt lgkmcnt(3)
buffer_store_dword v13, v3, s[8:11], s35 offen sc1
v_mov_b32 v118, v119
v_smfmac_f32_16x16x64_bf16 v[52:55], v[44:47], v[128:135], v14
s_waitcnt lgkmcnt(2)
ds_read_b128 v[128:131], v1 offset:12288
v_mov_b32 v118, v119
v_smfmac_f32_16x16x64_bf16 v[52:55], v[48:51], a[64:71], v14
ds_read_b128 v[132:135], v1 offset:13312
v_mov_b32 v118, v119
v_smfmac_f32_16x16x64_bf16 v[56:59], v[36:39], a[40:47], v14
buffer_store_dword v15, v3, s[8:11], s33 offen
v_mov_b32 v118, v119
v_smfmac_f32_16x16x64_bf16 v[56:59], v[40:43], a[56:63], v14
s_waitcnt lgkmcnt(2)
v_add_f32 v52, v52, v54
v_smfmac_f32_16x16x64_bf16 v[56:59], v[44:47], v[136:143], v14
ds_read_b128 v[136:139], v1 offset:16384
v_add_f32 v53, v53, v55
v_smfmac_f32_16x16x64_bf16 v[56:59], v[48:51], a[72:79], v14
ds_read_b128 v[140:143], v1 offset:17408
v_cvt_pk_bf16_f32 v54, v52, v53
v_smfmac_f32_16x16x64_bf16 v[60:63], v[28:31], a[112:119], v14
s_waitcnt lgkmcnt(2)
ds_write2_b32 v10, v54, v54 offset0:0 offset1:1
v_mov_b32 v118, v119
v_smfmac_f32_16x16x64_bf16 v[60:63], v[32:35], v[128:135], v14
ds_read_b128 v[128:131], v1 offset:14336
v_add_f32 v56, v56, v58
v_smfmac_f32_16x16x64_bf16 v[60:63], v[36:39], a[128:135], v14
v_add_f32 v57, v57, v59
v_smfmac_f32_16x16x64_bf16 v[60:63], v[40:43], a[144:151], v14
ds_read_b128 v[132:135], v1 offset:15360
v_cvt_pk_bf16_f32 v58, v56, v57
v_smfmac_f32_16x16x64_bf16 v[60:63], v[44:47], a[160:167], v14
s_waitcnt lgkmcnt(3)
ds_write2_b32 v10, v58, v58 offset0:8 offset1:9
v_mov_b32 v118, v119
v_smfmac_f32_16x16x64_bf16 v[60:63], v[48:51], v[136:143], v14
ds_read_b128 v[136:139], v1 offset:18432
v_mov_b32 v118, v119
v_smfmac_f32_16x16x64_bf16 v[64:67], v[20:23], a[88:95], v14
ds_read_b128 v[140:143], v1 offset:19456
v_mov_b32 v118, v119
v_smfmac_f32_16x16x64_bf16 v[64:67], v[24:27], a[104:111], v14
v_add_f32 v60, v60, v62
v_smfmac_f32_16x16x64_bf16 v[64:67], v[28:31], a[120:127], v14
s_waitcnt vmcnt(2) lgkmcnt(2)
s_barrier
ds_read_b64_tr_b16 v[84:85], v11 offset:8192
ds_read_b64_tr_b16 v[86:87], v11 offset:8328
v_add_f32 v61, v61, v63
v_smfmac_f32_16x16x64_bf16 v[64:67], v[32:35], v[128:135], v14
ds_read_b64_tr_b16 v[88:89], v11 offset:8736
ds_read_b64_tr_b16 v[90:91], v11 offset:8872
v_cvt_pk_bf16_f32 v62, v60, v61
v_smfmac_f32_16x16x64_bf16 v[64:67], v[36:39], a[136:143], v14
ds_read_b64_tr_b16 v[92:93], v11 offset:10496
ds_read_b64_tr_b16 v[94:95], v11 offset:10632
v_mov_b32 v52, 0
v_smfmac_f32_16x16x64_bf16 v[64:67], v[40:43], a[152:159], v14
ds_read_b64_tr_b16 v[96:97], v11 offset:11040
ds_read_b64_tr_b16 v[98:99], v11 offset:11176
v_mov_b32 v53, 0
v_smfmac_f32_16x16x64_bf16 v[64:67], v[44:47], a[168:175], v14
s_waitcnt lgkmcnt(8)
v_mov_b32 v54, 0
v_smfmac_f32_16x16x64_bf16 v[64:67], v[48:51], v[136:143], v14
s_waitcnt lgkmcnt(4)
v_mov_b32 v55, 0
v_smfmac_f32_16x16x64_bf16 v[76:79], v[100:103], v[84:91], v14
s_waitcnt lgkmcnt(0)
v_smfmac_f32_16x16x64_bf16 v[76:79], v[104:107], v[92:99], v14
v_add_f32 v64, v64, v66
v_add_f32 v65, v65, v67
v_cvt_pk_bf16_f32 v63, v64, v65
v_smfmac_f32_16x16x64_bf16 v[68:71], v[20:23], a[176:183], v14
ds_write_b64 v7, v[62:63] offset:12800
v_smfmac_f32_16x16x64_bf16 v[68:71], v[24:27], a[192:199], v14
v_add_f32 v76, v76, v78
v_add_f32 v77, v77, v79
v_smfmac_f32_16x16x64_bf16 v[68:71], v[28:31], a[208:215], v14
ds_read_b128 v[136:139], v1 offset:22528
v_exp_f32 v78, v76
v_smfmac_f32_16x16x64_bf16 v[68:71], v[32:35], a[224:231], v14
ds_read_b128 v[140:143], v1 offset:23552
v_exp_f32 v79, v77
v_smfmac_f32_16x16x64_bf16 v[68:71], v[36:39], a[240:247], v14
s_waitcnt lgkmcnt(2)
s_barrier
ds_read_b64_tr_b16 v[100:101], v9 offset:12800
v_cvt_pk_bf16_f32 v78, v78, v79
v_smfmac_f32_16x16x64_bf16 v[68:71], v[40:43], v[144:151], v14
ds_write_b32 v12, v78 offset:0
ds_read_b64_tr_b16 v[102:103], v9 offset:13312
v_smfmac_f32_16x16x64_bf16 v[68:71], v[44:47], v[160:167], v14
ds_read_b64_tr_b16 v[104:105], v9 offset:13824
v_smfmac_f32_16x16x64_bf16 v[68:71], v[48:51], v[176:183], v14
ds_read_b64_tr_b16 v[106:107], v9 offset:14336
v_smfmac_f32_16x16x64_bf16 v[72:75], v[20:23], a[184:191], v14
v_smfmac_f32_16x16x64_bf16 v[72:75], v[24:27], a[200:207], v14
s_waitcnt lgkmcnt(3)
s_barrier
ds_read_b128 v[124:127], v0 offset:0
v_smfmac_f32_16x16x64_bf16 v[72:75], v[28:31], a[216:223], v14
s_waitcnt lgkmcnt(3)
ds_read_b128 v[128:131], v1 offset:20480
v_add_f32 v68, v68, v70
v_smfmac_f32_16x16x64_bf16 v[80:83], v[100:103], v[84:91], v14
s_waitcnt lgkmcnt(2)
v_add_f32 v69, v69, v71
v_smfmac_f32_16x16x64_bf16 v[80:83], v[104:107], v[92:99], v14
v_cvt_pk_bf16_f32 v116, v68, v69
v_smfmac_f32_16x16x64_bf16 v[72:75], v[32:35], a[232:239], v14
ds_read_b128 v[132:135], v1 offset:21504
v_smfmac_f32_16x16x64_bf16 v[72:75], v[36:39], a[248:255], v14
v_mul_f32 v80, s26, v80
v_mul_f32 v81, s26, v81
v_fmac_f32 v80, s26, v82
v_smfmac_f32_16x16x64_bf16 v[72:75], v[40:43], v[152:159], v14
ds_read_b128 v[100:103], v1 offset:32768
v_fmac_f32 v81, s26, v83
v_smfmac_f32_16x16x64_bf16 v[72:75], v[44:47], v[168:175], v14
s_waitcnt lgkmcnt(3)
ds_read_b128 v[104:107], v1 offset:33792
v_exp_f32 v82, v80
v_mfma_f32_16x16x32_bf16 v[60:63], v[124:127], v[118:121], 0
v_exp_f32 v83, v81
v_smfmac_f32_16x16x64_bf16 v[72:75], v[48:51], v[184:191], v14
v_cvt_pk_bf16_f32 v122, v82, v83
v_smfmac_f32_16x16x64_bf16 v[52:55], v[124:127], v[108:115], v14
s_nop 0
v_mfma_f32_16x16x16_bf16 v[60:63], v[122:123], v[118:119], v[60:63]
v_add_f32 v72, v72, v74
v_add_f32 v73, v73, v75
v_cvt_pk_bf16_f32 v117, v72, v73
s_nop 1
v_smfmac_f32_16x16x32_bf16 v[52:55], v[122:123], v[116:119], v14
v_rcp_f32 v62, v60
v_rcp_f32 v63, v61
v_maximum3_f32 v16, v60, v61, v62
s_nop 1
v_mul_f32 v52, v52, v62
v_mul_f32 v53, v53, v63
v_mul_f32 v54, v54, v62
v_mul_f32 v55, v55, v63
v_cvt_pk_bf16_f32 v52, v52, v53
v_cvt_pk_bf16_f32 v53, v54, v55
ds_write2_b32 v6, v52, v53 offset0:0 offset1:64
v_maximum3_f32 v16, v16, v63, v63
v_cmp_nge_f32 vcc, s31, v16
s_cbranch_vccnz Lc_m0_r1_sl
Lc_m0_r1_slr:
v_mfma_f32_16x16x1_4b_f32 v[20:35], v123, v123, 0
s_waitcnt lgkmcnt(0)
s_barrier
ds_read_b64_tr_b16 v[84:85], v8 offset:8192
ds_read_b64_tr_b16 v[86:87], v8 offset:8448
ds_read_b64_tr_b16 v[88:89], v8 offset:8704
ds_read_b64_tr_b16 v[90:91], v8 offset:8960
ds_read_b64_tr_b16 v[92:93], v8 offset:9216
ds_read_b64_tr_b16 v[94:95], v8 offset:9472
ds_read_b64_tr_b16 v[96:97], v8 offset:9728
ds_read_b64_tr_b16 v[98:99], v8 offset:9984
s_waitcnt lgkmcnt(6)
v_smfmac_f32_16x16x64_bf16 v[20:23], v[84:87], v[128:135], v14 abid:1
s_waitcnt lgkmcnt(4)
ds_read_b128 v[36:39], v1 offset:24576
v_smfmac_f32_16x16x64_bf16 v[20:23], v[88:91], v[136:143], v14 abid:1
s_waitcnt lgkmcnt(3)
ds_read_b128 v[40:43], v1 offset:25600
v_smfmac_f32_16x16x64_bf16 v[20:23], v[92:95], v[192:199], v14 abid:1
s_waitcnt lgkmcnt(2)
ds_read_b128 v[44:47], v1 offset:26624
ds_read_b128 v[48:51], v1 offset:27648
v_smfmac_f32_16x16x64_bf16 v[20:23], v[96:99], v[200:207], v14 abid:1
v_smfmac_f32_16x16x64_bf16 v[24:27], v[84:87], v[208:215], v14 abid:1
ds_read_b128 v[128:131], v1 offset:28672
v_smfmac_f32_16x16x64_bf16 v[24:27], v[88:91], v[216:223], v14 abid:1
s_waitcnt lgkmcnt(3)
ds_read_b128 v[132:135], v1 offset:29696
v_cvt_pk_bf16_f32 v52, v20, v21
v_cvt_pk_bf16_f32 v53, v22, v23
v_smfmac_f32_16x16x64_bf16 v[24:27], v[92:95], v[36:43], v14 abid:1
s_waitcnt lgkmcnt(2)
ds_read_b128 v[136:139], v1 offset:30720
v_and_or_b32 v52, v52, -2, s32
v_smfmac_f32_16x16x64_bf16 v[24:27], v[96:99], v[44:51], v14 abid:1
ds_read_b128 v[140:143], v1 offset:31744
buffer_store_dwordx2 v[52:53], v2, s[8:11], s48 offen
v_smfmac_f32_16x16x64_bf16 v[28:31], v[84:87], v[224:231], v14 abid:1
v_smfmac_f32_16x16x64_bf16 v[28:31], v[88:91], v[232:239], v14 abid:1
s_waitcnt lgkmcnt(2)
ds_read_b128 v[36:39], v1 offset:34816
v_cvt_pk_bf16_f32 v54, v24, v25
v_cvt_pk_bf16_f32 v55, v26, v27
v_smfmac_f32_16x16x64_bf16 v[28:31], v[92:95], v[128:135], v14 abid:1
s_waitcnt lgkmcnt(1)
ds_read_b128 v[40:43], v1 offset:35840
v_and_or_b32 v54, v54, -2, s32
v_smfmac_f32_16x16x64_bf16 v[28:31], v[96:99], v[136:143], v14 abid:1
buffer_store_dwordx2 v[54:55], v2, s[8:11], s49 offen
v_smfmac_f32_16x16x64_bf16 v[32:35], v[84:87], v[240:247], v14 abid:1
v_smfmac_f32_16x16x64_bf16 v[32:35], v[88:91], v[248:255], v14 abid:1
v_cvt_pk_bf16_f32 v56, v28, v29
v_cvt_pk_bf16_f32 v57, v30, v31
v_smfmac_f32_16x16x64_bf16 v[32:35], v[92:95], v[100:107], v14 abid:1
s_waitcnt lgkmcnt(0)
ds_read_b128 v[68:71], v0 offset:14848
v_and_or_b32 v56, v56, -2, s32
v_smfmac_f32_16x16x64_bf16 v[32:35], v[96:99], v[36:43], v14 abid:1
buffer_store_dwordx2 v[56:57], v2, s[8:11], s50 offen
s_nop 5
s_nop 0
v_cvt_pk_bf16_f32 v58, v32, v33
v_cvt_pk_bf16_f32 v59, v34, v35
v_and_or_b32 v58, v58, -2, s32
buffer_store_dwordx2 v[58:59], v2, s[8:11], s51 offen
s_waitcnt lgkmcnt(0)
s_barrier
ds_read_b128 v[84:87], v1 offset:0
ds_read_b128 v[88:91], v1 offset:1024
ds_read_b128 v[92:95], v1 offset:2048
ds_read_b128 v[96:99], v1 offset:3072
ds_read_b128 v[128:131], v1 offset:4096
ds_read_b128 v[132:135], v1 offset:5120
ds_read_b128 v[136:139], v1 offset:6144
ds_read_b128 v[140:143], v1 offset:7168
s_nop 15
s_nop 11
buffer_load_dwordx4 v[20:23], v0, s[8:11], s21 offen offset:0 sc1
buffer_load_dwordx4 v[24:27], v0, s[8:11], s21 offen offset:1024 sc1
buffer_load_dwordx4 v[28:31], v0, s[8:11], s21 offen offset:2048 sc1
buffer_load_dwordx4 v[32:35], v0, s[8:11], s21 offen offset:3072 sc1
s_waitcnt vmcnt(3)
v_mfma_f32_16x16x32_bf16 v[72:75], v[68:71], v[20:23], 0
v_bitop3_b32 v16, v20, v22, s32 bitop3:0x7e
s_waitcnt vmcnt(2)
v_mfma_f32_16x16x32_bf16 v[72:75], v[68:71], v[24:27], v[72:75]
v_bitop3_b32 v17, v24, v26, s32 bitop3:0x7e
v_or_b32 v16, v16, v17
s_waitcnt vmcnt(1)
v_mfma_f32_16x16x32_bf16 v[72:75], v[68:71], v[28:31], v[72:75]
v_bitop3_b32 v17, v28, v30, s32 bitop3:0x7e
v_or_b32 v16, v16, v17
s_waitcnt vmcnt(0)
v_mfma_f32_16x16x32_bf16 v[72:75], v[68:71], v[32:35], v[72:75]
v_bitop3_b32 v17, v32, v34, s32 bitop3:0x7e
v_bitop3_b32 v16, v16, v17, 1 bitop3:0xa8
v_cmp_ne_u32 vcc, 0, v16
s_nop 3
v_add_f32_dpp v74, v72, v72 row_ror:8 row_mask:0xf bank_mask:0xf
v_add_f32_dpp v75, v73, v73 row_ror:8 row_mask:0xf bank_mask:0xf
v_cvt_pk_bf16_f32 v13, v74, v75
s_cbranch_vccnz Lc_m0_r1_r1
buffer_store_dword v13, v3, s[8:11], s23 offen
Lc_m0_r1_pu3:
v_mfma_f32_32x32x1_2b_f32 v[52:83], v123, v123, 0
s_add_u32 s18, s18, 1
s_bfe_u32 s32, s18, 0x10001
s_xor_b32 s48, s48, 0x40000
s_xor_b32 s49, s49, 0x40000
s_xor_b32 s50, s50, 0x40000
s_xor_b32 s51, s51, 0x40000
s_xor_b32 s21, s21, 0x40000
s_add_u32 s35, s35, 8192
s_add_u32 s24, s24, 1048576
s_add_u32 s25, s25, 1048576
s_cmp_eq_u32 s18, s40
s_cbranch_scc0 Lc_m0_r1_more
buffer_store_dword v13, v3, s[8:11], s35 offen sc1
s_branch Lc_m0_r1_exit
Lc_m0_r1_more:
s_add_u32 s22, s23, 4096
s_add_u32 s23, s23, 0x2000
s_and_b32 s23, s23, 1081343
s_xor_b32 s33, s23, 0x4000
s_nop 15
s_nop 10
buffer_load_dwordx4 v0, s[8:11], s22 offen offset:0 sc1 lds
buffer_load_dwordx4 v0, s[8:11], s22 offen offset:1024 sc1 lds
buffer_load_dwordx4 v0, s[8:11], s22 offen offset:2048 sc1 lds
buffer_load_dwordx4 v0, s[8:11], s22 offen offset:3072 sc1 lds
s_barrier
buffer_load_dwordx4 v[100:103], v0, s[8:11], s24 offen offset:0 sc1
buffer_load_dwordx4 v[104:107], v0, s[8:11], s24 offen offset:1024 sc1
buffer_load_dwordx4 v[108:111], v0, s[8:11], s25 offen offset:0 sc1
s_waitcnt lgkmcnt(0)
s_branch Lc_m0_r1_head
Lc_m0_r1_y0:
s_cmp_eq_u32 s18, s34
s_cbranch_scc1 Lc_m0_r1_y0r
Lc_m0_r1_y0l:
ds_read_b32 v16, v4 offset:0
ds_read_b128 v[20:23], v0 offset:0
ds_read_b128 v[24:27], v0 offset:1024
ds_read_b128 v[28:31], v0 offset:2048
ds_read_b128 v[32:35], v0 offset:3072
buffer_load_dwordx4 v0, s[8:11], s22 offen offset:0 sc1 lds
buffer_load_dwordx4 v0, s[8:11], s22 offen offset:1024 sc1 lds
buffer_load_dwordx4 v0, s[8:11], s22 offen offset:2048 sc1 lds
buffer_load_dwordx4 v0, s[8:11], s22 offen offset:3072 sc1 lds
s_waitcnt vmcnt(16)
s_add_u32 s46, s46, 1
s_waitcnt lgkmcnt(4)
v_cmp_eq_u32 vcc, s27, v16
s_cbranch_vccz Lc_m0_r1_y0k
ds_read_b32 v16, v4 offset:0
ds_read_b128 v[20:23], v0 offset:0
ds_read_b128 v[24:27], v0 offset:1024
ds_read_b128 v[28:31], v0 offset:2048
ds_read_b128 v[32:35], v0 offset:3072
s_add_u32 s46, s46, 1
s_waitcnt lgkmcnt(4)
v_cmp_eq_u32 vcc, s27, v16
s_cbranch_vccz Lc_m0_r1_y0k
s_add_u32 s30, s30, 1
s_cmp_gt_u32 s30, 1000000
s_cbranch_scc1 Lc_m0_abort
s_branch Lc_m0_r1_y0l
Lc_m0_r1_y0k:
v_mov_b32 v52, 0
v_mov_b32 v53, 0
v_mov_b32 v54, 0
v_mov_b32 v55, 0
v_mov_b32 v56, 0
v_mov_b32 v57, 0
v_mov_b32 v58, 0
v_mov_b32 v59, 0
s_waitcnt lgkmcnt(3)
v_smfmac_f32_16x16x64_bf16 v[52:55], v[20:23], v[84:91], v14
v_smfmac_f32_16x16x64_bf16 v[56:59], v[20:23], v[92:99], v14
s_waitcnt lgkmcnt(0)
s_branch Lc_m0_r1_y0r
Lc_m0_r1_y1:
s_cmp_eq_u32 s18, s34
s_cbranch_scc1 Lc_m0_r1_y1r
Lc_m0_r1_y1l:
ds_read_b32 v17, v4 offset:4096
ds_read_b128 v[36:39], v0 offset:4096
ds_read_b128 v[40:43], v0 offset:5120
ds_read_b128 v[44:47], v0 offset:6144
ds_read_b128 v[48:51], v0 offset:7168
buffer_load_dwordx4 v0, s[8:11], s22 offen offset:0 sc1 lds
buffer_load_dwordx4 v0, s[8:11], s22 offen offset:1024 sc1 lds
buffer_load_dwordx4 v0, s[8:11], s22 offen offset:2048 sc1 lds
buffer_load_dwordx4 v0, s[8:11], s22 offen offset:3072 sc1 lds
s_waitcnt vmcnt(16)
s_add_u32 s47, s47, 1
s_waitcnt lgkmcnt(4)
v_cmp_eq_u32 vcc, s27, v17
s_cbranch_vccz Lc_m0_r1_y1k
ds_read_b32 v17, v4 offset:4096
ds_read_b128 v[36:39], v0 offset:4096
ds_read_b128 v[40:43], v0 offset:5120
ds_read_b128 v[44:47], v0 offset:6144
ds_read_b128 v[48:51], v0 offset:7168
s_add_u32 s47, s47, 1
s_waitcnt lgkmcnt(4)
v_cmp_eq_u32 vcc, s27, v17
s_cbranch_vccz Lc_m0_r1_y1k
s_add_u32 s30, s30, 1
s_cmp_gt_u32 s30, 1000000
s_cbranch_scc1 Lc_m0_abort
s_branch Lc_m0_r1_y1l
Lc_m0_r1_y1k:
s_waitcnt lgkmcnt(0)
s_branch Lc_m0_r1_y1r
Lc_m0_r1_r1:
buffer_load_dwordx4 v[20:23], v0, s[8:11], s21 offen offset:0 sc1
buffer_load_dwordx4 v[24:27], v0, s[8:11], s21 offen offset:1024 sc1
buffer_load_dwordx4 v[28:31], v0, s[8:11], s21 offen offset:2048 sc1
buffer_load_dwordx4 v[32:35], v0, s[8:11], s21 offen offset:3072 sc1
s_nop 15
s_nop 11
Lc_m0_r1_r2:
buffer_load_dwordx4 v[36:39], v0, s[8:11], s21 offen offset:0 sc1
buffer_load_dwordx4 v[40:43], v0, s[8:11], s21 offen offset:1024 sc1
buffer_load_dwordx4 v[44:47], v0, s[8:11], s21 offen offset:2048 sc1
buffer_load_dwordx4 v[48:51], v0, s[8:11], s21 offen offset:3072 sc1
s_add_u32 s45, s45, 1
s_waitcnt vmcnt(7)
v_mfma_f32_16x16x32_bf16 v[72:75], v[68:71], v[20:23], 0
v_bitop3_b32 v16, v20, v22, s32 bitop3:0x7e
s_waitcnt vmcnt(6)
v_mfma_f32_16x16x32_bf16 v[72:75], v[68:71], v[24:27], v[72:75]
v_bitop3_b32 v17, v24, v26, s32 bitop3:0x7e
v_or_b32 v16, v16, v17
s_waitcnt vmcnt(5)
v_mfma_f32_16x16x32_bf16 v[72:75], v[68:71], v[28:31], v[72:75]
v_bitop3_b32 v17, v28, v30, s32 bitop3:0x7e
v_or_b32 v16, v16, v17
s_waitcnt vmcnt(4)
v_mfma_f32_16x16x32_bf16 v[72:75], v[68:71], v[32:35], v[72:75]
v_bitop3_b32 v17, v32, v34, s32 bitop3:0x7e
v_bitop3_b32 v16, v16, v17, 1 bitop3:0xa8
v_cmp_ne_u32 vcc, 0, v16
s_nop 3
v_add_f32_dpp v74, v72, v72 row_ror:8 row_mask:0xf bank_mask:0xf
v_add_f32_dpp v75, v73, v73 row_ror:8 row_mask:0xf bank_mask:0xf
v_cvt_pk_bf16_f32 v13, v74, v75
s_cbranch_vccz Lc_m0_r1_pu2
Lc_m0_r1_r3:
buffer_load_dwordx4 v[20:23], v0, s[8:11], s21 offen offset:0 sc1
buffer_load_dwordx4 v[24:27], v0, s[8:11], s21 offen offset:1024 sc1
buffer_load_dwordx4 v[28:31], v0, s[8:11], s21 offen offset:2048 sc1
buffer_load_dwordx4 v[32:35], v0, s[8:11], s21 offen offset:3072 sc1
s_add_u32 s45, s45, 1
s_waitcnt vmcnt(7)
v_mfma_f32_16x16x32_bf16 v[72:75], v[68:71], v[36:39], 0
v_bitop3_b32 v16, v36, v38, s32 bitop3:0x7e
s_waitcnt vmcnt(6)
v_mfma_f32_16x16x32_bf16 v[72:75], v[68:71], v[40:43], v[72:75]
v_bitop3_b32 v17, v40, v42, s32 bitop3:0x7e
v_or_b32 v16, v16, v17
s_waitcnt vmcnt(5)
v_mfma_f32_16x16x32_bf16 v[72:75], v[68:71], v[44:47], v[72:75]
v_bitop3_b32 v17, v44, v46, s32 bitop3:0x7e
v_or_b32 v16, v16, v17
s_waitcnt vmcnt(4)
v_mfma_f32_16x16x32_bf16 v[72:75], v[68:71], v[48:51], v[72:75]
v_bitop3_b32 v17, v48, v50, s32 bitop3:0x7e
v_bitop3_b32 v16, v16, v17, 1 bitop3:0xa8
v_cmp_ne_u32 vcc, 0, v16
s_nop 3
v_add_f32_dpp v74, v72, v72 row_ror:8 row_mask:0xf bank_mask:0xf
v_add_f32_dpp v75, v73, v73 row_ror:8 row_mask:0xf bank_mask:0xf
v_cvt_pk_bf16_f32 v13, v74, v75
s_cbranch_vccz Lc_m0_r1_pu2
s_add_u32 s30, s30, 1
s_cmp_gt_u32 s30, 1000000
s_cbranch_scc1 Lc_m0_abort
s_branch Lc_m0_r1_r2
Lc_m0_r1_pu2:
buffer_store_dword v13, v3, s[8:11], s23 offen
s_branch Lc_m0_r1_pu3
Lc_m0_r1_sl:
v_max3_f32 v16, v76, v77, v80
v_max_f32 v16, v16, v81
v_lshrrev_b32 v61, 2, v0
ds_write_b32 v61, v16 offset:1280
v_and_b32 v61, 63, v61
v_add_u32 v61, 1024, v61
s_mov_b64 s[38:39], 0
v_cmp_eq_u32 vcc, s27, v20
s_or_b64 s[38:39], s[38:39], vcc
v_cmp_eq_u32 vcc, s27, v21
s_or_b64 s[38:39], s[38:39], vcc
v_cmp_eq_u32 vcc, s27, v22
s_or_b64 s[38:39], s[38:39], vcc
v_cmp_eq_u32 vcc, s27, v23
s_or_b64 s[38:39], s[38:39], vcc
v_cmp_eq_u32 vcc, s27, v24
s_or_b64 s[38:39], s[38:39], vcc
v_cmp_eq_u32 vcc, s27, v25
s_or_b64 s[38:39], s[38:39], vcc
v_cmp_eq_u32 vcc, s27, v26
s_or_b64 s[38:39], s[38:39], vcc
v_cmp_eq_u32 vcc, s27, v27
s_or_b64 s[38:39], s[38:39], vcc
v_cmp_eq_u32 vcc, s27, v28
s_or_b64 s[38:39], s[38:39], vcc
v_cmp_eq_u32 vcc, s27, v29
s_or_b64 s[38:39], s[38:39], vcc
v_cmp_eq_u32 vcc, s27, v30
s_or_b64 s[38:39], s[38:39], vcc
v_cmp_eq_u32 vcc, s27, v31
s_or_b64 s[38:39], s[38:39], vcc
v_cmp_eq_u32 vcc, s27, v32
s_or_b64 s[38:39], s[38:39], vcc
v_cmp_eq_u32 vcc, s27, v33
s_or_b64 s[38:39], s[38:39], vcc
v_cmp_eq_u32 vcc, s27, v34
s_or_b64 s[38:39], s[38:39], vcc
v_cmp_eq_u32 vcc, s27, v35
s_or_b64 s[38:39], s[38:39], vcc
v_cmp_eq_u32 vcc, s27, v36
s_or_b64 s[38:39], s[38:39], vcc
v_cmp_eq_u32 vcc, s27, v37
s_or_b64 s[38:39], s[38:39], vcc
v_cmp_eq_u32 vcc, s27, v38
s_or_b64 s[38:39], s[38:39], vcc
v_cmp_eq_u32 vcc, s27, v39
s_or_b64 s[38:39], s[38:39], vcc
v_cmp_eq_u32 vcc, s27, v40
s_or_b64 s[38:39], s[38:39], vcc
v_cmp_eq_u32 vcc, s27, v41
s_or_b64 s[38:39], s[38:39], vcc
v_cmp_eq_u32 vcc, s27, v42
s_or_b64 s[38:39], s[38:39], vcc
v_cmp_eq_u32 vcc, s27, v43
s_or_b64 s[38:39], s[38:39], vcc
v_cmp_eq_u32 vcc, s27, v44
s_or_b64 s[38:39], s[38:39], vcc
v_cmp_eq_u32 vcc, s27, v45
s_or_b64 s[38:39], s[38:39], vcc
v_cmp_eq_u32 vcc, s27, v46
s_or_b64 s[38:39], s[38:39], vcc
v_cmp_eq_u32 vcc, s27, v47
s_or_b64 s[38:39], s[38:39], vcc
v_cmp_eq_u32 vcc, s27, v48
s_or_b64 s[38:39], s[38:39], vcc
v_cmp_eq_u32 vcc, s27, v49
s_or_b64 s[38:39], s[38:39], vcc
v_cmp_eq_u32 vcc, s27, v50
s_or_b64 s[38:39], s[38:39], vcc
v_cmp_eq_u32 vcc, s27, v51
s_or_b64 s[38:39], s[38:39], vcc
s_cselect_b32 s36, 1, 0
v_mov_b32 v60, s36
ds_write_b32 v123, v60 offset:2052
s_waitcnt lgkmcnt(0)
s_barrier
ds_read_b128 v[84:87], v123 offset:2048
s_waitcnt lgkmcnt(0)
v_or3_b32 v84, v84, v85, v86
v_or_b32 v84, v84, v87
v_cmp_ne_u32 vcc, 0, v84
s_cbranch_vccnz Lc_m0_r1_x
ds_read2_b32 v[84:85], v61 offset0:0 offset1:16
ds_read2_b32 v[86:87], v61 offset0:32 offset1:48
ds_read2_b32 v[88:89], v61 offset0:64 offset1:80
ds_read2_b32 v[90:91], v61 offset0:96 offset1:112
ds_read2_b32 v[92:93], v61 offset0:128 offset1:144
ds_read2_b32 v[94:95], v61 offset0:160 offset1:176
ds_read2_b32 v[96:97], v61 offset0:192 offset1:208
ds_read2_b32 v[98:99], v61 offset0:224 offset1:240
s_waitcnt lgkmcnt(0)
v_max3_f32 v16, v16, v84, v85
v_max3_f32 v16, v16, v86, v87
v_max3_f32 v16, v16, v88, v89
v_max3_f32 v16, v16, v90, v91
v_max3_f32 v16, v16, v92, v93
v_max3_f32 v16, v16, v94, v95
v_max3_f32 v16, v16, v96, v97
v_max3_f32 v16, v16, v98, v99
v_sub_f32 v78, v76, v16
v_sub_f32 v79, v77, v16
v_exp_f32 v78, v78
v_exp_f32 v79, v79
v_sub_f32 v82, v80, v16
v_sub_f32 v83, v81, v16
v_exp_f32 v82, v82
v_exp_f32 v83, v83
v_cvt_pk_bf16_f32 v78, v78, v79
ds_write_b32 v12, v78 offset:0
v_cvt_pk_bf16_f32 v122, v82, v83
v_mov_b32 v52, 0
v_mov_b32 v53, 0
v_mov_b32 v54, 0
v_mov_b32 v55, 0
s_waitcnt lgkmcnt(0)
s_barrier
ds_read_b128 v[124:127], v0 offset:0
s_waitcnt lgkmcnt(0)
v_mfma_f32_16x16x32_bf16 v[60:63], v[124:127], v[118:121], 0
v_smfmac_f32_16x16x64_bf16 v[52:55], v[124:127], v[108:115], v14
v_mfma_f32_16x16x16_bf16 v[60:63], v[122:123], v[118:119], v[60:63]
v_smfmac_f32_16x16x32_bf16 v[52:55], v[122:123], v[116:119], v14
s_nop 2
s_nop 0
v_rcp_f32 v62, v60
v_rcp_f32 v63, v61
v_maximum3_f32 v16, v60, v61, v62
v_mul_f32 v52, v52, v62
v_mul_f32 v53, v53, v63
v_mul_f32 v54, v54, v62
v_mul_f32 v55, v55, v63
v_cvt_pk_bf16_f32 v52, v52, v53
v_cvt_pk_bf16_f32 v53, v54, v55
ds_write2_b32 v6, v52, v53 offset0:0 offset1:64
s_branch Lc_m0_r1_slr
Lc_m0_r1_x:
s_add_u32 s44, s44, 1
s_add_u32 s30, s30, 1
s_cmp_gt_u32 s30, 1000000
s_cbranch_scc1 Lc_m0_abort
s_waitcnt vmcnt(0) lgkmcnt(0)
s_barrier
buffer_load_dwordx4 v0, s[8:11], s22 offen offset:0 sc1 lds
buffer_load_dwordx4 v0, s[8:11], s22 offen offset:1024 sc1 lds
buffer_load_dwordx4 v0, s[8:11], s22 offen offset:2048 sc1 lds
buffer_load_dwordx4 v0, s[8:11], s22 offen offset:3072 sc1 lds
buffer_load_dwordx4 v[100:103], v0, s[8:11], s24 offen offset:0 sc1
buffer_load_dwordx4 v[104:107], v0, s[8:11], s24 offen offset:1024 sc1
buffer_load_dwordx4 v[108:111], v0, s[8:11], s25 offen offset:0 sc1
v_mfma_f32_32x32x1_2b_f32 v[52:83], v123, v123, 0
ds_read_b128 v[84:87], v1 offset:0
ds_read_b128 v[88:91], v1 offset:1024
ds_read_b128 v[92:95], v1 offset:2048
ds_read_b128 v[96:99], v1 offset:3072
ds_read_b128 v[128:131], v1 offset:4096
ds_read_b128 v[132:135], v1 offset:5120
ds_read_b128 v[136:139], v1 offset:6144
ds_read_b128 v[140:143], v1 offset:7168
s_waitcnt vmcnt(0) lgkmcnt(0)
s_branch Lc_m0_r1_head
Lc_m0_r1_exit:
s_branch Lc_m0_done
Lc_m0_r2_entry:
.p2align 6
Lc_m0_r2_head:
s_barrier
ds_read_b32 v16, v3 offset:0
ds_read_b128 v[20:23], v0 offset:0
ds_read_b128 v[24:27], v0 offset:1024
ds_read_b128 v[28:31], v0 offset:2048
ds_read_b128 v[32:35], v0 offset:3072
buffer_load_dwordx4 v[112:115], v0, s[8:11], s25 offen offset:1024 sc1
s_waitcnt lgkmcnt(4)
v_cmp_eq_u32 vcc, s27, v16
Lc_m0_r2_q0:
s_waitcnt lgkmcnt(3)
v_smfmac_f32_16x16x64_bf16 v[52:55], v[20:23], v[84:91], v14
v_smfmac_f32_16x16x64_bf16 v[56:59], v[20:23], v[92:99], v14
s_waitcnt lgkmcnt(2)
s_cbranch_vccnz Lc_m0_r2_y0
Lc_m0_r2_y0r:
v_smfmac_f32_16x16x64_bf16 v[52:55], v[24:27], v[128:135], v14
ds_read_b128 v[128:131], v1 offset:8192
v_smfmac_f32_16x16x64_bf16 v[56:59], v[24:27], v[136:143], v14
s_waitcnt lgkmcnt(2)
ds_read_b128 v[132:135], v1 offset:9216
v_smfmac_f32_16x16x64_bf16 v[52:55], v[28:31], a[0:7], v14
s_barrier
ds_read_b32 v17, v3 offset:4096
v_smfmac_f32_16x16x64_bf16 v[56:59], v[28:31], a[8:15], v14
s_waitcnt lgkmcnt(3)
ds_read_b128 v[36:39], v0 offset:4096
v_smfmac_f32_16x16x64_bf16 v[52:55], v[32:35], a[16:23], v14
ds_read_b128 v[40:43], v0 offset:5120
v_smfmac_f32_16x16x64_bf16 v[56:59], v[32:35], a[24:31], v14
s_waitcnt lgkmcnt(2)
v_cmp_eq_u32 vcc, s27, v17
v_smfmac_f32_16x16x64_bf16 v[60:63], v[20:23], a[80:87], v14
ds_read_b128 v[44:47], v0 offset:6144
v_smfmac_f32_16x16x64_bf16 v[60:63], v[24:27], a[96:103], v14
s_waitcnt lgkmcnt(2)
s_cbranch_vccnz Lc_m0_r2_y1
Lc_m0_r2_y1r:
ds_read_b128 v[48:51], v0 offset:7168
ds_read_b128 v[136:139], v1 offset:10240
v_smfmac_f32_16x16x64_bf16 v[52:55], v[36:39], a[32:39], v14
s_waitcnt lgkmcnt(3)
ds_read_b128 v[140:143], v1 offset:11264
buffer_load_dword v15, v4, s[8:11], 0 offen sc1
v_mov_b32 v118, v119
v_smfmac_f32_16x16x64_bf16 v[52:55], v[40:43], a[48:55], v14
s_waitcnt lgkmcnt(3)
buffer_load_dword v13, v19, s[8:11], s19 offen sc1
v_mov_b32 v118, v119
v_smfmac_f32_16x16x64_bf16 v[52:55], v[44:47], v[128:135], v14
s_waitcnt lgkmcnt(2)
ds_read_b128 v[128:131], v1 offset:12288
v_mov_b32 v118, v119
v_smfmac_f32_16x16x64_bf16 v[52:55], v[48:51], a[64:71], v14
ds_read_b128 v[132:135], v1 offset:13312
v_mov_b32 v118, v119
v_smfmac_f32_16x16x64_bf16 v[56:59], v[36:39], a[40:47], v14
v_mov_b32 v118, v119
v_smfmac_f32_16x16x64_bf16 v[56:59], v[40:43], a[56:63], v14
s_waitcnt lgkmcnt(2)
buffer_load_dword v13, v19, s[8:11], s20 offen sc1
v_add_f32 v52, v52, v54
v_smfmac_f32_16x16x64_bf16 v[56:59], v[44:47], v[136:143], v14
ds_read_b128 v[136:139], v1 offset:16384
v_add_f32 v53, v53, v55
v_smfmac_f32_16x16x64_bf16 v[56:59], v[48:51], a[72:79], v14
ds_read_b128 v[140:143], v1 offset:17408
v_cvt_pk_bf16_f32 v54, v52, v53
v_smfmac_f32_16x16x64_bf16 v[60:63], v[28:31], a[112:119], v14
s_waitcnt lgkmcnt(2)
ds_write2_b32 v10, v54, v54 offset0:0 offset1:1
v_mov_b32 v118, v119
v_smfmac_f32_16x16x64_bf16 v[60:63], v[32:35], v[128:135], v14
ds_read_b128 v[128:131], v1 offset:14336
v_add_f32 v56, v56, v58
v_smfmac_f32_16x16x64_bf16 v[60:63], v[36:39], a[128:135], v14
buffer_load_dword v13, v19, s[8:11], s80 offen sc1
v_add_f32 v57, v57, v59
v_smfmac_f32_16x16x64_bf16 v[60:63], v[40:43], a[144:151], v14
ds_read_b128 v[132:135], v1 offset:15360
v_cvt_pk_bf16_f32 v58, v56, v57
v_smfmac_f32_16x16x64_bf16 v[60:63], v[44:47], a[160:167], v14
s_waitcnt lgkmcnt(3)
ds_write2_b32 v10, v58, v58 offset0:8 offset1:9
v_mov_b32 v118, v119
v_smfmac_f32_16x16x64_bf16 v[60:63], v[48:51], v[136:143], v14
ds_read_b128 v[136:139], v1 offset:18432
v_mov_b32 v118, v119
v_smfmac_f32_16x16x64_bf16 v[64:67], v[20:23], a[88:95], v14
ds_read_b128 v[140:143], v1 offset:19456
v_mov_b32 v118, v119
v_smfmac_f32_16x16x64_bf16 v[64:67], v[24:27], a[104:111], v14
buffer_load_dword v13, v19, s[8:11], s81 offen sc1
v_add_f32 v60, v60, v62
v_smfmac_f32_16x16x64_bf16 v[64:67], v[28:31], a[120:127], v14
s_waitcnt lgkmcnt(2)
s_barrier
ds_read_b64_tr_b16 v[84:85], v11 offset:8192
ds_read_b64_tr_b16 v[86:87], v11 offset:8328
v_add_f32 v61, v61, v63
v_smfmac_f32_16x16x64_bf16 v[64:67], v[32:35], v[128:135], v14
ds_read_b64_tr_b16 v[88:89], v11 offset:8736
ds_read_b64_tr_b16 v[90:91], v11 offset:8872
v_cvt_pk_bf16_f32 v62, v60, v61
v_smfmac_f32_16x16x64_bf16 v[64:67], v[36:39], a[136:143], v14
ds_read_b64_tr_b16 v[92:93], v11 offset:10496
ds_read_b64_tr_b16 v[94:95], v11 offset:10632
v_mov_b32 v52, 0
v_smfmac_f32_16x16x64_bf16 v[64:67], v[40:43], a[152:159], v14
ds_read_b64_tr_b16 v[96:97], v11 offset:11040
ds_read_b64_tr_b16 v[98:99], v11 offset:11176
v_mov_b32 v53, 0
v_smfmac_f32_16x16x64_bf16 v[64:67], v[44:47], a[168:175], v14
s_waitcnt lgkmcnt(8)
v_mov_b32 v54, 0
v_smfmac_f32_16x16x64_bf16 v[64:67], v[48:51], v[136:143], v14
s_waitcnt vmcnt(7) lgkmcnt(4)
v_mov_b32 v55, 0
v_smfmac_f32_16x16x64_bf16 v[76:79], v[100:103], v[84:91], v14
s_waitcnt lgkmcnt(0)
v_smfmac_f32_16x16x64_bf16 v[76:79], v[104:107], v[92:99], v14
v_add_f32 v64, v64, v66
v_add_f32 v65, v65, v67
v_cvt_pk_bf16_f32 v63, v64, v65
v_smfmac_f32_16x16x64_bf16 v[68:71], v[20:23], a[176:183], v14
ds_write_b64 v7, v[62:63] offset:12800
v_smfmac_f32_16x16x64_bf16 v[68:71], v[24:27], a[192:199], v14
v_add_f32 v76, v76, v78
v_add_f32 v77, v77, v79
v_smfmac_f32_16x16x64_bf16 v[68:71], v[28:31], a[208:215], v14
ds_read_b128 v[136:139], v1 offset:22528
v_exp_f32 v78, v76
v_smfmac_f32_16x16x64_bf16 v[68:71], v[32:35], a[224:231], v14
ds_read_b128 v[140:143], v1 offset:23552
v_exp_f32 v79, v77
v_smfmac_f32_16x16x64_bf16 v[68:71], v[36:39], a[240:247], v14
s_waitcnt lgkmcnt(2)
s_barrier
ds_read_b64_tr_b16 v[100:101], v9 offset:12800
v_cvt_pk_bf16_f32 v78, v78, v79
v_smfmac_f32_16x16x64_bf16 v[68:71], v[40:43], v[144:151], v14
ds_write_b32 v12, v78 offset:0
ds_read_b64_tr_b16 v[102:103], v9 offset:13312
v_smfmac_f32_16x16x64_bf16 v[68:71], v[44:47], v[160:167], v14
ds_read_b64_tr_b16 v[104:105], v9 offset:13824
v_smfmac_f32_16x16x64_bf16 v[68:71], v[48:51], v[176:183], v14
ds_read_b64_tr_b16 v[106:107], v9 offset:14336
v_smfmac_f32_16x16x64_bf16 v[72:75], v[20:23], a[184:191], v14
v_smfmac_f32_16x16x64_bf16 v[72:75], v[24:27], a[200:207], v14
s_waitcnt lgkmcnt(3)
s_barrier
ds_read_b128 v[124:127], v0 offset:0
v_smfmac_f32_16x16x64_bf16 v[72:75], v[28:31], a[216:223], v14
s_waitcnt lgkmcnt(3)
ds_read_b128 v[128:131], v1 offset:20480
v_add_f32 v68, v68, v70
v_smfmac_f32_16x16x64_bf16 v[80:83], v[100:103], v[84:91], v14
s_waitcnt lgkmcnt(2)
v_add_f32 v69, v69, v71
v_smfmac_f32_16x16x64_bf16 v[80:83], v[104:107], v[92:99], v14
v_cvt_pk_bf16_f32 v116, v68, v69
v_smfmac_f32_16x16x64_bf16 v[72:75], v[32:35], a[232:239], v14
ds_read_b128 v[132:135], v1 offset:21504
v_smfmac_f32_16x16x64_bf16 v[72:75], v[36:39], a[248:255], v14
v_mul_f32 v80, s26, v80
v_mul_f32 v81, s26, v81
v_fmac_f32 v80, s26, v82
v_smfmac_f32_16x16x64_bf16 v[72:75], v[40:43], v[152:159], v14
ds_read_b128 v[100:103], v1 offset:32768
v_fmac_f32 v81, s26, v83
v_smfmac_f32_16x16x64_bf16 v[72:75], v[44:47], v[168:175], v14
s_waitcnt lgkmcnt(3)
ds_read_b128 v[104:107], v1 offset:33792
v_exp_f32 v82, v80
v_mfma_f32_16x16x32_bf16 v[60:63], v[124:127], v[118:121], 0
v_exp_f32 v83, v81
v_smfmac_f32_16x16x64_bf16 v[72:75], v[48:51], v[184:191], v14
s_waitcnt vmcnt(5)
v_cvt_pk_bf16_f32 v122, v82, v83
v_smfmac_f32_16x16x64_bf16 v[52:55], v[124:127], v[108:115], v14
s_nop 0
v_mfma_f32_16x16x16_bf16 v[60:63], v[122:123], v[118:119], v[60:63]
v_add_f32 v72, v72, v74
v_add_f32 v73, v73, v75
v_cvt_pk_bf16_f32 v117, v72, v73
s_nop 1
v_smfmac_f32_16x16x32_bf16 v[52:55], v[122:123], v[116:119], v14
v_rcp_f32 v62, v60
v_rcp_f32 v63, v61
v_maximum3_f32 v16, v60, v61, v62
s_nop 1
v_mul_f32 v52, v52, v62
v_mul_f32 v53, v53, v63
v_mul_f32 v54, v54, v62
v_mul_f32 v55, v55, v63
v_cvt_pk_bf16_f32 v52, v52, v53
v_cvt_pk_bf16_f32 v53, v54, v55
ds_write2_b32 v6, v52, v53 offset0:0 offset1:64
v_maximum3_f32 v16, v16, v63, v63
v_cmp_nge_f32 vcc, s31, v16
s_cbranch_vccnz Lc_m0_r2_sl
Lc_m0_r2_slr:
v_mfma_f32_16x16x1_4b_f32 v[20:35], v123, v123, 0
s_waitcnt lgkmcnt(0)
s_barrier
ds_read_b64_tr_b16 v[84:85], v8 offset:8192
ds_read_b64_tr_b16 v[86:87], v8 offset:8448
ds_read_b64_tr_b16 v[88:89], v8 offset:8704
ds_read_b64_tr_b16 v[90:91], v8 offset:8960
ds_read_b64_tr_b16 v[92:93], v8 offset:9216
ds_read_b64_tr_b16 v[94:95], v8 offset:9472
ds_read_b64_tr_b16 v[96:97], v8 offset:9728
ds_read_b64_tr_b16 v[98:99], v8 offset:9984
buffer_load_dword v64, v18, s[8:11], 0 offen sc1
s_waitcnt lgkmcnt(6)
v_smfmac_f32_16x16x64_bf16 v[20:23], v[84:87], v[128:135], v14 abid:1
s_waitcnt lgkmcnt(4)
ds_read_b128 v[36:39], v1 offset:24576
v_smfmac_f32_16x16x64_bf16 v[20:23], v[88:91], v[136:143], v14 abid:1
s_waitcnt lgkmcnt(3)
ds_read_b128 v[40:43], v1 offset:25600
buffer_load_dword v65, v18, s[8:11], 0 offen sc1
v_smfmac_f32_16x16x64_bf16 v[20:23], v[92:95], v[192:199], v14 abid:1
s_waitcnt lgkmcnt(2)
ds_read_b128 v[44:47], v1 offset:26624
ds_read_b128 v[48:51], v1 offset:27648
v_smfmac_f32_16x16x64_bf16 v[20:23], v[96:99], v[200:207], v14 abid:1
buffer_load_dword v66, v18, s[8:11], 0 offen sc1
v_smfmac_f32_16x16x64_bf16 v[24:27], v[84:87], v[208:215], v14 abid:1
ds_read_b128 v[128:131], v1 offset:28672
v_smfmac_f32_16x16x64_bf16 v[24:27], v[88:91], v[216:223], v14 abid:1
s_waitcnt lgkmcnt(3)
ds_read_b128 v[132:135], v1 offset:29696
buffer_load_dword v67, v18, s[8:11], 0 offen sc1
v_cvt_pk_bf16_f32 v52, v20, v21
v_cvt_pk_bf16_f32 v53, v22, v23
v_smfmac_f32_16x16x64_bf16 v[24:27], v[92:95], v[36:43], v14 abid:1
s_waitcnt lgkmcnt(2)
ds_read_b128 v[136:139], v1 offset:30720
v_and_or_b32 v52, v52, -2, s32
v_smfmac_f32_16x16x64_bf16 v[24:27], v[96:99], v[44:51], v14 abid:1
ds_read_b128 v[140:143], v1 offset:31744
buffer_store_dwordx2 v[52:53], v2, s[8:11], s48 offen
buffer_load_dword v124, v18, s[8:11], 0 offen sc1
v_smfmac_f32_16x16x64_bf16 v[28:31], v[84:87], v[224:231], v14 abid:1
v_smfmac_f32_16x16x64_bf16 v[28:31], v[88:91], v[232:239], v14 abid:1
s_waitcnt lgkmcnt(2)
ds_read_b128 v[36:39], v1 offset:34816
buffer_load_dword v125, v18, s[8:11], 0 offen sc1
v_cvt_pk_bf16_f32 v54, v24, v25
v_cvt_pk_bf16_f32 v55, v26, v27
v_smfmac_f32_16x16x64_bf16 v[28:31], v[92:95], v[128:135], v14 abid:1
s_waitcnt lgkmcnt(1)
ds_read_b128 v[40:43], v1 offset:35840
v_and_or_b32 v54, v54, -2, s32
v_smfmac_f32_16x16x64_bf16 v[28:31], v[96:99], v[136:143], v14 abid:1
buffer_store_dwordx2 v[54:55], v2, s[8:11], s49 offen
buffer_load_dword v126, v18, s[8:11], 0 offen sc1
v_smfmac_f32_16x16x64_bf16 v[32:35], v[84:87], v[240:247], v14 abid:1
v_smfmac_f32_16x16x64_bf16 v[32:35], v[88:91], v[248:255], v14 abid:1
buffer_load_dword v127, v18, s[8:11], 0 offen sc1
v_cvt_pk_bf16_f32 v56, v28, v29
v_cvt_pk_bf16_f32 v57, v30, v31
v_smfmac_f32_16x16x64_bf16 v[32:35], v[92:95], v[100:107], v14 abid:1
s_waitcnt lgkmcnt(0)
v_and_or_b32 v56, v56, -2, s32
v_smfmac_f32_16x16x64_bf16 v[32:35], v[96:99], v[36:43], v14 abid:1
buffer_store_dwordx2 v[56:57], v2, s[8:11], s50 offen
buffer_load_dword v76, v18, s[8:11], 0 offen sc1
s_nop 5
v_cvt_pk_bf16_f32 v58, v32, v33
v_cvt_pk_bf16_f32 v59, v34, v35
v_and_or_b32 v58, v58, -2, s32
buffer_store_dwordx2 v[58:59], v2, s[8:11], s51 offen
buffer_load_dword v77, v18, s[8:11], 0 offen sc1
s_nop 3
buffer_load_dword v78, v18, s[8:11], 0 offen sc1
s_waitcnt vmcnt(14)
v_cmp_ge_u32 vcc, s18, v64
s_cbranch_vccz Lc_m0_r2_p0
buffer_load_dword v64, v18, s[8:11], 0 offen sc1
s_waitcnt vmcnt(14)
v_cmp_ge_u32 vcc, s18, v65
s_cbranch_vccz Lc_m0_r2_p0
buffer_load_dword v65, v18, s[8:11], 0 offen sc1
s_waitcnt vmcnt(14)
v_cmp_ge_u32 vcc, s18, v66
s_cbranch_vccz Lc_m0_r2_p0
buffer_load_dword v66, v18, s[8:11], 0 offen sc1
s_waitcnt vmcnt(14)
v_cmp_ge_u32 vcc, s18, v67
s_cbranch_vccz Lc_m0_r2_p0
buffer_load_dword v67, v18, s[8:11], 0 offen sc1
s_waitcnt vmcnt(13)
v_cmp_ge_u32 vcc, s18, v124
s_cbranch_vccz Lc_m0_r2_p0
buffer_load_dword v124, v18, s[8:11], 0 offen sc1
s_waitcnt vmcnt(13)
v_cmp_ge_u32 vcc, s18, v125
s_cbranch_vccz Lc_m0_r2_p0
buffer_load_dword v125, v18, s[8:11], 0 offen sc1
s_waitcnt vmcnt(12)
v_cmp_ge_u32 vcc, s18, v126
s_cbranch_vccz Lc_m0_r2_p0
buffer_load_dword v126, v18, s[8:11], 0 offen sc1
s_waitcnt vmcnt(12)
v_cmp_ge_u32 vcc, s18, v127
s_cbranch_vccz Lc_m0_r2_p0
buffer_load_dword v127, v18, s[8:11], 0 offen sc1
s_waitcnt vmcnt(11)
v_cmp_ge_u32 vcc, s18, v76
s_cbranch_vccz Lc_m0_r2_p0
buffer_load_dword v76, v18, s[8:11], 0 offen sc1
s_waitcnt vmcnt(10)
v_cmp_ge_u32 vcc, s18, v77
s_cbranch_vccz Lc_m0_r2_p0
s_add_u32 s44, s44, 1
Lc_m0_r2_rg:
buffer_load_dword v77, v18, s[8:11], 0 offen sc1
s_waitcnt vmcnt(10)
v_cmp_ge_u32 vcc, s18, v78
s_cbranch_vccz Lc_m0_r2_p0
buffer_load_dword v78, v18, s[8:11], 0 offen sc1
s_waitcnt vmcnt(10)
v_cmp_ge_u32 vcc, s18, v64
s_cbranch_vccz Lc_m0_r2_p0
buffer_load_dword v64, v18, s[8:11], 0 offen sc1
s_waitcnt vmcnt(10)
v_cmp_ge_u32 vcc, s18, v65
s_cbranch_vccz Lc_m0_r2_p0
buffer_load_dword v65, v18, s[8:11], 0 offen sc1
s_waitcnt vmcnt(10)
v_cmp_ge_u32 vcc, s18, v66
s_cbranch_vccz Lc_m0_r2_p0
buffer_load_dword v66, v18, s[8:11], 0 offen sc1
s_waitcnt vmcnt(10)
v_cmp_ge_u32 vcc, s18, v67
s_cbranch_vccz Lc_m0_r2_p0
buffer_load_dword v67, v18, s[8:11], 0 offen sc1
s_waitcnt vmcnt(10)
v_cmp_ge_u32 vcc, s18, v124
s_cbranch_vccz Lc_m0_r2_p0
buffer_load_dword v124, v18, s[8:11], 0 offen sc1
s_waitcnt vmcnt(10)
v_cmp_ge_u32 vcc, s18, v125
s_cbranch_vccz Lc_m0_r2_p0
buffer_load_dword v125, v18, s[8:11], 0 offen sc1
s_waitcnt vmcnt(10)
v_cmp_ge_u32 vcc, s18, v126
s_cbranch_vccz Lc_m0_r2_p0
buffer_load_dword v126, v18, s[8:11], 0 offen sc1
s_waitcnt vmcnt(10)
v_cmp_ge_u32 vcc, s18, v127
s_cbranch_vccz Lc_m0_r2_p0
buffer_load_dword v127, v18, s[8:11], 0 offen sc1
s_waitcnt vmcnt(10)
v_cmp_ge_u32 vcc, s18, v76
s_cbranch_vccz Lc_m0_r2_p0
buffer_load_dword v76, v18, s[8:11], 0 offen sc1
s_waitcnt vmcnt(10)
v_cmp_ge_u32 vcc, s18, v77
s_cbranch_vccz Lc_m0_r2_p0
s_add_u32 s30, s30, 1
s_cmp_gt_u32 s30, 1000000
s_cbranch_scc0 Lc_m0_r2_rg
s_branch Lc_m0_abort
Lc_m0_r2_p0:
s_barrier
s_add_u32 s18, s18, 1
s_bfe_u32 s32, s18, 0x10001
s_xor_b32 s48, s48, 0x40000
s_xor_b32 s49, s49, 0x40000
s_xor_b32 s50, s50, 0x40000
s_xor_b32 s51, s51, 0x40000
s_add_u32 s24, s24, 1048576
s_add_u32 s25, s25, 1048576
s_cmp_eq_u32 s18, s40
s_cbranch_scc1 Lc_m0_r2_exit
s_add_u32 s28, s18, 1
s_min_u32 s28, s28, 63
s_mul_i32 s36, s28, 1048576
s_lshl_b32 s29, s16, 13
s_add_u32 s36, s36, s29
s_add_u32 s36, s36, 16777216
s_and_b32 s29, s16, 3
s_lshl_b32 s29, s29, 11
s_add_u32 s19, s36, s29
s_xor_b32 s20, s19, 2048
s_xor_b32 s80, s19, 4096
s_xor_b32 s81, s19, 6144
Lc_m0_r2_rd:
v_cmp_ge_u32 vcc, s28, v15
s_cbranch_vccnz Lc_m0_r2_rr
s_waitcnt vmcnt(0)
v_mfma_f32_32x32x1_2b_f32 v[52:83], v123, v123, 0
ds_read_b128 v[84:87], v1 offset:0
ds_read_b128 v[88:91], v1 offset:1024
ds_read_b128 v[92:95], v1 offset:2048
ds_read_b128 v[96:99], v1 offset:3072
ds_read_b128 v[128:131], v1 offset:4096
ds_read_b128 v[132:135], v1 offset:5120
ds_read_b128 v[136:139], v1 offset:6144
ds_read_b128 v[140:143], v1 offset:7168
s_waitcnt lgkmcnt(0)
s_barrier
buffer_load_dwordx4 v[100:103], v0, s[8:11], s24 offen offset:0 sc1
buffer_load_dwordx4 v[104:107], v0, s[8:11], s24 offen offset:1024 sc1
buffer_load_dwordx4 v[108:111], v0, s[8:11], s25 offen offset:0 sc1
s_branch Lc_m0_r2_head
Lc_m0_r2_y0:
s_cmp_eq_u32 s18, s34
s_cbranch_scc1 Lc_m0_r2_y0r
Lc_m0_r2_y0l:
ds_read_b32 v16, v3 offset:0
ds_read_b128 v[20:23], v0 offset:0
ds_read_b128 v[24:27], v0 offset:1024
ds_read_b128 v[28:31], v0 offset:2048
ds_read_b128 v[32:35], v0 offset:3072
s_add_u32 s46, s46, 1
s_waitcnt lgkmcnt(4)
v_cmp_eq_u32 vcc, s27, v16
s_cbranch_vccz Lc_m0_r2_y0k
ds_read_b32 v16, v3 offset:0
ds_read_b128 v[20:23], v0 offset:0
ds_read_b128 v[24:27], v0 offset:1024
ds_read_b128 v[28:31], v0 offset:2048
ds_read_b128 v[32:35], v0 offset:3072
s_add_u32 s46, s46, 1
s_waitcnt lgkmcnt(4)
v_cmp_eq_u32 vcc, s27, v16
s_cbranch_vccz Lc_m0_r2_y0k
s_add_u32 s30, s30, 1
s_cmp_gt_u32 s30, 1000000
s_cbranch_scc1 Lc_m0_abort
s_branch Lc_m0_r2_y0l
Lc_m0_r2_y0k:
v_mov_b32 v52, 0
v_mov_b32 v53, 0
v_mov_b32 v54, 0
v_mov_b32 v55, 0
v_mov_b32 v56, 0
v_mov_b32 v57, 0
v_mov_b32 v58, 0
v_mov_b32 v59, 0
s_waitcnt lgkmcnt(3)
v_smfmac_f32_16x16x64_bf16 v[52:55], v[20:23], v[84:91], v14
v_smfmac_f32_16x16x64_bf16 v[56:59], v[20:23], v[92:99], v14
s_waitcnt lgkmcnt(0)
s_branch Lc_m0_r2_y0r
Lc_m0_r2_y1:
s_cmp_eq_u32 s18, s34
s_cbranch_scc1 Lc_m0_r2_y1r
Lc_m0_r2_y1l:
ds_read_b32 v17, v3 offset:4096
ds_read_b128 v[36:39], v0 offset:4096
ds_read_b128 v[40:43], v0 offset:5120
ds_read_b128 v[44:47], v0 offset:6144
ds_read_b128 v[48:51], v0 offset:7168
s_add_u32 s47, s47, 1
s_waitcnt lgkmcnt(4)
v_cmp_eq_u32 vcc, s27, v17
s_cbranch_vccz Lc_m0_r2_y1k
ds_read_b32 v17, v3 offset:4096
ds_read_b128 v[36:39], v0 offset:4096
ds_read_b128 v[40:43], v0 offset:5120
ds_read_b128 v[44:47], v0 offset:6144
ds_read_b128 v[48:51], v0 offset:7168
s_add_u32 s47, s47, 1
s_waitcnt lgkmcnt(4)
v_cmp_eq_u32 vcc, s27, v17
s_cbranch_vccz Lc_m0_r2_y1k
s_add_u32 s30, s30, 1
s_cmp_gt_u32 s30, 1000000
s_cbranch_scc1 Lc_m0_abort
s_branch Lc_m0_r2_y1l
Lc_m0_r2_y1k:
s_waitcnt lgkmcnt(0)
s_branch Lc_m0_r2_y1r
Lc_m0_r2_rr:
s_sleep 8
buffer_load_dword v15, v4, s[8:11], 0 offen sc1
s_add_u32 s30, s30, 1
s_cmp_gt_u32 s30, 1000000
s_cbranch_scc1 Lc_m0_abort
s_waitcnt vmcnt(0) lgkmcnt(0)
s_branch Lc_m0_r2_rd
Lc_m0_r2_sl:
v_max3_f32 v16, v76, v77, v80
v_max_f32 v16, v16, v81
v_lshrrev_b32 v61, 2, v0
ds_write_b32 v61, v16 offset:1536
v_and_b32 v61, 63, v61
v_add_u32 v61, 1024, v61
s_mov_b64 s[38:39], 0
v_cmp_eq_u32 vcc, s27, v20
s_or_b64 s[38:39], s[38:39], vcc
v_cmp_eq_u32 vcc, s27, v21
s_or_b64 s[38:39], s[38:39], vcc
v_cmp_eq_u32 vcc, s27, v22
s_or_b64 s[38:39], s[38:39], vcc
v_cmp_eq_u32 vcc, s27, v23
s_or_b64 s[38:39], s[38:39], vcc
v_cmp_eq_u32 vcc, s27, v24
s_or_b64 s[38:39], s[38:39], vcc
v_cmp_eq_u32 vcc, s27, v25
s_or_b64 s[38:39], s[38:39], vcc
v_cmp_eq_u32 vcc, s27, v26
s_or_b64 s[38:39], s[38:39], vcc
v_cmp_eq_u32 vcc, s27, v27
s_or_b64 s[38:39], s[38:39], vcc
v_cmp_eq_u32 vcc, s27, v28
s_or_b64 s[38:39], s[38:39], vcc
v_cmp_eq_u32 vcc, s27, v29
s_or_b64 s[38:39], s[38:39], vcc
v_cmp_eq_u32 vcc, s27, v30
s_or_b64 s[38:39], s[38:39], vcc
v_cmp_eq_u32 vcc, s27, v31
s_or_b64 s[38:39], s[38:39], vcc
v_cmp_eq_u32 vcc, s27, v32
s_or_b64 s[38:39], s[38:39], vcc
v_cmp_eq_u32 vcc, s27, v33
s_or_b64 s[38:39], s[38:39], vcc
v_cmp_eq_u32 vcc, s27, v34
s_or_b64 s[38:39], s[38:39], vcc
v_cmp_eq_u32 vcc, s27, v35
s_or_b64 s[38:39], s[38:39], vcc
v_cmp_eq_u32 vcc, s27, v36
s_or_b64 s[38:39], s[38:39], vcc
v_cmp_eq_u32 vcc, s27, v37
s_or_b64 s[38:39], s[38:39], vcc
v_cmp_eq_u32 vcc, s27, v38
s_or_b64 s[38:39], s[38:39], vcc
v_cmp_eq_u32 vcc, s27, v39
s_or_b64 s[38:39], s[38:39], vcc
v_cmp_eq_u32 vcc, s27, v40
s_or_b64 s[38:39], s[38:39], vcc
v_cmp_eq_u32 vcc, s27, v41
s_or_b64 s[38:39], s[38:39], vcc
v_cmp_eq_u32 vcc, s27, v42
s_or_b64 s[38:39], s[38:39], vcc
v_cmp_eq_u32 vcc, s27, v43
s_or_b64 s[38:39], s[38:39], vcc
v_cmp_eq_u32 vcc, s27, v44
s_or_b64 s[38:39], s[38:39], vcc
v_cmp_eq_u32 vcc, s27, v45
s_or_b64 s[38:39], s[38:39], vcc
v_cmp_eq_u32 vcc, s27, v46
s_or_b64 s[38:39], s[38:39], vcc
v_cmp_eq_u32 vcc, s27, v47
s_or_b64 s[38:39], s[38:39], vcc
v_cmp_eq_u32 vcc, s27, v48
s_or_b64 s[38:39], s[38:39], vcc
v_cmp_eq_u32 vcc, s27, v49
s_or_b64 s[38:39], s[38:39], vcc
v_cmp_eq_u32 vcc, s27, v50
s_or_b64 s[38:39], s[38:39], vcc
v_cmp_eq_u32 vcc, s27, v51
s_or_b64 s[38:39], s[38:39], vcc
s_cselect_b32 s36, 1, 0
v_mov_b32 v60, s36
ds_write_b32 v123, v60 offset:2056
s_waitcnt lgkmcnt(0)
s_barrier
ds_read_b128 v[84:87], v123 offset:2048
s_waitcnt lgkmcnt(0)
v_or3_b32 v84, v84, v85, v86
v_or_b32 v84, v84, v87
v_cmp_ne_u32 vcc, 0, v84
s_cbranch_vccnz Lc_m0_r2_x
ds_read2_b32 v[84:85], v61 offset0:0 offset1:16
ds_read2_b32 v[86:87], v61 offset0:32 offset1:48
ds_read2_b32 v[88:89], v61 offset0:64 offset1:80
ds_read2_b32 v[90:91], v61 offset0:96 offset1:112
ds_read2_b32 v[92:93], v61 offset0:128 offset1:144
ds_read2_b32 v[94:95], v61 offset0:160 offset1:176
ds_read2_b32 v[96:97], v61 offset0:192 offset1:208
ds_read2_b32 v[98:99], v61 offset0:224 offset1:240
s_waitcnt lgkmcnt(0)
v_max3_f32 v16, v16, v84, v85
v_max3_f32 v16, v16, v86, v87
v_max3_f32 v16, v16, v88, v89
v_max3_f32 v16, v16, v90, v91
v_max3_f32 v16, v16, v92, v93
v_max3_f32 v16, v16, v94, v95
v_max3_f32 v16, v16, v96, v97
v_max3_f32 v16, v16, v98, v99
v_sub_f32 v78, v76, v16
v_sub_f32 v79, v77, v16
v_exp_f32 v78, v78
v_exp_f32 v79, v79
v_sub_f32 v82, v80, v16
v_sub_f32 v83, v81, v16
v_exp_f32 v82, v82
v_exp_f32 v83, v83
v_cvt_pk_bf16_f32 v78, v78, v79
ds_write_b32 v12, v78 offset:0
v_cvt_pk_bf16_f32 v122, v82, v83
v_mov_b32 v52, 0
v_mov_b32 v53, 0
v_mov_b32 v54, 0
v_mov_b32 v55, 0
s_waitcnt lgkmcnt(0)
s_barrier
ds_read_b128 v[124:127], v0 offset:0
s_waitcnt lgkmcnt(0)
v_mfma_f32_16x16x32_bf16 v[60:63], v[124:127], v[118:121], 0
v_smfmac_f32_16x16x64_bf16 v[52:55], v[124:127], v[108:115], v14
v_mfma_f32_16x16x16_bf16 v[60:63], v[122:123], v[118:119], v[60:63]
v_smfmac_f32_16x16x32_bf16 v[52:55], v[122:123], v[116:119], v14
s_nop 2
s_nop 0
v_rcp_f32 v62, v60
v_rcp_f32 v63, v61
v_maximum3_f32 v16, v60, v61, v62
v_mul_f32 v52, v52, v62
v_mul_f32 v53, v53, v63
v_mul_f32 v54, v54, v62
v_mul_f32 v55, v55, v63
v_cvt_pk_bf16_f32 v52, v52, v53
v_cvt_pk_bf16_f32 v53, v54, v55
ds_write2_b32 v6, v52, v53 offset0:0 offset1:64
s_branch Lc_m0_r2_slr
Lc_m0_r2_x:
s_add_u32 s44, s44, 1
s_add_u32 s30, s30, 1
s_cmp_gt_u32 s30, 1000000
s_cbranch_scc1 Lc_m0_abort
s_waitcnt vmcnt(0) lgkmcnt(0)
s_barrier
buffer_load_dwordx4 v[100:103], v0, s[8:11], s24 offen offset:0 sc1
buffer_load_dwordx4 v[104:107], v0, s[8:11], s24 offen offset:1024 sc1
buffer_load_dwordx4 v[108:111], v0, s[8:11], s25 offen offset:0 sc1
v_mfma_f32_32x32x1_2b_f32 v[52:83], v123, v123, 0
ds_read_b128 v[84:87], v1 offset:0
ds_read_b128 v[88:91], v1 offset:1024
ds_read_b128 v[92:95], v1 offset:2048
ds_read_b128 v[96:99], v1 offset:3072
ds_read_b128 v[128:131], v1 offset:4096
ds_read_b128 v[132:135], v1 offset:5120
ds_read_b128 v[136:139], v1 offset:6144
ds_read_b128 v[140:143], v1 offset:7168
s_waitcnt vmcnt(0) lgkmcnt(0)
s_branch Lc_m0_r2_head
Lc_m0_r2_exit:
s_branch Lc_m0_done
Lc_m0_r3_entry:
.p2align 6
Lc_m0_r3_head:
s_barrier
ds_read_b32 v16, v3 offset:0
ds_read_b128 v[20:23], v0 offset:0
ds_read_b128 v[24:27], v0 offset:1024
ds_read_b128 v[28:31], v0 offset:2048
ds_read_b128 v[32:35], v0 offset:3072
buffer_load_dwordx4 v[112:115], v0, s[8:11], s25 offen offset:1024 sc1
s_waitcnt lgkmcnt(4)
v_cmp_eq_u32 vcc, s27, v16
Lc_m0_r3_q0:
s_waitcnt lgkmcnt(3)
v_smfmac_f32_16x16x64_bf16 v[52:55], v[20:23], v[84:91], v14
v_smfmac_f32_16x16x64_bf16 v[56:59], v[20:23], v[92:99], v14
s_waitcnt lgkmcnt(2)
s_cbranch_vccnz Lc_m0_r3_y0
Lc_m0_r3_y0r:
v_smfmac_f32_16x16x64_bf16 v[52:55], v[24:27], v[128:135], v14
ds_read_b128 v[128:131], v1 offset:8192
v_smfmac_f32_16x16x64_bf16 v[56:59], v[24:27], v[136:143], v14
s_waitcnt lgkmcnt(2)
ds_read_b128 v[132:135], v1 offset:9216
v_smfmac_f32_16x16x64_bf16 v[52:55], v[28:31], a[0:7], v14
s_barrier
ds_read_b32 v17, v3 offset:4096
v_smfmac_f32_16x16x64_bf16 v[56:59], v[28:31], a[8:15], v14
s_waitcnt lgkmcnt(3)
ds_read_b128 v[36:39], v0 offset:4096
v_smfmac_f32_16x16x64_bf16 v[52:55], v[32:35], a[16:23], v14
ds_read_b128 v[40:43], v0 offset:5120
v_smfmac_f32_16x16x64_bf16 v[56:59], v[32:35], a[24:31], v14
s_waitcnt lgkmcnt(2)
v_cmp_eq_u32 vcc, s27, v17
v_smfmac_f32_16x16x64_bf16 v[60:63], v[20:23], a[80:87], v14
ds_read_b128 v[44:47], v0 offset:6144
v_smfmac_f32_16x16x64_bf16 v[60:63], v[24:27], a[96:103], v14
s_waitcnt lgkmcnt(2)
s_cbranch_vccnz Lc_m0_r3_y1
Lc_m0_r3_y1r:
ds_read_b128 v[48:51], v0 offset:7168
ds_read_b128 v[136:139], v1 offset:10240
v_smfmac_f32_16x16x64_bf16 v[52:55], v[36:39], a[32:39], v14
s_waitcnt lgkmcnt(3)
ds_read_b128 v[140:143], v1 offset:11264
buffer_load_dword v15, v19, s[8:11], s19 offen sc1
v_mov_b32 v118, v119
v_smfmac_f32_16x16x64_bf16 v[52:55], v[40:43], a[48:55], v14
s_waitcnt lgkmcnt(3)
v_mov_b32 v118, v119
v_smfmac_f32_16x16x64_bf16 v[52:55], v[44:47], v[128:135], v14
s_waitcnt lgkmcnt(2)
ds_read_b128 v[128:131], v1 offset:12288
v_mov_b32 v118, v119
v_smfmac_f32_16x16x64_bf16 v[52:55], v[48:51], a[64:71], v14
ds_read_b128 v[132:135], v1 offset:13312
v_mov_b32 v118, v119
v_smfmac_f32_16x16x64_bf16 v[56:59], v[36:39], a[40:47], v14
buffer_load_dword v15, v19, s[8:11], s20 offen sc1
v_mov_b32 v118, v119
v_smfmac_f32_16x16x64_bf16 v[56:59], v[40:43], a[56:63], v14
s_waitcnt lgkmcnt(2)
v_add_f32 v52, v52, v54
v_smfmac_f32_16x16x64_bf16 v[56:59], v[44:47], v[136:143], v14
ds_read_b128 v[136:139], v1 offset:16384
v_add_f32 v53, v53, v55
v_smfmac_f32_16x16x64_bf16 v[56:59], v[48:51], a[72:79], v14
ds_read_b128 v[140:143], v1 offset:17408
v_cvt_pk_bf16_f32 v54, v52, v53
v_smfmac_f32_16x16x64_bf16 v[60:63], v[28:31], a[112:119], v14
s_waitcnt lgkmcnt(2)
buffer_load_dword v15, v19, s[8:11], s80 offen sc1
ds_write2_b32 v10, v54, v54 offset0:0 offset1:1
v_mov_b32 v118, v119
v_smfmac_f32_16x16x64_bf16 v[60:63], v[32:35], v[128:135], v14
ds_read_b128 v[128:131], v1 offset:14336
v_add_f32 v56, v56, v58
v_smfmac_f32_16x16x64_bf16 v[60:63], v[36:39], a[128:135], v14
v_add_f32 v57, v57, v59
v_smfmac_f32_16x16x64_bf16 v[60:63], v[40:43], a[144:151], v14
ds_read_b128 v[132:135], v1 offset:15360
v_cvt_pk_bf16_f32 v58, v56, v57
v_smfmac_f32_16x16x64_bf16 v[60:63], v[44:47], a[160:167], v14
s_waitcnt lgkmcnt(3)
ds_write2_b32 v10, v58, v58 offset0:8 offset1:9
v_mov_b32 v118, v119
v_smfmac_f32_16x16x64_bf16 v[60:63], v[48:51], v[136:143], v14
ds_read_b128 v[136:139], v1 offset:18432
buffer_load_dword v15, v19, s[8:11], s81 offen sc1
v_mov_b32 v118, v119
v_smfmac_f32_16x16x64_bf16 v[64:67], v[20:23], a[88:95], v14
ds_read_b128 v[140:143], v1 offset:19456
v_mov_b32 v118, v119
v_smfmac_f32_16x16x64_bf16 v[64:67], v[24:27], a[104:111], v14
v_add_f32 v60, v60, v62
v_smfmac_f32_16x16x64_bf16 v[64:67], v[28:31], a[120:127], v14
s_waitcnt lgkmcnt(2)
s_barrier
ds_read_b64_tr_b16 v[84:85], v11 offset:8192
ds_read_b64_tr_b16 v[86:87], v11 offset:8328
v_add_f32 v61, v61, v63
v_smfmac_f32_16x16x64_bf16 v[64:67], v[32:35], v[128:135], v14
ds_read_b64_tr_b16 v[88:89], v11 offset:8736
ds_read_b64_tr_b16 v[90:91], v11 offset:8872
v_cvt_pk_bf16_f32 v62, v60, v61
v_smfmac_f32_16x16x64_bf16 v[64:67], v[36:39], a[136:143], v14
ds_read_b64_tr_b16 v[92:93], v11 offset:10496
ds_read_b64_tr_b16 v[94:95], v11 offset:10632
v_mov_b32 v52, 0
v_smfmac_f32_16x16x64_bf16 v[64:67], v[40:43], a[152:159], v14
ds_read_b64_tr_b16 v[96:97], v11 offset:11040
ds_read_b64_tr_b16 v[98:99], v11 offset:11176
v_mov_b32 v53, 0
v_smfmac_f32_16x16x64_bf16 v[64:67], v[44:47], a[168:175], v14
s_waitcnt lgkmcnt(8)
v_mov_b32 v54, 0
v_smfmac_f32_16x16x64_bf16 v[64:67], v[48:51], v[136:143], v14
s_waitcnt vmcnt(6) lgkmcnt(4)
v_mov_b32 v55, 0
v_smfmac_f32_16x16x64_bf16 v[76:79], v[100:103], v[84:91], v14
s_waitcnt lgkmcnt(0)
v_smfmac_f32_16x16x64_bf16 v[76:79], v[104:107], v[92:99], v14
v_add_f32 v64, v64, v66
v_add_f32 v65, v65, v67
v_cvt_pk_bf16_f32 v63, v64, v65
v_smfmac_f32_16x16x64_bf16 v[68:71], v[20:23], a[176:183], v14
ds_write_b64 v7, v[62:63] offset:12800
v_smfmac_f32_16x16x64_bf16 v[68:71], v[24:27], a[192:199], v14
v_add_f32 v76, v76, v78
v_add_f32 v77, v77, v79
v_smfmac_f32_16x16x64_bf16 v[68:71], v[28:31], a[208:215], v14
ds_read_b128 v[136:139], v1 offset:22528
v_exp_f32 v78, v76
v_smfmac_f32_16x16x64_bf16 v[68:71], v[32:35], a[224:231], v14
ds_read_b128 v[140:143], v1 offset:23552
v_exp_f32 v79, v77
v_smfmac_f32_16x16x64_bf16 v[68:71], v[36:39], a[240:247], v14
s_waitcnt lgkmcnt(2)
s_barrier
ds_read_b64_tr_b16 v[100:101], v9 offset:12800
v_cvt_pk_bf16_f32 v78, v78, v79
v_smfmac_f32_16x16x64_bf16 v[68:71], v[40:43], v[144:151], v14
ds_write_b32 v12, v78 offset:0
ds_read_b64_tr_b16 v[102:103], v9 offset:13312
v_smfmac_f32_16x16x64_bf16 v[68:71], v[44:47], v[160:167], v14
ds_read_b64_tr_b16 v[104:105], v9 offset:13824
v_smfmac_f32_16x16x64_bf16 v[68:71], v[48:51], v[176:183], v14
ds_read_b64_tr_b16 v[106:107], v9 offset:14336
v_smfmac_f32_16x16x64_bf16 v[72:75], v[20:23], a[184:191], v14
v_smfmac_f32_16x16x64_bf16 v[72:75], v[24:27], a[200:207], v14
s_waitcnt lgkmcnt(3)
s_barrier
ds_read_b128 v[124:127], v0 offset:0
v_smfmac_f32_16x16x64_bf16 v[72:75], v[28:31], a[216:223], v14
s_waitcnt lgkmcnt(3)
ds_read_b128 v[128:131], v1 offset:20480
v_add_f32 v68, v68, v70
v_smfmac_f32_16x16x64_bf16 v[80:83], v[100:103], v[84:91], v14
s_waitcnt lgkmcnt(2)
v_add_f32 v69, v69, v71
v_smfmac_f32_16x16x64_bf16 v[80:83], v[104:107], v[92:99], v14
v_cvt_pk_bf16_f32 v116, v68, v69
v_smfmac_f32_16x16x64_bf16 v[72:75], v[32:35], a[232:239], v14
ds_read_b128 v[132:135], v1 offset:21504
v_smfmac_f32_16x16x64_bf16 v[72:75], v[36:39], a[248:255], v14
v_mul_f32 v80, s26, v80
v_mul_f32 v81, s26, v81
v_fmac_f32 v80, s26, v82
v_smfmac_f32_16x16x64_bf16 v[72:75], v[40:43], v[152:159], v14
ds_read_b128 v[100:103], v1 offset:32768
v_fmac_f32 v81, s26, v83
v_smfmac_f32_16x16x64_bf16 v[72:75], v[44:47], v[168:175], v14
s_waitcnt lgkmcnt(3)
ds_read_b128 v[104:107], v1 offset:33792
v_exp_f32 v82, v80
v_mfma_f32_16x16x32_bf16 v[60:63], v[124:127], v[118:121], 0
v_exp_f32 v83, v81
v_smfmac_f32_16x16x64_bf16 v[72:75], v[48:51], v[184:191], v14
s_waitcnt vmcnt(4)
v_cvt_pk_bf16_f32 v122, v82, v83
v_smfmac_f32_16x16x64_bf16 v[52:55], v[124:127], v[108:115], v14
s_nop 0
v_mfma_f32_16x16x16_bf16 v[60:63], v[122:123], v[118:119], v[60:63]
v_add_f32 v72, v72, v74
v_add_f32 v73, v73, v75
v_cvt_pk_bf16_f32 v117, v72, v73
s_nop 1
v_smfmac_f32_16x16x32_bf16 v[52:55], v[122:123], v[116:119], v14
v_rcp_f32 v62, v60
v_rcp_f32 v63, v61
v_maximum3_f32 v16, v60, v61, v62
s_nop 1
v_mul_f32 v52, v52, v62
v_mul_f32 v53, v53, v63
v_mul_f32 v54, v54, v62
v_mul_f32 v55, v55, v63
v_cvt_pk_bf16_f32 v52, v52, v53
v_cvt_pk_bf16_f32 v53, v54, v55
ds_write2_b32 v6, v52, v53 offset0:0 offset1:64
v_maximum3_f32 v16, v16, v63, v63
v_cmp_nge_f32 vcc, s31, v16
buffer_store_dword v13, v18, s[8:11], 0 offen
s_cbranch_vccnz Lc_m0_r3_sl
Lc_m0_r3_slr:
v_mfma_f32_16x16x1_4b_f32 v[20:35], v123, v123, 0
s_waitcnt lgkmcnt(0)
s_barrier
ds_read_b64_tr_b16 v[84:85], v8 offset:8192
ds_read_b64_tr_b16 v[86:87], v8 offset:8448
ds_read_b64_tr_b16 v[88:89], v8 offset:8704
ds_read_b64_tr_b16 v[90:91], v8 offset:8960
ds_read_b64_tr_b16 v[92:93], v8 offset:9216
ds_read_b64_tr_b16 v[94:95], v8 offset:9472
ds_read_b64_tr_b16 v[96:97], v8 offset:9728
ds_read_b64_tr_b16 v[98:99], v8 offset:9984
s_waitcnt lgkmcnt(6)
v_smfmac_f32_16x16x64_bf16 v[20:23], v[84:87], v[128:135], v14 abid:1
s_waitcnt lgkmcnt(4)
ds_read_b128 v[36:39], v1 offset:24576
v_smfmac_f32_16x16x64_bf16 v[20:23], v[88:91], v[136:143], v14 abid:1
s_waitcnt lgkmcnt(3)
ds_read_b128 v[40:43], v1 offset:25600
v_smfmac_f32_16x16x64_bf16 v[20:23], v[92:95], v[192:199], v14 abid:1
s_waitcnt lgkmcnt(2)
ds_read_b128 v[44:47], v1 offset:26624
ds_read_b128 v[48:51], v1 offset:27648
v_smfmac_f32_16x16x64_bf16 v[20:23], v[96:99], v[200:207], v14 abid:1
v_smfmac_f32_16x16x64_bf16 v[24:27], v[84:87], v[208:215], v14 abid:1
ds_read_b128 v[128:131], v1 offset:28672
v_smfmac_f32_16x16x64_bf16 v[24:27], v[88:91], v[216:223], v14 abid:1
s_waitcnt lgkmcnt(3)
ds_read_b128 v[132:135], v1 offset:29696
v_cvt_pk_bf16_f32 v52, v20, v21
v_cvt_pk_bf16_f32 v53, v22, v23
v_smfmac_f32_16x16x64_bf16 v[24:27], v[92:95], v[36:43], v14 abid:1
s_waitcnt lgkmcnt(2)
ds_read_b128 v[136:139], v1 offset:30720
v_and_or_b32 v52, v52, -2, s32
v_smfmac_f32_16x16x64_bf16 v[24:27], v[96:99], v[44:51], v14 abid:1
ds_read_b128 v[140:143], v1 offset:31744
buffer_store_dwordx2 v[52:53], v2, s[8:11], s48 offen
v_smfmac_f32_16x16x64_bf16 v[28:31], v[84:87], v[224:231], v14 abid:1
v_smfmac_f32_16x16x64_bf16 v[28:31], v[88:91], v[232:239], v14 abid:1
s_waitcnt lgkmcnt(2)
ds_read_b128 v[36:39], v1 offset:34816
v_cvt_pk_bf16_f32 v54, v24, v25
v_cvt_pk_bf16_f32 v55, v26, v27
v_smfmac_f32_16x16x64_bf16 v[28:31], v[92:95], v[128:135], v14 abid:1
s_waitcnt lgkmcnt(1)
ds_read_b128 v[40:43], v1 offset:35840
v_and_or_b32 v54, v54, -2, s32
v_smfmac_f32_16x16x64_bf16 v[28:31], v[96:99], v[136:143], v14 abid:1
buffer_store_dwordx2 v[54:55], v2, s[8:11], s49 offen
v_smfmac_f32_16x16x64_bf16 v[32:35], v[84:87], v[240:247], v14 abid:1
v_smfmac_f32_16x16x64_bf16 v[32:35], v[88:91], v[248:255], v14 abid:1
v_cvt_pk_bf16_f32 v56, v28, v29
v_cvt_pk_bf16_f32 v57, v30, v31
v_smfmac_f32_16x16x64_bf16 v[32:35], v[92:95], v[100:107], v14 abid:1
s_waitcnt lgkmcnt(0)
v_and_or_b32 v56, v56, -2, s32
v_smfmac_f32_16x16x64_bf16 v[32:35], v[96:99], v[36:43], v14 abid:1
buffer_store_dwordx2 v[56:57], v2, s[8:11], s50 offen
s_nop 5
s_nop 0
v_cvt_pk_bf16_f32 v58, v32, v33
v_cvt_pk_bf16_f32 v59, v34, v35
v_and_or_b32 v58, v58, -2, s32
buffer_store_dwordx2 v[58:59], v2, s[8:11], s51 offen
s_barrier
s_add_u32 s18, s18, 1
s_bfe_u32 s32, s18, 0x10001
s_xor_b32 s48, s48, 0x40000
s_xor_b32 s49, s49, 0x40000
s_xor_b32 s50, s50, 0x40000
s_xor_b32 s51, s51, 0x40000
s_add_u32 s24, s24, 1048576
s_add_u32 s25, s25, 1048576
s_cmp_eq_u32 s18, s40
s_cbranch_scc1 Lc_m0_r3_exit
s_add_u32 s28, s18, 1
v_mov_b32 v13, s28
s_min_u32 s28, s28, 63
s_mul_i32 s36, s28, 1048576
s_lshl_b32 s29, s16, 13
s_add_u32 s36, s36, s29
s_add_u32 s36, s36, 17039360
s_and_b32 s29, s16, 3
s_lshl_b32 s29, s29, 11
s_add_u32 s19, s36, s29
s_xor_b32 s20, s19, 2048
s_xor_b32 s80, s19, 4096
s_xor_b32 s81, s19, 6144
s_nop 9
v_mfma_f32_32x32x1_2b_f32 v[52:83], v123, v123, 0
ds_read_b128 v[84:87], v1 offset:0
ds_read_b128 v[88:91], v1 offset:1024
ds_read_b128 v[92:95], v1 offset:2048
ds_read_b128 v[96:99], v1 offset:3072
ds_read_b128 v[128:131], v1 offset:4096
ds_read_b128 v[132:135], v1 offset:5120
ds_read_b128 v[136:139], v1 offset:6144
ds_read_b128 v[140:143], v1 offset:7168
s_waitcnt lgkmcnt(0)
s_barrier
buffer_load_dwordx4 v[100:103], v0, s[8:11], s24 offen offset:0 sc1
buffer_load_dwordx4 v[104:107], v0, s[8:11], s24 offen offset:1024 sc1
buffer_load_dwordx4 v[108:111], v0, s[8:11], s25 offen offset:0 sc1
s_branch Lc_m0_r3_head
Lc_m0_r3_y0:
s_cmp_eq_u32 s18, s34
s_cbranch_scc1 Lc_m0_r3_y0r
Lc_m0_r3_y0l:
ds_read_b32 v16, v3 offset:0
ds_read_b128 v[20:23], v0 offset:0
ds_read_b128 v[24:27], v0 offset:1024
ds_read_b128 v[28:31], v0 offset:2048
ds_read_b128 v[32:35], v0 offset:3072
s_add_u32 s46, s46, 1
s_waitcnt lgkmcnt(4)
v_cmp_eq_u32 vcc, s27, v16
s_cbranch_vccz Lc_m0_r3_y0k
ds_read_b32 v16, v3 offset:0
ds_read_b128 v[20:23], v0 offset:0
ds_read_b128 v[24:27], v0 offset:1024
ds_read_b128 v[28:31], v0 offset:2048
ds_read_b128 v[32:35], v0 offset:3072
s_add_u32 s46, s46, 1
s_waitcnt lgkmcnt(4)
v_cmp_eq_u32 vcc, s27, v16
s_cbranch_vccz Lc_m0_r3_y0k
s_add_u32 s30, s30, 1
s_cmp_gt_u32 s30, 1000000
s_cbranch_scc1 Lc_m0_abort
s_branch Lc_m0_r3_y0l
Lc_m0_r3_y0k:
v_mov_b32 v52, 0
v_mov_b32 v53, 0
v_mov_b32 v54, 0
v_mov_b32 v55, 0
v_mov_b32 v56, 0
v_mov_b32 v57, 0
v_mov_b32 v58, 0
v_mov_b32 v59, 0
s_waitcnt lgkmcnt(3)
v_smfmac_f32_16x16x64_bf16 v[52:55], v[20:23], v[84:91], v14
v_smfmac_f32_16x16x64_bf16 v[56:59], v[20:23], v[92:99], v14
s_waitcnt lgkmcnt(0)
s_branch Lc_m0_r3_y0r
Lc_m0_r3_y1:
s_cmp_eq_u32 s18, s34
s_cbranch_scc1 Lc_m0_r3_y1r
Lc_m0_r3_y1l:
ds_read_b32 v17, v3 offset:4096
ds_read_b128 v[36:39], v0 offset:4096
ds_read_b128 v[40:43], v0 offset:5120
ds_read_b128 v[44:47], v0 offset:6144
ds_read_b128 v[48:51], v0 offset:7168
s_add_u32 s47, s47, 1
s_waitcnt lgkmcnt(4)
v_cmp_eq_u32 vcc, s27, v17
s_cbranch_vccz Lc_m0_r3_y1k
ds_read_b32 v17, v3 offset:4096
ds_read_b128 v[36:39], v0 offset:4096
ds_read_b128 v[40:43], v0 offset:5120
ds_read_b128 v[44:47], v0 offset:6144
ds_read_b128 v[48:51], v0 offset:7168
s_add_u32 s47, s47, 1
s_waitcnt lgkmcnt(4)
v_cmp_eq_u32 vcc, s27, v17
s_cbranch_vccz Lc_m0_r3_y1k
s_add_u32 s30, s30, 1
s_cmp_gt_u32 s30, 1000000
s_cbranch_scc1 Lc_m0_abort
s_branch Lc_m0_r3_y1l
Lc_m0_r3_y1k:
s_waitcnt lgkmcnt(0)
s_branch Lc_m0_r3_y1r
Lc_m0_r3_sl:
v_max3_f32 v16, v76, v77, v80
v_max_f32 v16, v16, v81
v_lshrrev_b32 v61, 2, v0
ds_write_b32 v61, v16 offset:1792
v_and_b32 v61, 63, v61
v_add_u32 v61, 1024, v61
s_mov_b64 s[38:39], 0
v_cmp_eq_u32 vcc, s27, v20
s_or_b64 s[38:39], s[38:39], vcc
v_cmp_eq_u32 vcc, s27, v21
s_or_b64 s[38:39], s[38:39], vcc
v_cmp_eq_u32 vcc, s27, v22
s_or_b64 s[38:39], s[38:39], vcc
v_cmp_eq_u32 vcc, s27, v23
s_or_b64 s[38:39], s[38:39], vcc
v_cmp_eq_u32 vcc, s27, v24
s_or_b64 s[38:39], s[38:39], vcc
v_cmp_eq_u32 vcc, s27, v25
s_or_b64 s[38:39], s[38:39], vcc
v_cmp_eq_u32 vcc, s27, v26
s_or_b64 s[38:39], s[38:39], vcc
v_cmp_eq_u32 vcc, s27, v27
s_or_b64 s[38:39], s[38:39], vcc
v_cmp_eq_u32 vcc, s27, v28
s_or_b64 s[38:39], s[38:39], vcc
v_cmp_eq_u32 vcc, s27, v29
s_or_b64 s[38:39], s[38:39], vcc
v_cmp_eq_u32 vcc, s27, v30
s_or_b64 s[38:39], s[38:39], vcc
v_cmp_eq_u32 vcc, s27, v31
s_or_b64 s[38:39], s[38:39], vcc
v_cmp_eq_u32 vcc, s27, v32
s_or_b64 s[38:39], s[38:39], vcc
v_cmp_eq_u32 vcc, s27, v33
s_or_b64 s[38:39], s[38:39], vcc
v_cmp_eq_u32 vcc, s27, v34
s_or_b64 s[38:39], s[38:39], vcc
v_cmp_eq_u32 vcc, s27, v35
s_or_b64 s[38:39], s[38:39], vcc
v_cmp_eq_u32 vcc, s27, v36
s_or_b64 s[38:39], s[38:39], vcc
v_cmp_eq_u32 vcc, s27, v37
s_or_b64 s[38:39], s[38:39], vcc
v_cmp_eq_u32 vcc, s27, v38
s_or_b64 s[38:39], s[38:39], vcc
v_cmp_eq_u32 vcc, s27, v39
s_or_b64 s[38:39], s[38:39], vcc
v_cmp_eq_u32 vcc, s27, v40
s_or_b64 s[38:39], s[38:39], vcc
v_cmp_eq_u32 vcc, s27, v41
s_or_b64 s[38:39], s[38:39], vcc
v_cmp_eq_u32 vcc, s27, v42
s_or_b64 s[38:39], s[38:39], vcc
v_cmp_eq_u32 vcc, s27, v43
s_or_b64 s[38:39], s[38:39], vcc
v_cmp_eq_u32 vcc, s27, v44
s_or_b64 s[38:39], s[38:39], vcc
v_cmp_eq_u32 vcc, s27, v45
s_or_b64 s[38:39], s[38:39], vcc
v_cmp_eq_u32 vcc, s27, v46
s_or_b64 s[38:39], s[38:39], vcc
v_cmp_eq_u32 vcc, s27, v47
s_or_b64 s[38:39], s[38:39], vcc
v_cmp_eq_u32 vcc, s27, v48
s_or_b64 s[38:39], s[38:39], vcc
v_cmp_eq_u32 vcc, s27, v49
s_or_b64 s[38:39], s[38:39], vcc
v_cmp_eq_u32 vcc, s27, v50
s_or_b64 s[38:39], s[38:39], vcc
v_cmp_eq_u32 vcc, s27, v51
s_or_b64 s[38:39], s[38:39], vcc
s_cselect_b32 s36, 1, 0
v_mov_b32 v60, s36
ds_write_b32 v123, v60 offset:2060
s_waitcnt lgkmcnt(0)
s_barrier
ds_read_b128 v[84:87], v123 offset:2048
s_waitcnt lgkmcnt(0)
v_or3_b32 v84, v84, v85, v86
v_or_b32 v84, v84, v87
v_cmp_ne_u32 vcc, 0, v84
s_cbranch_vccnz Lc_m0_r3_x
ds_read2_b32 v[84:85], v61 offset0:0 offset1:16
ds_read2_b32 v[86:87], v61 offset0:32 offset1:48
ds_read2_b32 v[88:89], v61 offset0:64 offset1:80
ds_read2_b32 v[90:91], v61 offset0:96 offset1:112
ds_read2_b32 v[92:93], v61 offset0:128 offset1:144
ds_read2_b32 v[94:95], v61 offset0:160 offset1:176
ds_read2_b32 v[96:97], v61 offset0:192 offset1:208
ds_read2_b32 v[98:99], v61 offset0:224 offset1:240
s_waitcnt lgkmcnt(0)
v_max3_f32 v16, v16, v84, v85
v_max3_f32 v16, v16, v86, v87
v_max3_f32 v16, v16, v88, v89
v_max3_f32 v16, v16, v90, v91
v_max3_f32 v16, v16, v92, v93
v_max3_f32 v16, v16, v94, v95
v_max3_f32 v16, v16, v96, v97
v_max3_f32 v16, v16, v98, v99
v_sub_f32 v78, v76, v16
v_sub_f32 v79, v77, v16
v_exp_f32 v78, v78
v_exp_f32 v79, v79
v_sub_f32 v82, v80, v16
v_sub_f32 v83, v81, v16
v_exp_f32 v82, v82
v_exp_f32 v83, v83
v_cvt_pk_bf16_f32 v78, v78, v79
ds_write_b32 v12, v78 offset:0
v_cvt_pk_bf16_f32 v122, v82, v83
v_mov_b32 v52, 0
v_mov_b32 v53, 0
v_mov_b32 v54, 0
v_mov_b32 v55, 0
s_waitcnt lgkmcnt(0)
s_barrier
ds_read_b128 v[124:127], v0 offset:0
s_waitcnt lgkmcnt(0)
v_mfma_f32_16x16x32_bf16 v[60:63], v[124:127], v[118:121], 0
v_smfmac_f32_16x16x64_bf16 v[52:55], v[124:127], v[108:115], v14
v_mfma_f32_16x16x16_bf16 v[60:63], v[122:123], v[118:119], v[60:63]
v_smfmac_f32_16x16x32_bf16 v[52:55], v[122:123], v[116:119], v14
s_nop 2
s_nop 0
v_rcp_f32 v62, v60
v_rcp_f32 v63, v61
v_maximum3_f32 v16, v60, v61, v62
v_mul_f32 v52, v52, v62
v_mul_f32 v53, v53, v63
v_mul_f32 v54, v54, v62
v_mul_f32 v55, v55, v63
v_cvt_pk_bf16_f32 v52, v52, v53
v_cvt_pk_bf16_f32 v53, v54, v55
ds_write2_b32 v6, v52, v53 offset0:0 offset1:64
s_branch Lc_m0_r3_slr
Lc_m0_r3_x:
s_add_u32 s44, s44, 1
s_add_u32 s30, s30, 1
s_cmp_gt_u32 s30, 1000000
s_cbranch_scc1 Lc_m0_abort
s_waitcnt vmcnt(0) lgkmcnt(0)
s_barrier
buffer_load_dwordx4 v[100:103], v0, s[8:11], s24 offen offset:0 sc1
buffer_load_dwordx4 v[104:107], v0, s[8:11], s24 offen offset:1024 sc1
buffer_load_dwordx4 v[108:111], v0, s[8:11], s25 offen offset:0 sc1
v_mfma_f32_32x32x1_2b_f32 v[52:83], v123, v123, 0
ds_read_b128 v[84:87], v1 offset:0
ds_read_b128 v[88:91], v1 offset:1024
ds_read_b128 v[92:95], v1 offset:2048
ds_read_b128 v[96:99], v1 offset:3072
ds_read_b128 v[128:131], v1 offset:4096
ds_read_b128 v[132:135], v1 offset:5120
ds_read_b128 v[136:139], v1 offset:6144
ds_read_b128 v[140:143], v1 offset:7168
s_waitcnt vmcnt(0) lgkmcnt(0)
s_branch Lc_m0_r3_head
Lc_m0_r3_exit:
s_branch Lc_m0_done
Lc_m0_abort:
s_branch Lc_abort
Lc_m0_done:
s_branch Lc_done
Lc_m1:
s_cmp_eq_u32 s17, 1
s_cbranch_scc1 Lc_m1_r1_entry
s_cmp_eq_u32 s17, 2
s_cbranch_scc1 Lc_m1_r2_entry
s_cmp_eq_u32 s17, 3
s_cbranch_scc1 Lc_m1_r3_entry
s_branch Lc_m1_r0_entry
Lc_m1_r0_entry:
.p2align 6
s_nop 0
s_nop 0
s_nop 0
s_nop 0
s_nop 0
s_nop 0
s_nop 0
s_nop 0
s_nop 0
s_nop 0
s_nop 0
s_nop 0
s_nop 0
s_nop 0
s_nop 0
Lc_m1_r0_head:
s_waitcnt vmcnt(7)
s_barrier
ds_read_b32 v16, v4 offset:0
ds_read_b128 v[20:23], v0 offset:0
ds_read_b128 v[24:27], v0 offset:1024
ds_read_b128 v[28:31], v0 offset:2048
ds_read_b128 v[32:35], v0 offset:3072
buffer_load_dwordx4 v[112:115], v0, s[8:11], s25 offen offset:1024 sc1
s_waitcnt lgkmcnt(4)
v_cmp_eq_u32 vcc, s27, v16
Lc_m1_r0_q0:
s_waitcnt lgkmcnt(3)
v_smfmac_f32_16x16x64_bf16 v[52:55], v[20:23], v[84:91], v14
v_smfmac_f32_16x16x64_bf16 v[56:59], v[20:23], v[92:99], v14
s_waitcnt lgkmcnt(2)
s_cbranch_vccnz Lc_m1_r0_y0
Lc_m1_r0_y0r:
v_smfmac_f32_16x16x64_bf16 v[52:55], v[24:27], v[128:135], v14
ds_read_b128 v[128:131], v1 offset:8192
v_smfmac_f32_16x16x64_bf16 v[56:59], v[24:27], v[136:143], v14
s_waitcnt lgkmcnt(2)
ds_read_b128 v[132:135], v1 offset:9216
v_smfmac_f32_16x16x64_bf16 v[52:55], v[28:31], a[0:7], v14
s_barrier
ds_read_b32 v17, v4 offset:4096
v_smfmac_f32_16x16x64_bf16 v[56:59], v[28:31], a[8:15], v14
s_waitcnt lgkmcnt(3)
ds_read_b128 v[36:39], v0 offset:4096
v_smfmac_f32_16x16x64_bf16 v[52:55], v[32:35], a[16:23], v14
ds_read_b128 v[40:43], v0 offset:5120
v_smfmac_f32_16x16x64_bf16 v[56:59], v[32:35], a[24:31], v14
s_waitcnt lgkmcnt(2)
v_cmp_eq_u32 vcc, s27, v17
v_smfmac_f32_16x16x64_bf16 v[60:63], v[20:23], a[80:87], v14
ds_read_b128 v[44:47], v0 offset:6144
v_smfmac_f32_16x16x64_bf16 v[60:63], v[24:27], a[96:103], v14
s_waitcnt lgkmcnt(2)
s_cbranch_vccnz Lc_m1_r0_y1
Lc_m1_r0_y1r:
ds_read_b128 v[48:51], v0 offset:7168
ds_read_b128 v[136:139], v1 offset:10240
v_smfmac_f32_16x16x64_bf16 v[52:55], v[36:39], a[32:39], v14
s_waitcnt lgkmcnt(3)
ds_read_b128 v[140:143], v1 offset:11264
v_mov_b32 v118, v119
v_smfmac_f32_16x16x64_bf16 v[52:55], v[40:43], a[48:55], v14
s_waitcnt lgkmcnt(3)
buffer_store_dword v13, v3, s[8:11], s35 offen sc1
v_mov_b32 v118, v119
v_smfmac_f32_16x16x64_bf16 v[52:55], v[44:47], v[128:135], v14
s_waitcnt lgkmcnt(2)
ds_read_b128 v[128:131], v1 offset:12288
v_mov_b32 v118, v119
v_smfmac_f32_16x16x64_bf16 v[52:55], v[48:51], a[64:71], v14
ds_read_b128 v[132:135], v1 offset:13312
v_mov_b32 v118, v119
v_smfmac_f32_16x16x64_bf16 v[56:59], v[36:39], a[40:47], v14
buffer_store_dword v15, v3, s[8:11], s33 offen sc1
v_mov_b32 v118, v119
v_smfmac_f32_16x16x64_bf16 v[56:59], v[40:43], a[56:63], v14
s_waitcnt lgkmcnt(2)
v_add_f32 v52, v52, v54
v_smfmac_f32_16x16x64_bf16 v[56:59], v[44:47], v[136:143], v14
ds_read_b128 v[136:139], v1 offset:16384
v_add_f32 v53, v53, v55
v_smfmac_f32_16x16x64_bf16 v[56:59], v[48:51], a[72:79], v14
ds_read_b128 v[140:143], v1 offset:17408
v_cvt_pk_bf16_f32 v54, v52, v53
v_smfmac_f32_16x16x64_bf16 v[60:63], v[28:31], a[112:119], v14
s_waitcnt lgkmcnt(2)
ds_write2_b32 v10, v54, v54 offset0:0 offset1:1
v_mov_b32 v118, v119
v_smfmac_f32_16x16x64_bf16 v[60:63], v[32:35], v[128:135], v14
ds_read_b128 v[128:131], v1 offset:14336
v_add_f32 v56, v56, v58
v_smfmac_f32_16x16x64_bf16 v[60:63], v[36:39], a[128:135], v14
v_add_f32 v57, v57, v59
v_smfmac_f32_16x16x64_bf16 v[60:63], v[40:43], a[144:151], v14
ds_read_b128 v[132:135], v1 offset:15360
v_cvt_pk_bf16_f32 v58, v56, v57
v_smfmac_f32_16x16x64_bf16 v[60:63], v[44:47], a[160:167], v14
s_waitcnt lgkmcnt(3)
ds_write2_b32 v10, v58, v58 offset0:8 offset1:9
v_mov_b32 v118, v119
v_smfmac_f32_16x16x64_bf16 v[60:63], v[48:51], v[136:143], v14
ds_read_b128 v[136:139], v1 offset:18432
v_mov_b32 v118, v119
v_smfmac_f32_16x16x64_bf16 v[64:67], v[20:23], a[88:95], v14
ds_read_b128 v[140:143], v1 offset:19456
v_mov_b32 v118, v119
v_smfmac_f32_16x16x64_bf16 v[64:67], v[24:27], a[104:111], v14
v_add_f32 v60, v60, v62
v_smfmac_f32_16x16x64_bf16 v[64:67], v[28:31], a[120:127], v14
s_waitcnt vmcnt(2) lgkmcnt(2)
s_barrier
ds_read_b64_tr_b16 v[84:85], v11 offset:8192
ds_read_b64_tr_b16 v[86:87], v11 offset:8328
v_add_f32 v61, v61, v63
v_smfmac_f32_16x16x64_bf16 v[64:67], v[32:35], v[128:135], v14
ds_read_b64_tr_b16 v[88:89], v11 offset:8736
ds_read_b64_tr_b16 v[90:91], v11 offset:8872
v_cvt_pk_bf16_f32 v62, v60, v61
v_smfmac_f32_16x16x64_bf16 v[64:67], v[36:39], a[136:143], v14
ds_read_b64_tr_b16 v[92:93], v11 offset:10496
ds_read_b64_tr_b16 v[94:95], v11 offset:10632
v_mov_b32 v52, 0
v_smfmac_f32_16x16x64_bf16 v[64:67], v[40:43], a[152:159], v14
ds_read_b64_tr_b16 v[96:97], v11 offset:11040
ds_read_b64_tr_b16 v[98:99], v11 offset:11176
v_mov_b32 v53, 0
v_smfmac_f32_16x16x64_bf16 v[64:67], v[44:47], a[168:175], v14
s_waitcnt lgkmcnt(8)
v_mov_b32 v54, 0
v_smfmac_f32_16x16x64_bf16 v[64:67], v[48:51], v[136:143], v14
s_waitcnt lgkmcnt(4)
v_mov_b32 v55, 0
v_smfmac_f32_16x16x64_bf16 v[76:79], v[100:103], v[84:91], v14
s_waitcnt lgkmcnt(0)
v_smfmac_f32_16x16x64_bf16 v[76:79], v[104:107], v[92:99], v14
v_add_f32 v64, v64, v66
v_add_f32 v65, v65, v67
v_cvt_pk_bf16_f32 v63, v64, v65
v_smfmac_f32_16x16x64_bf16 v[68:71], v[20:23], a[176:183], v14
ds_write_b64 v7, v[62:63] offset:12800
v_smfmac_f32_16x16x64_bf16 v[68:71], v[24:27], a[192:199], v14
v_add_f32 v76, v76, v78
v_add_f32 v77, v77, v79
v_smfmac_f32_16x16x64_bf16 v[68:71], v[28:31], a[208:215], v14
ds_read_b128 v[136:139], v1 offset:22528
v_exp_f32 v78, v76
v_smfmac_f32_16x16x64_bf16 v[68:71], v[32:35], a[224:231], v14
ds_read_b128 v[140:143], v1 offset:23552
v_exp_f32 v79, v77
v_smfmac_f32_16x16x64_bf16 v[68:71], v[36:39], a[240:247], v14
s_waitcnt lgkmcnt(2)
s_barrier
ds_read_b64_tr_b16 v[100:101], v9 offset:12800
v_cvt_pk_bf16_f32 v78, v78, v79
v_smfmac_f32_16x16x64_bf16 v[68:71], v[40:43], v[144:151], v14
ds_write_b32 v12, v78 offset:0
ds_read_b64_tr_b16 v[102:103], v9 offset:13312
v_smfmac_f32_16x16x64_bf16 v[68:71], v[44:47], v[160:167], v14
ds_read_b64_tr_b16 v[104:105], v9 offset:13824
v_smfmac_f32_16x16x64_bf16 v[68:71], v[48:51], v[176:183], v14
ds_read_b64_tr_b16 v[106:107], v9 offset:14336
v_smfmac_f32_16x16x64_bf16 v[72:75], v[20:23], a[184:191], v14
v_smfmac_f32_16x16x64_bf16 v[72:75], v[24:27], a[200:207], v14
s_waitcnt lgkmcnt(3)
s_barrier
ds_read_b128 v[124:127], v0 offset:0
v_smfmac_f32_16x16x64_bf16 v[72:75], v[28:31], a[216:223], v14
s_waitcnt lgkmcnt(3)
ds_read_b128 v[128:131], v1 offset:20480
v_add_f32 v68, v68, v70
v_smfmac_f32_16x16x64_bf16 v[80:83], v[100:103], v[84:91], v14
s_waitcnt lgkmcnt(2)
v_add_f32 v69, v69, v71
v_smfmac_f32_16x16x64_bf16 v[80:83], v[104:107], v[92:99], v14
v_cvt_pk_bf16_f32 v116, v68, v69
v_smfmac_f32_16x16x64_bf16 v[72:75], v[32:35], a[232:239], v14
ds_read_b128 v[132:135], v1 offset:21504
v_smfmac_f32_16x16x64_bf16 v[72:75], v[36:39], a[248:255], v14
v_mul_f32 v80, s26, v80
v_mul_f32 v81, s26, v81
v_fmac_f32 v80, s26, v82
v_smfmac_f32_16x16x64_bf16 v[72:75], v[40:43], v[152:159], v14
ds_read_b128 v[100:103], v1 offset:32768
v_fmac_f32 v81, s26, v83
v_smfmac_f32_16x16x64_bf16 v[72:75], v[44:47], v[168:175], v14
s_waitcnt lgkmcnt(3)
ds_read_b128 v[104:107], v1 offset:33792
v_exp_f32 v82, v80
v_mfma_f32_16x16x32_bf16 v[60:63], v[124:127], v[118:121], 0
v_exp_f32 v83, v81
v_smfmac_f32_16x16x64_bf16 v[72:75], v[48:51], v[184:191], v14
v_cvt_pk_bf16_f32 v122, v82, v83
v_smfmac_f32_16x16x64_bf16 v[52:55], v[124:127], v[108:115], v14
s_nop 0
v_mfma_f32_16x16x16_bf16 v[60:63], v[122:123], v[118:119], v[60:63]
v_add_f32 v72, v72, v74
v_add_f32 v73, v73, v75
v_cvt_pk_bf16_f32 v117, v72, v73
s_nop 1
v_smfmac_f32_16x16x32_bf16 v[52:55], v[122:123], v[116:119], v14
v_rcp_f32 v62, v60
v_rcp_f32 v63, v61
v_maximum3_f32 v16, v60, v61, v62
s_nop 1
v_mul_f32 v52, v52, v62
v_mul_f32 v53, v53, v63
v_mul_f32 v54, v54, v62
v_mul_f32 v55, v55, v63
v_cvt_pk_bf16_f32 v52, v52, v53
v_cvt_pk_bf16_f32 v53, v54, v55
ds_write2_b32 v6, v52, v53 offset0:0 offset1:64
v_maximum3_f32 v16, v16, v63, v63
v_cmp_nge_f32 vcc, s31, v16
s_cbranch_vccnz Lc_m1_r0_sl
Lc_m1_r0_slr:
v_mfma_f32_16x16x1_4b_f32 v[20:35], v123, v123, 0
s_waitcnt lgkmcnt(0)
s_barrier
ds_read_b64_tr_b16 v[84:85], v8 offset:8192
ds_read_b64_tr_b16 v[86:87], v8 offset:8448
ds_read_b64_tr_b16 v[88:89], v8 offset:8704
ds_read_b64_tr_b16 v[90:91], v8 offset:8960
ds_read_b64_tr_b16 v[92:93], v8 offset:9216
ds_read_b64_tr_b16 v[94:95], v8 offset:9472
ds_read_b64_tr_b16 v[96:97], v8 offset:9728
ds_read_b64_tr_b16 v[98:99], v8 offset:9984
s_waitcnt lgkmcnt(6)
v_smfmac_f32_16x16x64_bf16 v[20:23], v[84:87], v[128:135], v14 abid:1
s_waitcnt lgkmcnt(4)
ds_read_b128 v[36:39], v1 offset:24576
v_smfmac_f32_16x16x64_bf16 v[20:23], v[88:91], v[136:143], v14 abid:1
s_waitcnt lgkmcnt(3)
ds_read_b128 v[40:43], v1 offset:25600
v_smfmac_f32_16x16x64_bf16 v[20:23], v[92:95], v[192:199], v14 abid:1
s_waitcnt lgkmcnt(2)
ds_read_b128 v[44:47], v1 offset:26624
ds_read_b128 v[48:51], v1 offset:27648
v_smfmac_f32_16x16x64_bf16 v[20:23], v[96:99], v[200:207], v14 abid:1
v_smfmac_f32_16x16x64_bf16 v[24:27], v[84:87], v[208:215], v14 abid:1
ds_read_b128 v[128:131], v1 offset:28672
v_smfmac_f32_16x16x64_bf16 v[24:27], v[88:91], v[216:223], v14 abid:1
s_waitcnt lgkmcnt(3)
ds_read_b128 v[132:135], v1 offset:29696
v_cvt_pk_bf16_f32 v52, v20, v21
v_cvt_pk_bf16_f32 v53, v22, v23
v_smfmac_f32_16x16x64_bf16 v[24:27], v[92:95], v[36:43], v14 abid:1
s_waitcnt lgkmcnt(2)
ds_read_b128 v[136:139], v1 offset:30720
v_and_or_b32 v52, v52, -2, s32
v_smfmac_f32_16x16x64_bf16 v[24:27], v[96:99], v[44:51], v14 abid:1
ds_read_b128 v[140:143], v1 offset:31744
buffer_store_dwordx2 v[52:53], v2, s[8:11], s48 offen sc1
v_smfmac_f32_16x16x64_bf16 v[28:31], v[84:87], v[224:231], v14 abid:1
v_smfmac_f32_16x16x64_bf16 v[28:31], v[88:91], v[232:239], v14 abid:1
s_waitcnt lgkmcnt(2)
ds_read_b128 v[36:39], v1 offset:34816
v_cvt_pk_bf16_f32 v54, v24, v25
v_cvt_pk_bf16_f32 v55, v26, v27
v_smfmac_f32_16x16x64_bf16 v[28:31], v[92:95], v[128:135], v14 abid:1
s_waitcnt lgkmcnt(1)
ds_read_b128 v[40:43], v1 offset:35840
v_and_or_b32 v54, v54, -2, s32
v_smfmac_f32_16x16x64_bf16 v[28:31], v[96:99], v[136:143], v14 abid:1
buffer_store_dwordx2 v[54:55], v2, s[8:11], s49 offen sc1
v_smfmac_f32_16x16x64_bf16 v[32:35], v[84:87], v[240:247], v14 abid:1
v_smfmac_f32_16x16x64_bf16 v[32:35], v[88:91], v[248:255], v14 abid:1
v_cvt_pk_bf16_f32 v56, v28, v29
v_cvt_pk_bf16_f32 v57, v30, v31
v_smfmac_f32_16x16x64_bf16 v[32:35], v[92:95], v[100:107], v14 abid:1
s_waitcnt lgkmcnt(0)
ds_read_b128 v[68:71], v0 offset:14848
v_and_or_b32 v56, v56, -2, s32
v_smfmac_f32_16x16x64_bf16 v[32:35], v[96:99], v[36:43], v14 abid:1
buffer_store_dwordx2 v[56:57], v2, s[8:11], s50 offen sc1
s_nop 5
s_nop 0
v_cvt_pk_bf16_f32 v58, v32, v33
v_cvt_pk_bf16_f32 v59, v34, v35
v_and_or_b32 v58, v58, -2, s32
buffer_store_dwordx2 v[58:59], v2, s[8:11], s51 offen sc1
s_waitcnt lgkmcnt(0)
s_barrier
buffer_load_dwordx4 v[20:23], v0, s[8:11], s21 offen offset:0 sc1
buffer_load_dwordx4 v[24:27], v0, s[8:11], s21 offen offset:1024 sc1
buffer_load_dwordx4 v[28:31], v0, s[8:11], s21 offen offset:2048 sc1
buffer_load_dwordx4 v[32:35], v0, s[8:11], s21 offen offset:3072 sc1
ds_read_b128 v[84:87], v1 offset:0
ds_read_b128 v[88:91], v1 offset:1024
ds_read_b128 v[92:95], v1 offset:2048
ds_read_b128 v[96:99], v1 offset:3072
ds_read_b128 v[128:131], v1 offset:4096
ds_read_b128 v[132:135], v1 offset:5120
ds_read_b128 v[136:139], v1 offset:6144
ds_read_b128 v[140:143], v1 offset:7168
s_waitcnt vmcnt(3)
v_mfma_f32_16x16x32_bf16 v[72:75], v[68:71], v[20:23], 0
v_bitop3_b32 v16, v20, v22, s32 bitop3:0x7e
s_waitcnt vmcnt(2)
v_mfma_f32_16x16x32_bf16 v[72:75], v[68:71], v[24:27], v[72:75]
v_bitop3_b32 v17, v24, v26, s32 bitop3:0x7e
v_or_b32 v16, v16, v17
s_waitcnt vmcnt(1)
v_mfma_f32_16x16x32_bf16 v[72:75], v[68:71], v[28:31], v[72:75]
v_bitop3_b32 v17, v28, v30, s32 bitop3:0x7e
v_or_b32 v16, v16, v17
s_waitcnt vmcnt(0)
v_mfma_f32_16x16x32_bf16 v[72:75], v[68:71], v[32:35], v[72:75]
v_bitop3_b32 v17, v32, v34, s32 bitop3:0x7e
v_bitop3_b32 v16, v16, v17, 1 bitop3:0xa8
v_cmp_ne_u32 vcc, 0, v16
s_nop 3
v_add_f32_dpp v74, v72, v72 row_ror:8 row_mask:0xf bank_mask:0xf
v_add_f32_dpp v75, v73, v73 row_ror:8 row_mask:0xf bank_mask:0xf
v_cvt_pk_bf16_f32 v13, v74, v75
s_cbranch_vccnz Lc_m1_r0_r1
buffer_store_dword v13, v3, s[8:11], s23 offen sc1
Lc_m1_r0_pu3:
v_mfma_f32_32x32x1_2b_f32 v[52:83], v123, v123, 0
s_add_u32 s18, s18, 1
s_bfe_u32 s32, s18, 0x10001
s_xor_b32 s48, s48, 0x40000
s_xor_b32 s49, s49, 0x40000
s_xor_b32 s50, s50, 0x40000
s_xor_b32 s51, s51, 0x40000
s_xor_b32 s21, s21, 0x40000
s_add_u32 s35, s35, 8192
s_add_u32 s24, s24, 1048576
s_add_u32 s25, s25, 1048576
s_cmp_eq_u32 s18, s40
s_cbranch_scc0 Lc_m1_r0_more
buffer_store_dword v13, v3, s[8:11], s35 offen sc1
s_branch Lc_m1_r0_exit
Lc_m1_r0_more:
s_add_u32 s22, s23, 0
s_add_u32 s23, s23, 0x2000
s_and_b32 s23, s23, 1081343
s_xor_b32 s33, s23, 0x4000
s_nop 15
s_nop 15
s_nop 0
buffer_load_dwordx4 v0, s[8:11], s22 offen offset:0 sc1 lds
buffer_load_dwordx4 v0, s[8:11], s22 offen offset:1024 sc1 lds
buffer_load_dwordx4 v0, s[8:11], s22 offen offset:2048 sc1 lds
buffer_load_dwordx4 v0, s[8:11], s22 offen offset:3072 sc1 lds
s_barrier
buffer_load_dwordx4 v[100:103], v0, s[8:11], s24 offen offset:0 sc1
buffer_load_dwordx4 v[104:107], v0, s[8:11], s24 offen offset:1024 sc1
buffer_load_dwordx4 v[108:111], v0, s[8:11], s25 offen offset:0 sc1
s_nop 3
buffer_load_dwordx4 v0, s[8:11], s22 offen offset:0 sc1 lds
buffer_load_dwordx4 v0, s[8:11], s22 offen offset:1024 sc1 lds
buffer_load_dwordx4 v0, s[8:11], s22 offen offset:2048 sc1 lds
buffer_load_dwordx4 v0, s[8:11], s22 offen offset:3072 sc1 lds
s_waitcnt lgkmcnt(0)
s_branch Lc_m1_r0_head
Lc_m1_r0_y0:
s_cmp_eq_u32 s18, s34
s_cbranch_scc1 Lc_m1_r0_y0r
Lc_m1_r0_y0l:
ds_read_b32 v16, v4 offset:0
ds_read_b128 v[20:23], v0 offset:0
ds_read_b128 v[24:27], v0 offset:1024
ds_read_b128 v[28:31], v0 offset:2048
ds_read_b128 v[32:35], v0 offset:3072
buffer_load_dwordx4 v0, s[8:11], s22 offen offset:0 sc1 lds
buffer_load_dwordx4 v0, s[8:11], s22 offen offset:1024 sc1 lds
buffer_load_dwordx4 v0, s[8:11], s22 offen offset:2048 sc1 lds
buffer_load_dwordx4 v0, s[8:11], s22 offen offset:3072 sc1 lds
s_waitcnt vmcnt(16)
s_add_u32 s46, s46, 1
s_waitcnt lgkmcnt(4)
v_cmp_eq_u32 vcc, s27, v16
s_cbranch_vccz Lc_m1_r0_y0k
ds_read_b32 v16, v4 offset:0
ds_read_b128 v[20:23], v0 offset:0
ds_read_b128 v[24:27], v0 offset:1024
ds_read_b128 v[28:31], v0 offset:2048
ds_read_b128 v[32:35], v0 offset:3072
s_add_u32 s46, s46, 1
s_waitcnt lgkmcnt(4)
v_cmp_eq_u32 vcc, s27, v16
s_cbranch_vccz Lc_m1_r0_y0k
s_add_u32 s30, s30, 1
s_cmp_gt_u32 s30, 1000000
s_cbranch_scc1 Lc_m1_abort
s_branch Lc_m1_r0_y0l
Lc_m1_r0_y0k:
v_mov_b32 v52, 0
v_mov_b32 v53, 0
v_mov_b32 v54, 0
v_mov_b32 v55, 0
v_mov_b32 v56, 0
v_mov_b32 v57, 0
v_mov_b32 v58, 0
v_mov_b32 v59, 0
s_waitcnt lgkmcnt(3)
v_smfmac_f32_16x16x64_bf16 v[52:55], v[20:23], v[84:91], v14
v_smfmac_f32_16x16x64_bf16 v[56:59], v[20:23], v[92:99], v14
s_waitcnt lgkmcnt(0)
s_branch Lc_m1_r0_y0r
Lc_m1_r0_y1:
s_cmp_eq_u32 s18, s34
s_cbranch_scc1 Lc_m1_r0_y1r
Lc_m1_r0_y1l:
ds_read_b32 v17, v4 offset:4096
ds_read_b128 v[36:39], v0 offset:4096
ds_read_b128 v[40:43], v0 offset:5120
ds_read_b128 v[44:47], v0 offset:6144
ds_read_b128 v[48:51], v0 offset:7168
s_add_u32 s47, s47, 1
s_waitcnt lgkmcnt(4)
v_cmp_eq_u32 vcc, s27, v17
s_cbranch_vccz Lc_m1_r0_y1k
ds_read_b32 v17, v4 offset:4096
ds_read_b128 v[36:39], v0 offset:4096
ds_read_b128 v[40:43], v0 offset:5120
ds_read_b128 v[44:47], v0 offset:6144
ds_read_b128 v[48:51], v0 offset:7168
s_add_u32 s47, s47, 1
s_waitcnt lgkmcnt(4)
v_cmp_eq_u32 vcc, s27, v17
s_cbranch_vccz Lc_m1_r0_y1k
s_add_u32 s30, s30, 1
s_cmp_gt_u32 s30, 1000000
s_cbranch_scc1 Lc_m1_abort
s_branch Lc_m1_r0_y1l
Lc_m1_r0_y1k:
s_waitcnt lgkmcnt(0)
s_branch Lc_m1_r0_y1r
Lc_m1_r0_r1:
buffer_load_dwordx4 v[20:23], v0, s[8:11], s21 offen offset:0 sc1
buffer_load_dwordx4 v[24:27], v0, s[8:11], s21 offen offset:1024 sc1
buffer_load_dwordx4 v[28:31], v0, s[8:11], s21 offen offset:2048 sc1
buffer_load_dwordx4 v[32:35], v0, s[8:11], s21 offen offset:3072 sc1
s_nop 15
s_nop 11
Lc_m1_r0_r2:
buffer_load_dwordx4 v[36:39], v0, s[8:11], s21 offen offset:0 sc1
buffer_load_dwordx4 v[40:43], v0, s[8:11], s21 offen offset:1024 sc1
buffer_load_dwordx4 v[44:47], v0, s[8:11], s21 offen offset:2048 sc1
buffer_load_dwordx4 v[48:51], v0, s[8:11], s21 offen offset:3072 sc1
s_add_u32 s45, s45, 1
s_waitcnt vmcnt(7)
v_mfma_f32_16x16x32_bf16 v[72:75], v[68:71], v[20:23], 0
v_bitop3_b32 v16, v20, v22, s32 bitop3:0x7e
s_waitcnt vmcnt(6)
v_mfma_f32_16x16x32_bf16 v[72:75], v[68:71], v[24:27], v[72:75]
v_bitop3_b32 v17, v24, v26, s32 bitop3:0x7e
v_or_b32 v16, v16, v17
s_waitcnt vmcnt(5)
v_mfma_f32_16x16x32_bf16 v[72:75], v[68:71], v[28:31], v[72:75]
v_bitop3_b32 v17, v28, v30, s32 bitop3:0x7e
v_or_b32 v16, v16, v17
s_waitcnt vmcnt(4)
v_mfma_f32_16x16x32_bf16 v[72:75], v[68:71], v[32:35], v[72:75]
v_bitop3_b32 v17, v32, v34, s32 bitop3:0x7e
v_bitop3_b32 v16, v16, v17, 1 bitop3:0xa8
v_cmp_ne_u32 vcc, 0, v16
s_nop 3
v_add_f32_dpp v74, v72, v72 row_ror:8 row_mask:0xf bank_mask:0xf
v_add_f32_dpp v75, v73, v73 row_ror:8 row_mask:0xf bank_mask:0xf
v_cvt_pk_bf16_f32 v13, v74, v75
s_cbranch_vccz Lc_m1_r0_pu2
Lc_m1_r0_r3:
buffer_load_dwordx4 v[20:23], v0, s[8:11], s21 offen offset:0 sc1
buffer_load_dwordx4 v[24:27], v0, s[8:11], s21 offen offset:1024 sc1
buffer_load_dwordx4 v[28:31], v0, s[8:11], s21 offen offset:2048 sc1
buffer_load_dwordx4 v[32:35], v0, s[8:11], s21 offen offset:3072 sc1
s_add_u32 s45, s45, 1
s_waitcnt vmcnt(7)
v_mfma_f32_16x16x32_bf16 v[72:75], v[68:71], v[36:39], 0
v_bitop3_b32 v16, v36, v38, s32 bitop3:0x7e
s_waitcnt vmcnt(6)
v_mfma_f32_16x16x32_bf16 v[72:75], v[68:71], v[40:43], v[72:75]
v_bitop3_b32 v17, v40, v42, s32 bitop3:0x7e
v_or_b32 v16, v16, v17
s_waitcnt vmcnt(5)
v_mfma_f32_16x16x32_bf16 v[72:75], v[68:71], v[44:47], v[72:75]
v_bitop3_b32 v17, v44, v46, s32 bitop3:0x7e
v_or_b32 v16, v16, v17
s_waitcnt vmcnt(4)
v_mfma_f32_16x16x32_bf16 v[72:75], v[68:71], v[48:51], v[72:75]
v_bitop3_b32 v17, v48, v50, s32 bitop3:0x7e
v_bitop3_b32 v16, v16, v17, 1 bitop3:0xa8
v_cmp_ne_u32 vcc, 0, v16
s_nop 3
v_add_f32_dpp v74, v72, v72 row_ror:8 row_mask:0xf bank_mask:0xf
v_add_f32_dpp v75, v73, v73 row_ror:8 row_mask:0xf bank_mask:0xf
v_cvt_pk_bf16_f32 v13, v74, v75
s_cbranch_vccz Lc_m1_r0_pu2
s_add_u32 s30, s30, 1
s_cmp_gt_u32 s30, 1000000
s_cbranch_scc1 Lc_m1_abort
s_branch Lc_m1_r0_r2
Lc_m1_r0_pu2:
buffer_store_dword v13, v3, s[8:11], s23 offen sc1
s_branch Lc_m1_r0_pu3
Lc_m1_r0_sl:
v_max3_f32 v16, v76, v77, v80
v_max_f32 v16, v16, v81
v_lshrrev_b32 v61, 2, v0
ds_write_b32 v61, v16 offset:1024
v_and_b32 v61, 63, v61
v_add_u32 v61, 1024, v61
s_mov_b64 s[38:39], 0
v_cmp_eq_u32 vcc, s27, v20
s_or_b64 s[38:39], s[38:39], vcc
v_cmp_eq_u32 vcc, s27, v21
s_or_b64 s[38:39], s[38:39], vcc
v_cmp_eq_u32 vcc, s27, v22
s_or_b64 s[38:39], s[38:39], vcc
v_cmp_eq_u32 vcc, s27, v23
s_or_b64 s[38:39], s[38:39], vcc
v_cmp_eq_u32 vcc, s27, v24
s_or_b64 s[38:39], s[38:39], vcc
v_cmp_eq_u32 vcc, s27, v25
s_or_b64 s[38:39], s[38:39], vcc
v_cmp_eq_u32 vcc, s27, v26
s_or_b64 s[38:39], s[38:39], vcc
v_cmp_eq_u32 vcc, s27, v27
s_or_b64 s[38:39], s[38:39], vcc
v_cmp_eq_u32 vcc, s27, v28
s_or_b64 s[38:39], s[38:39], vcc
v_cmp_eq_u32 vcc, s27, v29
s_or_b64 s[38:39], s[38:39], vcc
v_cmp_eq_u32 vcc, s27, v30
s_or_b64 s[38:39], s[38:39], vcc
v_cmp_eq_u32 vcc, s27, v31
s_or_b64 s[38:39], s[38:39], vcc
v_cmp_eq_u32 vcc, s27, v32
s_or_b64 s[38:39], s[38:39], vcc
v_cmp_eq_u32 vcc, s27, v33
s_or_b64 s[38:39], s[38:39], vcc
v_cmp_eq_u32 vcc, s27, v34
s_or_b64 s[38:39], s[38:39], vcc
v_cmp_eq_u32 vcc, s27, v35
s_or_b64 s[38:39], s[38:39], vcc
v_cmp_eq_u32 vcc, s27, v36
s_or_b64 s[38:39], s[38:39], vcc
v_cmp_eq_u32 vcc, s27, v37
s_or_b64 s[38:39], s[38:39], vcc
v_cmp_eq_u32 vcc, s27, v38
s_or_b64 s[38:39], s[38:39], vcc
v_cmp_eq_u32 vcc, s27, v39
s_or_b64 s[38:39], s[38:39], vcc
v_cmp_eq_u32 vcc, s27, v40
s_or_b64 s[38:39], s[38:39], vcc
v_cmp_eq_u32 vcc, s27, v41
s_or_b64 s[38:39], s[38:39], vcc
v_cmp_eq_u32 vcc, s27, v42
s_or_b64 s[38:39], s[38:39], vcc
v_cmp_eq_u32 vcc, s27, v43
s_or_b64 s[38:39], s[38:39], vcc
v_cmp_eq_u32 vcc, s27, v44
s_or_b64 s[38:39], s[38:39], vcc
v_cmp_eq_u32 vcc, s27, v45
s_or_b64 s[38:39], s[38:39], vcc
v_cmp_eq_u32 vcc, s27, v46
s_or_b64 s[38:39], s[38:39], vcc
v_cmp_eq_u32 vcc, s27, v47
s_or_b64 s[38:39], s[38:39], vcc
v_cmp_eq_u32 vcc, s27, v48
s_or_b64 s[38:39], s[38:39], vcc
v_cmp_eq_u32 vcc, s27, v49
s_or_b64 s[38:39], s[38:39], vcc
v_cmp_eq_u32 vcc, s27, v50
s_or_b64 s[38:39], s[38:39], vcc
v_cmp_eq_u32 vcc, s27, v51
s_or_b64 s[38:39], s[38:39], vcc
s_cselect_b32 s36, 1, 0
v_mov_b32 v60, s36
ds_write_b32 v123, v60 offset:2048
s_waitcnt lgkmcnt(0)
s_barrier
ds_read_b128 v[84:87], v123 offset:2048
s_waitcnt lgkmcnt(0)
v_or3_b32 v84, v84, v85, v86
v_or_b32 v84, v84, v87
v_cmp_ne_u32 vcc, 0, v84
s_cbranch_vccnz Lc_m1_r0_x
ds_read2_b32 v[84:85], v61 offset0:0 offset1:16
ds_read2_b32 v[86:87], v61 offset0:32 offset1:48
ds_read2_b32 v[88:89], v61 offset0:64 offset1:80
ds_read2_b32 v[90:91], v61 offset0:96 offset1:112
ds_read2_b32 v[92:93], v61 offset0:128 offset1:144
ds_read2_b32 v[94:95], v61 offset0:160 offset1:176
ds_read2_b32 v[96:97], v61 offset0:192 offset1:208
ds_read2_b32 v[98:99], v61 offset0:224 offset1:240
s_waitcnt lgkmcnt(0)
v_max3_f32 v16, v16, v84, v85
v_max3_f32 v16, v16, v86, v87
v_max3_f32 v16, v16, v88, v89
v_max3_f32 v16, v16, v90, v91
v_max3_f32 v16, v16, v92, v93
v_max3_f32 v16, v16, v94, v95
v_max3_f32 v16, v16, v96, v97
v_max3_f32 v16, v16, v98, v99
v_sub_f32 v78, v76, v16
v_sub_f32 v79, v77, v16
v_exp_f32 v78, v78
v_exp_f32 v79, v79
v_sub_f32 v82, v80, v16
v_sub_f32 v83, v81, v16
v_exp_f32 v82, v82
v_exp_f32 v83, v83
v_cvt_pk_bf16_f32 v78, v78, v79
ds_write_b32 v12, v78 offset:0
v_cvt_pk_bf16_f32 v122, v82, v83
v_mov_b32 v52, 0
v_mov_b32 v53, 0
v_mov_b32 v54, 0
v_mov_b32 v55, 0
s_waitcnt lgkmcnt(0)
s_barrier
ds_read_b128 v[124:127], v0 offset:0
s_waitcnt lgkmcnt(0)
v_mfma_f32_16x16x32_bf16 v[60:63], v[124:127], v[118:121], 0
v_smfmac_f32_16x16x64_bf16 v[52:55], v[124:127], v[108:115], v14
v_mfma_f32_16x16x16_bf16 v[60:63], v[122:123], v[118:119], v[60:63]
v_smfmac_f32_16x16x32_bf16 v[52:55], v[122:123], v[116:119], v14
s_nop 2
s_nop 0
v_rcp_f32 v62, v60
v_rcp_f32 v63, v61
v_maximum3_f32 v16, v60, v61, v62
v_mul_f32 v52, v52, v62
v_mul_f32 v53, v53, v63
v_mul_f32 v54, v54, v62
v_mul_f32 v55, v55, v63
v_cvt_pk_bf16_f32 v52, v52, v53
v_cvt_pk_bf16_f32 v53, v54, v55
ds_write2_b32 v6, v52, v53 offset0:0 offset1:64
s_branch Lc_m1_r0_slr
Lc_m1_r0_x:
s_add_u32 s44, s44, 1
s_add_u32 s30, s30, 1
s_cmp_gt_u32 s30, 1000000
s_cbranch_scc1 Lc_m1_abort
s_waitcnt vmcnt(0) lgkmcnt(0)
s_barrier
buffer_load_dwordx4 v0, s[8:11], s22 offen offset:0 sc1 lds
buffer_load_dwordx4 v0, s[8:11], s22 offen offset:1024 sc1 lds
buffer_load_dwordx4 v0, s[8:11], s22 offen offset:2048 sc1 lds
buffer_load_dwordx4 v0, s[8:11], s22 offen offset:3072 sc1 lds
buffer_load_dwordx4 v[100:103], v0, s[8:11], s24 offen offset:0 sc1
buffer_load_dwordx4 v[104:107], v0, s[8:11], s24 offen offset:1024 sc1
buffer_load_dwordx4 v[108:111], v0, s[8:11], s25 offen offset:0 sc1
v_mfma_f32_32x32x1_2b_f32 v[52:83], v123, v123, 0
ds_read_b128 v[84:87], v1 offset:0
ds_read_b128 v[88:91], v1 offset:1024
ds_read_b128 v[92:95], v1 offset:2048
ds_read_b128 v[96:99], v1 offset:3072
ds_read_b128 v[128:131], v1 offset:4096
ds_read_b128 v[132:135], v1 offset:5120
ds_read_b128 v[136:139], v1 offset:6144
ds_read_b128 v[140:143], v1 offset:7168
s_waitcnt vmcnt(0) lgkmcnt(0)
s_branch Lc_m1_r0_head
Lc_m1_r0_exit:
s_branch Lc_m1_done
Lc_m1_r1_entry:
.p2align 6
s_nop 0
s_nop 0
s_nop 0
s_nop 0
s_nop 0
s_nop 0
s_nop 0
s_nop 0
s_nop 0
s_nop 0
s_nop 0
s_nop 0
s_nop 0
s_nop 0
s_nop 0
Lc_m1_r1_head:
s_waitcnt vmcnt(8)
s_barrier
ds_read_b32 v16, v4 offset:0
ds_read_b128 v[20:23], v0 offset:0
ds_read_b128 v[24:27], v0 offset:1024
ds_read_b128 v[28:31], v0 offset:2048
ds_read_b128 v[32:35], v0 offset:3072
buffer_load_dwordx4 v[112:115], v0, s[8:11], s25 offen offset:1024 sc1
s_waitcnt lgkmcnt(4)
v_cmp_eq_u32 vcc, s27, v16
Lc_m1_r1_q0:
s_waitcnt lgkmcnt(3)
v_smfmac_f32_16x16x64_bf16 v[52:55], v[20:23], v[84:91], v14
v_smfmac_f32_16x16x64_bf16 v[56:59], v[20:23], v[92:99], v14
s_waitcnt lgkmcnt(2)
s_cbranch_vccnz Lc_m1_r1_y0
Lc_m1_r1_y0r:
v_smfmac_f32_16x16x64_bf16 v[52:55], v[24:27], v[128:135], v14
ds_read_b128 v[128:131], v1 offset:8192
v_smfmac_f32_16x16x64_bf16 v[56:59], v[24:27], v[136:143], v14
s_waitcnt lgkmcnt(2)
ds_read_b128 v[132:135], v1 offset:9216
v_smfmac_f32_16x16x64_bf16 v[52:55], v[28:31], a[0:7], v14
s_waitcnt vmcnt(4)
s_barrier
ds_read_b32 v17, v4 offset:4096
v_smfmac_f32_16x16x64_bf16 v[56:59], v[28:31], a[8:15], v14
s_waitcnt lgkmcnt(3)
ds_read_b128 v[36:39], v0 offset:4096
v_smfmac_f32_16x16x64_bf16 v[52:55], v[32:35], a[16:23], v14
ds_read_b128 v[40:43], v0 offset:5120
v_smfmac_f32_16x16x64_bf16 v[56:59], v[32:35], a[24:31], v14
s_waitcnt lgkmcnt(2)
v_cmp_eq_u32 vcc, s27, v17
v_smfmac_f32_16x16x64_bf16 v[60:63], v[20:23], a[80:87], v14
ds_read_b128 v[44:47], v0 offset:6144
v_smfmac_f32_16x16x64_bf16 v[60:63], v[24:27], a[96:103], v14
s_waitcnt lgkmcnt(2)
s_cbranch_vccnz Lc_m1_r1_y1
Lc_m1_r1_y1r:
ds_read_b128 v[48:51], v0 offset:7168
ds_read_b128 v[136:139], v1 offset:10240
v_smfmac_f32_16x16x64_bf16 v[52:55], v[36:39], a[32:39], v14
s_waitcnt lgkmcnt(3)
ds_read_b128 v[140:143], v1 offset:11264
v_mov_b32 v118, v119
v_smfmac_f32_16x16x64_bf16 v[52:55], v[40:43], a[48:55], v14
s_waitcnt lgkmcnt(3)
buffer_store_dword v13, v3, s[8:11], s35 offen sc1
v_mov_b32 v118, v119
v_smfmac_f32_16x16x64_bf16 v[52:55], v[44:47], v[128:135], v14
s_waitcnt lgkmcnt(2)
ds_read_b128 v[128:131], v1 offset:12288
v_mov_b32 v118, v119
v_smfmac_f32_16x16x64_bf16 v[52:55], v[48:51], a[64:71], v14
ds_read_b128 v[132:135], v1 offset:13312
v_mov_b32 v118, v119
v_smfmac_f32_16x16x64_bf16 v[56:59], v[36:39], a[40:47], v14
buffer_store_dword v15, v3, s[8:11], s33 offen sc1
v_mov_b32 v118, v119
v_smfmac_f32_16x16x64_bf16 v[56:59], v[40:43], a[56:63], v14
s_waitcnt lgkmcnt(2)
v_add_f32 v52, v52, v54
v_smfmac_f32_16x16x64_bf16 v[56:59], v[44:47], v[136:143], v14
ds_read_b128 v[136:139], v1 offset:16384
v_add_f32 v53, v53, v55
v_smfmac_f32_16x16x64_bf16 v[56:59], v[48:51], a[72:79], v14
ds_read_b128 v[140:143], v1 offset:17408
v_cvt_pk_bf16_f32 v54, v52, v53
v_smfmac_f32_16x16x64_bf16 v[60:63], v[28:31], a[112:119], v14
s_waitcnt lgkmcnt(2)
ds_write2_b32 v10, v54, v54 offset0:0 offset1:1
v_mov_b32 v118, v119
v_smfmac_f32_16x16x64_bf16 v[60:63], v[32:35], v[128:135], v14
ds_read_b128 v[128:131], v1 offset:14336
v_add_f32 v56, v56, v58
v_smfmac_f32_16x16x64_bf16 v[60:63], v[36:39], a[128:135], v14
v_add_f32 v57, v57, v59
v_smfmac_f32_16x16x64_bf16 v[60:63], v[40:43], a[144:151], v14
ds_read_b128 v[132:135], v1 offset:15360
v_cvt_pk_bf16_f32 v58, v56, v57
v_smfmac_f32_16x16x64_bf16 v[60:63], v[44:47], a[160:167], v14
s_waitcnt lgkmcnt(3)
ds_write2_b32 v10, v58, v58 offset0:8 offset1:9
v_mov_b32 v118, v119
v_smfmac_f32_16x16x64_bf16 v[60:63], v[48:51], v[136:143], v14
ds_read_b128 v[136:139], v1 offset:18432
v_mov_b32 v118, v119
v_smfmac_f32_16x16x64_bf16 v[64:67], v[20:23], a[88:95], v14
ds_read_b128 v[140:143], v1 offset:19456
v_mov_b32 v118, v119
v_smfmac_f32_16x16x64_bf16 v[64:67], v[24:27], a[104:111], v14
v_add_f32 v60, v60, v62
v_smfmac_f32_16x16x64_bf16 v[64:67], v[28:31], a[120:127], v14
s_waitcnt vmcnt(2) lgkmcnt(2)
s_barrier
ds_read_b64_tr_b16 v[84:85], v11 offset:8192
ds_read_b64_tr_b16 v[86:87], v11 offset:8328
v_add_f32 v61, v61, v63
v_smfmac_f32_16x16x64_bf16 v[64:67], v[32:35], v[128:135], v14
ds_read_b64_tr_b16 v[88:89], v11 offset:8736
ds_read_b64_tr_b16 v[90:91], v11 offset:8872
v_cvt_pk_bf16_f32 v62, v60, v61
v_smfmac_f32_16x16x64_bf16 v[64:67], v[36:39], a[136:143], v14
ds_read_b64_tr_b16 v[92:93], v11 offset:10496
ds_read_b64_tr_b16 v[94:95], v11 offset:10632
v_mov_b32 v52, 0
v_smfmac_f32_16x16x64_bf16 v[64:67], v[40:43], a[152:159], v14
ds_read_b64_tr_b16 v[96:97], v11 offset:11040
ds_read_b64_tr_b16 v[98:99], v11 offset:11176
v_mov_b32 v53, 0
v_smfmac_f32_16x16x64_bf16 v[64:67], v[44:47], a[168:175], v14
s_waitcnt lgkmcnt(8)
v_mov_b32 v54, 0
v_smfmac_f32_16x16x64_bf16 v[64:67], v[48:51], v[136:143], v14
s_waitcnt lgkmcnt(4)
v_mov_b32 v55, 0
v_smfmac_f32_16x16x64_bf16 v[76:79], v[100:103], v[84:91], v14
s_waitcnt lgkmcnt(0)
v_smfmac_f32_16x16x64_bf16 v[76:79], v[104:107], v[92:99], v14
v_add_f32 v64, v64, v66
v_add_f32 v65, v65, v67
v_cvt_pk_bf16_f32 v63, v64, v65
v_smfmac_f32_16x16x64_bf16 v[68:71], v[20:23], a[176:183], v14
ds_write_b64 v7, v[62:63] offset:12800
v_smfmac_f32_16x16x64_bf16 v[68:71], v[24:27], a[192:199], v14
v_add_f32 v76, v76, v78
v_add_f32 v77, v77, v79
v_smfmac_f32_16x16x64_bf16 v[68:71], v[28:31], a[208:215], v14
ds_read_b128 v[136:139], v1 offset:22528
v_exp_f32 v78, v76
v_smfmac_f32_16x16x64_bf16 v[68:71], v[32:35], a[224:231], v14
ds_read_b128 v[140:143], v1 offset:23552
v_exp_f32 v79, v77
v_smfmac_f32_16x16x64_bf16 v[68:71], v[36:39], a[240:247], v14
s_waitcnt lgkmcnt(2)
s_barrier
ds_read_b64_tr_b16 v[100:101], v9 offset:12800
v_cvt_pk_bf16_f32 v78, v78, v79
v_smfmac_f32_16x16x64_bf16 v[68:71], v[40:43], v[144:151], v14
ds_write_b32 v12, v78 offset:0
ds_read_b64_tr_b16 v[102:103], v9 offset:13312
v_smfmac_f32_16x16x64_bf16 v[68:71], v[44:47], v[160:167], v14
ds_read_b64_tr_b16 v[104:105], v9 offset:13824
v_smfmac_f32_16x16x64_bf16 v[68:71], v[48:51], v[176:183], v14
ds_read_b64_tr_b16 v[106:107], v9 offset:14336
v_smfmac_f32_16x16x64_bf16 v[72:75], v[20:23], a[184:191], v14
v_smfmac_f32_16x16x64_bf16 v[72:75], v[24:27], a[200:207], v14
s_waitcnt lgkmcnt(3)
s_barrier
ds_read_b128 v[124:127], v0 offset:0
v_smfmac_f32_16x16x64_bf16 v[72:75], v[28:31], a[216:223], v14
s_waitcnt lgkmcnt(3)
ds_read_b128 v[128:131], v1 offset:20480
v_add_f32 v68, v68, v70
v_smfmac_f32_16x16x64_bf16 v[80:83], v[100:103], v[84:91], v14
s_waitcnt lgkmcnt(2)
v_add_f32 v69, v69, v71
v_smfmac_f32_16x16x64_bf16 v[80:83], v[104:107], v[92:99], v14
v_cvt_pk_bf16_f32 v116, v68, v69
v_smfmac_f32_16x16x64_bf16 v[72:75], v[32:35], a[232:239], v14
ds_read_b128 v[132:135], v1 offset:21504
v_smfmac_f32_16x16x64_bf16 v[72:75], v[36:39], a[248:255], v14
v_mul_f32 v80, s26, v80
v_mul_f32 v81, s26, v81
v_fmac_f32 v80, s26, v82
v_smfmac_f32_16x16x64_bf16 v[72:75], v[40:43], v[152:159], v14
ds_read_b128 v[100:103], v1 offset:32768
v_fmac_f32 v81, s26, v83
v_smfmac_f32_16x16x64_bf16 v[72:75], v[44:47], v[168:175], v14
s_waitcnt lgkmcnt(3)
ds_read_b128 v[104:107], v1 offset:33792
v_exp_f32 v82, v80
v_mfma_f32_16x16x32_bf16 v[60:63], v[124:127], v[118:121], 0
v_exp_f32 v83, v81
v_smfmac_f32_16x16x64_bf16 v[72:75], v[48:51], v[184:191], v14
v_cvt_pk_bf16_f32 v122, v82, v83
v_smfmac_f32_16x16x64_bf16 v[52:55], v[124:127], v[108:115], v14
s_nop 0
v_mfma_f32_16x16x16_bf16 v[60:63], v[122:123], v[118:119], v[60:63]
v_add_f32 v72, v72, v74
v_add_f32 v73, v73, v75
v_cvt_pk_bf16_f32 v117, v72, v73
s_nop 1
v_smfmac_f32_16x16x32_bf16 v[52:55], v[122:123], v[116:119], v14
v_rcp_f32 v62, v60
v_rcp_f32 v63, v61
v_maximum3_f32 v16, v60, v61, v62
s_nop 1
v_mul_f32 v52, v52, v62
v_mul_f32 v53, v53, v63
v_mul_f32 v54, v54, v62
v_mul_f32 v55, v55, v63
v_cvt_pk_bf16_f32 v52, v52, v53
v_cvt_pk_bf16_f32 v53, v54, v55
ds_write2_b32 v6, v52, v53 offset0:0 offset1:64
v_maximum3_f32 v16, v16, v63, v63
v_cmp_nge_f32 vcc, s31, v16
s_cbranch_vccnz Lc_m1_r1_sl
Lc_m1_r1_slr:
v_mfma_f32_16x16x1_4b_f32 v[20:35], v123, v123, 0
s_waitcnt lgkmcnt(0)
s_barrier
ds_read_b64_tr_b16 v[84:85], v8 offset:8192
ds_read_b64_tr_b16 v[86:87], v8 offset:8448
ds_read_b64_tr_b16 v[88:89], v8 offset:8704
ds_read_b64_tr_b16 v[90:91], v8 offset:8960
ds_read_b64_tr_b16 v[92:93], v8 offset:9216
ds_read_b64_tr_b16 v[94:95], v8 offset:9472
ds_read_b64_tr_b16 v[96:97], v8 offset:9728
ds_read_b64_tr_b16 v[98:99], v8 offset:9984
s_waitcnt lgkmcnt(6)
v_smfmac_f32_16x16x64_bf16 v[20:23], v[84:87], v[128:135], v14 abid:1
s_waitcnt lgkmcnt(4)
ds_read_b128 v[36:39], v1 offset:24576
v_smfmac_f32_16x16x64_bf16 v[20:23], v[88:91], v[136:143], v14 abid:1
s_waitcnt lgkmcnt(3)
ds_read_b128 v[40:43], v1 offset:25600
v_smfmac_f32_16x16x64_bf16 v[20:23], v[92:95], v[192:199], v14 abid:1
s_waitcnt lgkmcnt(2)
ds_read_b128 v[44:47], v1 offset:26624
ds_read_b128 v[48:51], v1 offset:27648
v_smfmac_f32_16x16x64_bf16 v[20:23], v[96:99], v[200:207], v14 abid:1
v_smfmac_f32_16x16x64_bf16 v[24:27], v[84:87], v[208:215], v14 abid:1
ds_read_b128 v[128:131], v1 offset:28672
v_smfmac_f32_16x16x64_bf16 v[24:27], v[88:91], v[216:223], v14 abid:1
s_waitcnt lgkmcnt(3)
ds_read_b128 v[132:135], v1 offset:29696
v_cvt_pk_bf16_f32 v52, v20, v21
v_cvt_pk_bf16_f32 v53, v22, v23
v_smfmac_f32_16x16x64_bf16 v[24:27], v[92:95], v[36:43], v14 abid:1
s_waitcnt lgkmcnt(2)
ds_read_b128 v[136:139], v1 offset:30720
v_and_or_b32 v52, v52, -2, s32
v_smfmac_f32_16x16x64_bf16 v[24:27], v[96:99], v[44:51], v14 abid:1
ds_read_b128 v[140:143], v1 offset:31744
buffer_store_dwordx2 v[52:53], v2, s[8:11], s48 offen sc1
v_smfmac_f32_16x16x64_bf16 v[28:31], v[84:87], v[224:231], v14 abid:1
v_smfmac_f32_16x16x64_bf16 v[28:31], v[88:91], v[232:239], v14 abid:1
s_waitcnt lgkmcnt(2)
ds_read_b128 v[36:39], v1 offset:34816
v_cvt_pk_bf16_f32 v54, v24, v25
v_cvt_pk_bf16_f32 v55, v26, v27
v_smfmac_f32_16x16x64_bf16 v[28:31], v[92:95], v[128:135], v14 abid:1
s_waitcnt lgkmcnt(1)
ds_read_b128 v[40:43], v1 offset:35840
v_and_or_b32 v54, v54, -2, s32
v_smfmac_f32_16x16x64_bf16 v[28:31], v[96:99], v[136:143], v14 abid:1
buffer_store_dwordx2 v[54:55], v2, s[8:11], s49 offen sc1
v_smfmac_f32_16x16x64_bf16 v[32:35], v[84:87], v[240:247], v14 abid:1
v_smfmac_f32_16x16x64_bf16 v[32:35], v[88:91], v[248:255], v14 abid:1
v_cvt_pk_bf16_f32 v56, v28, v29
v_cvt_pk_bf16_f32 v57, v30, v31
v_smfmac_f32_16x16x64_bf16 v[32:35], v[92:95], v[100:107], v14 abid:1
s_waitcnt lgkmcnt(0)
ds_read_b128 v[68:71], v0 offset:14848
v_and_or_b32 v56, v56, -2, s32
v_smfmac_f32_16x16x64_bf16 v[32:35], v[96:99], v[36:43], v14 abid:1
buffer_store_dwordx2 v[56:57], v2, s[8:11], s50 offen sc1
s_nop 5
s_nop 0
v_cvt_pk_bf16_f32 v58, v32, v33
v_cvt_pk_bf16_f32 v59, v34, v35
v_and_or_b32 v58, v58, -2, s32
buffer_store_dwordx2 v[58:59], v2, s[8:11], s51 offen sc1
s_waitcnt lgkmcnt(0)
s_barrier
ds_read_b128 v[84:87], v1 offset:0
ds_read_b128 v[88:91], v1 offset:1024
ds_read_b128 v[92:95], v1 offset:2048
ds_read_b128 v[96:99], v1 offset:3072
ds_read_b128 v[128:131], v1 offset:4096
ds_read_b128 v[132:135], v1 offset:5120
ds_read_b128 v[136:139], v1 offset:6144
ds_read_b128 v[140:143], v1 offset:7168
s_nop 15
s_nop 11
buffer_load_dwordx4 v[20:23], v0, s[8:11], s21 offen offset:0 sc1
buffer_load_dwordx4 v[24:27], v0, s[8:11], s21 offen offset:1024 sc1
buffer_load_dwordx4 v[28:31], v0, s[8:11], s21 offen offset:2048 sc1
buffer_load_dwordx4 v[32:35], v0, s[8:11], s21 offen offset:3072 sc1
s_waitcnt vmcnt(3)
v_mfma_f32_16x16x32_bf16 v[72:75], v[68:71], v[20:23], 0
v_bitop3_b32 v16, v20, v22, s32 bitop3:0x7e
s_waitcnt vmcnt(2)
v_mfma_f32_16x16x32_bf16 v[72:75], v[68:71], v[24:27], v[72:75]
v_bitop3_b32 v17, v24, v26, s32 bitop3:0x7e
v_or_b32 v16, v16, v17
s_waitcnt vmcnt(1)
v_mfma_f32_16x16x32_bf16 v[72:75], v[68:71], v[28:31], v[72:75]
v_bitop3_b32 v17, v28, v30, s32 bitop3:0x7e
v_or_b32 v16, v16, v17
s_waitcnt vmcnt(0)
v_mfma_f32_16x16x32_bf16 v[72:75], v[68:71], v[32:35], v[72:75]
v_bitop3_b32 v17, v32, v34, s32 bitop3:0x7e
v_bitop3_b32 v16, v16, v17, 1 bitop3:0xa8
v_cmp_ne_u32 vcc, 0, v16
s_nop 3
v_add_f32_dpp v74, v72, v72 row_ror:8 row_mask:0xf bank_mask:0xf
v_add_f32_dpp v75, v73, v73 row_ror:8 row_mask:0xf bank_mask:0xf
v_cvt_pk_bf16_f32 v13, v74, v75
s_cbranch_vccnz Lc_m1_r1_r1
buffer_store_dword v13, v3, s[8:11], s23 offen sc1
Lc_m1_r1_pu3:
v_mfma_f32_32x32x1_2b_f32 v[52:83], v123, v123, 0
s_add_u32 s18, s18, 1
s_bfe_u32 s32, s18, 0x10001
s_xor_b32 s48, s48, 0x40000
s_xor_b32 s49, s49, 0x40000
s_xor_b32 s50, s50, 0x40000
s_xor_b32 s51, s51, 0x40000
s_xor_b32 s21, s21, 0x40000
s_add_u32 s35, s35, 8192
s_add_u32 s24, s24, 1048576
s_add_u32 s25, s25, 1048576
s_cmp_eq_u32 s18, s40
s_cbranch_scc0 Lc_m1_r1_more
buffer_store_dword v13, v3, s[8:11], s35 offen sc1
s_branch Lc_m1_r1_exit
Lc_m1_r1_more:
s_add_u32 s22, s23, 4096
s_add_u32 s23, s23, 0x2000
s_and_b32 s23, s23, 1081343
s_xor_b32 s33, s23, 0x4000
s_nop 15
s_nop 10
buffer_load_dwordx4 v0, s[8:11], s22 offen offset:0 sc1 lds
buffer_load_dwordx4 v0, s[8:11], s22 offen offset:1024 sc1 lds
buffer_load_dwordx4 v0, s[8:11], s22 offen offset:2048 sc1 lds
buffer_load_dwordx4 v0, s[8:11], s22 offen offset:3072 sc1 lds
s_barrier
buffer_load_dwordx4 v[100:103], v0, s[8:11], s24 offen offset:0 sc1
buffer_load_dwordx4 v[104:107], v0, s[8:11], s24 offen offset:1024 sc1
buffer_load_dwordx4 v[108:111], v0, s[8:11], s25 offen offset:0 sc1
s_waitcnt lgkmcnt(0)
s_branch Lc_m1_r1_head
Lc_m1_r1_y0:
s_cmp_eq_u32 s18, s34
s_cbranch_scc1 Lc_m1_r1_y0r
Lc_m1_r1_y0l:
ds_read_b32 v16, v4 offset:0
ds_read_b128 v[20:23], v0 offset:0
ds_read_b128 v[24:27], v0 offset:1024
ds_read_b128 v[28:31], v0 offset:2048
ds_read_b128 v[32:35], v0 offset:3072
buffer_load_dwordx4 v0, s[8:11], s22 offen offset:0 sc1 lds
buffer_load_dwordx4 v0, s[8:11], s22 offen offset:1024 sc1 lds
buffer_load_dwordx4 v0, s[8:11], s22 offen offset:2048 sc1 lds
buffer_load_dwordx4 v0, s[8:11], s22 offen offset:3072 sc1 lds
s_waitcnt vmcnt(16)
s_add_u32 s46, s46, 1
s_waitcnt lgkmcnt(4)
v_cmp_eq_u32 vcc, s27, v16
s_cbranch_vccz Lc_m1_r1_y0k
ds_read_b32 v16, v4 offset:0
ds_read_b128 v[20:23], v0 offset:0
ds_read_b128 v[24:27], v0 offset:1024
ds_read_b128 v[28:31], v0 offset:2048
ds_read_b128 v[32:35], v0 offset:3072
s_add_u32 s46, s46, 1
s_waitcnt lgkmcnt(4)
v_cmp_eq_u32 vcc, s27, v16
s_cbranch_vccz Lc_m1_r1_y0k
s_add_u32 s30, s30, 1
s_cmp_gt_u32 s30, 1000000
s_cbranch_scc1 Lc_m1_abort
s_branch Lc_m1_r1_y0l
Lc_m1_r1_y0k:
v_mov_b32 v52, 0
v_mov_b32 v53, 0
v_mov_b32 v54, 0
v_mov_b32 v55, 0
v_mov_b32 v56, 0
v_mov_b32 v57, 0
v_mov_b32 v58, 0
v_mov_b32 v59, 0
s_waitcnt lgkmcnt(3)
v_smfmac_f32_16x16x64_bf16 v[52:55], v[20:23], v[84:91], v14
v_smfmac_f32_16x16x64_bf16 v[56:59], v[20:23], v[92:99], v14
s_waitcnt lgkmcnt(0)
s_branch Lc_m1_r1_y0r
Lc_m1_r1_y1:
s_cmp_eq_u32 s18, s34
s_cbranch_scc1 Lc_m1_r1_y1r
Lc_m1_r1_y1l:
ds_read_b32 v17, v4 offset:4096
ds_read_b128 v[36:39], v0 offset:4096
ds_read_b128 v[40:43], v0 offset:5120
ds_read_b128 v[44:47], v0 offset:6144
ds_read_b128 v[48:51], v0 offset:7168
buffer_load_dwordx4 v0, s[8:11], s22 offen offset:0 sc1 lds
buffer_load_dwordx4 v0, s[8:11], s22 offen offset:1024 sc1 lds
buffer_load_dwordx4 v0, s[8:11], s22 offen offset:2048 sc1 lds
buffer_load_dwordx4 v0, s[8:11], s22 offen offset:3072 sc1 lds
s_waitcnt vmcnt(16)
s_add_u32 s47, s47, 1
s_waitcnt lgkmcnt(4)
v_cmp_eq_u32 vcc, s27, v17
s_cbranch_vccz Lc_m1_r1_y1k
ds_read_b32 v17, v4 offset:4096
ds_read_b128 v[36:39], v0 offset:4096
ds_read_b128 v[40:43], v0 offset:5120
ds_read_b128 v[44:47], v0 offset:6144
ds_read_b128 v[48:51], v0 offset:7168
s_add_u32 s47, s47, 1
s_waitcnt lgkmcnt(4)
v_cmp_eq_u32 vcc, s27, v17
s_cbranch_vccz Lc_m1_r1_y1k
s_add_u32 s30, s30, 1
s_cmp_gt_u32 s30, 1000000
s_cbranch_scc1 Lc_m1_abort
s_branch Lc_m1_r1_y1l
Lc_m1_r1_y1k:
s_waitcnt lgkmcnt(0)
s_branch Lc_m1_r1_y1r
Lc_m1_r1_r1:
buffer_load_dwordx4 v[20:23], v0, s[8:11], s21 offen offset:0 sc1
buffer_load_dwordx4 v[24:27], v0, s[8:11], s21 offen offset:1024 sc1
buffer_load_dwordx4 v[28:31], v0, s[8:11], s21 offen offset:2048 sc1
buffer_load_dwordx4 v[32:35], v0, s[8:11], s21 offen offset:3072 sc1
s_nop 15
s_nop 11
Lc_m1_r1_r2:
buffer_load_dwordx4 v[36:39], v0, s[8:11], s21 offen offset:0 sc1
buffer_load_dwordx4 v[40:43], v0, s[8:11], s21 offen offset:1024 sc1
buffer_load_dwordx4 v[44:47], v0, s[8:11], s21 offen offset:2048 sc1
buffer_load_dwordx4 v[48:51], v0, s[8:11], s21 offen offset:3072 sc1
s_add_u32 s45, s45, 1
s_waitcnt vmcnt(7)
v_mfma_f32_16x16x32_bf16 v[72:75], v[68:71], v[20:23], 0
v_bitop3_b32 v16, v20, v22, s32 bitop3:0x7e
s_waitcnt vmcnt(6)
v_mfma_f32_16x16x32_bf16 v[72:75], v[68:71], v[24:27], v[72:75]
v_bitop3_b32 v17, v24, v26, s32 bitop3:0x7e
v_or_b32 v16, v16, v17
s_waitcnt vmcnt(5)
v_mfma_f32_16x16x32_bf16 v[72:75], v[68:71], v[28:31], v[72:75]
v_bitop3_b32 v17, v28, v30, s32 bitop3:0x7e
v_or_b32 v16, v16, v17
s_waitcnt vmcnt(4)
v_mfma_f32_16x16x32_bf16 v[72:75], v[68:71], v[32:35], v[72:75]
v_bitop3_b32 v17, v32, v34, s32 bitop3:0x7e
v_bitop3_b32 v16, v16, v17, 1 bitop3:0xa8
v_cmp_ne_u32 vcc, 0, v16
s_nop 3
v_add_f32_dpp v74, v72, v72 row_ror:8 row_mask:0xf bank_mask:0xf
v_add_f32_dpp v75, v73, v73 row_ror:8 row_mask:0xf bank_mask:0xf
v_cvt_pk_bf16_f32 v13, v74, v75
s_cbranch_vccz Lc_m1_r1_pu2
Lc_m1_r1_r3:
buffer_load_dwordx4 v[20:23], v0, s[8:11], s21 offen offset:0 sc1
buffer_load_dwordx4 v[24:27], v0, s[8:11], s21 offen offset:1024 sc1
buffer_load_dwordx4 v[28:31], v0, s[8:11], s21 offen offset:2048 sc1
buffer_load_dwordx4 v[32:35], v0, s[8:11], s21 offen offset:3072 sc1
s_add_u32 s45, s45, 1
s_waitcnt vmcnt(7)
v_mfma_f32_16x16x32_bf16 v[72:75], v[68:71], v[36:39], 0
v_bitop3_b32 v16, v36, v38, s32 bitop3:0x7e
s_waitcnt vmcnt(6)
v_mfma_f32_16x16x32_bf16 v[72:75], v[68:71], v[40:43], v[72:75]
v_bitop3_b32 v17, v40, v42, s32 bitop3:0x7e
v_or_b32 v16, v16, v17
s_waitcnt vmcnt(5)
v_mfma_f32_16x16x32_bf16 v[72:75], v[68:71], v[44:47], v[72:75]
v_bitop3_b32 v17, v44, v46, s32 bitop3:0x7e
v_or_b32 v16, v16, v17
s_waitcnt vmcnt(4)
v_mfma_f32_16x16x32_bf16 v[72:75], v[68:71], v[48:51], v[72:75]
v_bitop3_b32 v17, v48, v50, s32 bitop3:0x7e
v_bitop3_b32 v16, v16, v17, 1 bitop3:0xa8
v_cmp_ne_u32 vcc, 0, v16
s_nop 3
v_add_f32_dpp v74, v72, v72 row_ror:8 row_mask:0xf bank_mask:0xf
v_add_f32_dpp v75, v73, v73 row_ror:8 row_mask:0xf bank_mask:0xf
v_cvt_pk_bf16_f32 v13, v74, v75
s_cbranch_vccz Lc_m1_r1_pu2
s_add_u32 s30, s30, 1
s_cmp_gt_u32 s30, 1000000
s_cbranch_scc1 Lc_m1_abort
s_branch Lc_m1_r1_r2
Lc_m1_r1_pu2:
buffer_store_dword v13, v3, s[8:11], s23 offen sc1
s_branch Lc_m1_r1_pu3
Lc_m1_r1_sl:
v_max3_f32 v16, v76, v77, v80
v_max_f32 v16, v16, v81
v_lshrrev_b32 v61, 2, v0
ds_write_b32 v61, v16 offset:1280
v_and_b32 v61, 63, v61
v_add_u32 v61, 1024, v61
s_mov_b64 s[38:39], 0
v_cmp_eq_u32 vcc, s27, v20
s_or_b64 s[38:39], s[38:39], vcc
v_cmp_eq_u32 vcc, s27, v21
s_or_b64 s[38:39], s[38:39], vcc
v_cmp_eq_u32 vcc, s27, v22
s_or_b64 s[38:39], s[38:39], vcc
v_cmp_eq_u32 vcc, s27, v23
s_or_b64 s[38:39], s[38:39], vcc
v_cmp_eq_u32 vcc, s27, v24
s_or_b64 s[38:39], s[38:39], vcc
v_cmp_eq_u32 vcc, s27, v25
s_or_b64 s[38:39], s[38:39], vcc
v_cmp_eq_u32 vcc, s27, v26
s_or_b64 s[38:39], s[38:39], vcc
v_cmp_eq_u32 vcc, s27, v27
s_or_b64 s[38:39], s[38:39], vcc
v_cmp_eq_u32 vcc, s27, v28
s_or_b64 s[38:39], s[38:39], vcc
v_cmp_eq_u32 vcc, s27, v29
s_or_b64 s[38:39], s[38:39], vcc
v_cmp_eq_u32 vcc, s27, v30
s_or_b64 s[38:39], s[38:39], vcc
v_cmp_eq_u32 vcc, s27, v31
s_or_b64 s[38:39], s[38:39], vcc
v_cmp_eq_u32 vcc, s27, v32
s_or_b64 s[38:39], s[38:39], vcc
v_cmp_eq_u32 vcc, s27, v33
s_or_b64 s[38:39], s[38:39], vcc
v_cmp_eq_u32 vcc, s27, v34
s_or_b64 s[38:39], s[38:39], vcc
v_cmp_eq_u32 vcc, s27, v35
s_or_b64 s[38:39], s[38:39], vcc
v_cmp_eq_u32 vcc, s27, v36
s_or_b64 s[38:39], s[38:39], vcc
v_cmp_eq_u32 vcc, s27, v37
s_or_b64 s[38:39], s[38:39], vcc
v_cmp_eq_u32 vcc, s27, v38
s_or_b64 s[38:39], s[38:39], vcc
v_cmp_eq_u32 vcc, s27, v39
s_or_b64 s[38:39], s[38:39], vcc
v_cmp_eq_u32 vcc, s27, v40
s_or_b64 s[38:39], s[38:39], vcc
v_cmp_eq_u32 vcc, s27, v41
s_or_b64 s[38:39], s[38:39], vcc
v_cmp_eq_u32 vcc, s27, v42
s_or_b64 s[38:39], s[38:39], vcc
v_cmp_eq_u32 vcc, s27, v43
s_or_b64 s[38:39], s[38:39], vcc
v_cmp_eq_u32 vcc, s27, v44
s_or_b64 s[38:39], s[38:39], vcc
v_cmp_eq_u32 vcc, s27, v45
s_or_b64 s[38:39], s[38:39], vcc
v_cmp_eq_u32 vcc, s27, v46
s_or_b64 s[38:39], s[38:39], vcc
v_cmp_eq_u32 vcc, s27, v47
s_or_b64 s[38:39], s[38:39], vcc
v_cmp_eq_u32 vcc, s27, v48
s_or_b64 s[38:39], s[38:39], vcc
v_cmp_eq_u32 vcc, s27, v49
s_or_b64 s[38:39], s[38:39], vcc
v_cmp_eq_u32 vcc, s27, v50
s_or_b64 s[38:39], s[38:39], vcc
v_cmp_eq_u32 vcc, s27, v51
s_or_b64 s[38:39], s[38:39], vcc
s_cselect_b32 s36, 1, 0
v_mov_b32 v60, s36
ds_write_b32 v123, v60 offset:2052
s_waitcnt lgkmcnt(0)
s_barrier
ds_read_b128 v[84:87], v123 offset:2048
s_waitcnt lgkmcnt(0)
v_or3_b32 v84, v84, v85, v86
v_or_b32 v84, v84, v87
v_cmp_ne_u32 vcc, 0, v84
s_cbranch_vccnz Lc_m1_r1_x
ds_read2_b32 v[84:85], v61 offset0:0 offset1:16
ds_read2_b32 v[86:87], v61 offset0:32 offset1:48
ds_read2_b32 v[88:89], v61 offset0:64 offset1:80
ds_read2_b32 v[90:91], v61 offset0:96 offset1:112
ds_read2_b32 v[92:93], v61 offset0:128 offset1:144
ds_read2_b32 v[94:95], v61 offset0:160 offset1:176
ds_read2_b32 v[96:97], v61 offset0:192 offset1:208
ds_read2_b32 v[98:99], v61 offset0:224 offset1:240
s_waitcnt lgkmcnt(0)
v_max3_f32 v16, v16, v84, v85
v_max3_f32 v16, v16, v86, v87
v_max3_f32 v16, v16, v88, v89
v_max3_f32 v16, v16, v90, v91
v_max3_f32 v16, v16, v92, v93
v_max3_f32 v16, v16, v94, v95
v_max3_f32 v16, v16, v96, v97
v_max3_f32 v16, v16, v98, v99
v_sub_f32 v78, v76, v16
v_sub_f32 v79, v77, v16
v_exp_f32 v78, v78
v_exp_f32 v79, v79
v_sub_f32 v82, v80, v16
v_sub_f32 v83, v81, v16
v_exp_f32 v82, v82
v_exp_f32 v83, v83
v_cvt_pk_bf16_f32 v78, v78, v79
ds_write_b32 v12, v78 offset:0
v_cvt_pk_bf16_f32 v122, v82, v83
v_mov_b32 v52, 0
v_mov_b32 v53, 0
v_mov_b32 v54, 0
v_mov_b32 v55, 0
s_waitcnt lgkmcnt(0)
s_barrier
ds_read_b128 v[124:127], v0 offset:0
s_waitcnt lgkmcnt(0)
v_mfma_f32_16x16x32_bf16 v[60:63], v[124:127], v[118:121], 0
v_smfmac_f32_16x16x64_bf16 v[52:55], v[124:127], v[108:115], v14
v_mfma_f32_16x16x16_bf16 v[60:63], v[122:123], v[118:119], v[60:63]
v_smfmac_f32_16x16x32_bf16 v[52:55], v[122:123], v[116:119], v14
s_nop 2
s_nop 0
v_rcp_f32 v62, v60
v_rcp_f32 v63, v61
v_maximum3_f32 v16, v60, v61, v62
v_mul_f32 v52, v52, v62
v_mul_f32 v53, v53, v63
v_mul_f32 v54, v54, v62
v_mul_f32 v55, v55, v63
v_cvt_pk_bf16_f32 v52, v52, v53
v_cvt_pk_bf16_f32 v53, v54, v55
ds_write2_b32 v6, v52, v53 offset0:0 offset1:64
s_branch Lc_m1_r1_slr
Lc_m1_r1_x:
s_add_u32 s44, s44, 1
s_add_u32 s30, s30, 1
s_cmp_gt_u32 s30, 1000000
s_cbranch_scc1 Lc_m1_abort
s_waitcnt vmcnt(0) lgkmcnt(0)
s_barrier
buffer_load_dwordx4 v0, s[8:11], s22 offen offset:0 sc1 lds
buffer_load_dwordx4 v0, s[8:11], s22 offen offset:1024 sc1 lds
buffer_load_dwordx4 v0, s[8:11], s22 offen offset:2048 sc1 lds
buffer_load_dwordx4 v0, s[8:11], s22 offen offset:3072 sc1 lds
buffer_load_dwordx4 v[100:103], v0, s[8:11], s24 offen offset:0 sc1
buffer_load_dwordx4 v[104:107], v0, s[8:11], s24 offen offset:1024 sc1
buffer_load_dwordx4 v[108:111], v0, s[8:11], s25 offen offset:0 sc1
v_mfma_f32_32x32x1_2b_f32 v[52:83], v123, v123, 0
ds_read_b128 v[84:87], v1 offset:0
ds_read_b128 v[88:91], v1 offset:1024
ds_read_b128 v[92:95], v1 offset:2048
ds_read_b128 v[96:99], v1 offset:3072
ds_read_b128 v[128:131], v1 offset:4096
ds_read_b128 v[132:135], v1 offset:5120
ds_read_b128 v[136:139], v1 offset:6144
ds_read_b128 v[140:143], v1 offset:7168
s_waitcnt vmcnt(0) lgkmcnt(0)
s_branch Lc_m1_r1_head
Lc_m1_r1_exit:
s_branch Lc_m1_done
Lc_m1_r2_entry:
.p2align 6
Lc_m1_r2_head:
s_barrier
ds_read_b32 v16, v3 offset:0
ds_read_b128 v[20:23], v0 offset:0
ds_read_b128 v[24:27], v0 offset:1024
ds_read_b128 v[28:31], v0 offset:2048
ds_read_b128 v[32:35], v0 offset:3072
buffer_load_dwordx4 v[112:115], v0, s[8:11], s25 offen offset:1024 sc1
s_waitcnt lgkmcnt(4)
v_cmp_eq_u32 vcc, s27, v16
Lc_m1_r2_q0:
s_waitcnt lgkmcnt(3)
v_smfmac_f32_16x16x64_bf16 v[52:55], v[20:23], v[84:91], v14
v_smfmac_f32_16x16x64_bf16 v[56:59], v[20:23], v[92:99], v14
s_waitcnt lgkmcnt(2)
s_cbranch_vccnz Lc_m1_r2_y0
Lc_m1_r2_y0r:
v_smfmac_f32_16x16x64_bf16 v[52:55], v[24:27], v[128:135], v14
ds_read_b128 v[128:131], v1 offset:8192
v_smfmac_f32_16x16x64_bf16 v[56:59], v[24:27], v[136:143], v14
s_waitcnt lgkmcnt(2)
ds_read_b128 v[132:135], v1 offset:9216
v_smfmac_f32_16x16x64_bf16 v[52:55], v[28:31], a[0:7], v14
s_barrier
ds_read_b32 v17, v3 offset:4096
v_smfmac_f32_16x16x64_bf16 v[56:59], v[28:31], a[8:15], v14
s_waitcnt lgkmcnt(3)
ds_read_b128 v[36:39], v0 offset:4096
v_smfmac_f32_16x16x64_bf16 v[52:55], v[32:35], a[16:23], v14
ds_read_b128 v[40:43], v0 offset:5120
v_smfmac_f32_16x16x64_bf16 v[56:59], v[32:35], a[24:31], v14
s_waitcnt lgkmcnt(2)
v_cmp_eq_u32 vcc, s27, v17
v_smfmac_f32_16x16x64_bf16 v[60:63], v[20:23], a[80:87], v14
ds_read_b128 v[44:47], v0 offset:6144
v_smfmac_f32_16x16x64_bf16 v[60:63], v[24:27], a[96:103], v14
s_waitcnt lgkmcnt(2)
s_cbranch_vccnz Lc_m1_r2_y1
Lc_m1_r2_y1r:
ds_read_b128 v[48:51], v0 offset:7168
ds_read_b128 v[136:139], v1 offset:10240
v_smfmac_f32_16x16x64_bf16 v[52:55], v[36:39], a[32:39], v14
s_waitcnt lgkmcnt(3)
ds_read_b128 v[140:143], v1 offset:11264
buffer_load_dword v15, v4, s[8:11], 0 offen sc1
v_mov_b32 v118, v119
v_smfmac_f32_16x16x64_bf16 v[52:55], v[40:43], a[48:55], v14
s_waitcnt lgkmcnt(3)
buffer_load_dword v13, v19, s[8:11], s19 offen sc1
v_mov_b32 v118, v119
v_smfmac_f32_16x16x64_bf16 v[52:55], v[44:47], v[128:135], v14
s_waitcnt lgkmcnt(2)
ds_read_b128 v[128:131], v1 offset:12288
v_mov_b32 v118, v119
v_smfmac_f32_16x16x64_bf16 v[52:55], v[48:51], a[64:71], v14
ds_read_b128 v[132:135], v1 offset:13312
v_mov_b32 v118, v119
v_smfmac_f32_16x16x64_bf16 v[56:59], v[36:39], a[40:47], v14
v_mov_b32 v118, v119
v_smfmac_f32_16x16x64_bf16 v[56:59], v[40:43], a[56:63], v14
s_waitcnt lgkmcnt(2)
buffer_load_dword v13, v19, s[8:11], s20 offen sc1
v_add_f32 v52, v52, v54
v_smfmac_f32_16x16x64_bf16 v[56:59], v[44:47], v[136:143], v14
ds_read_b128 v[136:139], v1 offset:16384
v_add_f32 v53, v53, v55
v_smfmac_f32_16x16x64_bf16 v[56:59], v[48:51], a[72:79], v14
ds_read_b128 v[140:143], v1 offset:17408
v_cvt_pk_bf16_f32 v54, v52, v53
v_smfmac_f32_16x16x64_bf16 v[60:63], v[28:31], a[112:119], v14
s_waitcnt lgkmcnt(2)
ds_write2_b32 v10, v54, v54 offset0:0 offset1:1
v_mov_b32 v118, v119
v_smfmac_f32_16x16x64_bf16 v[60:63], v[32:35], v[128:135], v14
ds_read_b128 v[128:131], v1 offset:14336
v_add_f32 v56, v56, v58
v_smfmac_f32_16x16x64_bf16 v[60:63], v[36:39], a[128:135], v14
buffer_load_dword v13, v19, s[8:11], s80 offen sc1
v_add_f32 v57, v57, v59
v_smfmac_f32_16x16x64_bf16 v[60:63], v[40:43], a[144:151], v14
ds_read_b128 v[132:135], v1 offset:15360
v_cvt_pk_bf16_f32 v58, v56, v57
v_smfmac_f32_16x16x64_bf16 v[60:63], v[44:47], a[160:167], v14
s_waitcnt lgkmcnt(3)
ds_write2_b32 v10, v58, v58 offset0:8 offset1:9
v_mov_b32 v118, v119
v_smfmac_f32_16x16x64_bf16 v[60:63], v[48:51], v[136:143], v14
ds_read_b128 v[136:139], v1 offset:18432
v_mov_b32 v118, v119
v_smfmac_f32_16x16x64_bf16 v[64:67], v[20:23], a[88:95], v14
ds_read_b128 v[140:143], v1 offset:19456
v_mov_b32 v118, v119
v_smfmac_f32_16x16x64_bf16 v[64:67], v[24:27], a[104:111], v14
buffer_load_dword v13, v19, s[8:11], s81 offen sc1
v_add_f32 v60, v60, v62
v_smfmac_f32_16x16x64_bf16 v[64:67], v[28:31], a[120:127], v14
s_waitcnt lgkmcnt(2)
s_barrier
ds_read_b64_tr_b16 v[84:85], v11 offset:8192
ds_read_b64_tr_b16 v[86:87], v11 offset:8328
v_add_f32 v61, v61, v63
v_smfmac_f32_16x16x64_bf16 v[64:67], v[32:35], v[128:135], v14
ds_read_b64_tr_b16 v[88:89], v11 offset:8736
ds_read_b64_tr_b16 v[90:91], v11 offset:8872
v_cvt_pk_bf16_f32 v62, v60, v61
v_smfmac_f32_16x16x64_bf16 v[64:67], v[36:39], a[136:143], v14
ds_read_b64_tr_b16 v[92:93], v11 offset:10496
ds_read_b64_tr_b16 v[94:95], v11 offset:10632
v_mov_b32 v52, 0
v_smfmac_f32_16x16x64_bf16 v[64:67], v[40:43], a[152:159], v14
ds_read_b64_tr_b16 v[96:97], v11 offset:11040
ds_read_b64_tr_b16 v[98:99], v11 offset:11176
v_mov_b32 v53, 0
v_smfmac_f32_16x16x64_bf16 v[64:67], v[44:47], a[168:175], v14
s_waitcnt lgkmcnt(8)
v_mov_b32 v54, 0
v_smfmac_f32_16x16x64_bf16 v[64:67], v[48:51], v[136:143], v14
s_waitcnt vmcnt(7) lgkmcnt(4)
v_mov_b32 v55, 0
v_smfmac_f32_16x16x64_bf16 v[76:79], v[100:103], v[84:91], v14
s_waitcnt lgkmcnt(0)
v_smfmac_f32_16x16x64_bf16 v[76:79], v[104:107], v[92:99], v14
v_add_f32 v64, v64, v66
v_add_f32 v65, v65, v67
v_cvt_pk_bf16_f32 v63, v64, v65
v_smfmac_f32_16x16x64_bf16 v[68:71], v[20:23], a[176:183], v14
ds_write_b64 v7, v[62:63] offset:12800
v_smfmac_f32_16x16x64_bf16 v[68:71], v[24:27], a[192:199], v14
v_add_f32 v76, v76, v78
v_add_f32 v77, v77, v79
v_smfmac_f32_16x16x64_bf16 v[68:71], v[28:31], a[208:215], v14
ds_read_b128 v[136:139], v1 offset:22528
v_exp_f32 v78, v76
v_smfmac_f32_16x16x64_bf16 v[68:71], v[32:35], a[224:231], v14
ds_read_b128 v[140:143], v1 offset:23552
v_exp_f32 v79, v77
v_smfmac_f32_16x16x64_bf16 v[68:71], v[36:39], a[240:247], v14
s_waitcnt lgkmcnt(2)
s_barrier
ds_read_b64_tr_b16 v[100:101], v9 offset:12800
v_cvt_pk_bf16_f32 v78, v78, v79
v_smfmac_f32_16x16x64_bf16 v[68:71], v[40:43], v[144:151], v14
ds_write_b32 v12, v78 offset:0
ds_read_b64_tr_b16 v[102:103], v9 offset:13312
v_smfmac_f32_16x16x64_bf16 v[68:71], v[44:47], v[160:167], v14
ds_read_b64_tr_b16 v[104:105], v9 offset:13824
v_smfmac_f32_16x16x64_bf16 v[68:71], v[48:51], v[176:183], v14
ds_read_b64_tr_b16 v[106:107], v9 offset:14336
v_smfmac_f32_16x16x64_bf16 v[72:75], v[20:23], a[184:191], v14
v_smfmac_f32_16x16x64_bf16 v[72:75], v[24:27], a[200:207], v14
s_waitcnt lgkmcnt(3)
s_barrier
ds_read_b128 v[124:127], v0 offset:0
v_smfmac_f32_16x16x64_bf16 v[72:75], v[28:31], a[216:223], v14
s_waitcnt lgkmcnt(3)
ds_read_b128 v[128:131], v1 offset:20480
v_add_f32 v68, v68, v70
v_smfmac_f32_16x16x64_bf16 v[80:83], v[100:103], v[84:91], v14
s_waitcnt lgkmcnt(2)
v_add_f32 v69, v69, v71
v_smfmac_f32_16x16x64_bf16 v[80:83], v[104:107], v[92:99], v14
v_cvt_pk_bf16_f32 v116, v68, v69
v_smfmac_f32_16x16x64_bf16 v[72:75], v[32:35], a[232:239], v14
ds_read_b128 v[132:135], v1 offset:21504
v_smfmac_f32_16x16x64_bf16 v[72:75], v[36:39], a[248:255], v14
v_mul_f32 v80, s26, v80
v_mul_f32 v81, s26, v81
v_fmac_f32 v80, s26, v82
v_smfmac_f32_16x16x64_bf16 v[72:75], v[40:43], v[152:159], v14
ds_read_b128 v[100:103], v1 offset:32768
v_fmac_f32 v81, s26, v83
v_smfmac_f32_16x16x64_bf16 v[72:75], v[44:47], v[168:175], v14
s_waitcnt lgkmcnt(3)
ds_read_b128 v[104:107], v1 offset:33792
v_exp_f32 v82, v80
v_mfma_f32_16x16x32_bf16 v[60:63], v[124:127], v[118:121], 0
v_exp_f32 v83, v81
v_smfmac_f32_16x16x64_bf16 v[72:75], v[48:51], v[184:191], v14
s_waitcnt vmcnt(5)
v_cvt_pk_bf16_f32 v122, v82, v83
v_smfmac_f32_16x16x64_bf16 v[52:55], v[124:127], v[108:115], v14
s_nop 0
v_mfma_f32_16x16x16_bf16 v[60:63], v[122:123], v[118:119], v[60:63]
v_add_f32 v72, v72, v74
v_add_f32 v73, v73, v75
v_cvt_pk_bf16_f32 v117, v72, v73
s_nop 1
v_smfmac_f32_16x16x32_bf16 v[52:55], v[122:123], v[116:119], v14
v_rcp_f32 v62, v60
v_rcp_f32 v63, v61
v_maximum3_f32 v16, v60, v61, v62
s_nop 1
v_mul_f32 v52, v52, v62
v_mul_f32 v53, v53, v63
v_mul_f32 v54, v54, v62
v_mul_f32 v55, v55, v63
v_cvt_pk_bf16_f32 v52, v52, v53
v_cvt_pk_bf16_f32 v53, v54, v55
ds_write2_b32 v6, v52, v53 offset0:0 offset1:64
v_maximum3_f32 v16, v16, v63, v63
v_cmp_nge_f32 vcc, s31, v16
s_cbranch_vccnz Lc_m1_r2_sl
Lc_m1_r2_slr:
v_mfma_f32_16x16x1_4b_f32 v[20:35], v123, v123, 0
s_waitcnt lgkmcnt(0)
s_barrier
ds_read_b64_tr_b16 v[84:85], v8 offset:8192
ds_read_b64_tr_b16 v[86:87], v8 offset:8448
ds_read_b64_tr_b16 v[88:89], v8 offset:8704
ds_read_b64_tr_b16 v[90:91], v8 offset:8960
ds_read_b64_tr_b16 v[92:93], v8 offset:9216
ds_read_b64_tr_b16 v[94:95], v8 offset:9472
ds_read_b64_tr_b16 v[96:97], v8 offset:9728
ds_read_b64_tr_b16 v[98:99], v8 offset:9984
buffer_load_dword v64, v18, s[8:11], 0 offen sc1
s_waitcnt lgkmcnt(6)
v_smfmac_f32_16x16x64_bf16 v[20:23], v[84:87], v[128:135], v14 abid:1
s_waitcnt lgkmcnt(4)
ds_read_b128 v[36:39], v1 offset:24576
v_smfmac_f32_16x16x64_bf16 v[20:23], v[88:91], v[136:143], v14 abid:1
s_waitcnt lgkmcnt(3)
ds_read_b128 v[40:43], v1 offset:25600
buffer_load_dword v65, v18, s[8:11], 0 offen sc1
v_smfmac_f32_16x16x64_bf16 v[20:23], v[92:95], v[192:199], v14 abid:1
s_waitcnt lgkmcnt(2)
ds_read_b128 v[44:47], v1 offset:26624
ds_read_b128 v[48:51], v1 offset:27648
v_smfmac_f32_16x16x64_bf16 v[20:23], v[96:99], v[200:207], v14 abid:1
buffer_load_dword v66, v18, s[8:11], 0 offen sc1
v_smfmac_f32_16x16x64_bf16 v[24:27], v[84:87], v[208:215], v14 abid:1
ds_read_b128 v[128:131], v1 offset:28672
v_smfmac_f32_16x16x64_bf16 v[24:27], v[88:91], v[216:223], v14 abid:1
s_waitcnt lgkmcnt(3)
ds_read_b128 v[132:135], v1 offset:29696
buffer_load_dword v67, v18, s[8:11], 0 offen sc1
v_cvt_pk_bf16_f32 v52, v20, v21
v_cvt_pk_bf16_f32 v53, v22, v23
v_smfmac_f32_16x16x64_bf16 v[24:27], v[92:95], v[36:43], v14 abid:1
s_waitcnt lgkmcnt(2)
ds_read_b128 v[136:139], v1 offset:30720
v_and_or_b32 v52, v52, -2, s32
v_smfmac_f32_16x16x64_bf16 v[24:27], v[96:99], v[44:51], v14 abid:1
ds_read_b128 v[140:143], v1 offset:31744
buffer_store_dwordx2 v[52:53], v2, s[8:11], s48 offen sc1
buffer_load_dword v124, v18, s[8:11], 0 offen sc1
v_smfmac_f32_16x16x64_bf16 v[28:31], v[84:87], v[224:231], v14 abid:1
v_smfmac_f32_16x16x64_bf16 v[28:31], v[88:91], v[232:239], v14 abid:1
s_waitcnt lgkmcnt(2)
ds_read_b128 v[36:39], v1 offset:34816
buffer_load_dword v125, v18, s[8:11], 0 offen sc1
v_cvt_pk_bf16_f32 v54, v24, v25
v_cvt_pk_bf16_f32 v55, v26, v27
v_smfmac_f32_16x16x64_bf16 v[28:31], v[92:95], v[128:135], v14 abid:1
s_waitcnt lgkmcnt(1)
ds_read_b128 v[40:43], v1 offset:35840
v_and_or_b32 v54, v54, -2, s32
v_smfmac_f32_16x16x64_bf16 v[28:31], v[96:99], v[136:143], v14 abid:1
buffer_store_dwordx2 v[54:55], v2, s[8:11], s49 offen sc1
buffer_load_dword v126, v18, s[8:11], 0 offen sc1
v_smfmac_f32_16x16x64_bf16 v[32:35], v[84:87], v[240:247], v14 abid:1
v_smfmac_f32_16x16x64_bf16 v[32:35], v[88:91], v[248:255], v14 abid:1
buffer_load_dword v127, v18, s[8:11], 0 offen sc1
v_cvt_pk_bf16_f32 v56, v28, v29
v_cvt_pk_bf16_f32 v57, v30, v31
v_smfmac_f32_16x16x64_bf16 v[32:35], v[92:95], v[100:107], v14 abid:1
s_waitcnt lgkmcnt(0)
v_and_or_b32 v56, v56, -2, s32
v_smfmac_f32_16x16x64_bf16 v[32:35], v[96:99], v[36:43], v14 abid:1
buffer_store_dwordx2 v[56:57], v2, s[8:11], s50 offen sc1
buffer_load_dword v76, v18, s[8:11], 0 offen sc1
s_nop 5
v_cvt_pk_bf16_f32 v58, v32, v33
v_cvt_pk_bf16_f32 v59, v34, v35
v_and_or_b32 v58, v58, -2, s32
buffer_store_dwordx2 v[58:59], v2, s[8:11], s51 offen sc1
buffer_load_dword v77, v18, s[8:11], 0 offen sc1
s_nop 3
buffer_load_dword v78, v18, s[8:11], 0 offen sc1
s_waitcnt vmcnt(14)
v_cmp_ge_u32 vcc, s18, v64
s_cbranch_vccz Lc_m1_r2_p0
buffer_load_dword v64, v18, s[8:11], 0 offen sc1
s_waitcnt vmcnt(14)
v_cmp_ge_u32 vcc, s18, v65
s_cbranch_vccz Lc_m1_r2_p0
buffer_load_dword v65, v18, s[8:11], 0 offen sc1
s_waitcnt vmcnt(14)
v_cmp_ge_u32 vcc, s18, v66
s_cbranch_vccz Lc_m1_r2_p0
buffer_load_dword v66, v18, s[8:11], 0 offen sc1
s_waitcnt vmcnt(14)
v_cmp_ge_u32 vcc, s18, v67
s_cbranch_vccz Lc_m1_r2_p0
buffer_load_dword v67, v18, s[8:11], 0 offen sc1
s_waitcnt vmcnt(13)
v_cmp_ge_u32 vcc, s18, v124
s_cbranch_vccz Lc_m1_r2_p0
buffer_load_dword v124, v18, s[8:11], 0 offen sc1
s_waitcnt vmcnt(13)
v_cmp_ge_u32 vcc, s18, v125
s_cbranch_vccz Lc_m1_r2_p0
buffer_load_dword v125, v18, s[8:11], 0 offen sc1
s_waitcnt vmcnt(12)
v_cmp_ge_u32 vcc, s18, v126
s_cbranch_vccz Lc_m1_r2_p0
buffer_load_dword v126, v18, s[8:11], 0 offen sc1
s_waitcnt vmcnt(12)
v_cmp_ge_u32 vcc, s18, v127
s_cbranch_vccz Lc_m1_r2_p0
buffer_load_dword v127, v18, s[8:11], 0 offen sc1
s_waitcnt vmcnt(11)
v_cmp_ge_u32 vcc, s18, v76
s_cbranch_vccz Lc_m1_r2_p0
buffer_load_dword v76, v18, s[8:11], 0 offen sc1
s_waitcnt vmcnt(10)
v_cmp_ge_u32 vcc, s18, v77
s_cbranch_vccz Lc_m1_r2_p0
s_add_u32 s44, s44, 1
Lc_m1_r2_rg:
buffer_load_dword v77, v18, s[8:11], 0 offen sc1
s_waitcnt vmcnt(10)
v_cmp_ge_u32 vcc, s18, v78
s_cbranch_vccz Lc_m1_r2_p0
buffer_load_dword v78, v18, s[8:11], 0 offen sc1
s_waitcnt vmcnt(10)
v_cmp_ge_u32 vcc, s18, v64
s_cbranch_vccz Lc_m1_r2_p0
buffer_load_dword v64, v18, s[8:11], 0 offen sc1
s_waitcnt vmcnt(10)
v_cmp_ge_u32 vcc, s18, v65
s_cbranch_vccz Lc_m1_r2_p0
buffer_load_dword v65, v18, s[8:11], 0 offen sc1
s_waitcnt vmcnt(10)
v_cmp_ge_u32 vcc, s18, v66
s_cbranch_vccz Lc_m1_r2_p0
buffer_load_dword v66, v18, s[8:11], 0 offen sc1
s_waitcnt vmcnt(10)
v_cmp_ge_u32 vcc, s18, v67
s_cbranch_vccz Lc_m1_r2_p0
buffer_load_dword v67, v18, s[8:11], 0 offen sc1
s_waitcnt vmcnt(10)
v_cmp_ge_u32 vcc, s18, v124
s_cbranch_vccz Lc_m1_r2_p0
buffer_load_dword v124, v18, s[8:11], 0 offen sc1
s_waitcnt vmcnt(10)
v_cmp_ge_u32 vcc, s18, v125
s_cbranch_vccz Lc_m1_r2_p0
buffer_load_dword v125, v18, s[8:11], 0 offen sc1
s_waitcnt vmcnt(10)
v_cmp_ge_u32 vcc, s18, v126
s_cbranch_vccz Lc_m1_r2_p0
buffer_load_dword v126, v18, s[8:11], 0 offen sc1
s_waitcnt vmcnt(10)
v_cmp_ge_u32 vcc, s18, v127
s_cbranch_vccz Lc_m1_r2_p0
buffer_load_dword v127, v18, s[8:11], 0 offen sc1
s_waitcnt vmcnt(10)
v_cmp_ge_u32 vcc, s18, v76
s_cbranch_vccz Lc_m1_r2_p0
buffer_load_dword v76, v18, s[8:11], 0 offen sc1
s_waitcnt vmcnt(10)
v_cmp_ge_u32 vcc, s18, v77
s_cbranch_vccz Lc_m1_r2_p0
s_add_u32 s30, s30, 1
s_cmp_gt_u32 s30, 1000000
s_cbranch_scc0 Lc_m1_r2_rg
s_branch Lc_m1_abort
Lc_m1_r2_p0:
s_barrier
s_add_u32 s18, s18, 1
s_bfe_u32 s32, s18, 0x10001
s_xor_b32 s48, s48, 0x40000
s_xor_b32 s49, s49, 0x40000
s_xor_b32 s50, s50, 0x40000
s_xor_b32 s51, s51, 0x40000
s_add_u32 s24, s24, 1048576
s_add_u32 s25, s25, 1048576
s_cmp_eq_u32 s18, s40
s_cbranch_scc1 Lc_m1_r2_exit
s_add_u32 s28, s18, 1
s_min_u32 s28, s28, 63
s_mul_i32 s36, s28, 1048576
s_lshl_b32 s29, s16, 13
s_add_u32 s36, s36, s29
s_add_u32 s36, s36, 16777216
s_and_b32 s29, s16, 3
s_lshl_b32 s29, s29, 11
s_add_u32 s19, s36, s29
s_xor_b32 s20, s19, 2048
s_xor_b32 s80, s19, 4096
s_xor_b32 s81, s19, 6144
Lc_m1_r2_rd:
v_cmp_ge_u32 vcc, s28, v15
s_cbranch_vccnz Lc_m1_r2_rr
s_waitcnt vmcnt(0)
v_mfma_f32_32x32x1_2b_f32 v[52:83], v123, v123, 0
ds_read_b128 v[84:87], v1 offset:0
ds_read_b128 v[88:91], v1 offset:1024
ds_read_b128 v[92:95], v1 offset:2048
ds_read_b128 v[96:99], v1 offset:3072
ds_read_b128 v[128:131], v1 offset:4096
ds_read_b128 v[132:135], v1 offset:5120
ds_read_b128 v[136:139], v1 offset:6144
ds_read_b128 v[140:143], v1 offset:7168
s_waitcnt lgkmcnt(0)
s_barrier
buffer_load_dwordx4 v[100:103], v0, s[8:11], s24 offen offset:0 sc1
buffer_load_dwordx4 v[104:107], v0, s[8:11], s24 offen offset:1024 sc1
buffer_load_dwordx4 v[108:111], v0, s[8:11], s25 offen offset:0 sc1
s_branch Lc_m1_r2_head
Lc_m1_r2_y0:
s_cmp_eq_u32 s18, s34
s_cbranch_scc1 Lc_m1_r2_y0r
Lc_m1_r2_y0l:
ds_read_b32 v16, v3 offset:0
ds_read_b128 v[20:23], v0 offset:0
ds_read_b128 v[24:27], v0 offset:1024
ds_read_b128 v[28:31], v0 offset:2048
ds_read_b128 v[32:35], v0 offset:3072
s_add_u32 s46, s46, 1
s_waitcnt lgkmcnt(4)
v_cmp_eq_u32 vcc, s27, v16
s_cbranch_vccz Lc_m1_r2_y0k
ds_read_b32 v16, v3 offset:0
ds_read_b128 v[20:23], v0 offset:0
ds_read_b128 v[24:27], v0 offset:1024
ds_read_b128 v[28:31], v0 offset:2048
ds_read_b128 v[32:35], v0 offset:3072
s_add_u32 s46, s46, 1
s_waitcnt lgkmcnt(4)
v_cmp_eq_u32 vcc, s27, v16
s_cbranch_vccz Lc_m1_r2_y0k
s_add_u32 s30, s30, 1
s_cmp_gt_u32 s30, 1000000
s_cbranch_scc1 Lc_m1_abort
s_branch Lc_m1_r2_y0l
Lc_m1_r2_y0k:
v_mov_b32 v52, 0
v_mov_b32 v53, 0
v_mov_b32 v54, 0
v_mov_b32 v55, 0
v_mov_b32 v56, 0
v_mov_b32 v57, 0
v_mov_b32 v58, 0
v_mov_b32 v59, 0
s_waitcnt lgkmcnt(3)
v_smfmac_f32_16x16x64_bf16 v[52:55], v[20:23], v[84:91], v14
v_smfmac_f32_16x16x64_bf16 v[56:59], v[20:23], v[92:99], v14
s_waitcnt lgkmcnt(0)
s_branch Lc_m1_r2_y0r
Lc_m1_r2_y1:
s_cmp_eq_u32 s18, s34
s_cbranch_scc1 Lc_m1_r2_y1r
Lc_m1_r2_y1l:
ds_read_b32 v17, v3 offset:4096
ds_read_b128 v[36:39], v0 offset:4096
ds_read_b128 v[40:43], v0 offset:5120
ds_read_b128 v[44:47], v0 offset:6144
ds_read_b128 v[48:51], v0 offset:7168
s_add_u32 s47, s47, 1
s_waitcnt lgkmcnt(4)
v_cmp_eq_u32 vcc, s27, v17
s_cbranch_vccz Lc_m1_r2_y1k
ds_read_b32 v17, v3 offset:4096
ds_read_b128 v[36:39], v0 offset:4096
ds_read_b128 v[40:43], v0 offset:5120
ds_read_b128 v[44:47], v0 offset:6144
ds_read_b128 v[48:51], v0 offset:7168
s_add_u32 s47, s47, 1
s_waitcnt lgkmcnt(4)
v_cmp_eq_u32 vcc, s27, v17
s_cbranch_vccz Lc_m1_r2_y1k
s_add_u32 s30, s30, 1
s_cmp_gt_u32 s30, 1000000
s_cbranch_scc1 Lc_m1_abort
s_branch Lc_m1_r2_y1l
Lc_m1_r2_y1k:
s_waitcnt lgkmcnt(0)
s_branch Lc_m1_r2_y1r
Lc_m1_r2_rr:
s_sleep 8
buffer_load_dword v15, v4, s[8:11], 0 offen sc1
s_add_u32 s30, s30, 1
s_cmp_gt_u32 s30, 1000000
s_cbranch_scc1 Lc_m1_abort
s_waitcnt vmcnt(0) lgkmcnt(0)
s_branch Lc_m1_r2_rd
Lc_m1_r2_sl:
v_max3_f32 v16, v76, v77, v80
v_max_f32 v16, v16, v81
v_lshrrev_b32 v61, 2, v0
ds_write_b32 v61, v16 offset:1536
v_and_b32 v61, 63, v61
v_add_u32 v61, 1024, v61
s_mov_b64 s[38:39], 0
v_cmp_eq_u32 vcc, s27, v20
s_or_b64 s[38:39], s[38:39], vcc
v_cmp_eq_u32 vcc, s27, v21
s_or_b64 s[38:39], s[38:39], vcc
v_cmp_eq_u32 vcc, s27, v22
s_or_b64 s[38:39], s[38:39], vcc
v_cmp_eq_u32 vcc, s27, v23
s_or_b64 s[38:39], s[38:39], vcc
v_cmp_eq_u32 vcc, s27, v24
s_or_b64 s[38:39], s[38:39], vcc
v_cmp_eq_u32 vcc, s27, v25
s_or_b64 s[38:39], s[38:39], vcc
v_cmp_eq_u32 vcc, s27, v26
s_or_b64 s[38:39], s[38:39], vcc
v_cmp_eq_u32 vcc, s27, v27
s_or_b64 s[38:39], s[38:39], vcc
v_cmp_eq_u32 vcc, s27, v28
s_or_b64 s[38:39], s[38:39], vcc
v_cmp_eq_u32 vcc, s27, v29
s_or_b64 s[38:39], s[38:39], vcc
v_cmp_eq_u32 vcc, s27, v30
s_or_b64 s[38:39], s[38:39], vcc
v_cmp_eq_u32 vcc, s27, v31
s_or_b64 s[38:39], s[38:39], vcc
v_cmp_eq_u32 vcc, s27, v32
s_or_b64 s[38:39], s[38:39], vcc
v_cmp_eq_u32 vcc, s27, v33
s_or_b64 s[38:39], s[38:39], vcc
v_cmp_eq_u32 vcc, s27, v34
s_or_b64 s[38:39], s[38:39], vcc
v_cmp_eq_u32 vcc, s27, v35
s_or_b64 s[38:39], s[38:39], vcc
v_cmp_eq_u32 vcc, s27, v36
s_or_b64 s[38:39], s[38:39], vcc
v_cmp_eq_u32 vcc, s27, v37
s_or_b64 s[38:39], s[38:39], vcc
v_cmp_eq_u32 vcc, s27, v38
s_or_b64 s[38:39], s[38:39], vcc
v_cmp_eq_u32 vcc, s27, v39
s_or_b64 s[38:39], s[38:39], vcc
v_cmp_eq_u32 vcc, s27, v40
s_or_b64 s[38:39], s[38:39], vcc
v_cmp_eq_u32 vcc, s27, v41
s_or_b64 s[38:39], s[38:39], vcc
v_cmp_eq_u32 vcc, s27, v42
s_or_b64 s[38:39], s[38:39], vcc
v_cmp_eq_u32 vcc, s27, v43
s_or_b64 s[38:39], s[38:39], vcc
v_cmp_eq_u32 vcc, s27, v44
s_or_b64 s[38:39], s[38:39], vcc
v_cmp_eq_u32 vcc, s27, v45
s_or_b64 s[38:39], s[38:39], vcc
v_cmp_eq_u32 vcc, s27, v46
s_or_b64 s[38:39], s[38:39], vcc
v_cmp_eq_u32 vcc, s27, v47
s_or_b64 s[38:39], s[38:39], vcc
v_cmp_eq_u32 vcc, s27, v48
s_or_b64 s[38:39], s[38:39], vcc
v_cmp_eq_u32 vcc, s27, v49
s_or_b64 s[38:39], s[38:39], vcc
v_cmp_eq_u32 vcc, s27, v50
s_or_b64 s[38:39], s[38:39], vcc
v_cmp_eq_u32 vcc, s27, v51
s_or_b64 s[38:39], s[38:39], vcc
s_cselect_b32 s36, 1, 0
v_mov_b32 v60, s36
ds_write_b32 v123, v60 offset:2056
s_waitcnt lgkmcnt(0)
s_barrier
ds_read_b128 v[84:87], v123 offset:2048
s_waitcnt lgkmcnt(0)
v_or3_b32 v84, v84, v85, v86
v_or_b32 v84, v84, v87
v_cmp_ne_u32 vcc, 0, v84
s_cbranch_vccnz Lc_m1_r2_x
ds_read2_b32 v[84:85], v61 offset0:0 offset1:16
ds_read2_b32 v[86:87], v61 offset0:32 offset1:48
ds_read2_b32 v[88:89], v61 offset0:64 offset1:80
ds_read2_b32 v[90:91], v61 offset0:96 offset1:112
ds_read2_b32 v[92:93], v61 offset0:128 offset1:144
ds_read2_b32 v[94:95], v61 offset0:160 offset1:176
ds_read2_b32 v[96:97], v61 offset0:192 offset1:208
ds_read2_b32 v[98:99], v61 offset0:224 offset1:240
s_waitcnt lgkmcnt(0)
v_max3_f32 v16, v16, v84, v85
v_max3_f32 v16, v16, v86, v87
v_max3_f32 v16, v16, v88, v89
v_max3_f32 v16, v16, v90, v91
v_max3_f32 v16, v16, v92, v93
v_max3_f32 v16, v16, v94, v95
v_max3_f32 v16, v16, v96, v97
v_max3_f32 v16, v16, v98, v99
v_sub_f32 v78, v76, v16
v_sub_f32 v79, v77, v16
v_exp_f32 v78, v78
v_exp_f32 v79, v79
v_sub_f32 v82, v80, v16
v_sub_f32 v83, v81, v16
v_exp_f32 v82, v82
v_exp_f32 v83, v83
v_cvt_pk_bf16_f32 v78, v78, v79
ds_write_b32 v12, v78 offset:0
v_cvt_pk_bf16_f32 v122, v82, v83
v_mov_b32 v52, 0
v_mov_b32 v53, 0
v_mov_b32 v54, 0
v_mov_b32 v55, 0
s_waitcnt lgkmcnt(0)
s_barrier
ds_read_b128 v[124:127], v0 offset:0
s_waitcnt lgkmcnt(0)
v_mfma_f32_16x16x32_bf16 v[60:63], v[124:127], v[118:121], 0
v_smfmac_f32_16x16x64_bf16 v[52:55], v[124:127], v[108:115], v14
v_mfma_f32_16x16x16_bf16 v[60:63], v[122:123], v[118:119], v[60:63]
v_smfmac_f32_16x16x32_bf16 v[52:55], v[122:123], v[116:119], v14
s_nop 2
s_nop 0
v_rcp_f32 v62, v60
v_rcp_f32 v63, v61
v_maximum3_f32 v16, v60, v61, v62
v_mul_f32 v52, v52, v62
v_mul_f32 v53, v53, v63
v_mul_f32 v54, v54, v62
v_mul_f32 v55, v55, v63
v_cvt_pk_bf16_f32 v52, v52, v53
v_cvt_pk_bf16_f32 v53, v54, v55
ds_write2_b32 v6, v52, v53 offset0:0 offset1:64
s_branch Lc_m1_r2_slr
Lc_m1_r2_x:
s_add_u32 s44, s44, 1
s_add_u32 s30, s30, 1
s_cmp_gt_u32 s30, 1000000
s_cbranch_scc1 Lc_m1_abort
s_waitcnt vmcnt(0) lgkmcnt(0)
s_barrier
buffer_load_dwordx4 v[100:103], v0, s[8:11], s24 offen offset:0 sc1
buffer_load_dwordx4 v[104:107], v0, s[8:11], s24 offen offset:1024 sc1
buffer_load_dwordx4 v[108:111], v0, s[8:11], s25 offen offset:0 sc1
v_mfma_f32_32x32x1_2b_f32 v[52:83], v123, v123, 0
ds_read_b128 v[84:87], v1 offset:0
ds_read_b128 v[88:91], v1 offset:1024
ds_read_b128 v[92:95], v1 offset:2048
ds_read_b128 v[96:99], v1 offset:3072
ds_read_b128 v[128:131], v1 offset:4096
ds_read_b128 v[132:135], v1 offset:5120
ds_read_b128 v[136:139], v1 offset:6144
ds_read_b128 v[140:143], v1 offset:7168
s_waitcnt vmcnt(0) lgkmcnt(0)
s_branch Lc_m1_r2_head
Lc_m1_r2_exit:
s_branch Lc_m1_done
Lc_m1_r3_entry:
.p2align 6
Lc_m1_r3_head:
s_barrier
ds_read_b32 v16, v3 offset:0
ds_read_b128 v[20:23], v0 offset:0
ds_read_b128 v[24:27], v0 offset:1024
ds_read_b128 v[28:31], v0 offset:2048
ds_read_b128 v[32:35], v0 offset:3072
buffer_load_dwordx4 v[112:115], v0, s[8:11], s25 offen offset:1024 sc1
s_waitcnt lgkmcnt(4)
v_cmp_eq_u32 vcc, s27, v16
Lc_m1_r3_q0:
s_waitcnt lgkmcnt(3)
v_smfmac_f32_16x16x64_bf16 v[52:55], v[20:23], v[84:91], v14
v_smfmac_f32_16x16x64_bf16 v[56:59], v[20:23], v[92:99], v14
s_waitcnt lgkmcnt(2)
s_cbranch_vccnz Lc_m1_r3_y0
Lc_m1_r3_y0r:
v_smfmac_f32_16x16x64_bf16 v[52:55], v[24:27], v[128:135], v14
ds_read_b128 v[128:131], v1 offset:8192
v_smfmac_f32_16x16x64_bf16 v[56:59], v[24:27], v[136:143], v14
s_waitcnt lgkmcnt(2)
ds_read_b128 v[132:135], v1 offset:9216
v_smfmac_f32_16x16x64_bf16 v[52:55], v[28:31], a[0:7], v14
s_barrier
ds_read_b32 v17, v3 offset:4096
v_smfmac_f32_16x16x64_bf16 v[56:59], v[28:31], a[8:15], v14
s_waitcnt lgkmcnt(3)
ds_read_b128 v[36:39], v0 offset:4096
v_smfmac_f32_16x16x64_bf16 v[52:55], v[32:35], a[16:23], v14
ds_read_b128 v[40:43], v0 offset:5120
v_smfmac_f32_16x16x64_bf16 v[56:59], v[32:35], a[24:31], v14
s_waitcnt lgkmcnt(2)
v_cmp_eq_u32 vcc, s27, v17
v_smfmac_f32_16x16x64_bf16 v[60:63], v[20:23], a[80:87], v14
ds_read_b128 v[44:47], v0 offset:6144
v_smfmac_f32_16x16x64_bf16 v[60:63], v[24:27], a[96:103], v14
s_waitcnt lgkmcnt(2)
s_cbranch_vccnz Lc_m1_r3_y1
Lc_m1_r3_y1r:
ds_read_b128 v[48:51], v0 offset:7168
ds_read_b128 v[136:139], v1 offset:10240
v_smfmac_f32_16x16x64_bf16 v[52:55], v[36:39], a[32:39], v14
s_waitcnt lgkmcnt(3)
ds_read_b128 v[140:143], v1 offset:11264
buffer_load_dword v15, v19, s[8:11], s19 offen sc1
v_mov_b32 v118, v119
v_smfmac_f32_16x16x64_bf16 v[52:55], v[40:43], a[48:55], v14
s_waitcnt lgkmcnt(3)
v_mov_b32 v118, v119
v_smfmac_f32_16x16x64_bf16 v[52:55], v[44:47], v[128:135], v14
s_waitcnt lgkmcnt(2)
ds_read_b128 v[128:131], v1 offset:12288
v_mov_b32 v118, v119
v_smfmac_f32_16x16x64_bf16 v[52:55], v[48:51], a[64:71], v14
ds_read_b128 v[132:135], v1 offset:13312
v_mov_b32 v118, v119
v_smfmac_f32_16x16x64_bf16 v[56:59], v[36:39], a[40:47], v14
buffer_load_dword v15, v19, s[8:11], s20 offen sc1
v_mov_b32 v118, v119
v_smfmac_f32_16x16x64_bf16 v[56:59], v[40:43], a[56:63], v14
s_waitcnt lgkmcnt(2)
v_add_f32 v52, v52, v54
v_smfmac_f32_16x16x64_bf16 v[56:59], v[44:47], v[136:143], v14
ds_read_b128 v[136:139], v1 offset:16384
v_add_f32 v53, v53, v55
v_smfmac_f32_16x16x64_bf16 v[56:59], v[48:51], a[72:79], v14
ds_read_b128 v[140:143], v1 offset:17408
v_cvt_pk_bf16_f32 v54, v52, v53
v_smfmac_f32_16x16x64_bf16 v[60:63], v[28:31], a[112:119], v14
s_waitcnt lgkmcnt(2)
buffer_load_dword v15, v19, s[8:11], s80 offen sc1
ds_write2_b32 v10, v54, v54 offset0:0 offset1:1
v_mov_b32 v118, v119
v_smfmac_f32_16x16x64_bf16 v[60:63], v[32:35], v[128:135], v14
ds_read_b128 v[128:131], v1 offset:14336
v_add_f32 v56, v56, v58
v_smfmac_f32_16x16x64_bf16 v[60:63], v[36:39], a[128:135], v14
v_add_f32 v57, v57, v59
v_smfmac_f32_16x16x64_bf16 v[60:63], v[40:43], a[144:151], v14
ds_read_b128 v[132:135], v1 offset:15360
v_cvt_pk_bf16_f32 v58, v56, v57
v_smfmac_f32_16x16x64_bf16 v[60:63], v[44:47], a[160:167], v14
s_waitcnt lgkmcnt(3)
ds_write2_b32 v10, v58, v58 offset0:8 offset1:9
v_mov_b32 v118, v119
v_smfmac_f32_16x16x64_bf16 v[60:63], v[48:51], v[136:143], v14
ds_read_b128 v[136:139], v1 offset:18432
buffer_load_dword v15, v19, s[8:11], s81 offen sc1
v_mov_b32 v118, v119
v_smfmac_f32_16x16x64_bf16 v[64:67], v[20:23], a[88:95], v14
ds_read_b128 v[140:143], v1 offset:19456
v_mov_b32 v118, v119
v_smfmac_f32_16x16x64_bf16 v[64:67], v[24:27], a[104:111], v14
v_add_f32 v60, v60, v62
v_smfmac_f32_16x16x64_bf16 v[64:67], v[28:31], a[120:127], v14
s_waitcnt lgkmcnt(2)
s_barrier
ds_read_b64_tr_b16 v[84:85], v11 offset:8192
ds_read_b64_tr_b16 v[86:87], v11 offset:8328
v_add_f32 v61, v61, v63
v_smfmac_f32_16x16x64_bf16 v[64:67], v[32:35], v[128:135], v14
ds_read_b64_tr_b16 v[88:89], v11 offset:8736
ds_read_b64_tr_b16 v[90:91], v11 offset:8872
v_cvt_pk_bf16_f32 v62, v60, v61
v_smfmac_f32_16x16x64_bf16 v[64:67], v[36:39], a[136:143], v14
ds_read_b64_tr_b16 v[92:93], v11 offset:10496
ds_read_b64_tr_b16 v[94:95], v11 offset:10632
v_mov_b32 v52, 0
v_smfmac_f32_16x16x64_bf16 v[64:67], v[40:43], a[152:159], v14
ds_read_b64_tr_b16 v[96:97], v11 offset:11040
ds_read_b64_tr_b16 v[98:99], v11 offset:11176
v_mov_b32 v53, 0
v_smfmac_f32_16x16x64_bf16 v[64:67], v[44:47], a[168:175], v14
s_waitcnt lgkmcnt(8)
v_mov_b32 v54, 0
v_smfmac_f32_16x16x64_bf16 v[64:67], v[48:51], v[136:143], v14
s_waitcnt vmcnt(6) lgkmcnt(4)
v_mov_b32 v55, 0
v_smfmac_f32_16x16x64_bf16 v[76:79], v[100:103], v[84:91], v14
s_waitcnt lgkmcnt(0)
v_smfmac_f32_16x16x64_bf16 v[76:79], v[104:107], v[92:99], v14
v_add_f32 v64, v64, v66
v_add_f32 v65, v65, v67
v_cvt_pk_bf16_f32 v63, v64, v65
v_smfmac_f32_16x16x64_bf16 v[68:71], v[20:23], a[176:183], v14
ds_write_b64 v7, v[62:63] offset:12800
v_smfmac_f32_16x16x64_bf16 v[68:71], v[24:27], a[192:199], v14
v_add_f32 v76, v76, v78
v_add_f32 v77, v77, v79
v_smfmac_f32_16x16x64_bf16 v[68:71], v[28:31], a[208:215], v14
ds_read_b128 v[136:139], v1 offset:22528
v_exp_f32 v78, v76
v_smfmac_f32_16x16x64_bf16 v[68:71], v[32:35], a[224:231], v14
ds_read_b128 v[140:143], v1 offset:23552
v_exp_f32 v79, v77
v_smfmac_f32_16x16x64_bf16 v[68:71], v[36:39], a[240:247], v14
s_waitcnt lgkmcnt(2)
s_barrier
ds_read_b64_tr_b16 v[100:101], v9 offset:12800
v_cvt_pk_bf16_f32 v78, v78, v79
v_smfmac_f32_16x16x64_bf16 v[68:71], v[40:43], v[144:151], v14
ds_write_b32 v12, v78 offset:0
ds_read_b64_tr_b16 v[102:103], v9 offset:13312
v_smfmac_f32_16x16x64_bf16 v[68:71], v[44:47], v[160:167], v14
ds_read_b64_tr_b16 v[104:105], v9 offset:13824
v_smfmac_f32_16x16x64_bf16 v[68:71], v[48:51], v[176:183], v14
ds_read_b64_tr_b16 v[106:107], v9 offset:14336
v_smfmac_f32_16x16x64_bf16 v[72:75], v[20:23], a[184:191], v14
v_smfmac_f32_16x16x64_bf16 v[72:75], v[24:27], a[200:207], v14
s_waitcnt lgkmcnt(3)
s_barrier
ds_read_b128 v[124:127], v0 offset:0
v_smfmac_f32_16x16x64_bf16 v[72:75], v[28:31], a[216:223], v14
s_waitcnt lgkmcnt(3)
ds_read_b128 v[128:131], v1 offset:20480
v_add_f32 v68, v68, v70
v_smfmac_f32_16x16x64_bf16 v[80:83], v[100:103], v[84:91], v14
s_waitcnt lgkmcnt(2)
v_add_f32 v69, v69, v71
v_smfmac_f32_16x16x64_bf16 v[80:83], v[104:107], v[92:99], v14
v_cvt_pk_bf16_f32 v116, v68, v69
v_smfmac_f32_16x16x64_bf16 v[72:75], v[32:35], a[232:239], v14
ds_read_b128 v[132:135], v1 offset:21504
v_smfmac_f32_16x16x64_bf16 v[72:75], v[36:39], a[248:255], v14
v_mul_f32 v80, s26, v80
v_mul_f32 v81, s26, v81
v_fmac_f32 v80, s26, v82
v_smfmac_f32_16x16x64_bf16 v[72:75], v[40:43], v[152:159], v14
ds_read_b128 v[100:103], v1 offset:32768
v_fmac_f32 v81, s26, v83
v_smfmac_f32_16x16x64_bf16 v[72:75], v[44:47], v[168:175], v14
s_waitcnt lgkmcnt(3)
ds_read_b128 v[104:107], v1 offset:33792
v_exp_f32 v82, v80
v_mfma_f32_16x16x32_bf16 v[60:63], v[124:127], v[118:121], 0
v_exp_f32 v83, v81
v_smfmac_f32_16x16x64_bf16 v[72:75], v[48:51], v[184:191], v14
s_waitcnt vmcnt(4)
v_cvt_pk_bf16_f32 v122, v82, v83
v_smfmac_f32_16x16x64_bf16 v[52:55], v[124:127], v[108:115], v14
s_nop 0
v_mfma_f32_16x16x16_bf16 v[60:63], v[122:123], v[118:119], v[60:63]
v_add_f32 v72, v72, v74
v_add_f32 v73, v73, v75
v_cvt_pk_bf16_f32 v117, v72, v73
s_nop 1
v_smfmac_f32_16x16x32_bf16 v[52:55], v[122:123], v[116:119], v14
v_rcp_f32 v62, v60
v_rcp_f32 v63, v61
v_maximum3_f32 v16, v60, v61, v62
s_nop 1
v_mul_f32 v52, v52, v62
v_mul_f32 v53, v53, v63
v_mul_f32 v54, v54, v62
v_mul_f32 v55, v55, v63
v_cvt_pk_bf16_f32 v52, v52, v53
v_cvt_pk_bf16_f32 v53, v54, v55
ds_write2_b32 v6, v52, v53 offset0:0 offset1:64
v_maximum3_f32 v16, v16, v63, v63
v_cmp_nge_f32 vcc, s31, v16
buffer_store_dword v13, v18, s[8:11], 0 offen sc1
s_cbranch_vccnz Lc_m1_r3_sl
Lc_m1_r3_slr:
v_mfma_f32_16x16x1_4b_f32 v[20:35], v123, v123, 0
s_waitcnt lgkmcnt(0)
s_barrier
ds_read_b64_tr_b16 v[84:85], v8 offset:8192
ds_read_b64_tr_b16 v[86:87], v8 offset:8448
ds_read_b64_tr_b16 v[88:89], v8 offset:8704
ds_read_b64_tr_b16 v[90:91], v8 offset:8960
ds_read_b64_tr_b16 v[92:93], v8 offset:9216
ds_read_b64_tr_b16 v[94:95], v8 offset:9472
ds_read_b64_tr_b16 v[96:97], v8 offset:9728
ds_read_b64_tr_b16 v[98:99], v8 offset:9984
s_waitcnt lgkmcnt(6)
v_smfmac_f32_16x16x64_bf16 v[20:23], v[84:87], v[128:135], v14 abid:1
s_waitcnt lgkmcnt(4)
ds_read_b128 v[36:39], v1 offset:24576
v_smfmac_f32_16x16x64_bf16 v[20:23], v[88:91], v[136:143], v14 abid:1
s_waitcnt lgkmcnt(3)
ds_read_b128 v[40:43], v1 offset:25600
v_smfmac_f32_16x16x64_bf16 v[20:23], v[92:95], v[192:199], v14 abid:1
s_waitcnt lgkmcnt(2)
ds_read_b128 v[44:47], v1 offset:26624
ds_read_b128 v[48:51], v1 offset:27648
v_smfmac_f32_16x16x64_bf16 v[20:23], v[96:99], v[200:207], v14 abid:1
v_smfmac_f32_16x16x64_bf16 v[24:27], v[84:87], v[208:215], v14 abid:1
ds_read_b128 v[128:131], v1 offset:28672
v_smfmac_f32_16x16x64_bf16 v[24:27], v[88:91], v[216:223], v14 abid:1
s_waitcnt lgkmcnt(3)
ds_read_b128 v[132:135], v1 offset:29696
v_cvt_pk_bf16_f32 v52, v20, v21
v_cvt_pk_bf16_f32 v53, v22, v23
v_smfmac_f32_16x16x64_bf16 v[24:27], v[92:95], v[36:43], v14 abid:1
s_waitcnt lgkmcnt(2)
ds_read_b128 v[136:139], v1 offset:30720
v_and_or_b32 v52, v52, -2, s32
v_smfmac_f32_16x16x64_bf16 v[24:27], v[96:99], v[44:51], v14 abid:1
ds_read_b128 v[140:143], v1 offset:31744
buffer_store_dwordx2 v[52:53], v2, s[8:11], s48 offen sc1
v_smfmac_f32_16x16x64_bf16 v[28:31], v[84:87], v[224:231], v14 abid:1
v_smfmac_f32_16x16x64_bf16 v[28:31], v[88:91], v[232:239], v14 abid:1
s_waitcnt lgkmcnt(2)
ds_read_b128 v[36:39], v1 offset:34816
v_cvt_pk_bf16_f32 v54, v24, v25
v_cvt_pk_bf16_f32 v55, v26, v27
v_smfmac_f32_16x16x64_bf16 v[28:31], v[92:95], v[128:135], v14 abid:1
s_waitcnt lgkmcnt(1)
ds_read_b128 v[40:43], v1 offset:35840
v_and_or_b32 v54, v54, -2, s32
v_smfmac_f32_16x16x64_bf16 v[28:31], v[96:99], v[136:143], v14 abid:1
buffer_store_dwordx2 v[54:55], v2, s[8:11], s49 offen sc1
v_smfmac_f32_16x16x64_bf16 v[32:35], v[84:87], v[240:247], v14 abid:1
v_smfmac_f32_16x16x64_bf16 v[32:35], v[88:91], v[248:255], v14 abid:1
v_cvt_pk_bf16_f32 v56, v28, v29
v_cvt_pk_bf16_f32 v57, v30, v31
v_smfmac_f32_16x16x64_bf16 v[32:35], v[92:95], v[100:107], v14 abid:1
s_waitcnt lgkmcnt(0)
v_and_or_b32 v56, v56, -2, s32
v_smfmac_f32_16x16x64_bf16 v[32:35], v[96:99], v[36:43], v14 abid:1
buffer_store_dwordx2 v[56:57], v2, s[8:11], s50 offen sc1
s_nop 5
s_nop 0
v_cvt_pk_bf16_f32 v58, v32, v33
v_cvt_pk_bf16_f32 v59, v34, v35
v_and_or_b32 v58, v58, -2, s32
buffer_store_dwordx2 v[58:59], v2, s[8:11], s51 offen sc1
s_barrier
s_add_u32 s18, s18, 1
s_bfe_u32 s32, s18, 0x10001
s_xor_b32 s48, s48, 0x40000
s_xor_b32 s49, s49, 0x40000
s_xor_b32 s50, s50, 0x40000
s_xor_b32 s51, s51, 0x40000
s_add_u32 s24, s24, 1048576
s_add_u32 s25, s25, 1048576
s_cmp_eq_u32 s18, s40
s_cbranch_scc1 Lc_m1_r3_exit
s_add_u32 s28, s18, 1
v_mov_b32 v13, s28
s_min_u32 s28, s28, 63
s_mul_i32 s36, s28, 1048576
s_lshl_b32 s29, s16, 13
s_add_u32 s36, s36, s29
s_add_u32 s36, s36, 17039360
s_and_b32 s29, s16, 3
s_lshl_b32 s29, s29, 11
s_add_u32 s19, s36, s29
s_xor_b32 s20, s19, 2048
s_xor_b32 s80, s19, 4096
s_xor_b32 s81, s19, 6144
s_nop 9
v_mfma_f32_32x32x1_2b_f32 v[52:83], v123, v123, 0
ds_read_b128 v[84:87], v1 offset:0
ds_read_b128 v[88:91], v1 offset:1024
ds_read_b128 v[92:95], v1 offset:2048
ds_read_b128 v[96:99], v1 offset:3072
ds_read_b128 v[128:131], v1 offset:4096
ds_read_b128 v[132:135], v1 offset:5120
ds_read_b128 v[136:139], v1 offset:6144
ds_read_b128 v[140:143], v1 offset:7168
s_waitcnt lgkmcnt(0)
s_barrier
buffer_load_dwordx4 v[100:103], v0, s[8:11], s24 offen offset:0 sc1
buffer_load_dwordx4 v[104:107], v0, s[8:11], s24 offen offset:1024 sc1
buffer_load_dwordx4 v[108:111], v0, s[8:11], s25 offen offset:0 sc1
s_branch Lc_m1_r3_head
Lc_m1_r3_y0:
s_cmp_eq_u32 s18, s34
s_cbranch_scc1 Lc_m1_r3_y0r
Lc_m1_r3_y0l:
ds_read_b32 v16, v3 offset:0
ds_read_b128 v[20:23], v0 offset:0
ds_read_b128 v[24:27], v0 offset:1024
ds_read_b128 v[28:31], v0 offset:2048
ds_read_b128 v[32:35], v0 offset:3072
s_add_u32 s46, s46, 1
s_waitcnt lgkmcnt(4)
v_cmp_eq_u32 vcc, s27, v16
s_cbranch_vccz Lc_m1_r3_y0k
ds_read_b32 v16, v3 offset:0
ds_read_b128 v[20:23], v0 offset:0
ds_read_b128 v[24:27], v0 offset:1024
ds_read_b128 v[28:31], v0 offset:2048
ds_read_b128 v[32:35], v0 offset:3072
s_add_u32 s46, s46, 1
s_waitcnt lgkmcnt(4)
v_cmp_eq_u32 vcc, s27, v16
s_cbranch_vccz Lc_m1_r3_y0k
s_add_u32 s30, s30, 1
s_cmp_gt_u32 s30, 1000000
s_cbranch_scc1 Lc_m1_abort
s_branch Lc_m1_r3_y0l
Lc_m1_r3_y0k:
v_mov_b32 v52, 0
v_mov_b32 v53, 0
v_mov_b32 v54, 0
v_mov_b32 v55, 0
v_mov_b32 v56, 0
v_mov_b32 v57, 0
v_mov_b32 v58, 0
v_mov_b32 v59, 0
s_waitcnt lgkmcnt(3)
v_smfmac_f32_16x16x64_bf16 v[52:55], v[20:23], v[84:91], v14
v_smfmac_f32_16x16x64_bf16 v[56:59], v[20:23], v[92:99], v14
s_waitcnt lgkmcnt(0)
s_branch Lc_m1_r3_y0r
Lc_m1_r3_y1:
s_cmp_eq_u32 s18, s34
s_cbranch_scc1 Lc_m1_r3_y1r
Lc_m1_r3_y1l:
ds_read_b32 v17, v3 offset:4096
ds_read_b128 v[36:39], v0 offset:4096
ds_read_b128 v[40:43], v0 offset:5120
ds_read_b128 v[44:47], v0 offset:6144
ds_read_b128 v[48:51], v0 offset:7168
s_add_u32 s47, s47, 1
s_waitcnt lgkmcnt(4)
v_cmp_eq_u32 vcc, s27, v17
s_cbranch_vccz Lc_m1_r3_y1k
ds_read_b32 v17, v3 offset:4096
ds_read_b128 v[36:39], v0 offset:4096
ds_read_b128 v[40:43], v0 offset:5120
ds_read_b128 v[44:47], v0 offset:6144
ds_read_b128 v[48:51], v0 offset:7168
s_add_u32 s47, s47, 1
s_waitcnt lgkmcnt(4)
v_cmp_eq_u32 vcc, s27, v17
s_cbranch_vccz Lc_m1_r3_y1k
s_add_u32 s30, s30, 1
s_cmp_gt_u32 s30, 1000000
s_cbranch_scc1 Lc_m1_abort
s_branch Lc_m1_r3_y1l
Lc_m1_r3_y1k:
s_waitcnt lgkmcnt(0)
s_branch Lc_m1_r3_y1r
Lc_m1_r3_sl:
v_max3_f32 v16, v76, v77, v80
v_max_f32 v16, v16, v81
v_lshrrev_b32 v61, 2, v0
ds_write_b32 v61, v16 offset:1792
v_and_b32 v61, 63, v61
v_add_u32 v61, 1024, v61
s_mov_b64 s[38:39], 0
v_cmp_eq_u32 vcc, s27, v20
s_or_b64 s[38:39], s[38:39], vcc
v_cmp_eq_u32 vcc, s27, v21
s_or_b64 s[38:39], s[38:39], vcc
v_cmp_eq_u32 vcc, s27, v22
s_or_b64 s[38:39], s[38:39], vcc
v_cmp_eq_u32 vcc, s27, v23
s_or_b64 s[38:39], s[38:39], vcc
v_cmp_eq_u32 vcc, s27, v24
s_or_b64 s[38:39], s[38:39], vcc
v_cmp_eq_u32 vcc, s27, v25
s_or_b64 s[38:39], s[38:39], vcc
v_cmp_eq_u32 vcc, s27, v26
s_or_b64 s[38:39], s[38:39], vcc
v_cmp_eq_u32 vcc, s27, v27
s_or_b64 s[38:39], s[38:39], vcc
v_cmp_eq_u32 vcc, s27, v28
s_or_b64 s[38:39], s[38:39], vcc
v_cmp_eq_u32 vcc, s27, v29
s_or_b64 s[38:39], s[38:39], vcc
v_cmp_eq_u32 vcc, s27, v30
s_or_b64 s[38:39], s[38:39], vcc
v_cmp_eq_u32 vcc, s27, v31
s_or_b64 s[38:39], s[38:39], vcc
v_cmp_eq_u32 vcc, s27, v32
s_or_b64 s[38:39], s[38:39], vcc
v_cmp_eq_u32 vcc, s27, v33
s_or_b64 s[38:39], s[38:39], vcc
v_cmp_eq_u32 vcc, s27, v34
s_or_b64 s[38:39], s[38:39], vcc
v_cmp_eq_u32 vcc, s27, v35
s_or_b64 s[38:39], s[38:39], vcc
v_cmp_eq_u32 vcc, s27, v36
s_or_b64 s[38:39], s[38:39], vcc
v_cmp_eq_u32 vcc, s27, v37
s_or_b64 s[38:39], s[38:39], vcc
v_cmp_eq_u32 vcc, s27, v38
s_or_b64 s[38:39], s[38:39], vcc
v_cmp_eq_u32 vcc, s27, v39
s_or_b64 s[38:39], s[38:39], vcc
v_cmp_eq_u32 vcc, s27, v40
s_or_b64 s[38:39], s[38:39], vcc
v_cmp_eq_u32 vcc, s27, v41
s_or_b64 s[38:39], s[38:39], vcc
v_cmp_eq_u32 vcc, s27, v42
s_or_b64 s[38:39], s[38:39], vcc
v_cmp_eq_u32 vcc, s27, v43
s_or_b64 s[38:39], s[38:39], vcc
v_cmp_eq_u32 vcc, s27, v44
s_or_b64 s[38:39], s[38:39], vcc
v_cmp_eq_u32 vcc, s27, v45
s_or_b64 s[38:39], s[38:39], vcc
v_cmp_eq_u32 vcc, s27, v46
s_or_b64 s[38:39], s[38:39], vcc
v_cmp_eq_u32 vcc, s27, v47
s_or_b64 s[38:39], s[38:39], vcc
v_cmp_eq_u32 vcc, s27, v48
s_or_b64 s[38:39], s[38:39], vcc
v_cmp_eq_u32 vcc, s27, v49
s_or_b64 s[38:39], s[38:39], vcc
v_cmp_eq_u32 vcc, s27, v50
s_or_b64 s[38:39], s[38:39], vcc
v_cmp_eq_u32 vcc, s27, v51
s_or_b64 s[38:39], s[38:39], vcc
s_cselect_b32 s36, 1, 0
v_mov_b32 v60, s36
ds_write_b32 v123, v60 offset:2060
s_waitcnt lgkmcnt(0)
s_barrier
ds_read_b128 v[84:87], v123 offset:2048
s_waitcnt lgkmcnt(0)
v_or3_b32 v84, v84, v85, v86
v_or_b32 v84, v84, v87
v_cmp_ne_u32 vcc, 0, v84
s_cbranch_vccnz Lc_m1_r3_x
ds_read2_b32 v[84:85], v61 offset0:0 offset1:16
ds_read2_b32 v[86:87], v61 offset0:32 offset1:48
ds_read2_b32 v[88:89], v61 offset0:64 offset1:80
ds_read2_b32 v[90:91], v61 offset0:96 offset1:112
ds_read2_b32 v[92:93], v61 offset0:128 offset1:144
ds_read2_b32 v[94:95], v61 offset0:160 offset1:176
ds_read2_b32 v[96:97], v61 offset0:192 offset1:208
ds_read2_b32 v[98:99], v61 offset0:224 offset1:240
s_waitcnt lgkmcnt(0)
v_max3_f32 v16, v16, v84, v85
v_max3_f32 v16, v16, v86, v87
v_max3_f32 v16, v16, v88, v89
v_max3_f32 v16, v16, v90, v91
v_max3_f32 v16, v16, v92, v93
v_max3_f32 v16, v16, v94, v95
v_max3_f32 v16, v16, v96, v97
v_max3_f32 v16, v16, v98, v99
v_sub_f32 v78, v76, v16
v_sub_f32 v79, v77, v16
v_exp_f32 v78, v78
v_exp_f32 v79, v79
v_sub_f32 v82, v80, v16
v_sub_f32 v83, v81, v16
v_exp_f32 v82, v82
v_exp_f32 v83, v83
v_cvt_pk_bf16_f32 v78, v78, v79
ds_write_b32 v12, v78 offset:0
v_cvt_pk_bf16_f32 v122, v82, v83
v_mov_b32 v52, 0
v_mov_b32 v53, 0
v_mov_b32 v54, 0
v_mov_b32 v55, 0
s_waitcnt lgkmcnt(0)
s_barrier
ds_read_b128 v[124:127], v0 offset:0
s_waitcnt lgkmcnt(0)
v_mfma_f32_16x16x32_bf16 v[60:63], v[124:127], v[118:121], 0
v_smfmac_f32_16x16x64_bf16 v[52:55], v[124:127], v[108:115], v14
v_mfma_f32_16x16x16_bf16 v[60:63], v[122:123], v[118:119], v[60:63]
v_smfmac_f32_16x16x32_bf16 v[52:55], v[122:123], v[116:119], v14
s_nop 2
s_nop 0
v_rcp_f32 v62, v60
v_rcp_f32 v63, v61
v_maximum3_f32 v16, v60, v61, v62
v_mul_f32 v52, v52, v62
v_mul_f32 v53, v53, v63
v_mul_f32 v54, v54, v62
v_mul_f32 v55, v55, v63
v_cvt_pk_bf16_f32 v52, v52, v53
v_cvt_pk_bf16_f32 v53, v54, v55
ds_write2_b32 v6, v52, v53 offset0:0 offset1:64
s_branch Lc_m1_r3_slr
Lc_m1_r3_x:
s_add_u32 s44, s44, 1
s_add_u32 s30, s30, 1
s_cmp_gt_u32 s30, 1000000
s_cbranch_scc1 Lc_m1_abort
s_waitcnt vmcnt(0) lgkmcnt(0)
s_barrier
buffer_load_dwordx4 v[100:103], v0, s[8:11], s24 offen offset:0 sc1
buffer_load_dwordx4 v[104:107], v0, s[8:11], s24 offen offset:1024 sc1
buffer_load_dwordx4 v[108:111], v0, s[8:11], s25 offen offset:0 sc1
v_mfma_f32_32x32x1_2b_f32 v[52:83], v123, v123, 0
ds_read_b128 v[84:87], v1 offset:0
ds_read_b128 v[88:91], v1 offset:1024
ds_read_b128 v[92:95], v1 offset:2048
ds_read_b128 v[96:99], v1 offset:3072
ds_read_b128 v[128:131], v1 offset:4096
ds_read_b128 v[132:135], v1 offset:5120
ds_read_b128 v[136:139], v1 offset:6144
ds_read_b128 v[140:143], v1 offset:7168
s_waitcnt vmcnt(0) lgkmcnt(0)
s_branch Lc_m1_r3_head
Lc_m1_r3_exit:
s_branch Lc_m1_done
Lc_m1_abort:
s_branch Lc_abort
Lc_m1_done:
s_branch Lc_done
Lc_abort:
Lc_done:
s_branch L_fin
L_redo:
s_barrier
s_cmp_lg_u32 s17, 0
s_cbranch_scc1 L_rr
s_mov_b32 s20, s3
s_mov_b32 s21, 0
s_mov_b32 s82, 256
s_mul_i32 s26, s2, 11
s_and_b32 s26, s26, 31
L_rs:
s_lshl_b32 s27, s20, 2
s_cselect_b32 s27, s27, 160
s_mov_b32 s23, 0
s_atomic_or s23, s[6:7], s27 glc
s_waitcnt lgkmcnt(0)
L_rt:
s_cmp_eq_u32 s23, -1
s_cbranch_scc1 L_rn
s_mov_b32 s22, s23
s_lshr_b64 s[24:25], s[22:23], s26
s_ff0_i32_b32 s22, s24
s_add_u32 s22, s22, s26
s_and_b32 s22, s22, 31
s_lshl_b32 s24, 1, s22
s_mov_b32 s23, s24
s_atomic_or s23, s[6:7], s27 glc
s_waitcnt lgkmcnt(0)
s_and_b32 s25, s23, s24
s_cbranch_scc1 L_rt
s_lshl_b32 s82, s20, 5
s_add_u32 s82, s82, s22
s_branch L_rh
L_rn:
s_add_u32 s20, s20, 1
s_and_b32 s20, s20, 7
s_add_u32 s21, s21, 1
s_cmp_lt_u32 s21, 8
s_cbranch_scc1 L_rs
L_rh:
v_mov_b32 v61, s82
ds_write_b32 v60, v61
L_rr:
s_waitcnt vmcnt(0) lgkmcnt(0)
s_barrier
ds_read_b32 v61, v60
s_waitcnt lgkmcnt(0)
v_readfirstlane_b32 s82, v61
s_mov_b32 s83, 1
s_cmp_ge_u32 s82, 256
s_cbranch_scc1 L_end
s_branch L_go
L_work:
s_lshr_b32 s21, s82, 5
s_and_b32 s22, s82, 31
s_mov_b32 s62, s22
s_cmp_eq_u32 s21, 1
s_cbranch_scc1 L_fft
s_sub_u32 s23, s82, 128
s_cmp_ge_u32 s21, 6
s_cbranch_scc1 L_hj
s_sub_u32 s21, s21, 2
s_lshl_b32 s21, s21, 4
s_and_b32 s23, s22, 15
s_add_u32 s23, s23, s21
s_mov_b32 s62, s23
s_cmp_lt_u32 s22, 16
s_cbranch_scc1 L_out
L_hj:
s_lshr_b32 s16, s23, 2
s_and_b32 s41, s23, 3
s_and_b32 s18, s23, 1
v_mbcnt_lo_u32_b32 v51, -1, 0
v_mbcnt_hi_u32_b32 v51, -1, v51
s_lshl_b32 s28, s17, 6
v_add_u32 v51, s28, v51
v_bfe_u32 v50, v51, 1, 3
v_bfe_u32 v49, v51, 4, 2
v_xor_b32 v50, v50, v49
v_lshlrev_b32 v50, 5, v50
v_and_b32 v49, 1, v51
v_lshl_add_u32 v48, v49, 4, v50
s_lshl_b32 s28, s16, 8
v_bfe_u32 v0, v51, 4, 2
v_lshlrev_b32 v0, 13, v0
v_bfe_u32 v50, v51, 6, 2
v_lshl_add_u32 v0, v50, 17, v0
v_add_u32 v0, s28, v0
v_add_u32 v0, v0, v48
v_xor_b32 v1, 128, v0
s_mul_i32 s36, s17, 36864
s_add_u32 s36, s36, 16384
s_mov_b32 s14, 0x400000
s_mov_b32 s15, 0x20000
s_mov_b32 s14, 0x400000
s_mov_b32 s15, 0x20000
s_lshl_b32 s28, s41, 8
v_add_u32 v49, s28, v51
s_lshl_b32 s28, s16, 8
v_bfe_u32 v58, v49, 1, 10
v_lshlrev_b32 v58, 13, v58
v_bfe_u32 v50, v49, 0, 1
v_lshl_add_u32 v58, v50, 7, v58
v_add_u32 v58, s28, v58
v_lshlrev_b32 v57, 7, v49
s_lshl_b32 s29, s16, 17
v_add_u32 v57, s29, v57
s_mov_b32 s12, s74
s_mov_b32 s13, s75
s_add_u32 m0, s36, 0
s_mov_b32 s28, 0
buffer_load_dwordx4 v0, s[12:15], s28 offen  lds
s_add_u32 m0, s36, 1024
s_mov_b32 s28, 32768
buffer_load_dwordx4 v1, s[12:15], s28 offen  lds
s_add_u32 m0, s36, 2048
s_mov_b32 s28, 65536
buffer_load_dwordx4 v0, s[12:15], s28 offen  lds
s_add_u32 m0, s36, 3072
s_mov_b32 s28, 98304
buffer_load_dwordx4 v1, s[12:15], s28 offen  lds
s_add_u32 m0, s36, 4096
s_mov_b32 s28, 524288
buffer_load_dwordx4 v0, s[12:15], s28 offen  lds
s_add_u32 m0, s36, 5120
s_mov_b32 s28, 557056
buffer_load_dwordx4 v1, s[12:15], s28 offen  lds
s_add_u32 m0, s36, 6144
s_mov_b32 s28, 589824
buffer_load_dwordx4 v0, s[12:15], s28 offen  lds
s_add_u32 m0, s36, 7168
s_mov_b32 s28, 622592
buffer_load_dwordx4 v1, s[12:15], s28 offen  lds
s_add_u32 m0, s36, 8192
s_mov_b32 s28, 1048576
buffer_load_dwordx4 v0, s[12:15], s28 offen  lds
s_add_u32 m0, s36, 9216
s_mov_b32 s28, 1081344
buffer_load_dwordx4 v1, s[12:15], s28 offen  lds
s_add_u32 m0, s36, 10240
s_mov_b32 s28, 1114112
buffer_load_dwordx4 v0, s[12:15], s28 offen  lds
s_add_u32 m0, s36, 11264
s_mov_b32 s28, 1146880
buffer_load_dwordx4 v1, s[12:15], s28 offen  lds
s_add_u32 m0, s36, 12288
s_mov_b32 s28, 1572864
buffer_load_dwordx4 v0, s[12:15], s28 offen  lds
s_add_u32 m0, s36, 13312
s_mov_b32 s28, 1605632
buffer_load_dwordx4 v1, s[12:15], s28 offen  lds
s_add_u32 m0, s36, 14336
s_mov_b32 s28, 1638400
buffer_load_dwordx4 v0, s[12:15], s28 offen  lds
s_add_u32 m0, s36, 15360
s_mov_b32 s28, 1671168
buffer_load_dwordx4 v1, s[12:15], s28 offen  lds
s_add_u32 m0, s36, 16384
s_mov_b32 s28, 2097152
buffer_load_dwordx4 v0, s[12:15], s28 offen  lds
s_add_u32 m0, s36, 17408
s_mov_b32 s28, 2129920
buffer_load_dwordx4 v1, s[12:15], s28 offen  lds
s_add_u32 m0, s36, 18432
s_mov_b32 s28, 2162688
buffer_load_dwordx4 v0, s[12:15], s28 offen  lds
s_add_u32 m0, s36, 19456
s_mov_b32 s28, 2195456
buffer_load_dwordx4 v1, s[12:15], s28 offen  lds
s_add_u32 m0, s36, 20480
s_mov_b32 s28, 2621440
buffer_load_dwordx4 v0, s[12:15], s28 offen  lds
s_add_u32 m0, s36, 21504
s_mov_b32 s28, 2654208
buffer_load_dwordx4 v1, s[12:15], s28 offen  lds
s_add_u32 m0, s36, 22528
s_mov_b32 s28, 2686976
buffer_load_dwordx4 v0, s[12:15], s28 offen  lds
s_add_u32 m0, s36, 23552
s_mov_b32 s28, 2719744
buffer_load_dwordx4 v1, s[12:15], s28 offen  lds
s_add_u32 m0, s36, 24576
s_mov_b32 s28, 3145728
buffer_load_dwordx4 v0, s[12:15], s28 offen  lds
s_add_u32 m0, s36, 25600
s_mov_b32 s28, 3178496
buffer_load_dwordx4 v1, s[12:15], s28 offen  lds
s_add_u32 m0, s36, 26624
s_mov_b32 s28, 3211264
buffer_load_dwordx4 v0, s[12:15], s28 offen  lds
s_add_u32 m0, s36, 27648
s_mov_b32 s28, 3244032
buffer_load_dwordx4 v1, s[12:15], s28 offen  lds
s_add_u32 m0, s36, 28672
s_mov_b32 s28, 3670016
buffer_load_dwordx4 v0, s[12:15], s28 offen  lds
s_add_u32 m0, s36, 29696
s_mov_b32 s28, 3702784
buffer_load_dwordx4 v1, s[12:15], s28 offen  lds
s_add_u32 m0, s36, 30720
s_mov_b32 s28, 3735552
buffer_load_dwordx4 v0, s[12:15], s28 offen  lds
s_add_u32 m0, s36, 31744
s_mov_b32 s28, 3768320
buffer_load_dwordx4 v1, s[12:15], s28 offen  lds
s_mov_b32 s12, s76
s_mov_b32 s13, s77
s_add_u32 m0, s36, 32768
s_mov_b32 s28, 0
buffer_load_dwordx4 v0, s[12:15], s28 offen  lds
s_add_u32 m0, s36, 33792
s_mov_b32 s28, 32768
buffer_load_dwordx4 v1, s[12:15], s28 offen  lds
s_add_u32 m0, s36, 34816
s_mov_b32 s28, 65536
buffer_load_dwordx4 v0, s[12:15], s28 offen  lds
s_add_u32 m0, s36, 35840
s_mov_b32 s28, 98304
buffer_load_dwordx4 v1, s[12:15], s28 offen  lds
v_bfe_u32 v48, v51, 7, 1
v_lshlrev_b32 v48, 2, v48
v_bfe_u32 v50, v51, 6, 1
v_lshl_add_u32 v48, v50, 0, v48
v_bfe_u32 v50, v51, 1, 1
v_lshl_add_u32 v48, v50, 1, v48
v_bfe_u32 v49, v51, 5, 1
v_lshlrev_b32 v49, 11, v49
v_bfe_u32 v50, v51, 2, 2
v_lshl_add_u32 v49, v50, 8, v49
v_bfe_u32 v50, v51, 0, 1
v_lshl_add_u32 v49, v50, 4, v49
v_bfe_u32 v50, v51, 4, 1
v_lshl_add_u32 v49, v50, 3, v49
v_bfe_u32 v50, v51, 2, 2
v_xor_b32 v48, v48, v50
v_lshl_add_u32 v49, v48, 5, v49
v_add_u32 v2, 16384, v49
v_xor_b32 v3, 128, v2
v_add_u32 v3, 1024, v3
v_bfe_u32 v48, v51, 6, 2
v_lshlrev_b32 v48, 1, v48
v_bfe_u32 v50, v51, 4, 1
v_lshl_add_u32 v48, v50, 0, v48
v_bfe_u32 v49, v51, 5, 1
v_lshlrev_b32 v49, 11, v49
v_bfe_u32 v50, v51, 2, 2
v_lshl_add_u32 v49, v50, 8, v49
v_bfe_u32 v50, v51, 0, 2
v_lshl_add_u32 v49, v50, 3, v49
v_bfe_u32 v50, v51, 2, 2
v_xor_b32 v48, v48, v50
v_lshl_add_u32 v49, v48, 5, v49
v_add_u32 v6, 16384, v49
v_xor_b32 v7, 128, v6
v_add_u32 v7, 1024, v7
v_bfe_u32 v10, v51, 0, 6
v_lshlrev_b32 v10, 4, v10
v_bfe_u32 v11, v51, 0, 5
v_mul_u32_u24 v11, 1040, v11
v_bfe_u32 v50, v51, 5, 1
v_lshl_add_u32 v11, v50, 4, v11
v_bfe_u32 v48, v51, 2, 1
v_lshlrev_b32 v48, 4, v48
v_bfe_u32 v50, v51, 3, 2
v_lshl_add_u32 v48, v50, 2, v48
v_bfe_u32 v50, v51, 0, 2
v_lshl_add_u32 v48, v50, 0, v48
v_bfe_u32 v49, v51, 6, 2
v_lshlrev_b32 v49, 2, v49
v_bfe_u32 v50, v51, 5, 1
v_lshl_add_u32 v49, v50, 1, v49
v_and_b32 v50, 7, v51
v_xor_b32 v49, v49, v50
v_lshlrev_b32 v49, 4, v49
v_bfe_u32 v12, v51, 0, 5
v_lshlrev_b32 v12, 8, v12
v_add_u32 v12, 99840, v12
v_add_u32 v12, v12, v49
v_bfe_u32 v13, v51, 5, 3
v_lshlrev_b32 v13, 10, v13
v_bfe_u32 v50, v51, 0, 4
v_lshl_add_u32 v13, v50, 4, v13
v_bfe_u32 v50, v51, 4, 1
v_lshl_add_u32 v13, v50, 2, v13
v_add_u32 v13, 116224, v13
v_bfe_u32 v14, v51, 0, 8
v_lshlrev_b32 v14, 4, v14
v_add_u32 v14, 99840, v14
v_bfe_u32 v50, v51, 4, 3
v_and_b32 v49, 15, v51
v_xor_b32 v49, v49, v50
v_bfe_u32 v15, v51, 6, 1
v_lshlrev_b32 v15, 12, v15
v_bfe_u32 v50, v51, 7, 1
v_lshl_add_u32 v15, v50, 10, v15
v_bfe_u32 v50, v51, 4, 2
v_lshl_add_u32 v15, v50, 8, v15
v_lshl_add_u32 v15, v49, 4, v15
v_bfe_u32 v17, v51, 0, 8
v_lshlrev_b32 v17, 4, v17
v_bfe_u32 v49, v51, 6, 1
v_lshlrev_b32 v49, 3, v49
v_bfe_u32 v50, v51, 1, 1
v_lshl_add_u32 v49, v50, 2, v49
v_bfe_u32 v50, v51, 4, 2
v_lshl_add_u32 v49, v50, 0, v49
v_bfe_u32 v48, v51, 0, 1
v_bfe_u32 v50, v51, 2, 1
v_lshl_add_u32 v48, v50, 1, v48
v_xor_b32 v49, v49, v48
v_bfe_u32 v20, v51, 0, 1
v_lshlrev_b32 v20, 8, v20
v_bfe_u32 v50, v51, 2, 1
v_lshl_add_u32 v20, v50, 9, v20
v_bfe_u32 v50, v51, 3, 1
v_lshl_add_u32 v20, v50, 11, v20
v_bfe_u32 v50, v51, 7, 1
v_lshl_add_u32 v20, v50, 12, v20
v_add_u32 v20, 99840, v20
v_lshl_add_u32 v20, v49, 4, v20
v_xor_b32 v21, 64, v20
v_add_u32 v21, 1024, v21
s_lshl_b32 s28, s16, 7
s_lshl_b32 s29, s41, 2
s_add_u32 s28, s28, s29
v_bfe_u32 v16, v51, 0, 8
v_lshlrev_b32 v16, 20, v16
v_min_u32 v16, 1, v16
v_lshlrev_b32 v16, 30, v16
v_add_u32 v16, 1122304, v16
v_add_u32 v16, s28, v16
s_waitcnt vmcnt(32)
s_barrier
ds_read_b64_tr_b16 a[128:129], v2 offset:0
ds_read_b64_tr_b16 a[130:131], v3 offset:0
v_add_u32 v4, 36864, v2
v_add_u32 v5, 36864, v3
ds_read_b64_tr_b16 a[132:133], v4 offset:0
ds_read_b64_tr_b16 a[134:135], v5 offset:0
v_add_u32 v4, 73728, v2
v_add_u32 v5, 73728, v3
ds_read_b64_tr_b16 a[136:137], v4 offset:0
ds_read_b64_tr_b16 a[138:139], v5 offset:0
v_add_u32 v4, 110592, v2
v_add_u32 v5, 110592, v3
ds_read_b64_tr_b16 a[140:141], v4 offset:0
ds_read_b64_tr_b16 a[142:143], v5 offset:0
s_waitcnt lgkmcnt(0)
s_waitcnt vmcnt(28)
s_barrier
s_cmp_lg_u32 s83, 0
s_cbranch_scc1 L_vf_11
v_mov_b32 v60, 15920
s_cmp_lg_u32 s17, 0
s_cbranch_scc1 L_vg_12
s_waitcnt lgkmcnt(0)
s_and_b32 s100, s100, s101
v_mov_b32 v61, s100
ds_write_b32 v60, v61
L_vg_12:
s_waitcnt lgkmcnt(0)
s_barrier
ds_read_b32 v61, v60
s_waitcnt lgkmcnt(0)
v_cmp_ne_u32 vcc, 0, v61
s_cbranch_vccnz L_redo
L_vf_11:
s_add_u32 m0, s36, 0
s_mov_b32 s28, 524288
buffer_load_dwordx4 v0, s[12:15], s28 offen  lds
s_add_u32 m0, s36, 1024
s_mov_b32 s28, 557056
buffer_load_dwordx4 v1, s[12:15], s28 offen  lds
s_add_u32 m0, s36, 2048
s_mov_b32 s28, 589824
buffer_load_dwordx4 v0, s[12:15], s28 offen  lds
s_add_u32 m0, s36, 3072
s_mov_b32 s28, 622592
buffer_load_dwordx4 v1, s[12:15], s28 offen  lds
ds_read_b64_tr_b16 a[144:145], v2 offset:4096
ds_read_b64_tr_b16 a[146:147], v3 offset:4096
v_add_u32 v4, 36864, v2
v_add_u32 v5, 36864, v3
ds_read_b64_tr_b16 a[148:149], v4 offset:4096
ds_read_b64_tr_b16 a[150:151], v5 offset:4096
v_add_u32 v4, 73728, v2
v_add_u32 v5, 73728, v3
ds_read_b64_tr_b16 a[152:153], v4 offset:4096
ds_read_b64_tr_b16 a[154:155], v5 offset:4096
v_add_u32 v4, 110592, v2
v_add_u32 v5, 110592, v3
ds_read_b64_tr_b16 a[156:157], v4 offset:4096
ds_read_b64_tr_b16 a[158:159], v5 offset:4096
s_waitcnt lgkmcnt(0)
s_waitcnt vmcnt(28)
s_barrier
s_add_u32 m0, s36, 4096
s_mov_b32 s28, 1048576
buffer_load_dwordx4 v0, s[12:15], s28 offen  lds
s_add_u32 m0, s36, 5120
s_mov_b32 s28, 1081344
buffer_load_dwordx4 v1, s[12:15], s28 offen  lds
s_add_u32 m0, s36, 6144
s_mov_b32 s28, 1114112
buffer_load_dwordx4 v0, s[12:15], s28 offen  lds
s_add_u32 m0, s36, 7168
s_mov_b32 s28, 1146880
buffer_load_dwordx4 v1, s[12:15], s28 offen  lds
ds_read_b64_tr_b16 a[160:161], v2 offset:8192
ds_read_b64_tr_b16 a[162:163], v3 offset:8192
v_add_u32 v4, 36864, v2
v_add_u32 v5, 36864, v3
ds_read_b64_tr_b16 a[164:165], v4 offset:8192
ds_read_b64_tr_b16 a[166:167], v5 offset:8192
v_add_u32 v4, 73728, v2
v_add_u32 v5, 73728, v3
ds_read_b64_tr_b16 a[168:169], v4 offset:8192
ds_read_b64_tr_b16 a[170:171], v5 offset:8192
v_add_u32 v4, 110592, v2
v_add_u32 v5, 110592, v3
ds_read_b64_tr_b16 a[172:173], v4 offset:8192
ds_read_b64_tr_b16 a[174:175], v5 offset:8192
s_waitcnt lgkmcnt(0)
s_waitcnt vmcnt(28)
s_barrier
s_add_u32 m0, s36, 8192
s_mov_b32 s28, 1572864
buffer_load_dwordx4 v0, s[12:15], s28 offen  lds
s_add_u32 m0, s36, 9216
s_mov_b32 s28, 1605632
buffer_load_dwordx4 v1, s[12:15], s28 offen  lds
s_add_u32 m0, s36, 10240
s_mov_b32 s28, 1638400
buffer_load_dwordx4 v0, s[12:15], s28 offen  lds
s_add_u32 m0, s36, 11264
s_mov_b32 s28, 1671168
buffer_load_dwordx4 v1, s[12:15], s28 offen  lds
ds_read_b64_tr_b16 a[176:177], v2 offset:12288
ds_read_b64_tr_b16 a[178:179], v3 offset:12288
v_add_u32 v4, 36864, v2
v_add_u32 v5, 36864, v3
ds_read_b64_tr_b16 a[180:181], v4 offset:12288
ds_read_b64_tr_b16 a[182:183], v5 offset:12288
v_add_u32 v4, 73728, v2
v_add_u32 v5, 73728, v3
ds_read_b64_tr_b16 a[184:185], v4 offset:12288
ds_read_b64_tr_b16 a[186:187], v5 offset:12288
v_add_u32 v4, 110592, v2
v_add_u32 v5, 110592, v3
ds_read_b64_tr_b16 a[188:189], v4 offset:12288
ds_read_b64_tr_b16 a[190:191], v5 offset:12288
s_waitcnt lgkmcnt(0)
s_waitcnt vmcnt(28)
s_barrier
s_add_u32 m0, s36, 12288
s_mov_b32 s28, 2097152
buffer_load_dwordx4 v0, s[12:15], s28 offen  lds
s_add_u32 m0, s36, 13312
s_mov_b32 s28, 2129920
buffer_load_dwordx4 v1, s[12:15], s28 offen  lds
s_add_u32 m0, s36, 14336
s_mov_b32 s28, 2162688
buffer_load_dwordx4 v0, s[12:15], s28 offen  lds
s_add_u32 m0, s36, 15360
s_mov_b32 s28, 2195456
buffer_load_dwordx4 v1, s[12:15], s28 offen  lds
ds_read_b64_tr_b16 a[192:193], v2 offset:16384
ds_read_b64_tr_b16 a[194:195], v3 offset:16384
v_add_u32 v4, 36864, v2
v_add_u32 v5, 36864, v3
ds_read_b64_tr_b16 a[196:197], v4 offset:16384
ds_read_b64_tr_b16 a[198:199], v5 offset:16384
v_add_u32 v4, 73728, v2
v_add_u32 v5, 73728, v3
ds_read_b64_tr_b16 a[200:201], v4 offset:16384
ds_read_b64_tr_b16 a[202:203], v5 offset:16384
v_add_u32 v4, 110592, v2
v_add_u32 v5, 110592, v3
ds_read_b64_tr_b16 a[204:205], v4 offset:16384
ds_read_b64_tr_b16 a[206:207], v5 offset:16384
s_waitcnt lgkmcnt(0)
s_waitcnt vmcnt(28)
s_barrier
s_add_u32 m0, s36, 16384
s_mov_b32 s28, 2621440
buffer_load_dwordx4 v0, s[12:15], s28 offen  lds
s_add_u32 m0, s36, 17408
s_mov_b32 s28, 2654208
buffer_load_dwordx4 v1, s[12:15], s28 offen  lds
s_add_u32 m0, s36, 18432
s_mov_b32 s28, 2686976
buffer_load_dwordx4 v0, s[12:15], s28 offen  lds
s_add_u32 m0, s36, 19456
s_mov_b32 s28, 2719744
buffer_load_dwordx4 v1, s[12:15], s28 offen  lds
ds_read_b64_tr_b16 a[208:209], v2 offset:20480
ds_read_b64_tr_b16 a[210:211], v3 offset:20480
v_add_u32 v4, 36864, v2
v_add_u32 v5, 36864, v3
ds_read_b64_tr_b16 a[212:213], v4 offset:20480
ds_read_b64_tr_b16 a[214:215], v5 offset:20480
v_add_u32 v4, 73728, v2
v_add_u32 v5, 73728, v3
ds_read_b64_tr_b16 a[216:217], v4 offset:20480
ds_read_b64_tr_b16 a[218:219], v5 offset:20480
v_add_u32 v4, 110592, v2
v_add_u32 v5, 110592, v3
ds_read_b64_tr_b16 a[220:221], v4 offset:20480
ds_read_b64_tr_b16 a[222:223], v5 offset:20480
s_waitcnt lgkmcnt(0)
s_waitcnt vmcnt(28)
s_barrier
s_add_u32 m0, s36, 20480
s_mov_b32 s28, 3145728
buffer_load_dwordx4 v0, s[12:15], s28 offen  lds
s_add_u32 m0, s36, 21504
s_mov_b32 s28, 3178496
buffer_load_dwordx4 v1, s[12:15], s28 offen  lds
s_add_u32 m0, s36, 22528
s_mov_b32 s28, 3211264
buffer_load_dwordx4 v0, s[12:15], s28 offen  lds
s_add_u32 m0, s36, 23552
s_mov_b32 s28, 3244032
buffer_load_dwordx4 v1, s[12:15], s28 offen  lds
ds_read_b64_tr_b16 a[224:225], v2 offset:24576
ds_read_b64_tr_b16 a[226:227], v3 offset:24576
v_add_u32 v4, 36864, v2
v_add_u32 v5, 36864, v3
ds_read_b64_tr_b16 a[228:229], v4 offset:24576
ds_read_b64_tr_b16 a[230:231], v5 offset:24576
v_add_u32 v4, 73728, v2
v_add_u32 v5, 73728, v3
ds_read_b64_tr_b16 a[232:233], v4 offset:24576
ds_read_b64_tr_b16 a[234:235], v5 offset:24576
v_add_u32 v4, 110592, v2
v_add_u32 v5, 110592, v3
ds_read_b64_tr_b16 a[236:237], v4 offset:24576
ds_read_b64_tr_b16 a[238:239], v5 offset:24576
s_waitcnt lgkmcnt(0)
s_waitcnt vmcnt(28)
s_barrier
s_add_u32 m0, s36, 24576
s_mov_b32 s28, 3670016
buffer_load_dwordx4 v0, s[12:15], s28 offen  lds
s_add_u32 m0, s36, 25600
s_mov_b32 s28, 3702784
buffer_load_dwordx4 v1, s[12:15], s28 offen  lds
s_add_u32 m0, s36, 26624
s_mov_b32 s28, 3735552
buffer_load_dwordx4 v0, s[12:15], s28 offen  lds
s_add_u32 m0, s36, 27648
s_mov_b32 s28, 3768320
buffer_load_dwordx4 v1, s[12:15], s28 offen  lds
ds_read_b64_tr_b16 a[240:241], v2 offset:28672
ds_read_b64_tr_b16 a[242:243], v3 offset:28672
v_add_u32 v4, 36864, v2
v_add_u32 v5, 36864, v3
ds_read_b64_tr_b16 a[244:245], v4 offset:28672
ds_read_b64_tr_b16 a[246:247], v5 offset:28672
v_add_u32 v4, 73728, v2
v_add_u32 v5, 73728, v3
ds_read_b64_tr_b16 a[248:249], v4 offset:28672
ds_read_b64_tr_b16 a[250:251], v5 offset:28672
v_add_u32 v4, 110592, v2
v_add_u32 v5, 110592, v3
ds_read_b64_tr_b16 a[252:253], v4 offset:28672
ds_read_b64_tr_b16 a[254:255], v5 offset:28672
s_waitcnt lgkmcnt(0)
s_waitcnt vmcnt(28)
s_barrier
s_mov_b32 s12, s78
s_mov_b32 s13, s79
s_add_u32 m0, s36, 28672
s_mov_b32 s28, 0
buffer_load_dwordx4 v0, s[12:15], s28 offen  lds
s_add_u32 m0, s36, 29696
s_mov_b32 s28, 32768
buffer_load_dwordx4 v1, s[12:15], s28 offen  lds
s_add_u32 m0, s36, 30720
s_mov_b32 s28, 65536
buffer_load_dwordx4 v0, s[12:15], s28 offen  lds
s_add_u32 m0, s36, 31744
s_mov_b32 s28, 98304
buffer_load_dwordx4 v1, s[12:15], s28 offen  lds
ds_read_b64_tr_b16 a[0:1], v2 offset:32768
ds_read_b64_tr_b16 a[2:3], v3 offset:32768
v_add_u32 v4, 36864, v2
v_add_u32 v5, 36864, v3
ds_read_b64_tr_b16 a[4:5], v4 offset:32768
ds_read_b64_tr_b16 a[6:7], v5 offset:32768
v_add_u32 v4, 73728, v2
v_add_u32 v5, 73728, v3
ds_read_b64_tr_b16 a[8:9], v4 offset:32768
ds_read_b64_tr_b16 a[10:11], v5 offset:32768
v_add_u32 v4, 110592, v2
v_add_u32 v5, 110592, v3
ds_read_b64_tr_b16 a[12:13], v4 offset:32768
ds_read_b64_tr_b16 a[14:15], v5 offset:32768
s_waitcnt lgkmcnt(0)
s_waitcnt vmcnt(28)
s_barrier
s_add_u32 m0, s36, 32768
s_mov_b32 s28, 524288
buffer_load_dwordx4 v0, s[12:15], s28 offen  lds
s_add_u32 m0, s36, 33792
s_mov_b32 s28, 557056
buffer_load_dwordx4 v1, s[12:15], s28 offen  lds
s_add_u32 m0, s36, 34816
s_mov_b32 s28, 589824
buffer_load_dwordx4 v0, s[12:15], s28 offen  lds
s_add_u32 m0, s36, 35840
s_mov_b32 s28, 622592
buffer_load_dwordx4 v1, s[12:15], s28 offen  lds
ds_read_b64_tr_b16 a[16:17], v2 offset:0
ds_read_b64_tr_b16 a[18:19], v3 offset:0
v_add_u32 v4, 36864, v2
v_add_u32 v5, 36864, v3
ds_read_b64_tr_b16 a[20:21], v4 offset:0
ds_read_b64_tr_b16 a[22:23], v5 offset:0
v_add_u32 v4, 73728, v2
v_add_u32 v5, 73728, v3
ds_read_b64_tr_b16 a[24:25], v4 offset:0
ds_read_b64_tr_b16 a[26:27], v5 offset:0
v_add_u32 v4, 110592, v2
v_add_u32 v5, 110592, v3
ds_read_b64_tr_b16 a[28:29], v4 offset:0
ds_read_b64_tr_b16 a[30:31], v5 offset:0
s_waitcnt lgkmcnt(0)
s_waitcnt vmcnt(28)
s_barrier
s_add_u32 m0, s36, 0
s_mov_b32 s28, 1048576
buffer_load_dwordx4 v0, s[12:15], s28 offen  lds
s_add_u32 m0, s36, 1024
s_mov_b32 s28, 1081344
buffer_load_dwordx4 v1, s[12:15], s28 offen  lds
s_add_u32 m0, s36, 2048
s_mov_b32 s28, 1114112
buffer_load_dwordx4 v0, s[12:15], s28 offen  lds
s_add_u32 m0, s36, 3072
s_mov_b32 s28, 1146880
buffer_load_dwordx4 v1, s[12:15], s28 offen  lds
ds_read_b64_tr_b16 a[32:33], v2 offset:4096
ds_read_b64_tr_b16 a[34:35], v3 offset:4096
v_add_u32 v4, 36864, v2
v_add_u32 v5, 36864, v3
ds_read_b64_tr_b16 a[36:37], v4 offset:4096
ds_read_b64_tr_b16 a[38:39], v5 offset:4096
v_add_u32 v4, 73728, v2
v_add_u32 v5, 73728, v3
ds_read_b64_tr_b16 a[40:41], v4 offset:4096
ds_read_b64_tr_b16 a[42:43], v5 offset:4096
v_add_u32 v4, 110592, v2
v_add_u32 v5, 110592, v3
ds_read_b64_tr_b16 a[44:45], v4 offset:4096
ds_read_b64_tr_b16 a[46:47], v5 offset:4096
s_waitcnt lgkmcnt(0)
s_waitcnt vmcnt(28)
s_barrier
s_add_u32 m0, s36, 4096
s_mov_b32 s28, 1572864
buffer_load_dwordx4 v0, s[12:15], s28 offen  lds
s_add_u32 m0, s36, 5120
s_mov_b32 s28, 1605632
buffer_load_dwordx4 v1, s[12:15], s28 offen  lds
s_add_u32 m0, s36, 6144
s_mov_b32 s28, 1638400
buffer_load_dwordx4 v0, s[12:15], s28 offen  lds
s_add_u32 m0, s36, 7168
s_mov_b32 s28, 1671168
buffer_load_dwordx4 v1, s[12:15], s28 offen  lds
ds_read_b64_tr_b16 a[48:49], v2 offset:8192
ds_read_b64_tr_b16 a[50:51], v3 offset:8192
v_add_u32 v4, 36864, v2
v_add_u32 v5, 36864, v3
ds_read_b64_tr_b16 a[52:53], v4 offset:8192
ds_read_b64_tr_b16 a[54:55], v5 offset:8192
v_add_u32 v4, 73728, v2
v_add_u32 v5, 73728, v3
ds_read_b64_tr_b16 a[56:57], v4 offset:8192
ds_read_b64_tr_b16 a[58:59], v5 offset:8192
v_add_u32 v4, 110592, v2
v_add_u32 v5, 110592, v3
ds_read_b64_tr_b16 a[60:61], v4 offset:8192
ds_read_b64_tr_b16 a[62:63], v5 offset:8192
s_waitcnt lgkmcnt(0)
s_waitcnt vmcnt(28)
s_barrier
s_add_u32 m0, s36, 8192
s_mov_b32 s28, 2097152
buffer_load_dwordx4 v0, s[12:15], s28 offen  lds
s_add_u32 m0, s36, 9216
s_mov_b32 s28, 2129920
buffer_load_dwordx4 v1, s[12:15], s28 offen  lds
s_add_u32 m0, s36, 10240
s_mov_b32 s28, 2162688
buffer_load_dwordx4 v0, s[12:15], s28 offen  lds
s_add_u32 m0, s36, 11264
s_mov_b32 s28, 2195456
buffer_load_dwordx4 v1, s[12:15], s28 offen  lds
ds_read_b64_tr_b16 a[64:65], v2 offset:12288
ds_read_b64_tr_b16 a[66:67], v3 offset:12288
v_add_u32 v4, 36864, v2
v_add_u32 v5, 36864, v3
ds_read_b64_tr_b16 a[68:69], v4 offset:12288
ds_read_b64_tr_b16 a[70:71], v5 offset:12288
v_add_u32 v4, 73728, v2
v_add_u32 v5, 73728, v3
ds_read_b64_tr_b16 a[72:73], v4 offset:12288
ds_read_b64_tr_b16 a[74:75], v5 offset:12288
v_add_u32 v4, 110592, v2
v_add_u32 v5, 110592, v3
ds_read_b64_tr_b16 a[76:77], v4 offset:12288
ds_read_b64_tr_b16 a[78:79], v5 offset:12288
s_waitcnt lgkmcnt(0)
s_waitcnt vmcnt(28)
s_barrier
s_add_u32 m0, s36, 12288
s_mov_b32 s28, 2621440
buffer_load_dwordx4 v0, s[12:15], s28 offen  lds
s_add_u32 m0, s36, 13312
s_mov_b32 s28, 2654208
buffer_load_dwordx4 v1, s[12:15], s28 offen  lds
s_add_u32 m0, s36, 14336
s_mov_b32 s28, 2686976
buffer_load_dwordx4 v0, s[12:15], s28 offen  lds
s_add_u32 m0, s36, 15360
s_mov_b32 s28, 2719744
buffer_load_dwordx4 v1, s[12:15], s28 offen  lds
ds_read_b64_tr_b16 a[80:81], v2 offset:16384
ds_read_b64_tr_b16 a[82:83], v3 offset:16384
v_add_u32 v4, 36864, v2
v_add_u32 v5, 36864, v3
ds_read_b64_tr_b16 a[84:85], v4 offset:16384
ds_read_b64_tr_b16 a[86:87], v5 offset:16384
v_add_u32 v4, 73728, v2
v_add_u32 v5, 73728, v3
ds_read_b64_tr_b16 a[88:89], v4 offset:16384
ds_read_b64_tr_b16 a[90:91], v5 offset:16384
v_add_u32 v4, 110592, v2
v_add_u32 v5, 110592, v3
ds_read_b64_tr_b16 a[92:93], v4 offset:16384
ds_read_b64_tr_b16 a[94:95], v5 offset:16384
s_waitcnt lgkmcnt(0)
s_waitcnt vmcnt(28)
s_barrier
s_add_u32 m0, s36, 16384
s_mov_b32 s28, 3145728
buffer_load_dwordx4 v0, s[12:15], s28 offen  lds
s_add_u32 m0, s36, 17408
s_mov_b32 s28, 3178496
buffer_load_dwordx4 v1, s[12:15], s28 offen  lds
s_add_u32 m0, s36, 18432
s_mov_b32 s28, 3211264
buffer_load_dwordx4 v0, s[12:15], s28 offen  lds
s_add_u32 m0, s36, 19456
s_mov_b32 s28, 3244032
buffer_load_dwordx4 v1, s[12:15], s28 offen  lds
ds_read_b64_tr_b16 a[96:97], v2 offset:20480
ds_read_b64_tr_b16 a[98:99], v3 offset:20480
v_add_u32 v4, 36864, v2
v_add_u32 v5, 36864, v3
ds_read_b64_tr_b16 a[100:101], v4 offset:20480
ds_read_b64_tr_b16 a[102:103], v5 offset:20480
v_add_u32 v4, 73728, v2
v_add_u32 v5, 73728, v3
ds_read_b64_tr_b16 a[104:105], v4 offset:20480
ds_read_b64_tr_b16 a[106:107], v5 offset:20480
v_add_u32 v4, 110592, v2
v_add_u32 v5, 110592, v3
ds_read_b64_tr_b16 a[108:109], v4 offset:20480
ds_read_b64_tr_b16 a[110:111], v5 offset:20480
s_waitcnt lgkmcnt(0)
s_waitcnt vmcnt(28)
s_barrier
s_add_u32 m0, s36, 20480
s_mov_b32 s28, 3670016
buffer_load_dwordx4 v0, s[12:15], s28 offen  lds
s_add_u32 m0, s36, 21504
s_mov_b32 s28, 3702784
buffer_load_dwordx4 v1, s[12:15], s28 offen  lds
s_add_u32 m0, s36, 22528
s_mov_b32 s28, 3735552
buffer_load_dwordx4 v0, s[12:15], s28 offen  lds
s_add_u32 m0, s36, 23552
s_mov_b32 s28, 3768320
buffer_load_dwordx4 v1, s[12:15], s28 offen  lds
ds_read_b64_tr_b16 a[112:113], v2 offset:24576
ds_read_b64_tr_b16 a[114:115], v3 offset:24576
v_add_u32 v4, 36864, v2
v_add_u32 v5, 36864, v3
ds_read_b64_tr_b16 a[116:117], v4 offset:24576
ds_read_b64_tr_b16 a[118:119], v5 offset:24576
v_add_u32 v4, 73728, v2
v_add_u32 v5, 73728, v3
ds_read_b64_tr_b16 a[120:121], v4 offset:24576
ds_read_b64_tr_b16 a[122:123], v5 offset:24576
v_add_u32 v4, 110592, v2
v_add_u32 v5, 110592, v3
ds_read_b64_tr_b16 a[124:125], v4 offset:24576
ds_read_b64_tr_b16 a[126:127], v5 offset:24576
s_waitcnt lgkmcnt(0)
s_waitcnt vmcnt(28)
s_barrier
ds_read_b64_tr_b16 v[128:129], v6 offset:28672
ds_read_b64_tr_b16 v[130:131], v7 offset:28672
v_add_u32 v8, 36864, v6
v_add_u32 v9, 36864, v7
ds_read_b64_tr_b16 v[132:133], v8 offset:28672
ds_read_b64_tr_b16 v[134:135], v9 offset:28672
v_add_u32 v8, 73728, v6
v_add_u32 v9, 73728, v7
ds_read_b64_tr_b16 v[136:137], v8 offset:28672
ds_read_b64_tr_b16 v[138:139], v9 offset:28672
v_add_u32 v8, 110592, v6
v_add_u32 v9, 110592, v7
ds_read_b64_tr_b16 v[140:141], v8 offset:28672
ds_read_b64_tr_b16 v[142:143], v9 offset:28672
s_waitcnt lgkmcnt(0)
s_waitcnt vmcnt(24)
s_barrier
ds_read_b64_tr_b16 v[144:145], v6 offset:32768
ds_read_b64_tr_b16 v[146:147], v7 offset:32768
v_add_u32 v8, 36864, v6
v_add_u32 v9, 36864, v7
ds_read_b64_tr_b16 v[148:149], v8 offset:32768
ds_read_b64_tr_b16 v[150:151], v9 offset:32768
v_add_u32 v8, 73728, v6
v_add_u32 v9, 73728, v7
ds_read_b64_tr_b16 v[152:153], v8 offset:32768
ds_read_b64_tr_b16 v[154:155], v9 offset:32768
v_add_u32 v8, 110592, v6
v_add_u32 v9, 110592, v7
ds_read_b64_tr_b16 v[156:157], v8 offset:32768
ds_read_b64_tr_b16 v[158:159], v9 offset:32768
s_waitcnt lgkmcnt(0)
s_waitcnt vmcnt(20)
s_barrier
ds_read_b64_tr_b16 v[160:161], v6 offset:0
ds_read_b64_tr_b16 v[162:163], v7 offset:0
v_add_u32 v8, 36864, v6
v_add_u32 v9, 36864, v7
ds_read_b64_tr_b16 v[164:165], v8 offset:0
ds_read_b64_tr_b16 v[166:167], v9 offset:0
v_add_u32 v8, 73728, v6
v_add_u32 v9, 73728, v7
ds_read_b64_tr_b16 v[168:169], v8 offset:0
ds_read_b64_tr_b16 v[170:171], v9 offset:0
v_add_u32 v8, 110592, v6
v_add_u32 v9, 110592, v7
ds_read_b64_tr_b16 v[172:173], v8 offset:0
ds_read_b64_tr_b16 v[174:175], v9 offset:0
s_waitcnt lgkmcnt(0)
s_waitcnt vmcnt(16)
s_barrier
ds_read_b64_tr_b16 v[176:177], v6 offset:4096
ds_read_b64_tr_b16 v[178:179], v7 offset:4096
v_add_u32 v8, 36864, v6
v_add_u32 v9, 36864, v7
ds_read_b64_tr_b16 v[180:181], v8 offset:4096
ds_read_b64_tr_b16 v[182:183], v9 offset:4096
v_add_u32 v8, 73728, v6
v_add_u32 v9, 73728, v7
ds_read_b64_tr_b16 v[184:185], v8 offset:4096
ds_read_b64_tr_b16 v[186:187], v9 offset:4096
v_add_u32 v8, 110592, v6
v_add_u32 v9, 110592, v7
ds_read_b64_tr_b16 v[188:189], v8 offset:4096
ds_read_b64_tr_b16 v[190:191], v9 offset:4096
s_waitcnt lgkmcnt(0)
s_waitcnt vmcnt(12)
s_barrier
ds_read_b64_tr_b16 v[192:193], v6 offset:8192
ds_read_b64_tr_b16 v[194:195], v7 offset:8192
v_add_u32 v8, 36864, v6
v_add_u32 v9, 36864, v7
ds_read_b64_tr_b16 v[196:197], v8 offset:8192
ds_read_b64_tr_b16 v[198:199], v9 offset:8192
v_add_u32 v8, 73728, v6
v_add_u32 v9, 73728, v7
ds_read_b64_tr_b16 v[200:201], v8 offset:8192
ds_read_b64_tr_b16 v[202:203], v9 offset:8192
v_add_u32 v8, 110592, v6
v_add_u32 v9, 110592, v7
ds_read_b64_tr_b16 v[204:205], v8 offset:8192
ds_read_b64_tr_b16 v[206:207], v9 offset:8192
s_waitcnt lgkmcnt(0)
s_waitcnt vmcnt(8)
s_barrier
ds_read_b64_tr_b16 v[208:209], v6 offset:12288
ds_read_b64_tr_b16 v[210:211], v7 offset:12288
v_add_u32 v8, 36864, v6
v_add_u32 v9, 36864, v7
ds_read_b64_tr_b16 v[212:213], v8 offset:12288
ds_read_b64_tr_b16 v[214:215], v9 offset:12288
v_add_u32 v8, 73728, v6
v_add_u32 v9, 73728, v7
ds_read_b64_tr_b16 v[216:217], v8 offset:12288
ds_read_b64_tr_b16 v[218:219], v9 offset:12288
v_add_u32 v8, 110592, v6
v_add_u32 v9, 110592, v7
ds_read_b64_tr_b16 v[220:221], v8 offset:12288
ds_read_b64_tr_b16 v[222:223], v9 offset:12288
s_waitcnt lgkmcnt(0)
s_waitcnt vmcnt(4)
s_barrier
ds_read_b64_tr_b16 v[224:225], v6 offset:16384
ds_read_b64_tr_b16 v[226:227], v7 offset:16384
v_add_u32 v8, 36864, v6
v_add_u32 v9, 36864, v7
ds_read_b64_tr_b16 v[228:229], v8 offset:16384
ds_read_b64_tr_b16 v[230:231], v9 offset:16384
v_add_u32 v8, 73728, v6
v_add_u32 v9, 73728, v7
ds_read_b64_tr_b16 v[232:233], v8 offset:16384
ds_read_b64_tr_b16 v[234:235], v9 offset:16384
v_add_u32 v8, 110592, v6
v_add_u32 v9, 110592, v7
ds_read_b64_tr_b16 v[236:237], v8 offset:16384
ds_read_b64_tr_b16 v[238:239], v9 offset:16384
s_waitcnt lgkmcnt(0)
s_waitcnt vmcnt(0)
s_barrier
ds_read_b64_tr_b16 v[240:241], v6 offset:20480
ds_read_b64_tr_b16 v[242:243], v7 offset:20480
v_add_u32 v8, 36864, v6
v_add_u32 v9, 36864, v7
ds_read_b64_tr_b16 v[244:245], v8 offset:20480
ds_read_b64_tr_b16 v[246:247], v9 offset:20480
v_add_u32 v8, 73728, v6
v_add_u32 v9, 73728, v7
ds_read_b64_tr_b16 v[248:249], v8 offset:20480
ds_read_b64_tr_b16 v[250:251], v9 offset:20480
v_add_u32 v8, 110592, v6
v_add_u32 v9, 110592, v7
ds_read_b64_tr_b16 v[252:253], v8 offset:20480
ds_read_b64_tr_b16 v[254:255], v9 offset:20480
s_waitcnt lgkmcnt(0)
s_barrier
s_mov_b32 s12, s70
s_mov_b32 s13, s71
s_mov_b32 s14, 2097152
s_mov_b32 s15, 0x20000
s_mov_b32 s19, s41
s_mov_b32 s20, 0
s_lshl_b32 s21, s19, 15
s_mov_b32 s22, 0
s_mov_b32 s26, 1040356334
s_lshl_b32 s43, s17, 12
s_add_u32 s43, s43, s21
s_mul_i32 s44, s17, 8320
s_add_u32 s44, s44, s22
s_add_u32 m0, s44, 0
s_add_u32 s28, s43, 0
buffer_load_dwordx4 v10, s[12:15], s28 offen lds
s_add_u32 m0, s44, 1040
s_add_u32 s28, s43, 1024
buffer_load_dwordx4 v10, s[12:15], s28 offen lds
s_add_u32 m0, s44, 2080
s_add_u32 s28, s43, 2048
buffer_load_dwordx4 v10, s[12:15], s28 offen lds
s_add_u32 m0, s44, 3120
s_add_u32 s28, s43, 3072
buffer_load_dwordx4 v10, s[12:15], s28 offen lds
s_add_u32 m0, s44, 4160
s_add_u32 s28, s43, 16384
buffer_load_dwordx4 v10, s[12:15], s28 offen lds
s_add_u32 m0, s44, 5200
s_add_u32 s28, s43, 17408
buffer_load_dwordx4 v10, s[12:15], s28 offen lds
s_add_u32 m0, s44, 6240
s_add_u32 s28, s43, 18432
buffer_load_dwordx4 v10, s[12:15], s28 offen lds
s_add_u32 m0, s44, 7280
s_add_u32 s28, s43, 19456
buffer_load_dwordx4 v10, s[12:15], s28 offen lds
s_cmp_lt_u32 s41, 2
s_cselect_b32 s25, 4, 64
s_lshl_b32 s28, s25, 15
s_add_u32 s21, s21, s28
s_mov_b32 s22, 33280
s_lshl_b32 s43, s17, 12
s_add_u32 s43, s43, s21
s_mul_i32 s44, s17, 8320
s_add_u32 s44, s44, s22
s_add_u32 m0, s44, 0
s_add_u32 s28, s43, 0
buffer_load_dwordx4 v10, s[12:15], s28 offen lds
s_add_u32 m0, s44, 1040
s_add_u32 s28, s43, 1024
buffer_load_dwordx4 v10, s[12:15], s28 offen lds
s_add_u32 m0, s44, 2080
s_add_u32 s28, s43, 2048
buffer_load_dwordx4 v10, s[12:15], s28 offen lds
s_add_u32 m0, s44, 3120
s_add_u32 s28, s43, 3072
buffer_load_dwordx4 v10, s[12:15], s28 offen lds
s_add_u32 m0, s44, 4160
s_add_u32 s28, s43, 16384
buffer_load_dwordx4 v10, s[12:15], s28 offen lds
s_add_u32 m0, s44, 5200
s_add_u32 s28, s43, 17408
buffer_load_dwordx4 v10, s[12:15], s28 offen lds
s_add_u32 m0, s44, 6240
s_add_u32 s28, s43, 18432
buffer_load_dwordx4 v10, s[12:15], s28 offen lds
s_add_u32 m0, s44, 7280
s_add_u32 s28, s43, 19456
buffer_load_dwordx4 v10, s[12:15], s28 offen lds
v_xor_b32 v18, 16, v12
s_mov_b32 s46, 0x40000000
s_mov_b32 s47, 0x40000000
s_mov_b32 s49, 0x40000000
s_mov_b32 s24, 0
s_waitcnt vmcnt(8)
s_barrier
Lq_seg:
s_cmp_eq_u32 s17, 1
s_cbranch_scc1 Lq_sg1
s_cmp_eq_u32 s17, 2
s_cbranch_scc1 Lq_sg2
s_cmp_eq_u32 s17, 3
s_cbranch_scc1 Lq_sg3
Lq_sg0:
s_mul_i32 s28, s19, 1048576
s_lshl_b32 s29, s16, 13
s_add_u32 s23, s28, s29
s_add_u32 s45, s23, 16777216
s_add_u32 s50, s45, 4096
s_add_u32 s48, s23, 17301504
s_add_u32 s21, s21, 65536
s_add_u32 s22, s22, 33280
s_cmp_eq_u32 s22, 99840
s_cselect_b32 s22, 0, s22
s_lshl_b32 s43, s17, 12
s_add_u32 s43, s43, s21
s_mul_i32 s44, s17, 8320
s_add_u32 s44, s44, s22
ds_read_b128 v[24:27], v11 offset:0
ds_read_b128 v[28:31], v11 offset:32
ds_read_b128 v[32:35], v11 offset:64
ds_read_b128 v[36:39], v11 offset:96
ds_read_b128 v[40:43], v11 offset:128
ds_read_b128 v[44:47], v11 offset:160
s_waitcnt lgkmcnt(5)
v_mfma_f32_32x32x16_bf16 v[64:79], a[128:131], v[24:27], 0
ds_read_b128 v[48:51], v11 offset:192
s_waitcnt lgkmcnt(5)
v_mfma_f32_32x32x16_bf16 v[64:79], a[132:135], v[28:31], v[64:79]
ds_read_b128 v[52:55], v11 offset:224
s_waitcnt lgkmcnt(5)
v_mfma_f32_32x32x16_bf16 v[64:79], a[136:139], v[32:35], v[64:79]
ds_read_b128 v[24:27], v11 offset:256
v_cvt_pk_bf16_f32 v112, v96, v97
v_cvt_pk_bf16_f32 v113, v98, v99
v_cvt_pk_bf16_f32 v114, v100, v101
v_cvt_pk_bf16_f32 v115, v102, v103
s_waitcnt lgkmcnt(5)
v_mfma_f32_32x32x16_bf16 v[64:79], a[140:143], v[36:39], v[64:79]
ds_read_b128 v[28:31], v11 offset:288
v_cvt_pk_bf16_f32 v116, v104, v105
v_cvt_pk_bf16_f32 v117, v106, v107
v_cvt_pk_bf16_f32 v118, v108, v109
v_cvt_pk_bf16_f32 v119, v110, v111
s_waitcnt lgkmcnt(5)
v_mfma_f32_32x32x16_bf16 v[64:79], a[144:147], v[40:43], v[64:79]
ds_read_b128 v[32:35], v11 offset:320
ds_write2_b32 v13, v112, v113 offset0:0 offset1:2
s_waitcnt lgkmcnt(6)
v_mfma_f32_32x32x16_bf16 v[64:79], a[148:151], v[44:47], v[64:79]
ds_read_b128 v[36:39], v11 offset:352
ds_write2_b32 v13, v114, v115 offset0:64 offset1:66
s_waitcnt lgkmcnt(7)
v_mfma_f32_32x32x16_bf16 v[64:79], a[152:155], v[48:51], v[64:79]
ds_read_b128 v[40:43], v11 offset:384
ds_write2_b32 v13, v116, v117 offset0:128 offset1:130
s_waitcnt lgkmcnt(8)
v_mfma_f32_32x32x16_bf16 v[64:79], a[156:159], v[52:55], v[64:79]
ds_read_b128 v[44:47], v11 offset:416
ds_write2_b32 v13, v118, v119 offset0:192 offset1:194
s_waitcnt lgkmcnt(9)
v_mfma_f32_32x32x16_bf16 v[64:79], a[160:163], v[24:27], v[64:79]
ds_read_b128 v[48:51], v11 offset:448
s_waitcnt lgkmcnt(9)
v_mfma_f32_32x32x16_bf16 v[64:79], a[164:167], v[28:31], v[64:79]
ds_read_b128 v[52:55], v11 offset:480
s_waitcnt lgkmcnt(9)
v_mfma_f32_32x32x16_bf16 v[64:79], a[168:171], v[32:35], v[64:79]
ds_read_b128 v[24:27], v11 offset:512
s_waitcnt lgkmcnt(8)
v_mfma_f32_32x32x16_bf16 v[64:79], a[172:175], v[36:39], v[64:79]
ds_read_b128 v[28:31], v11 offset:544
s_waitcnt lgkmcnt(4)
s_barrier
ds_read_b128 v[120:123], v14 offset:16384
v_mfma_f32_32x32x16_bf16 v[64:79], a[176:179], v[40:43], v[64:79]
ds_read_b128 v[32:35], v11 offset:576
ds_read_b128 v[124:127], v14 offset:20480
v_mfma_f32_32x32x16_bf16 v[64:79], a[180:183], v[44:47], v[64:79]
ds_read_b128 v[36:39], v11 offset:608
s_waitcnt lgkmcnt(7)
v_mfma_f32_32x32x16_bf16 v[64:79], a[184:187], v[48:51], v[64:79]
ds_read_b128 v[40:43], v11 offset:640
s_waitcnt lgkmcnt(7)
v_mfma_f32_32x32x16_bf16 v[64:79], a[188:191], v[52:55], v[64:79]
ds_read_b128 v[44:47], v11 offset:672
s_waitcnt lgkmcnt(7)
v_mfma_f32_32x32x16_bf16 v[64:79], a[192:195], v[24:27], v[64:79]
ds_read_b128 v[48:51], v11 offset:704
s_waitcnt lgkmcnt(4)
buffer_store_dwordx4 v[120:123], v17, s[8:11], s46 offen sc1
v_mfma_f32_32x32x16_bf16 v[64:79], a[196:199], v[28:31], v[64:79]
ds_read_b128 v[52:55], v11 offset:736
v_mfma_f32_32x32x16_bf16 v[64:79], a[200:203], v[32:35], v[64:79]
ds_read_b128 v[24:27], v11 offset:768
s_waitcnt lgkmcnt(5)
v_mfma_f32_32x32x16_bf16 v[64:79], a[204:207], v[36:39], v[64:79]
ds_read_b128 v[28:31], v11 offset:800
s_waitcnt lgkmcnt(5)
v_mfma_f32_32x32x16_bf16 v[64:79], a[208:211], v[40:43], v[64:79]
ds_read_b128 v[32:35], v11 offset:832
buffer_store_dwordx4 v[124:127], v17, s[8:11], s47 offen sc1
s_waitcnt lgkmcnt(5)
v_mfma_f32_32x32x16_bf16 v[64:79], a[212:215], v[44:47], v[64:79]
ds_read_b128 v[36:39], v11 offset:864
s_waitcnt lgkmcnt(5)
v_mfma_f32_32x32x16_bf16 v[64:79], a[216:219], v[48:51], v[64:79]
ds_read_b128 v[40:43], v11 offset:896
s_waitcnt lgkmcnt(5)
v_mfma_f32_32x32x16_bf16 v[64:79], a[220:223], v[52:55], v[64:79]
ds_read_b128 v[44:47], v11 offset:928
s_waitcnt lgkmcnt(5)
v_mfma_f32_32x32x16_bf16 v[64:79], a[224:227], v[24:27], v[64:79]
ds_read_b128 v[48:51], v11 offset:960
s_waitcnt lgkmcnt(5)
v_mfma_f32_32x32x16_bf16 v[64:79], a[228:231], v[28:31], v[64:79]
ds_read_b128 v[52:55], v11 offset:992
s_waitcnt lgkmcnt(5)
v_mfma_f32_32x32x16_bf16 v[64:79], a[232:235], v[32:35], v[64:79]
ds_read_b128 v[24:27], v11 offset:0
s_waitcnt lgkmcnt(5)
v_mfma_f32_32x32x16_bf16 v[64:79], a[236:239], v[36:39], v[64:79]
ds_read_b128 v[28:31], v11 offset:32
s_waitcnt lgkmcnt(5)
v_mfma_f32_32x32x16_bf16 v[64:79], a[240:243], v[40:43], v[64:79]
ds_read_b128 v[32:35], v11 offset:64
s_add_u32 m0, s44, 0
s_add_u32 s28, s43, 0
buffer_load_dwordx4 v10, s[12:15], s28 offen lds
s_waitcnt lgkmcnt(5)
v_mfma_f32_32x32x16_bf16 v[64:79], a[244:247], v[44:47], v[64:79]
ds_read_b128 v[36:39], v11 offset:96
s_waitcnt lgkmcnt(5)
v_mfma_f32_32x32x16_bf16 v[64:79], a[248:251], v[48:51], v[64:79]
ds_read_b128 v[40:43], v11 offset:128
s_waitcnt lgkmcnt(5)
v_mfma_f32_32x32x16_bf16 v[64:79], a[252:255], v[52:55], v[64:79]
ds_read_b128 v[44:47], v11 offset:160
s_waitcnt lgkmcnt(5)
v_mfma_f32_32x32x16_bf16 v[80:95], a[0:3], v[24:27], 0
ds_read_b128 v[48:51], v11 offset:192
s_waitcnt lgkmcnt(5)
v_mfma_f32_32x32x16_bf16 v[80:95], a[4:7], v[28:31], v[80:95]
ds_read_b128 v[52:55], v11 offset:224
s_waitcnt lgkmcnt(5)
v_mfma_f32_32x32x16_bf16 v[80:95], a[8:11], v[32:35], v[80:95]
ds_read_b128 v[24:27], v11 offset:256
v_cvt_pk_bf16_f32 v112, v64, v65
v_cvt_pk_bf16_f32 v113, v66, v67
v_cvt_pk_bf16_f32 v114, v68, v69
v_cvt_pk_bf16_f32 v115, v70, v71
s_add_u32 m0, s44, 1040
s_add_u32 s28, s43, 1024
buffer_load_dwordx4 v10, s[12:15], s28 offen lds
s_waitcnt lgkmcnt(5)
v_mfma_f32_32x32x16_bf16 v[80:95], a[12:15], v[36:39], v[80:95]
ds_read_b128 v[28:31], v11 offset:288
v_cvt_pk_bf16_f32 v116, v72, v73
v_cvt_pk_bf16_f32 v117, v74, v75
v_cvt_pk_bf16_f32 v118, v76, v77
v_cvt_pk_bf16_f32 v119, v78, v79
s_waitcnt lgkmcnt(5)
v_mfma_f32_32x32x16_bf16 v[80:95], a[16:19], v[40:43], v[80:95]
ds_read_b128 v[32:35], v11 offset:320
ds_write_b128 v12, v[112:115] offset:8192
s_waitcnt lgkmcnt(6)
v_mfma_f32_32x32x16_bf16 v[80:95], a[20:23], v[44:47], v[80:95]
ds_read_b128 v[36:39], v11 offset:352
ds_write_b128 v18, v[116:119] offset:8192
s_waitcnt lgkmcnt(7)
v_mfma_f32_32x32x16_bf16 v[80:95], a[24:27], v[48:51], v[80:95]
ds_read_b128 v[40:43], v11 offset:384
s_waitcnt lgkmcnt(7)
v_mfma_f32_32x32x16_bf16 v[80:95], a[28:31], v[52:55], v[80:95]
ds_read_b128 v[44:47], v11 offset:416
s_waitcnt lgkmcnt(7)
v_mfma_f32_32x32x16_bf16 v[80:95], a[32:35], v[24:27], v[80:95]
ds_read_b128 v[48:51], v11 offset:448
s_add_u32 m0, s44, 2080
s_add_u32 s28, s43, 2048
buffer_load_dwordx4 v10, s[12:15], s28 offen lds
s_waitcnt lgkmcnt(7)
v_mfma_f32_32x32x16_bf16 v[80:95], a[36:39], v[28:31], v[80:95]
ds_read_b128 v[52:55], v11 offset:480
s_waitcnt lgkmcnt(4)
s_barrier
ds_read_b128 v[120:123], v14 offset:8192
v_mfma_f32_32x32x16_bf16 v[80:95], a[40:43], v[32:35], v[80:95]
ds_read_b128 v[24:27], v11 offset:512
ds_read_b128 v[124:127], v14 offset:12288
v_mfma_f32_32x32x16_bf16 v[80:95], a[44:47], v[36:39], v[80:95]
ds_read_b128 v[28:31], v11 offset:544
s_waitcnt lgkmcnt(7)
v_mfma_f32_32x32x16_bf16 v[80:95], a[48:51], v[40:43], v[80:95]
ds_read_b128 v[32:35], v11 offset:576
s_waitcnt lgkmcnt(7)
v_mfma_f32_32x32x16_bf16 v[80:95], a[52:55], v[44:47], v[80:95]
ds_read_b128 v[36:39], v11 offset:608
s_waitcnt lgkmcnt(7)
v_mfma_f32_32x32x16_bf16 v[80:95], a[56:59], v[48:51], v[80:95]
ds_read_b128 v[40:43], v11 offset:640
s_waitcnt lgkmcnt(4)
buffer_store_dwordx4 v[120:123], v15, s[8:11], s48 offen offset:0 sc1
s_add_u32 m0, s44, 3120
s_add_u32 s28, s43, 3072
buffer_load_dwordx4 v10, s[12:15], s28 offen lds
v_mfma_f32_32x32x16_bf16 v[80:95], a[60:63], v[52:55], v[80:95]
ds_read_b128 v[44:47], v11 offset:672
v_mfma_f32_32x32x16_bf16 v[80:95], a[64:67], v[24:27], v[80:95]
ds_read_b128 v[48:51], v11 offset:704
s_waitcnt lgkmcnt(5)
v_mfma_f32_32x32x16_bf16 v[80:95], a[68:71], v[28:31], v[80:95]
ds_read_b128 v[52:55], v11 offset:736
s_waitcnt lgkmcnt(5)
v_mfma_f32_32x32x16_bf16 v[80:95], a[72:75], v[32:35], v[80:95]
ds_read_b128 v[24:27], v11 offset:768
buffer_store_dwordx4 v[124:127], v15, s[8:11], s48 offen offset:2048 sc1
s_waitcnt lgkmcnt(5)
v_mfma_f32_32x32x16_bf16 v[80:95], a[76:79], v[36:39], v[80:95]
ds_read_b128 v[28:31], v11 offset:800
s_waitcnt lgkmcnt(5)
v_mfma_f32_32x32x16_bf16 v[80:95], a[80:83], v[40:43], v[80:95]
ds_read_b128 v[32:35], v11 offset:832
s_waitcnt lgkmcnt(5)
v_mfma_f32_32x32x16_bf16 v[80:95], a[84:87], v[44:47], v[80:95]
ds_read_b128 v[36:39], v11 offset:864
s_waitcnt lgkmcnt(5)
v_mfma_f32_32x32x16_bf16 v[80:95], a[88:91], v[48:51], v[80:95]
ds_read_b128 v[40:43], v11 offset:896
s_waitcnt lgkmcnt(5)
v_mfma_f32_32x32x16_bf16 v[80:95], a[92:95], v[52:55], v[80:95]
ds_read_b128 v[44:47], v11 offset:928
s_waitcnt lgkmcnt(5)
v_mfma_f32_32x32x16_bf16 v[80:95], a[96:99], v[24:27], v[80:95]
ds_read_b128 v[48:51], v11 offset:960
s_waitcnt lgkmcnt(5)
v_mfma_f32_32x32x16_bf16 v[80:95], a[100:103], v[28:31], v[80:95]
ds_read_b128 v[52:55], v11 offset:992
s_waitcnt lgkmcnt(5)
v_mfma_f32_32x32x16_bf16 v[80:95], a[104:107], v[32:35], v[80:95]
ds_read_b128 v[24:27], v11 offset:0
s_waitcnt lgkmcnt(5)
v_mfma_f32_32x32x16_bf16 v[80:95], a[108:111], v[36:39], v[80:95]
ds_read_b128 v[28:31], v11 offset:32
s_waitcnt lgkmcnt(5)
v_mfma_f32_32x32x16_bf16 v[80:95], a[112:115], v[40:43], v[80:95]
ds_read_b128 v[32:35], v11 offset:64
s_waitcnt lgkmcnt(5)
v_mfma_f32_32x32x16_bf16 v[80:95], a[116:119], v[44:47], v[80:95]
ds_read_b128 v[36:39], v11 offset:96
s_waitcnt lgkmcnt(5)
v_mfma_f32_32x32x16_bf16 v[80:95], a[120:123], v[48:51], v[80:95]
ds_read_b128 v[40:43], v11 offset:128
s_waitcnt vmcnt(6)
s_barrier
v_mov_b32 v19, s19
s_waitcnt lgkmcnt(5)
v_mfma_f32_32x32x16_bf16 v[80:95], a[124:127], v[52:55], v[80:95]
ds_read_b128 v[44:47], v11 offset:160
buffer_store_dword v19, v16, s[8:11], s49 offen sc1
s_waitcnt lgkmcnt(5)
v_mfma_f32_32x32x16_bf16 v[96:111], v[24:27], v[128:131], 0
ds_read_b128 v[48:51], v11 offset:192
s_add_u32 m0, s44, 4160
s_add_u32 s28, s43, 16384
buffer_load_dwordx4 v10, s[12:15], s28 offen lds
s_waitcnt lgkmcnt(5)
v_mfma_f32_32x32x16_bf16 v[96:111], v[28:31], v[132:135], v[96:111]
ds_read_b128 v[52:55], v11 offset:224
s_waitcnt lgkmcnt(5)
v_mfma_f32_32x32x16_bf16 v[96:111], v[32:35], v[136:139], v[96:111]
ds_read_b128 v[24:27], v11 offset:256
v_mul_f32 v80, s26, v80
v_mul_f32 v81, s26, v81
v_mul_f32 v82, s26, v82
v_mul_f32 v83, s26, v83
s_waitcnt lgkmcnt(5)
v_mfma_f32_32x32x16_bf16 v[96:111], v[36:39], v[140:143], v[96:111]
ds_read_b128 v[28:31], v11 offset:288
v_mul_f32 v84, s26, v84
v_mul_f32 v85, s26, v85
v_mul_f32 v86, s26, v86
v_mul_f32 v87, s26, v87
s_waitcnt lgkmcnt(5)
v_mfma_f32_32x32x16_bf16 v[96:111], v[40:43], v[144:147], v[96:111]
ds_read_b128 v[32:35], v11 offset:320
v_mul_f32 v88, s26, v88
v_mul_f32 v89, s26, v89
v_mul_f32 v90, s26, v90
v_mul_f32 v91, s26, v91
s_waitcnt lgkmcnt(5)
v_mfma_f32_32x32x16_bf16 v[96:111], v[44:47], v[148:151], v[96:111]
ds_read_b128 v[36:39], v11 offset:352
v_mul_f32 v92, s26, v92
v_mul_f32 v93, s26, v93
v_mul_f32 v94, s26, v94
v_mul_f32 v95, s26, v95
s_waitcnt lgkmcnt(5)
v_mfma_f32_32x32x16_bf16 v[96:111], v[48:51], v[152:155], v[96:111]
ds_read_b128 v[40:43], v11 offset:384
v_cvt_pk_bf16_f32 v112, v80, v81
v_cvt_pk_bf16_f32 v113, v82, v83
v_cvt_pk_bf16_f32 v114, v84, v85
v_cvt_pk_bf16_f32 v115, v86, v87
s_add_u32 m0, s44, 5200
s_add_u32 s28, s43, 17408
buffer_load_dwordx4 v10, s[12:15], s28 offen lds
s_waitcnt lgkmcnt(5)
v_mfma_f32_32x32x16_bf16 v[96:111], v[52:55], v[156:159], v[96:111]
ds_read_b128 v[44:47], v11 offset:416
v_cvt_pk_bf16_f32 v116, v88, v89
v_cvt_pk_bf16_f32 v117, v90, v91
v_cvt_pk_bf16_f32 v118, v92, v93
v_cvt_pk_bf16_f32 v119, v94, v95
s_waitcnt lgkmcnt(5)
v_mfma_f32_32x32x16_bf16 v[96:111], v[24:27], v[160:163], v[96:111]
ds_read_b128 v[48:51], v11 offset:448
ds_write_b128 v12, v[112:115] offset:0
s_waitcnt lgkmcnt(6)
v_mfma_f32_32x32x16_bf16 v[96:111], v[28:31], v[164:167], v[96:111]
ds_read_b128 v[52:55], v11 offset:480
ds_write_b128 v18, v[116:119] offset:0
s_waitcnt lgkmcnt(7)
v_mfma_f32_32x32x16_bf16 v[96:111], v[32:35], v[168:171], v[96:111]
ds_read_b128 v[24:27], v11 offset:512
s_waitcnt lgkmcnt(7)
v_mfma_f32_32x32x16_bf16 v[96:111], v[36:39], v[172:175], v[96:111]
ds_read_b128 v[28:31], v11 offset:544
s_waitcnt lgkmcnt(7)
v_mfma_f32_32x32x16_bf16 v[96:111], v[40:43], v[176:179], v[96:111]
ds_read_b128 v[32:35], v11 offset:576
s_waitcnt lgkmcnt(7)
v_mfma_f32_32x32x16_bf16 v[96:111], v[44:47], v[180:183], v[96:111]
ds_read_b128 v[36:39], v11 offset:608
s_waitcnt lgkmcnt(4)
s_barrier
ds_read_b128 v[120:123], v20
v_mfma_f32_32x32x16_bf16 v[96:111], v[48:51], v[184:187], v[96:111]
ds_read_b128 v[40:43], v11 offset:640
ds_read_b128 v[124:127], v21
v_mfma_f32_32x32x16_bf16 v[96:111], v[52:55], v[188:191], v[96:111]
ds_read_b128 v[44:47], v11 offset:672
s_waitcnt lgkmcnt(7)
v_mfma_f32_32x32x16_bf16 v[96:111], v[24:27], v[192:195], v[96:111]
ds_read_b128 v[48:51], v11 offset:704
s_waitcnt lgkmcnt(7)
v_mfma_f32_32x32x16_bf16 v[96:111], v[28:31], v[196:199], v[96:111]
ds_read_b128 v[52:55], v11 offset:736
s_waitcnt lgkmcnt(7)
v_mfma_f32_32x32x16_bf16 v[96:111], v[32:35], v[200:203], v[96:111]
ds_read_b128 v[24:27], v11 offset:768
s_waitcnt lgkmcnt(4)
buffer_store_dwordx4 v[120:123], v17, s[8:11], s45 offen sc1
v_mfma_f32_32x32x16_bf16 v[96:111], v[36:39], v[204:207], v[96:111]
ds_read_b128 v[28:31], v11 offset:800
v_mfma_f32_32x32x16_bf16 v[96:111], v[40:43], v[208:211], v[96:111]
ds_read_b128 v[32:35], v11 offset:832
s_waitcnt lgkmcnt(5)
v_mfma_f32_32x32x16_bf16 v[96:111], v[44:47], v[212:215], v[96:111]
ds_read_b128 v[36:39], v11 offset:864
s_waitcnt lgkmcnt(5)
v_mfma_f32_32x32x16_bf16 v[96:111], v[48:51], v[216:219], v[96:111]
ds_read_b128 v[40:43], v11 offset:896
buffer_store_dwordx4 v[124:127], v17, s[8:11], s50 offen sc1
s_waitcnt lgkmcnt(5)
v_mfma_f32_32x32x16_bf16 v[96:111], v[52:55], v[220:223], v[96:111]
ds_read_b128 v[44:47], v11 offset:928
s_waitcnt lgkmcnt(5)
v_mfma_f32_32x32x16_bf16 v[96:111], v[24:27], v[224:227], v[96:111]
ds_read_b128 v[48:51], v11 offset:960
s_add_u32 m0, s44, 6240
s_add_u32 s28, s43, 18432
buffer_load_dwordx4 v10, s[12:15], s28 offen lds
s_waitcnt lgkmcnt(5)
v_mfma_f32_32x32x16_bf16 v[96:111], v[28:31], v[228:231], v[96:111]
ds_read_b128 v[52:55], v11 offset:992
s_waitcnt lgkmcnt(5)
v_mfma_f32_32x32x16_bf16 v[96:111], v[32:35], v[232:235], v[96:111]
s_waitcnt lgkmcnt(4)
v_mfma_f32_32x32x16_bf16 v[96:111], v[36:39], v[236:239], v[96:111]
s_waitcnt lgkmcnt(3)
v_mfma_f32_32x32x16_bf16 v[96:111], v[40:43], v[240:243], v[96:111]
s_add_u32 m0, s44, 7280
s_add_u32 s28, s43, 19456
buffer_load_dwordx4 v10, s[12:15], s28 offen lds
s_waitcnt lgkmcnt(2)
v_mfma_f32_32x32x16_bf16 v[96:111], v[44:47], v[244:247], v[96:111]
s_waitcnt lgkmcnt(1)
v_mfma_f32_32x32x16_bf16 v[96:111], v[48:51], v[248:251], v[96:111]
s_waitcnt lgkmcnt(0)
v_mfma_f32_32x32x16_bf16 v[96:111], v[52:55], v[252:255], v[96:111]
s_add_u32 s46, s23, 17039360
s_add_u32 s47, s46, 4096
s_add_u32 s24, s24, 1
s_cmp_eq_u32 s24, 3
s_cselect_b32 s24, 0, s24
s_mov_b32 s28, 33280
s_cselect_b32 s29, -2, 1
s_mul_i32 s28, s28, s29
v_add_u32 v11, s28, v11
s_add_u32 s19, s19, s25
s_mov_b32 s25, 2
s_add_u32 s20, s20, 1
s_cmp_eq_u32 s20, 1
s_cbranch_scc1 Lq_fl
s_cmp_lt_u32 s19, 64
s_cbranch_scc1 Lq_sg0
s_branch Lq_fl
Lq_sg1:
s_mul_i32 s28, s19, 1048576
s_lshl_b32 s29, s16, 13
s_add_u32 s23, s28, s29
s_add_u32 s45, s23, 16777216
s_add_u32 s50, s45, 4096
s_add_u32 s48, s23, 17301504
s_add_u32 s21, s21, 65536
s_add_u32 s22, s22, 33280
s_cmp_eq_u32 s22, 99840
s_cselect_b32 s22, 0, s22
s_lshl_b32 s43, s17, 12
s_add_u32 s43, s43, s21
s_mul_i32 s44, s17, 8320
s_add_u32 s44, s44, s22
ds_read_b128 v[24:27], v11 offset:0
ds_read_b128 v[28:31], v11 offset:32
ds_read_b128 v[32:35], v11 offset:64
ds_read_b128 v[36:39], v11 offset:96
ds_read_b128 v[40:43], v11 offset:128
ds_read_b128 v[44:47], v11 offset:160
s_waitcnt lgkmcnt(5)
v_mfma_f32_32x32x16_bf16 v[64:79], a[128:131], v[24:27], 0
ds_read_b128 v[48:51], v11 offset:192
s_waitcnt lgkmcnt(5)
v_mfma_f32_32x32x16_bf16 v[64:79], a[132:135], v[28:31], v[64:79]
ds_read_b128 v[52:55], v11 offset:224
s_waitcnt lgkmcnt(5)
v_mfma_f32_32x32x16_bf16 v[64:79], a[136:139], v[32:35], v[64:79]
ds_read_b128 v[24:27], v11 offset:256
v_cvt_pk_bf16_f32 v112, v96, v97
v_cvt_pk_bf16_f32 v113, v98, v99
v_cvt_pk_bf16_f32 v114, v100, v101
v_cvt_pk_bf16_f32 v115, v102, v103
s_waitcnt lgkmcnt(5)
v_mfma_f32_32x32x16_bf16 v[64:79], a[140:143], v[36:39], v[64:79]
ds_read_b128 v[28:31], v11 offset:288
v_cvt_pk_bf16_f32 v116, v104, v105
v_cvt_pk_bf16_f32 v117, v106, v107
v_cvt_pk_bf16_f32 v118, v108, v109
v_cvt_pk_bf16_f32 v119, v110, v111
s_waitcnt lgkmcnt(5)
v_mfma_f32_32x32x16_bf16 v[64:79], a[144:147], v[40:43], v[64:79]
ds_read_b128 v[32:35], v11 offset:320
ds_write2_b32 v13, v112, v113 offset0:0 offset1:2
s_waitcnt lgkmcnt(6)
v_mfma_f32_32x32x16_bf16 v[64:79], a[148:151], v[44:47], v[64:79]
ds_read_b128 v[36:39], v11 offset:352
ds_write2_b32 v13, v114, v115 offset0:64 offset1:66
s_waitcnt lgkmcnt(7)
v_mfma_f32_32x32x16_bf16 v[64:79], a[152:155], v[48:51], v[64:79]
ds_read_b128 v[40:43], v11 offset:384
ds_write2_b32 v13, v116, v117 offset0:128 offset1:130
s_waitcnt lgkmcnt(8)
v_mfma_f32_32x32x16_bf16 v[64:79], a[156:159], v[52:55], v[64:79]
ds_read_b128 v[44:47], v11 offset:416
ds_write2_b32 v13, v118, v119 offset0:192 offset1:194
s_waitcnt lgkmcnt(9)
v_mfma_f32_32x32x16_bf16 v[64:79], a[160:163], v[24:27], v[64:79]
ds_read_b128 v[48:51], v11 offset:448
s_waitcnt lgkmcnt(9)
v_mfma_f32_32x32x16_bf16 v[64:79], a[164:167], v[28:31], v[64:79]
ds_read_b128 v[52:55], v11 offset:480
s_waitcnt lgkmcnt(9)
v_mfma_f32_32x32x16_bf16 v[64:79], a[168:171], v[32:35], v[64:79]
ds_read_b128 v[24:27], v11 offset:512
s_waitcnt lgkmcnt(8)
v_mfma_f32_32x32x16_bf16 v[64:79], a[172:175], v[36:39], v[64:79]
ds_read_b128 v[28:31], v11 offset:544
s_waitcnt lgkmcnt(4)
s_barrier
ds_read_b128 v[120:123], v14 offset:16384
v_mfma_f32_32x32x16_bf16 v[64:79], a[176:179], v[40:43], v[64:79]
ds_read_b128 v[32:35], v11 offset:576
ds_read_b128 v[124:127], v14 offset:20480
v_mfma_f32_32x32x16_bf16 v[64:79], a[180:183], v[44:47], v[64:79]
ds_read_b128 v[36:39], v11 offset:608
s_waitcnt lgkmcnt(7)
v_mfma_f32_32x32x16_bf16 v[64:79], a[184:187], v[48:51], v[64:79]
ds_read_b128 v[40:43], v11 offset:640
s_waitcnt lgkmcnt(7)
v_mfma_f32_32x32x16_bf16 v[64:79], a[188:191], v[52:55], v[64:79]
ds_read_b128 v[44:47], v11 offset:672
s_waitcnt lgkmcnt(7)
v_mfma_f32_32x32x16_bf16 v[64:79], a[192:195], v[24:27], v[64:79]
ds_read_b128 v[48:51], v11 offset:704
s_waitcnt lgkmcnt(7)
v_mfma_f32_32x32x16_bf16 v[64:79], a[196:199], v[28:31], v[64:79]
ds_read_b128 v[52:55], v11 offset:736
s_waitcnt lgkmcnt(5)
buffer_store_dwordx4 v[120:123], v17, s[8:11], s46 offen sc1
v_mfma_f32_32x32x16_bf16 v[64:79], a[200:203], v[32:35], v[64:79]
ds_read_b128 v[24:27], v11 offset:768
s_waitcnt lgkmcnt(5)
v_mfma_f32_32x32x16_bf16 v[64:79], a[204:207], v[36:39], v[64:79]
ds_read_b128 v[28:31], v11 offset:800
s_waitcnt lgkmcnt(5)
v_mfma_f32_32x32x16_bf16 v[64:79], a[208:211], v[40:43], v[64:79]
ds_read_b128 v[32:35], v11 offset:832
s_waitcnt lgkmcnt(5)
v_mfma_f32_32x32x16_bf16 v[64:79], a[212:215], v[44:47], v[64:79]
ds_read_b128 v[36:39], v11 offset:864
buffer_store_dwordx4 v[124:127], v17, s[8:11], s47 offen sc1
s_waitcnt lgkmcnt(5)
v_mfma_f32_32x32x16_bf16 v[64:79], a[216:219], v[48:51], v[64:79]
ds_read_b128 v[40:43], v11 offset:896
s_waitcnt lgkmcnt(5)
v_mfma_f32_32x32x16_bf16 v[64:79], a[220:223], v[52:55], v[64:79]
ds_read_b128 v[44:47], v11 offset:928
s_waitcnt lgkmcnt(5)
v_mfma_f32_32x32x16_bf16 v[64:79], a[224:227], v[24:27], v[64:79]
ds_read_b128 v[48:51], v11 offset:960
s_waitcnt lgkmcnt(5)
v_mfma_f32_32x32x16_bf16 v[64:79], a[228:231], v[28:31], v[64:79]
ds_read_b128 v[52:55], v11 offset:992
s_waitcnt lgkmcnt(5)
v_mfma_f32_32x32x16_bf16 v[64:79], a[232:235], v[32:35], v[64:79]
ds_read_b128 v[24:27], v11 offset:0
s_waitcnt lgkmcnt(5)
v_mfma_f32_32x32x16_bf16 v[64:79], a[236:239], v[36:39], v[64:79]
ds_read_b128 v[28:31], v11 offset:32
s_waitcnt lgkmcnt(5)
v_mfma_f32_32x32x16_bf16 v[64:79], a[240:243], v[40:43], v[64:79]
ds_read_b128 v[32:35], v11 offset:64
s_waitcnt lgkmcnt(5)
v_mfma_f32_32x32x16_bf16 v[64:79], a[244:247], v[44:47], v[64:79]
ds_read_b128 v[36:39], v11 offset:96
s_add_u32 m0, s44, 0
s_add_u32 s28, s43, 0
buffer_load_dwordx4 v10, s[12:15], s28 offen lds
s_waitcnt lgkmcnt(5)
v_mfma_f32_32x32x16_bf16 v[64:79], a[248:251], v[48:51], v[64:79]
ds_read_b128 v[40:43], v11 offset:128
s_waitcnt lgkmcnt(5)
v_mfma_f32_32x32x16_bf16 v[64:79], a[252:255], v[52:55], v[64:79]
ds_read_b128 v[44:47], v11 offset:160
s_waitcnt lgkmcnt(5)
v_mfma_f32_32x32x16_bf16 v[80:95], a[0:3], v[24:27], 0
ds_read_b128 v[48:51], v11 offset:192
s_waitcnt lgkmcnt(5)
v_mfma_f32_32x32x16_bf16 v[80:95], a[4:7], v[28:31], v[80:95]
ds_read_b128 v[52:55], v11 offset:224
s_waitcnt lgkmcnt(5)
v_mfma_f32_32x32x16_bf16 v[80:95], a[8:11], v[32:35], v[80:95]
ds_read_b128 v[24:27], v11 offset:256
v_cvt_pk_bf16_f32 v112, v64, v65
v_cvt_pk_bf16_f32 v113, v66, v67
v_cvt_pk_bf16_f32 v114, v68, v69
v_cvt_pk_bf16_f32 v115, v70, v71
s_waitcnt lgkmcnt(5)
v_mfma_f32_32x32x16_bf16 v[80:95], a[12:15], v[36:39], v[80:95]
ds_read_b128 v[28:31], v11 offset:288
v_cvt_pk_bf16_f32 v116, v72, v73
v_cvt_pk_bf16_f32 v117, v74, v75
v_cvt_pk_bf16_f32 v118, v76, v77
v_cvt_pk_bf16_f32 v119, v78, v79
s_add_u32 m0, s44, 1040
s_add_u32 s28, s43, 1024
buffer_load_dwordx4 v10, s[12:15], s28 offen lds
s_waitcnt lgkmcnt(5)
v_mfma_f32_32x32x16_bf16 v[80:95], a[16:19], v[40:43], v[80:95]
ds_read_b128 v[32:35], v11 offset:320
ds_write_b128 v12, v[112:115] offset:8192
s_waitcnt lgkmcnt(6)
v_mfma_f32_32x32x16_bf16 v[80:95], a[20:23], v[44:47], v[80:95]
ds_read_b128 v[36:39], v11 offset:352
ds_write_b128 v18, v[116:119] offset:8192
s_waitcnt lgkmcnt(7)
v_mfma_f32_32x32x16_bf16 v[80:95], a[24:27], v[48:51], v[80:95]
ds_read_b128 v[40:43], v11 offset:384
s_waitcnt lgkmcnt(7)
v_mfma_f32_32x32x16_bf16 v[80:95], a[28:31], v[52:55], v[80:95]
ds_read_b128 v[44:47], v11 offset:416
s_waitcnt lgkmcnt(7)
v_mfma_f32_32x32x16_bf16 v[80:95], a[32:35], v[24:27], v[80:95]
ds_read_b128 v[48:51], v11 offset:448
s_waitcnt lgkmcnt(7)
v_mfma_f32_32x32x16_bf16 v[80:95], a[36:39], v[28:31], v[80:95]
ds_read_b128 v[52:55], v11 offset:480
s_waitcnt lgkmcnt(4)
s_barrier
ds_read_b128 v[120:123], v14 offset:8192
s_add_u32 m0, s44, 2080
s_add_u32 s28, s43, 2048
buffer_load_dwordx4 v10, s[12:15], s28 offen lds
v_mfma_f32_32x32x16_bf16 v[80:95], a[40:43], v[32:35], v[80:95]
ds_read_b128 v[24:27], v11 offset:512
ds_read_b128 v[124:127], v14 offset:12288
v_mfma_f32_32x32x16_bf16 v[80:95], a[44:47], v[36:39], v[80:95]
ds_read_b128 v[28:31], v11 offset:544
s_waitcnt lgkmcnt(7)
v_mfma_f32_32x32x16_bf16 v[80:95], a[48:51], v[40:43], v[80:95]
ds_read_b128 v[32:35], v11 offset:576
s_waitcnt lgkmcnt(7)
v_mfma_f32_32x32x16_bf16 v[80:95], a[52:55], v[44:47], v[80:95]
ds_read_b128 v[36:39], v11 offset:608
s_waitcnt lgkmcnt(7)
v_mfma_f32_32x32x16_bf16 v[80:95], a[56:59], v[48:51], v[80:95]
ds_read_b128 v[40:43], v11 offset:640
s_waitcnt lgkmcnt(7)
v_mfma_f32_32x32x16_bf16 v[80:95], a[60:63], v[52:55], v[80:95]
ds_read_b128 v[44:47], v11 offset:672
s_waitcnt lgkmcnt(5)
buffer_store_dwordx4 v[120:123], v15, s[8:11], s48 offen offset:0 sc1
s_add_u32 m0, s44, 3120
s_add_u32 s28, s43, 3072
buffer_load_dwordx4 v10, s[12:15], s28 offen lds
v_mfma_f32_32x32x16_bf16 v[80:95], a[64:67], v[24:27], v[80:95]
ds_read_b128 v[48:51], v11 offset:704
s_waitcnt lgkmcnt(5)
v_mfma_f32_32x32x16_bf16 v[80:95], a[68:71], v[28:31], v[80:95]
ds_read_b128 v[52:55], v11 offset:736
s_waitcnt lgkmcnt(5)
v_mfma_f32_32x32x16_bf16 v[80:95], a[72:75], v[32:35], v[80:95]
ds_read_b128 v[24:27], v11 offset:768
s_waitcnt lgkmcnt(5)
v_mfma_f32_32x32x16_bf16 v[80:95], a[76:79], v[36:39], v[80:95]
ds_read_b128 v[28:31], v11 offset:800
buffer_store_dwordx4 v[124:127], v15, s[8:11], s48 offen offset:2048 sc1
s_waitcnt lgkmcnt(5)
v_mfma_f32_32x32x16_bf16 v[80:95], a[80:83], v[40:43], v[80:95]
ds_read_b128 v[32:35], v11 offset:832
s_waitcnt lgkmcnt(5)
v_mfma_f32_32x32x16_bf16 v[80:95], a[84:87], v[44:47], v[80:95]
ds_read_b128 v[36:39], v11 offset:864
s_waitcnt lgkmcnt(5)
v_mfma_f32_32x32x16_bf16 v[80:95], a[88:91], v[48:51], v[80:95]
ds_read_b128 v[40:43], v11 offset:896
s_waitcnt lgkmcnt(5)
v_mfma_f32_32x32x16_bf16 v[80:95], a[92:95], v[52:55], v[80:95]
ds_read_b128 v[44:47], v11 offset:928
s_waitcnt lgkmcnt(5)
v_mfma_f32_32x32x16_bf16 v[80:95], a[96:99], v[24:27], v[80:95]
ds_read_b128 v[48:51], v11 offset:960
s_waitcnt lgkmcnt(5)
v_mfma_f32_32x32x16_bf16 v[80:95], a[100:103], v[28:31], v[80:95]
ds_read_b128 v[52:55], v11 offset:992
s_waitcnt lgkmcnt(5)
v_mfma_f32_32x32x16_bf16 v[80:95], a[104:107], v[32:35], v[80:95]
ds_read_b128 v[24:27], v11 offset:0
s_waitcnt lgkmcnt(5)
v_mfma_f32_32x32x16_bf16 v[80:95], a[108:111], v[36:39], v[80:95]
ds_read_b128 v[28:31], v11 offset:32
s_waitcnt lgkmcnt(5)
v_mfma_f32_32x32x16_bf16 v[80:95], a[112:115], v[40:43], v[80:95]
ds_read_b128 v[32:35], v11 offset:64
s_waitcnt lgkmcnt(5)
v_mfma_f32_32x32x16_bf16 v[80:95], a[116:119], v[44:47], v[80:95]
ds_read_b128 v[36:39], v11 offset:96
s_waitcnt lgkmcnt(5)
v_mfma_f32_32x32x16_bf16 v[80:95], a[120:123], v[48:51], v[80:95]
ds_read_b128 v[40:43], v11 offset:128
s_waitcnt vmcnt(6)
s_barrier
v_mov_b32 v19, s19
s_waitcnt lgkmcnt(5)
v_mfma_f32_32x32x16_bf16 v[80:95], a[124:127], v[52:55], v[80:95]
ds_read_b128 v[44:47], v11 offset:160
buffer_store_dword v19, v16, s[8:11], s49 offen sc1
s_waitcnt lgkmcnt(5)
v_mfma_f32_32x32x16_bf16 v[96:111], v[24:27], v[128:131], 0
ds_read_b128 v[48:51], v11 offset:192
s_waitcnt lgkmcnt(5)
v_mfma_f32_32x32x16_bf16 v[96:111], v[28:31], v[132:135], v[96:111]
ds_read_b128 v[52:55], v11 offset:224
s_add_u32 m0, s44, 4160
s_add_u32 s28, s43, 16384
buffer_load_dwordx4 v10, s[12:15], s28 offen lds
s_waitcnt lgkmcnt(5)
v_mfma_f32_32x32x16_bf16 v[96:111], v[32:35], v[136:139], v[96:111]
ds_read_b128 v[24:27], v11 offset:256
v_mul_f32 v80, s26, v80
v_mul_f32 v81, s26, v81
v_mul_f32 v82, s26, v82
v_mul_f32 v83, s26, v83
s_waitcnt lgkmcnt(5)
v_mfma_f32_32x32x16_bf16 v[96:111], v[36:39], v[140:143], v[96:111]
ds_read_b128 v[28:31], v11 offset:288
v_mul_f32 v84, s26, v84
v_mul_f32 v85, s26, v85
v_mul_f32 v86, s26, v86
v_mul_f32 v87, s26, v87
s_waitcnt lgkmcnt(5)
v_mfma_f32_32x32x16_bf16 v[96:111], v[40:43], v[144:147], v[96:111]
ds_read_b128 v[32:35], v11 offset:320
v_mul_f32 v88, s26, v88
v_mul_f32 v89, s26, v89
v_mul_f32 v90, s26, v90
v_mul_f32 v91, s26, v91
s_waitcnt lgkmcnt(5)
v_mfma_f32_32x32x16_bf16 v[96:111], v[44:47], v[148:151], v[96:111]
ds_read_b128 v[36:39], v11 offset:352
v_mul_f32 v92, s26, v92
v_mul_f32 v93, s26, v93
v_mul_f32 v94, s26, v94
v_mul_f32 v95, s26, v95
s_waitcnt lgkmcnt(5)
v_mfma_f32_32x32x16_bf16 v[96:111], v[48:51], v[152:155], v[96:111]
ds_read_b128 v[40:43], v11 offset:384
v_cvt_pk_bf16_f32 v112, v80, v81
v_cvt_pk_bf16_f32 v113, v82, v83
v_cvt_pk_bf16_f32 v114, v84, v85
v_cvt_pk_bf16_f32 v115, v86, v87
s_waitcnt lgkmcnt(5)
v_mfma_f32_32x32x16_bf16 v[96:111], v[52:55], v[156:159], v[96:111]
ds_read_b128 v[44:47], v11 offset:416
v_cvt_pk_bf16_f32 v116, v88, v89
v_cvt_pk_bf16_f32 v117, v90, v91
v_cvt_pk_bf16_f32 v118, v92, v93
v_cvt_pk_bf16_f32 v119, v94, v95
s_add_u32 m0, s44, 5200
s_add_u32 s28, s43, 17408
buffer_load_dwordx4 v10, s[12:15], s28 offen lds
s_waitcnt lgkmcnt(5)
v_mfma_f32_32x32x16_bf16 v[96:111], v[24:27], v[160:163], v[96:111]
ds_read_b128 v[48:51], v11 offset:448
ds_write_b128 v12, v[112:115] offset:0
s_waitcnt lgkmcnt(6)
v_mfma_f32_32x32x16_bf16 v[96:111], v[28:31], v[164:167], v[96:111]
ds_read_b128 v[52:55], v11 offset:480
ds_write_b128 v18, v[116:119] offset:0
s_waitcnt lgkmcnt(7)
v_mfma_f32_32x32x16_bf16 v[96:111], v[32:35], v[168:171], v[96:111]
ds_read_b128 v[24:27], v11 offset:512
s_waitcnt lgkmcnt(7)
v_mfma_f32_32x32x16_bf16 v[96:111], v[36:39], v[172:175], v[96:111]
ds_read_b128 v[28:31], v11 offset:544
s_waitcnt lgkmcnt(7)
v_mfma_f32_32x32x16_bf16 v[96:111], v[40:43], v[176:179], v[96:111]
ds_read_b128 v[32:35], v11 offset:576
s_waitcnt lgkmcnt(7)
v_mfma_f32_32x32x16_bf16 v[96:111], v[44:47], v[180:183], v[96:111]
ds_read_b128 v[36:39], v11 offset:608
s_waitcnt lgkmcnt(4)
s_barrier
ds_read_b128 v[120:123], v20
v_mfma_f32_32x32x16_bf16 v[96:111], v[48:51], v[184:187], v[96:111]
ds_read_b128 v[40:43], v11 offset:640
ds_read_b128 v[124:127], v21
v_mfma_f32_32x32x16_bf16 v[96:111], v[52:55], v[188:191], v[96:111]
ds_read_b128 v[44:47], v11 offset:672
s_waitcnt lgkmcnt(7)
v_mfma_f32_32x32x16_bf16 v[96:111], v[24:27], v[192:195], v[96:111]
ds_read_b128 v[48:51], v11 offset:704
s_waitcnt lgkmcnt(7)
v_mfma_f32_32x32x16_bf16 v[96:111], v[28:31], v[196:199], v[96:111]
ds_read_b128 v[52:55], v11 offset:736
s_waitcnt lgkmcnt(7)
v_mfma_f32_32x32x16_bf16 v[96:111], v[32:35], v[200:203], v[96:111]
ds_read_b128 v[24:27], v11 offset:768
s_waitcnt lgkmcnt(7)
v_mfma_f32_32x32x16_bf16 v[96:111], v[36:39], v[204:207], v[96:111]
ds_read_b128 v[28:31], v11 offset:800
s_waitcnt lgkmcnt(5)
buffer_store_dwordx4 v[120:123], v17, s[8:11], s45 offen sc1
v_mfma_f32_32x32x16_bf16 v[96:111], v[40:43], v[208:211], v[96:111]
ds_read_b128 v[32:35], v11 offset:832
s_waitcnt lgkmcnt(5)
v_mfma_f32_32x32x16_bf16 v[96:111], v[44:47], v[212:215], v[96:111]
ds_read_b128 v[36:39], v11 offset:864
s_waitcnt lgkmcnt(5)
v_mfma_f32_32x32x16_bf16 v[96:111], v[48:51], v[216:219], v[96:111]
ds_read_b128 v[40:43], v11 offset:896
s_waitcnt lgkmcnt(5)
v_mfma_f32_32x32x16_bf16 v[96:111], v[52:55], v[220:223], v[96:111]
ds_read_b128 v[44:47], v11 offset:928
buffer_store_dwordx4 v[124:127], v17, s[8:11], s50 offen sc1
s_waitcnt lgkmcnt(5)
v_mfma_f32_32x32x16_bf16 v[96:111], v[24:27], v[224:227], v[96:111]
ds_read_b128 v[48:51], v11 offset:960
s_waitcnt lgkmcnt(5)
v_mfma_f32_32x32x16_bf16 v[96:111], v[28:31], v[228:231], v[96:111]
ds_read_b128 v[52:55], v11 offset:992
s_add_u32 m0, s44, 6240
s_add_u32 s28, s43, 18432
buffer_load_dwordx4 v10, s[12:15], s28 offen lds
s_waitcnt lgkmcnt(5)
v_mfma_f32_32x32x16_bf16 v[96:111], v[32:35], v[232:235], v[96:111]
s_waitcnt lgkmcnt(4)
v_mfma_f32_32x32x16_bf16 v[96:111], v[36:39], v[236:239], v[96:111]
s_waitcnt lgkmcnt(3)
v_mfma_f32_32x32x16_bf16 v[96:111], v[40:43], v[240:243], v[96:111]
s_waitcnt lgkmcnt(2)
v_mfma_f32_32x32x16_bf16 v[96:111], v[44:47], v[244:247], v[96:111]
s_add_u32 m0, s44, 7280
s_add_u32 s28, s43, 19456
buffer_load_dwordx4 v10, s[12:15], s28 offen lds
s_waitcnt lgkmcnt(1)
v_mfma_f32_32x32x16_bf16 v[96:111], v[48:51], v[248:251], v[96:111]
s_waitcnt lgkmcnt(0)
v_mfma_f32_32x32x16_bf16 v[96:111], v[52:55], v[252:255], v[96:111]
s_add_u32 s46, s23, 17039360
s_add_u32 s47, s46, 4096
s_add_u32 s24, s24, 1
s_cmp_eq_u32 s24, 3
s_cselect_b32 s24, 0, s24
s_mov_b32 s28, 33280
s_cselect_b32 s29, -2, 1
s_mul_i32 s28, s28, s29
v_add_u32 v11, s28, v11
s_add_u32 s19, s19, s25
s_mov_b32 s25, 2
s_add_u32 s20, s20, 1
s_cmp_eq_u32 s20, 1
s_cbranch_scc1 Lq_fl
s_cmp_lt_u32 s19, 64
s_cbranch_scc1 Lq_sg1
s_branch Lq_fl
Lq_sg2:
s_mul_i32 s28, s19, 1048576
s_lshl_b32 s29, s16, 13
s_add_u32 s23, s28, s29
s_add_u32 s45, s23, 16777216
s_add_u32 s50, s45, 4096
s_add_u32 s48, s23, 17301504
s_add_u32 s21, s21, 65536
s_add_u32 s22, s22, 33280
s_cmp_eq_u32 s22, 99840
s_cselect_b32 s22, 0, s22
s_lshl_b32 s43, s17, 12
s_add_u32 s43, s43, s21
s_mul_i32 s44, s17, 8320
s_add_u32 s44, s44, s22
ds_read_b128 v[24:27], v11 offset:0
ds_read_b128 v[28:31], v11 offset:32
ds_read_b128 v[32:35], v11 offset:64
ds_read_b128 v[36:39], v11 offset:96
ds_read_b128 v[40:43], v11 offset:128
ds_read_b128 v[44:47], v11 offset:160
s_waitcnt lgkmcnt(5)
v_mfma_f32_32x32x16_bf16 v[64:79], a[128:131], v[24:27], 0
ds_read_b128 v[48:51], v11 offset:192
s_waitcnt lgkmcnt(5)
v_mfma_f32_32x32x16_bf16 v[64:79], a[132:135], v[28:31], v[64:79]
ds_read_b128 v[52:55], v11 offset:224
s_waitcnt lgkmcnt(5)
v_mfma_f32_32x32x16_bf16 v[64:79], a[136:139], v[32:35], v[64:79]
ds_read_b128 v[24:27], v11 offset:256
v_cvt_pk_bf16_f32 v112, v96, v97
v_cvt_pk_bf16_f32 v113, v98, v99
v_cvt_pk_bf16_f32 v114, v100, v101
v_cvt_pk_bf16_f32 v115, v102, v103
s_waitcnt lgkmcnt(5)
v_mfma_f32_32x32x16_bf16 v[64:79], a[140:143], v[36:39], v[64:79]
ds_read_b128 v[28:31], v11 offset:288
v_cvt_pk_bf16_f32 v116, v104, v105
v_cvt_pk_bf16_f32 v117, v106, v107
v_cvt_pk_bf16_f32 v118, v108, v109
v_cvt_pk_bf16_f32 v119, v110, v111
s_waitcnt lgkmcnt(5)
v_mfma_f32_32x32x16_bf16 v[64:79], a[144:147], v[40:43], v[64:79]
ds_read_b128 v[32:35], v11 offset:320
ds_write2_b32 v13, v112, v113 offset0:0 offset1:2
s_waitcnt lgkmcnt(6)
v_mfma_f32_32x32x16_bf16 v[64:79], a[148:151], v[44:47], v[64:79]
ds_read_b128 v[36:39], v11 offset:352
ds_write2_b32 v13, v114, v115 offset0:64 offset1:66
s_waitcnt lgkmcnt(7)
v_mfma_f32_32x32x16_bf16 v[64:79], a[152:155], v[48:51], v[64:79]
ds_read_b128 v[40:43], v11 offset:384
ds_write2_b32 v13, v116, v117 offset0:128 offset1:130
s_waitcnt lgkmcnt(8)
v_mfma_f32_32x32x16_bf16 v[64:79], a[156:159], v[52:55], v[64:79]
ds_read_b128 v[44:47], v11 offset:416
ds_write2_b32 v13, v118, v119 offset0:192 offset1:194
s_waitcnt lgkmcnt(9)
v_mfma_f32_32x32x16_bf16 v[64:79], a[160:163], v[24:27], v[64:79]
ds_read_b128 v[48:51], v11 offset:448
s_waitcnt lgkmcnt(9)
v_mfma_f32_32x32x16_bf16 v[64:79], a[164:167], v[28:31], v[64:79]
ds_read_b128 v[52:55], v11 offset:480
s_waitcnt lgkmcnt(9)
v_mfma_f32_32x32x16_bf16 v[64:79], a[168:171], v[32:35], v[64:79]
ds_read_b128 v[24:27], v11 offset:512
s_waitcnt lgkmcnt(8)
v_mfma_f32_32x32x16_bf16 v[64:79], a[172:175], v[36:39], v[64:79]
ds_read_b128 v[28:31], v11 offset:544
s_waitcnt lgkmcnt(4)
s_barrier
ds_read_b128 v[120:123], v14 offset:16384
v_mfma_f32_32x32x16_bf16 v[64:79], a[176:179], v[40:43], v[64:79]
ds_read_b128 v[32:35], v11 offset:576
ds_read_b128 v[124:127], v14 offset:20480
v_mfma_f32_32x32x16_bf16 v[64:79], a[180:183], v[44:47], v[64:79]
ds_read_b128 v[36:39], v11 offset:608
s_waitcnt lgkmcnt(7)
v_mfma_f32_32x32x16_bf16 v[64:79], a[184:187], v[48:51], v[64:79]
ds_read_b128 v[40:43], v11 offset:640
s_waitcnt lgkmcnt(7)
v_mfma_f32_32x32x16_bf16 v[64:79], a[188:191], v[52:55], v[64:79]
ds_read_b128 v[44:47], v11 offset:672
s_waitcnt lgkmcnt(7)
v_mfma_f32_32x32x16_bf16 v[64:79], a[192:195], v[24:27], v[64:79]
ds_read_b128 v[48:51], v11 offset:704
s_waitcnt lgkmcnt(7)
v_mfma_f32_32x32x16_bf16 v[64:79], a[196:199], v[28:31], v[64:79]
ds_read_b128 v[52:55], v11 offset:736
s_waitcnt lgkmcnt(6)
v_mfma_f32_32x32x16_bf16 v[64:79], a[200:203], v[32:35], v[64:79]
ds_read_b128 v[24:27], v11 offset:768
s_waitcnt lgkmcnt(6)
buffer_store_dwordx4 v[120:123], v17, s[8:11], s46 offen sc1
s_waitcnt lgkmcnt(5)
v_mfma_f32_32x32x16_bf16 v[64:79], a[204:207], v[36:39], v[64:79]
ds_read_b128 v[28:31], v11 offset:800
s_waitcnt lgkmcnt(5)
v_mfma_f32_32x32x16_bf16 v[64:79], a[208:211], v[40:43], v[64:79]
ds_read_b128 v[32:35], v11 offset:832
s_waitcnt lgkmcnt(5)
v_mfma_f32_32x32x16_bf16 v[64:79], a[212:215], v[44:47], v[64:79]
ds_read_b128 v[36:39], v11 offset:864
s_waitcnt lgkmcnt(5)
v_mfma_f32_32x32x16_bf16 v[64:79], a[216:219], v[48:51], v[64:79]
ds_read_b128 v[40:43], v11 offset:896
buffer_store_dwordx4 v[124:127], v17, s[8:11], s47 offen sc1
s_waitcnt lgkmcnt(5)
v_mfma_f32_32x32x16_bf16 v[64:79], a[220:223], v[52:55], v[64:79]
ds_read_b128 v[44:47], v11 offset:928
s_waitcnt lgkmcnt(5)
v_mfma_f32_32x32x16_bf16 v[64:79], a[224:227], v[24:27], v[64:79]
ds_read_b128 v[48:51], v11 offset:960
s_waitcnt lgkmcnt(5)
v_mfma_f32_32x32x16_bf16 v[64:79], a[228:231], v[28:31], v[64:79]
ds_read_b128 v[52:55], v11 offset:992
s_waitcnt lgkmcnt(5)
v_mfma_f32_32x32x16_bf16 v[64:79], a[232:235], v[32:35], v[64:79]
ds_read_b128 v[24:27], v11 offset:0
s_waitcnt lgkmcnt(5)
v_mfma_f32_32x32x16_bf16 v[64:79], a[236:239], v[36:39], v[64:79]
ds_read_b128 v[28:31], v11 offset:32
s_waitcnt lgkmcnt(5)
v_mfma_f32_32x32x16_bf16 v[64:79], a[240:243], v[40:43], v[64:79]
ds_read_b128 v[32:35], v11 offset:64
s_waitcnt lgkmcnt(5)
v_mfma_f32_32x32x16_bf16 v[64:79], a[244:247], v[44:47], v[64:79]
ds_read_b128 v[36:39], v11 offset:96
s_waitcnt lgkmcnt(5)
v_mfma_f32_32x32x16_bf16 v[64:79], a[248:251], v[48:51], v[64:79]
ds_read_b128 v[40:43], v11 offset:128
s_add_u32 m0, s44, 0
s_add_u32 s28, s43, 0
buffer_load_dwordx4 v10, s[12:15], s28 offen lds
s_waitcnt lgkmcnt(5)
v_mfma_f32_32x32x16_bf16 v[64:79], a[252:255], v[52:55], v[64:79]
ds_read_b128 v[44:47], v11 offset:160
s_waitcnt lgkmcnt(5)
v_mfma_f32_32x32x16_bf16 v[80:95], a[0:3], v[24:27], 0
ds_read_b128 v[48:51], v11 offset:192
s_waitcnt lgkmcnt(5)
v_mfma_f32_32x32x16_bf16 v[80:95], a[4:7], v[28:31], v[80:95]
ds_read_b128 v[52:55], v11 offset:224
s_waitcnt lgkmcnt(5)
v_mfma_f32_32x32x16_bf16 v[80:95], a[8:11], v[32:35], v[80:95]
ds_read_b128 v[24:27], v11 offset:256
v_cvt_pk_bf16_f32 v112, v64, v65
v_cvt_pk_bf16_f32 v113, v66, v67
v_cvt_pk_bf16_f32 v114, v68, v69
v_cvt_pk_bf16_f32 v115, v70, v71
s_waitcnt lgkmcnt(5)
v_mfma_f32_32x32x16_bf16 v[80:95], a[12:15], v[36:39], v[80:95]
ds_read_b128 v[28:31], v11 offset:288
v_cvt_pk_bf16_f32 v116, v72, v73
v_cvt_pk_bf16_f32 v117, v74, v75
v_cvt_pk_bf16_f32 v118, v76, v77
v_cvt_pk_bf16_f32 v119, v78, v79
s_waitcnt lgkmcnt(5)
v_mfma_f32_32x32x16_bf16 v[80:95], a[16:19], v[40:43], v[80:95]
ds_read_b128 v[32:35], v11 offset:320
ds_write_b128 v12, v[112:115] offset:8192
s_add_u32 m0, s44, 1040
s_add_u32 s28, s43, 1024
buffer_load_dwordx4 v10, s[12:15], s28 offen lds
s_waitcnt lgkmcnt(6)
v_mfma_f32_32x32x16_bf16 v[80:95], a[20:23], v[44:47], v[80:95]
ds_read_b128 v[36:39], v11 offset:352
ds_write_b128 v18, v[116:119] offset:8192
s_waitcnt lgkmcnt(7)
v_mfma_f32_32x32x16_bf16 v[80:95], a[24:27], v[48:51], v[80:95]
ds_read_b128 v[40:43], v11 offset:384
s_waitcnt lgkmcnt(7)
v_mfma_f32_32x32x16_bf16 v[80:95], a[28:31], v[52:55], v[80:95]
ds_read_b128 v[44:47], v11 offset:416
s_waitcnt lgkmcnt(7)
v_mfma_f32_32x32x16_bf16 v[80:95], a[32:35], v[24:27], v[80:95]
ds_read_b128 v[48:51], v11 offset:448
s_waitcnt lgkmcnt(7)
v_mfma_f32_32x32x16_bf16 v[80:95], a[36:39], v[28:31], v[80:95]
ds_read_b128 v[52:55], v11 offset:480
s_waitcnt lgkmcnt(4)
s_barrier
ds_read_b128 v[120:123], v14 offset:8192
v_mfma_f32_32x32x16_bf16 v[80:95], a[40:43], v[32:35], v[80:95]
ds_read_b128 v[24:27], v11 offset:512
ds_read_b128 v[124:127], v14 offset:12288
s_add_u32 m0, s44, 2080
s_add_u32 s28, s43, 2048
buffer_load_dwordx4 v10, s[12:15], s28 offen lds
v_mfma_f32_32x32x16_bf16 v[80:95], a[44:47], v[36:39], v[80:95]
ds_read_b128 v[28:31], v11 offset:544
s_waitcnt lgkmcnt(7)
v_mfma_f32_32x32x16_bf16 v[80:95], a[48:51], v[40:43], v[80:95]
ds_read_b128 v[32:35], v11 offset:576
s_waitcnt lgkmcnt(7)
v_mfma_f32_32x32x16_bf16 v[80:95], a[52:55], v[44:47], v[80:95]
ds_read_b128 v[36:39], v11 offset:608
s_waitcnt lgkmcnt(7)
v_mfma_f32_32x32x16_bf16 v[80:95], a[56:59], v[48:51], v[80:95]
ds_read_b128 v[40:43], v11 offset:640
s_waitcnt lgkmcnt(7)
v_mfma_f32_32x32x16_bf16 v[80:95], a[60:63], v[52:55], v[80:95]
ds_read_b128 v[44:47], v11 offset:672
s_waitcnt lgkmcnt(6)
v_mfma_f32_32x32x16_bf16 v[80:95], a[64:67], v[24:27], v[80:95]
ds_read_b128 v[48:51], v11 offset:704
s_waitcnt lgkmcnt(6)
buffer_store_dwordx4 v[120:123], v15, s[8:11], s48 offen offset:0 sc1
s_add_u32 m0, s44, 3120
s_add_u32 s28, s43, 3072
buffer_load_dwordx4 v10, s[12:15], s28 offen lds
s_waitcnt lgkmcnt(5)
v_mfma_f32_32x32x16_bf16 v[80:95], a[68:71], v[28:31], v[80:95]
ds_read_b128 v[52:55], v11 offset:736
s_waitcnt lgkmcnt(5)
v_mfma_f32_32x32x16_bf16 v[80:95], a[72:75], v[32:35], v[80:95]
ds_read_b128 v[24:27], v11 offset:768
s_waitcnt lgkmcnt(5)
v_mfma_f32_32x32x16_bf16 v[80:95], a[76:79], v[36:39], v[80:95]
ds_read_b128 v[28:31], v11 offset:800
s_waitcnt lgkmcnt(5)
v_mfma_f32_32x32x16_bf16 v[80:95], a[80:83], v[40:43], v[80:95]
ds_read_b128 v[32:35], v11 offset:832
buffer_store_dwordx4 v[124:127], v15, s[8:11], s48 offen offset:2048 sc1
s_waitcnt lgkmcnt(5)
v_mfma_f32_32x32x16_bf16 v[80:95], a[84:87], v[44:47], v[80:95]
ds_read_b128 v[36:39], v11 offset:864
s_waitcnt lgkmcnt(5)
v_mfma_f32_32x32x16_bf16 v[80:95], a[88:91], v[48:51], v[80:95]
ds_read_b128 v[40:43], v11 offset:896
s_waitcnt lgkmcnt(5)
v_mfma_f32_32x32x16_bf16 v[80:95], a[92:95], v[52:55], v[80:95]
ds_read_b128 v[44:47], v11 offset:928
s_waitcnt lgkmcnt(5)
v_mfma_f32_32x32x16_bf16 v[80:95], a[96:99], v[24:27], v[80:95]
ds_read_b128 v[48:51], v11 offset:960
s_waitcnt lgkmcnt(5)
v_mfma_f32_32x32x16_bf16 v[80:95], a[100:103], v[28:31], v[80:95]
ds_read_b128 v[52:55], v11 offset:992
s_waitcnt lgkmcnt(5)
v_mfma_f32_32x32x16_bf16 v[80:95], a[104:107], v[32:35], v[80:95]
ds_read_b128 v[24:27], v11 offset:0
s_waitcnt lgkmcnt(5)
v_mfma_f32_32x32x16_bf16 v[80:95], a[108:111], v[36:39], v[80:95]
ds_read_b128 v[28:31], v11 offset:32
s_waitcnt lgkmcnt(5)
v_mfma_f32_32x32x16_bf16 v[80:95], a[112:115], v[40:43], v[80:95]
ds_read_b128 v[32:35], v11 offset:64
s_waitcnt lgkmcnt(5)
v_mfma_f32_32x32x16_bf16 v[80:95], a[116:119], v[44:47], v[80:95]
ds_read_b128 v[36:39], v11 offset:96
s_waitcnt lgkmcnt(5)
v_mfma_f32_32x32x16_bf16 v[80:95], a[120:123], v[48:51], v[80:95]
ds_read_b128 v[40:43], v11 offset:128
s_waitcnt vmcnt(6)
s_barrier
v_mov_b32 v19, s19
s_waitcnt lgkmcnt(5)
v_mfma_f32_32x32x16_bf16 v[80:95], a[124:127], v[52:55], v[80:95]
ds_read_b128 v[44:47], v11 offset:160
buffer_store_dword v19, v16, s[8:11], s49 offen sc1
s_waitcnt lgkmcnt(5)
v_mfma_f32_32x32x16_bf16 v[96:111], v[24:27], v[128:131], 0
ds_read_b128 v[48:51], v11 offset:192
s_waitcnt lgkmcnt(5)
v_mfma_f32_32x32x16_bf16 v[96:111], v[28:31], v[132:135], v[96:111]
ds_read_b128 v[52:55], v11 offset:224
s_waitcnt lgkmcnt(5)
v_mfma_f32_32x32x16_bf16 v[96:111], v[32:35], v[136:139], v[96:111]
ds_read_b128 v[24:27], v11 offset:256
v_mul_f32 v80, s26, v80
v_mul_f32 v81, s26, v81
v_mul_f32 v82, s26, v82
v_mul_f32 v83, s26, v83
s_add_u32 m0, s44, 4160
s_add_u32 s28, s43, 16384
buffer_load_dwordx4 v10, s[12:15], s28 offen lds
s_waitcnt lgkmcnt(5)
v_mfma_f32_32x32x16_bf16 v[96:111], v[36:39], v[140:143], v[96:111]
ds_read_b128 v[28:31], v11 offset:288
v_mul_f32 v84, s26, v84
v_mul_f32 v85, s26, v85
v_mul_f32 v86, s26, v86
v_mul_f32 v87, s26, v87
s_waitcnt lgkmcnt(5)
v_mfma_f32_32x32x16_bf16 v[96:111], v[40:43], v[144:147], v[96:111]
ds_read_b128 v[32:35], v11 offset:320
v_mul_f32 v88, s26, v88
v_mul_f32 v89, s26, v89
v_mul_f32 v90, s26, v90
v_mul_f32 v91, s26, v91
s_waitcnt lgkmcnt(5)
v_mfma_f32_32x32x16_bf16 v[96:111], v[44:47], v[148:151], v[96:111]
ds_read_b128 v[36:39], v11 offset:352
v_mul_f32 v92, s26, v92
v_mul_f32 v93, s26, v93
v_mul_f32 v94, s26, v94
v_mul_f32 v95, s26, v95
s_waitcnt lgkmcnt(5)
v_mfma_f32_32x32x16_bf16 v[96:111], v[48:51], v[152:155], v[96:111]
ds_read_b128 v[40:43], v11 offset:384
v_cvt_pk_bf16_f32 v112, v80, v81
v_cvt_pk_bf16_f32 v113, v82, v83
v_cvt_pk_bf16_f32 v114, v84, v85
v_cvt_pk_bf16_f32 v115, v86, v87
s_waitcnt lgkmcnt(5)
v_mfma_f32_32x32x16_bf16 v[96:111], v[52:55], v[156:159], v[96:111]
ds_read_b128 v[44:47], v11 offset:416
v_cvt_pk_bf16_f32 v116, v88, v89
v_cvt_pk_bf16_f32 v117, v90, v91
v_cvt_pk_bf16_f32 v118, v92, v93
v_cvt_pk_bf16_f32 v119, v94, v95
s_waitcnt lgkmcnt(5)
v_mfma_f32_32x32x16_bf16 v[96:111], v[24:27], v[160:163], v[96:111]
ds_read_b128 v[48:51], v11 offset:448
ds_write_b128 v12, v[112:115] offset:0
s_add_u32 m0, s44, 5200
s_add_u32 s28, s43, 17408
buffer_load_dwordx4 v10, s[12:15], s28 offen lds
s_waitcnt lgkmcnt(6)
v_mfma_f32_32x32x16_bf16 v[96:111], v[28:31], v[164:167], v[96:111]
ds_read_b128 v[52:55], v11 offset:480
ds_write_b128 v18, v[116:119] offset:0
s_waitcnt lgkmcnt(7)
v_mfma_f32_32x32x16_bf16 v[96:111], v[32:35], v[168:171], v[96:111]
ds_read_b128 v[24:27], v11 offset:512
s_waitcnt lgkmcnt(7)
v_mfma_f32_32x32x16_bf16 v[96:111], v[36:39], v[172:175], v[96:111]
ds_read_b128 v[28:31], v11 offset:544
s_waitcnt lgkmcnt(7)
v_mfma_f32_32x32x16_bf16 v[96:111], v[40:43], v[176:179], v[96:111]
ds_read_b128 v[32:35], v11 offset:576
s_waitcnt lgkmcnt(7)
v_mfma_f32_32x32x16_bf16 v[96:111], v[44:47], v[180:183], v[96:111]
ds_read_b128 v[36:39], v11 offset:608
s_waitcnt lgkmcnt(4)
s_barrier
ds_read_b128 v[120:123], v20
v_mfma_f32_32x32x16_bf16 v[96:111], v[48:51], v[184:187], v[96:111]
ds_read_b128 v[40:43], v11 offset:640
ds_read_b128 v[124:127], v21
v_mfma_f32_32x32x16_bf16 v[96:111], v[52:55], v[188:191], v[96:111]
ds_read_b128 v[44:47], v11 offset:672
s_waitcnt lgkmcnt(7)
v_mfma_f32_32x32x16_bf16 v[96:111], v[24:27], v[192:195], v[96:111]
ds_read_b128 v[48:51], v11 offset:704
s_waitcnt lgkmcnt(7)
v_mfma_f32_32x32x16_bf16 v[96:111], v[28:31], v[196:199], v[96:111]
ds_read_b128 v[52:55], v11 offset:736
s_waitcnt lgkmcnt(7)
v_mfma_f32_32x32x16_bf16 v[96:111], v[32:35], v[200:203], v[96:111]
ds_read_b128 v[24:27], v11 offset:768
s_waitcnt lgkmcnt(7)
v_mfma_f32_32x32x16_bf16 v[96:111], v[36:39], v[204:207], v[96:111]
ds_read_b128 v[28:31], v11 offset:800
s_waitcnt lgkmcnt(6)
v_mfma_f32_32x32x16_bf16 v[96:111], v[40:43], v[208:211], v[96:111]
ds_read_b128 v[32:35], v11 offset:832
s_waitcnt lgkmcnt(6)
buffer_store_dwordx4 v[120:123], v17, s[8:11], s45 offen sc1
s_waitcnt lgkmcnt(5)
v_mfma_f32_32x32x16_bf16 v[96:111], v[44:47], v[212:215], v[96:111]
ds_read_b128 v[36:39], v11 offset:864
s_waitcnt lgkmcnt(5)
v_mfma_f32_32x32x16_bf16 v[96:111], v[48:51], v[216:219], v[96:111]
ds_read_b128 v[40:43], v11 offset:896
s_waitcnt lgkmcnt(5)
v_mfma_f32_32x32x16_bf16 v[96:111], v[52:55], v[220:223], v[96:111]
ds_read_b128 v[44:47], v11 offset:928
s_waitcnt lgkmcnt(5)
v_mfma_f32_32x32x16_bf16 v[96:111], v[24:27], v[224:227], v[96:111]
ds_read_b128 v[48:51], v11 offset:960
buffer_store_dwordx4 v[124:127], v17, s[8:11], s50 offen sc1
s_waitcnt lgkmcnt(5)
v_mfma_f32_32x32x16_bf16 v[96:111], v[28:31], v[228:231], v[96:111]
ds_read_b128 v[52:55], v11 offset:992
s_waitcnt lgkmcnt(5)
v_mfma_f32_32x32x16_bf16 v[96:111], v[32:35], v[232:235], v[96:111]
s_add_u32 m0, s44, 6240
s_add_u32 s28, s43, 18432
buffer_load_dwordx4 v10, s[12:15], s28 offen lds
s_waitcnt lgkmcnt(4)
v_mfma_f32_32x32x16_bf16 v[96:111], v[36:39], v[236:239], v[96:111]
s_waitcnt lgkmcnt(3)
v_mfma_f32_32x32x16_bf16 v[96:111], v[40:43], v[240:243], v[96:111]
s_waitcnt lgkmcnt(2)
v_mfma_f32_32x32x16_bf16 v[96:111], v[44:47], v[244:247], v[96:111]
s_waitcnt lgkmcnt(1)
v_mfma_f32_32x32x16_bf16 v[96:111], v[48:51], v[248:251], v[96:111]
s_add_u32 m0, s44, 7280
s_add_u32 s28, s43, 19456
buffer_load_dwordx4 v10, s[12:15], s28 offen lds
s_waitcnt lgkmcnt(0)
v_mfma_f32_32x32x16_bf16 v[96:111], v[52:55], v[252:255], v[96:111]
s_add_u32 s46, s23, 17039360
s_add_u32 s47, s46, 4096
s_add_u32 s24, s24, 1
s_cmp_eq_u32 s24, 3
s_cselect_b32 s24, 0, s24
s_mov_b32 s28, 33280
s_cselect_b32 s29, -2, 1
s_mul_i32 s28, s28, s29
v_add_u32 v11, s28, v11
s_add_u32 s19, s19, s25
s_mov_b32 s25, 2
s_add_u32 s20, s20, 1
s_cmp_eq_u32 s20, 1
s_cbranch_scc1 Lq_fl
s_cmp_lt_u32 s19, 64
s_cbranch_scc1 Lq_sg2
s_branch Lq_fl
Lq_sg3:
s_mul_i32 s28, s19, 1048576
s_lshl_b32 s29, s16, 13
s_add_u32 s23, s28, s29
s_add_u32 s45, s23, 16777216
s_add_u32 s50, s45, 4096
s_add_u32 s48, s23, 17301504
s_add_u32 s21, s21, 65536
s_add_u32 s22, s22, 33280
s_cmp_eq_u32 s22, 99840
s_cselect_b32 s22, 0, s22
s_lshl_b32 s43, s17, 12
s_add_u32 s43, s43, s21
s_mul_i32 s44, s17, 8320
s_add_u32 s44, s44, s22
ds_read_b128 v[24:27], v11 offset:0
ds_read_b128 v[28:31], v11 offset:32
ds_read_b128 v[32:35], v11 offset:64
ds_read_b128 v[36:39], v11 offset:96
ds_read_b128 v[40:43], v11 offset:128
ds_read_b128 v[44:47], v11 offset:160
s_waitcnt lgkmcnt(5)
v_mfma_f32_32x32x16_bf16 v[64:79], a[128:131], v[24:27], 0
ds_read_b128 v[48:51], v11 offset:192
s_waitcnt lgkmcnt(5)
v_mfma_f32_32x32x16_bf16 v[64:79], a[132:135], v[28:31], v[64:79]
ds_read_b128 v[52:55], v11 offset:224
s_waitcnt lgkmcnt(5)
v_mfma_f32_32x32x16_bf16 v[64:79], a[136:139], v[32:35], v[64:79]
ds_read_b128 v[24:27], v11 offset:256
v_cvt_pk_bf16_f32 v112, v96, v97
v_cvt_pk_bf16_f32 v113, v98, v99
v_cvt_pk_bf16_f32 v114, v100, v101
v_cvt_pk_bf16_f32 v115, v102, v103
s_waitcnt lgkmcnt(5)
v_mfma_f32_32x32x16_bf16 v[64:79], a[140:143], v[36:39], v[64:79]
ds_read_b128 v[28:31], v11 offset:288
v_cvt_pk_bf16_f32 v116, v104, v105
v_cvt_pk_bf16_f32 v117, v106, v107
v_cvt_pk_bf16_f32 v118, v108, v109
v_cvt_pk_bf16_f32 v119, v110, v111
s_waitcnt lgkmcnt(5)
v_mfma_f32_32x32x16_bf16 v[64:79], a[144:147], v[40:43], v[64:79]
ds_read_b128 v[32:35], v11 offset:320
ds_write2_b32 v13, v112, v113 offset0:0 offset1:2
s_waitcnt lgkmcnt(6)
v_mfma_f32_32x32x16_bf16 v[64:79], a[148:151], v[44:47], v[64:79]
ds_read_b128 v[36:39], v11 offset:352
ds_write2_b32 v13, v114, v115 offset0:64 offset1:66
s_waitcnt lgkmcnt(7)
v_mfma_f32_32x32x16_bf16 v[64:79], a[152:155], v[48:51], v[64:79]
ds_read_b128 v[40:43], v11 offset:384
ds_write2_b32 v13, v116, v117 offset0:128 offset1:130
s_waitcnt lgkmcnt(8)
v_mfma_f32_32x32x16_bf16 v[64:79], a[156:159], v[52:55], v[64:79]
ds_read_b128 v[44:47], v11 offset:416
ds_write2_b32 v13, v118, v119 offset0:192 offset1:194
s_waitcnt lgkmcnt(9)
v_mfma_f32_32x32x16_bf16 v[64:79], a[160:163], v[24:27], v[64:79]
ds_read_b128 v[48:51], v11 offset:448
s_waitcnt lgkmcnt(9)
v_mfma_f32_32x32x16_bf16 v[64:79], a[164:167], v[28:31], v[64:79]
ds_read_b128 v[52:55], v11 offset:480
s_waitcnt lgkmcnt(9)
v_mfma_f32_32x32x16_bf16 v[64:79], a[168:171], v[32:35], v[64:79]
ds_read_b128 v[24:27], v11 offset:512
s_waitcnt lgkmcnt(8)
v_mfma_f32_32x32x16_bf16 v[64:79], a[172:175], v[36:39], v[64:79]
ds_read_b128 v[28:31], v11 offset:544
s_waitcnt lgkmcnt(4)
s_barrier
ds_read_b128 v[120:123], v14 offset:16384
v_mfma_f32_32x32x16_bf16 v[64:79], a[176:179], v[40:43], v[64:79]
ds_read_b128 v[32:35], v11 offset:576
ds_read_b128 v[124:127], v14 offset:20480
v_mfma_f32_32x32x16_bf16 v[64:79], a[180:183], v[44:47], v[64:79]
ds_read_b128 v[36:39], v11 offset:608
s_waitcnt lgkmcnt(7)
v_mfma_f32_32x32x16_bf16 v[64:79], a[184:187], v[48:51], v[64:79]
ds_read_b128 v[40:43], v11 offset:640
s_waitcnt lgkmcnt(7)
v_mfma_f32_32x32x16_bf16 v[64:79], a[188:191], v[52:55], v[64:79]
ds_read_b128 v[44:47], v11 offset:672
s_waitcnt lgkmcnt(7)
v_mfma_f32_32x32x16_bf16 v[64:79], a[192:195], v[24:27], v[64:79]
ds_read_b128 v[48:51], v11 offset:704
s_waitcnt lgkmcnt(7)
v_mfma_f32_32x32x16_bf16 v[64:79], a[196:199], v[28:31], v[64:79]
ds_read_b128 v[52:55], v11 offset:736
s_waitcnt lgkmcnt(6)
v_mfma_f32_32x32x16_bf16 v[64:79], a[200:203], v[32:35], v[64:79]
ds_read_b128 v[24:27], v11 offset:768
s_waitcnt lgkmcnt(5)
v_mfma_f32_32x32x16_bf16 v[64:79], a[204:207], v[36:39], v[64:79]
ds_read_b128 v[28:31], v11 offset:800
buffer_store_dwordx4 v[120:123], v17, s[8:11], s46 offen sc1
s_waitcnt lgkmcnt(5)
v_mfma_f32_32x32x16_bf16 v[64:79], a[208:211], v[40:43], v[64:79]
ds_read_b128 v[32:35], v11 offset:832
s_waitcnt lgkmcnt(5)
v_mfma_f32_32x32x16_bf16 v[64:79], a[212:215], v[44:47], v[64:79]
ds_read_b128 v[36:39], v11 offset:864
s_waitcnt lgkmcnt(5)
v_mfma_f32_32x32x16_bf16 v[64:79], a[216:219], v[48:51], v[64:79]
ds_read_b128 v[40:43], v11 offset:896
s_waitcnt lgkmcnt(5)
v_mfma_f32_32x32x16_bf16 v[64:79], a[220:223], v[52:55], v[64:79]
ds_read_b128 v[44:47], v11 offset:928
buffer_store_dwordx4 v[124:127], v17, s[8:11], s47 offen sc1
s_waitcnt lgkmcnt(5)
v_mfma_f32_32x32x16_bf16 v[64:79], a[224:227], v[24:27], v[64:79]
ds_read_b128 v[48:51], v11 offset:960
s_waitcnt lgkmcnt(5)
v_mfma_f32_32x32x16_bf16 v[64:79], a[228:231], v[28:31], v[64:79]
ds_read_b128 v[52:55], v11 offset:992
s_waitcnt lgkmcnt(5)
v_mfma_f32_32x32x16_bf16 v[64:79], a[232:235], v[32:35], v[64:79]
ds_read_b128 v[24:27], v11 offset:0
s_waitcnt lgkmcnt(5)
v_mfma_f32_32x32x16_bf16 v[64:79], a[236:239], v[36:39], v[64:79]
ds_read_b128 v[28:31], v11 offset:32
s_waitcnt lgkmcnt(5)
v_mfma_f32_32x32x16_bf16 v[64:79], a[240:243], v[40:43], v[64:79]
ds_read_b128 v[32:35], v11 offset:64
s_waitcnt lgkmcnt(5)
v_mfma_f32_32x32x16_bf16 v[64:79], a[244:247], v[44:47], v[64:79]
ds_read_b128 v[36:39], v11 offset:96
s_waitcnt lgkmcnt(5)
v_mfma_f32_32x32x16_bf16 v[64:79], a[248:251], v[48:51], v[64:79]
ds_read_b128 v[40:43], v11 offset:128
s_waitcnt lgkmcnt(5)
v_mfma_f32_32x32x16_bf16 v[64:79], a[252:255], v[52:55], v[64:79]
ds_read_b128 v[44:47], v11 offset:160
s_add_u32 m0, s44, 0
s_add_u32 s28, s43, 0
buffer_load_dwordx4 v10, s[12:15], s28 offen lds
s_waitcnt lgkmcnt(5)
v_mfma_f32_32x32x16_bf16 v[80:95], a[0:3], v[24:27], 0
ds_read_b128 v[48:51], v11 offset:192
s_waitcnt lgkmcnt(5)
v_mfma_f32_32x32x16_bf16 v[80:95], a[4:7], v[28:31], v[80:95]
ds_read_b128 v[52:55], v11 offset:224
s_waitcnt lgkmcnt(5)
v_mfma_f32_32x32x16_bf16 v[80:95], a[8:11], v[32:35], v[80:95]
ds_read_b128 v[24:27], v11 offset:256
v_cvt_pk_bf16_f32 v112, v64, v65
v_cvt_pk_bf16_f32 v113, v66, v67
v_cvt_pk_bf16_f32 v114, v68, v69
v_cvt_pk_bf16_f32 v115, v70, v71
s_waitcnt lgkmcnt(5)
v_mfma_f32_32x32x16_bf16 v[80:95], a[12:15], v[36:39], v[80:95]
ds_read_b128 v[28:31], v11 offset:288
v_cvt_pk_bf16_f32 v116, v72, v73
v_cvt_pk_bf16_f32 v117, v74, v75
v_cvt_pk_bf16_f32 v118, v76, v77
v_cvt_pk_bf16_f32 v119, v78, v79
s_waitcnt lgkmcnt(5)
v_mfma_f32_32x32x16_bf16 v[80:95], a[16:19], v[40:43], v[80:95]
ds_read_b128 v[32:35], v11 offset:320
ds_write_b128 v12, v[112:115] offset:8192
s_waitcnt lgkmcnt(6)
v_mfma_f32_32x32x16_bf16 v[80:95], a[20:23], v[44:47], v[80:95]
ds_read_b128 v[36:39], v11 offset:352
ds_write_b128 v18, v[116:119] offset:8192
s_add_u32 m0, s44, 1040
s_add_u32 s28, s43, 1024
buffer_load_dwordx4 v10, s[12:15], s28 offen lds
s_waitcnt lgkmcnt(7)
v_mfma_f32_32x32x16_bf16 v[80:95], a[24:27], v[48:51], v[80:95]
ds_read_b128 v[40:43], v11 offset:384
s_waitcnt lgkmcnt(7)
v_mfma_f32_32x32x16_bf16 v[80:95], a[28:31], v[52:55], v[80:95]
ds_read_b128 v[44:47], v11 offset:416
s_waitcnt lgkmcnt(7)
v_mfma_f32_32x32x16_bf16 v[80:95], a[32:35], v[24:27], v[80:95]
ds_read_b128 v[48:51], v11 offset:448
s_waitcnt lgkmcnt(7)
v_mfma_f32_32x32x16_bf16 v[80:95], a[36:39], v[28:31], v[80:95]
ds_read_b128 v[52:55], v11 offset:480
s_waitcnt lgkmcnt(4)
s_barrier
ds_read_b128 v[120:123], v14 offset:8192
v_mfma_f32_32x32x16_bf16 v[80:95], a[40:43], v[32:35], v[80:95]
ds_read_b128 v[24:27], v11 offset:512
ds_read_b128 v[124:127], v14 offset:12288
v_mfma_f32_32x32x16_bf16 v[80:95], a[44:47], v[36:39], v[80:95]
ds_read_b128 v[28:31], v11 offset:544
s_add_u32 m0, s44, 2080
s_add_u32 s28, s43, 2048
buffer_load_dwordx4 v10, s[12:15], s28 offen lds
s_waitcnt lgkmcnt(7)
v_mfma_f32_32x32x16_bf16 v[80:95], a[48:51], v[40:43], v[80:95]
ds_read_b128 v[32:35], v11 offset:576
s_waitcnt lgkmcnt(7)
v_mfma_f32_32x32x16_bf16 v[80:95], a[52:55], v[44:47], v[80:95]
ds_read_b128 v[36:39], v11 offset:608
s_waitcnt lgkmcnt(7)
v_mfma_f32_32x32x16_bf16 v[80:95], a[56:59], v[48:51], v[80:95]
ds_read_b128 v[40:43], v11 offset:640
s_waitcnt lgkmcnt(7)
v_mfma_f32_32x32x16_bf16 v[80:95], a[60:63], v[52:55], v[80:95]
ds_read_b128 v[44:47], v11 offset:672
s_waitcnt lgkmcnt(6)
v_mfma_f32_32x32x16_bf16 v[80:95], a[64:67], v[24:27], v[80:95]
ds_read_b128 v[48:51], v11 offset:704
s_waitcnt lgkmcnt(5)
v_mfma_f32_32x32x16_bf16 v[80:95], a[68:71], v[28:31], v[80:95]
ds_read_b128 v[52:55], v11 offset:736
buffer_store_dwordx4 v[120:123], v15, s[8:11], s48 offen offset:0 sc1
s_add_u32 m0, s44, 3120
s_add_u32 s28, s43, 3072
buffer_load_dwordx4 v10, s[12:15], s28 offen lds
s_waitcnt lgkmcnt(5)
v_mfma_f32_32x32x16_bf16 v[80:95], a[72:75], v[32:35], v[80:95]
ds_read_b128 v[24:27], v11 offset:768
s_waitcnt lgkmcnt(5)
v_mfma_f32_32x32x16_bf16 v[80:95], a[76:79], v[36:39], v[80:95]
ds_read_b128 v[28:31], v11 offset:800
s_waitcnt lgkmcnt(5)
v_mfma_f32_32x32x16_bf16 v[80:95], a[80:83], v[40:43], v[80:95]
ds_read_b128 v[32:35], v11 offset:832
s_waitcnt lgkmcnt(5)
v_mfma_f32_32x32x16_bf16 v[80:95], a[84:87], v[44:47], v[80:95]
ds_read_b128 v[36:39], v11 offset:864
buffer_store_dwordx4 v[124:127], v15, s[8:11], s48 offen offset:2048 sc1
s_waitcnt lgkmcnt(5)
v_mfma_f32_32x32x16_bf16 v[80:95], a[88:91], v[48:51], v[80:95]
ds_read_b128 v[40:43], v11 offset:896
s_waitcnt lgkmcnt(5)
v_mfma_f32_32x32x16_bf16 v[80:95], a[92:95], v[52:55], v[80:95]
ds_read_b128 v[44:47], v11 offset:928
s_waitcnt lgkmcnt(5)
v_mfma_f32_32x32x16_bf16 v[80:95], a[96:99], v[24:27], v[80:95]
ds_read_b128 v[48:51], v11 offset:960
s_waitcnt lgkmcnt(5)
v_mfma_f32_32x32x16_bf16 v[80:95], a[100:103], v[28:31], v[80:95]
ds_read_b128 v[52:55], v11 offset:992
s_waitcnt lgkmcnt(5)
v_mfma_f32_32x32x16_bf16 v[80:95], a[104:107], v[32:35], v[80:95]
ds_read_b128 v[24:27], v11 offset:0
s_waitcnt lgkmcnt(5)
v_mfma_f32_32x32x16_bf16 v[80:95], a[108:111], v[36:39], v[80:95]
ds_read_b128 v[28:31], v11 offset:32
s_waitcnt lgkmcnt(5)
v_mfma_f32_32x32x16_bf16 v[80:95], a[112:115], v[40:43], v[80:95]
ds_read_b128 v[32:35], v11 offset:64
s_waitcnt lgkmcnt(5)
v_mfma_f32_32x32x16_bf16 v[80:95], a[116:119], v[44:47], v[80:95]
ds_read_b128 v[36:39], v11 offset:96
s_waitcnt lgkmcnt(5)
v_mfma_f32_32x32x16_bf16 v[80:95], a[120:123], v[48:51], v[80:95]
ds_read_b128 v[40:43], v11 offset:128
s_waitcnt vmcnt(6)
s_barrier
v_mov_b32 v19, s19
s_waitcnt lgkmcnt(5)
v_mfma_f32_32x32x16_bf16 v[80:95], a[124:127], v[52:55], v[80:95]
ds_read_b128 v[44:47], v11 offset:160
buffer_store_dword v19, v16, s[8:11], s49 offen sc1
s_waitcnt lgkmcnt(5)
v_mfma_f32_32x32x16_bf16 v[96:111], v[24:27], v[128:131], 0
ds_read_b128 v[48:51], v11 offset:192
s_waitcnt lgkmcnt(5)
v_mfma_f32_32x32x16_bf16 v[96:111], v[28:31], v[132:135], v[96:111]
ds_read_b128 v[52:55], v11 offset:224
s_waitcnt lgkmcnt(5)
v_mfma_f32_32x32x16_bf16 v[96:111], v[32:35], v[136:139], v[96:111]
ds_read_b128 v[24:27], v11 offset:256
v_mul_f32 v80, s26, v80
v_mul_f32 v81, s26, v81
v_mul_f32 v82, s26, v82
v_mul_f32 v83, s26, v83
s_waitcnt lgkmcnt(5)
v_mfma_f32_32x32x16_bf16 v[96:111], v[36:39], v[140:143], v[96:111]
ds_read_b128 v[28:31], v11 offset:288
v_mul_f32 v84, s26, v84
v_mul_f32 v85, s26, v85
v_mul_f32 v86, s26, v86
v_mul_f32 v87, s26, v87
s_add_u32 m0, s44, 4160
s_add_u32 s28, s43, 16384
buffer_load_dwordx4 v10, s[12:15], s28 offen lds
s_waitcnt lgkmcnt(5)
v_mfma_f32_32x32x16_bf16 v[96:111], v[40:43], v[144:147], v[96:111]
ds_read_b128 v[32:35], v11 offset:320
v_mul_f32 v88, s26, v88
v_mul_f32 v89, s26, v89
v_mul_f32 v90, s26, v90
v_mul_f32 v91, s26, v91
s_waitcnt lgkmcnt(5)
v_mfma_f32_32x32x16_bf16 v[96:111], v[44:47], v[148:151], v[96:111]
ds_read_b128 v[36:39], v11 offset:352
v_mul_f32 v92, s26, v92
v_mul_f32 v93, s26, v93
v_mul_f32 v94, s26, v94
v_mul_f32 v95, s26, v95
s_waitcnt lgkmcnt(5)
v_mfma_f32_32x32x16_bf16 v[96:111], v[48:51], v[152:155], v[96:111]
ds_read_b128 v[40:43], v11 offset:384
v_cvt_pk_bf16_f32 v112, v80, v81
v_cvt_pk_bf16_f32 v113, v82, v83
v_cvt_pk_bf16_f32 v114, v84, v85
v_cvt_pk_bf16_f32 v115, v86, v87
s_waitcnt lgkmcnt(5)
v_mfma_f32_32x32x16_bf16 v[96:111], v[52:55], v[156:159], v[96:111]
ds_read_b128 v[44:47], v11 offset:416
v_cvt_pk_bf16_f32 v116, v88, v89
v_cvt_pk_bf16_f32 v117, v90, v91
v_cvt_pk_bf16_f32 v118, v92, v93
v_cvt_pk_bf16_f32 v119, v94, v95
s_waitcnt lgkmcnt(5)
v_mfma_f32_32x32x16_bf16 v[96:111], v[24:27], v[160:163], v[96:111]
ds_read_b128 v[48:51], v11 offset:448
ds_write_b128 v12, v[112:115] offset:0
s_waitcnt lgkmcnt(6)
v_mfma_f32_32x32x16_bf16 v[96:111], v[28:31], v[164:167], v[96:111]
ds_read_b128 v[52:55], v11 offset:480
ds_write_b128 v18, v[116:119] offset:0
s_add_u32 m0, s44, 5200
s_add_u32 s28, s43, 17408
buffer_load_dwordx4 v10, s[12:15], s28 offen lds
s_waitcnt lgkmcnt(7)
v_mfma_f32_32x32x16_bf16 v[96:111], v[32:35], v[168:171], v[96:111]
ds_read_b128 v[24:27], v11 offset:512
s_waitcnt lgkmcnt(7)
v_mfma_f32_32x32x16_bf16 v[96:111], v[36:39], v[172:175], v[96:111]
ds_read_b128 v[28:31], v11 offset:544
s_waitcnt lgkmcnt(7)
v_mfma_f32_32x32x16_bf16 v[96:111], v[40:43], v[176:179], v[96:111]
ds_read_b128 v[32:35], v11 offset:576
s_waitcnt lgkmcnt(7)
v_mfma_f32_32x32x16_bf16 v[96:111], v[44:47], v[180:183], v[96:111]
ds_read_b128 v[36:39], v11 offset:608
s_waitcnt lgkmcnt(4)
s_barrier
ds_read_b128 v[120:123], v20
v_mfma_f32_32x32x16_bf16 v[96:111], v[48:51], v[184:187], v[96:111]
ds_read_b128 v[40:43], v11 offset:640
ds_read_b128 v[124:127], v21
v_mfma_f32_32x32x16_bf16 v[96:111], v[52:55], v[188:191], v[96:111]
ds_read_b128 v[44:47], v11 offset:672
s_waitcnt lgkmcnt(7)
v_mfma_f32_32x32x16_bf16 v[96:111], v[24:27], v[192:195], v[96:111]
ds_read_b128 v[48:51], v11 offset:704
s_waitcnt lgkmcnt(7)
v_mfma_f32_32x32x16_bf16 v[96:111], v[28:31], v[196:199], v[96:111]
ds_read_b128 v[52:55], v11 offset:736
s_waitcnt lgkmcnt(7)
v_mfma_f32_32x32x16_bf16 v[96:111], v[32:35], v[200:203], v[96:111]
ds_read_b128 v[24:27], v11 offset:768
s_waitcnt lgkmcnt(7)
v_mfma_f32_32x32x16_bf16 v[96:111], v[36:39], v[204:207], v[96:111]
ds_read_b128 v[28:31], v11 offset:800
s_waitcnt lgkmcnt(6)
v_mfma_f32_32x32x16_bf16 v[96:111], v[40:43], v[208:211], v[96:111]
ds_read_b128 v[32:35], v11 offset:832
s_waitcnt lgkmcnt(5)
v_mfma_f32_32x32x16_bf16 v[96:111], v[44:47], v[212:215], v[96:111]
ds_read_b128 v[36:39], v11 offset:864
buffer_store_dwordx4 v[120:123], v17, s[8:11], s45 offen sc1
s_waitcnt lgkmcnt(5)
v_mfma_f32_32x32x16_bf16 v[96:111], v[48:51], v[216:219], v[96:111]
ds_read_b128 v[40:43], v11 offset:896
s_waitcnt lgkmcnt(5)
v_mfma_f32_32x32x16_bf16 v[96:111], v[52:55], v[220:223], v[96:111]
ds_read_b128 v[44:47], v11 offset:928
s_waitcnt lgkmcnt(5)
v_mfma_f32_32x32x16_bf16 v[96:111], v[24:27], v[224:227], v[96:111]
ds_read_b128 v[48:51], v11 offset:960
s_waitcnt lgkmcnt(5)
v_mfma_f32_32x32x16_bf16 v[96:111], v[28:31], v[228:231], v[96:111]
ds_read_b128 v[52:55], v11 offset:992
buffer_store_dwordx4 v[124:127], v17, s[8:11], s50 offen sc1
s_waitcnt lgkmcnt(5)
v_mfma_f32_32x32x16_bf16 v[96:111], v[32:35], v[232:235], v[96:111]
s_waitcnt lgkmcnt(4)
v_mfma_f32_32x32x16_bf16 v[96:111], v[36:39], v[236:239], v[96:111]
s_add_u32 m0, s44, 6240
s_add_u32 s28, s43, 18432
buffer_load_dwordx4 v10, s[12:15], s28 offen lds
s_waitcnt lgkmcnt(3)
v_mfma_f32_32x32x16_bf16 v[96:111], v[40:43], v[240:243], v[96:111]
s_waitcnt lgkmcnt(2)
v_mfma_f32_32x32x16_bf16 v[96:111], v[44:47], v[244:247], v[96:111]
s_waitcnt lgkmcnt(1)
v_mfma_f32_32x32x16_bf16 v[96:111], v[48:51], v[248:251], v[96:111]
s_waitcnt lgkmcnt(0)
v_mfma_f32_32x32x16_bf16 v[96:111], v[52:55], v[252:255], v[96:111]
s_add_u32 m0, s44, 7280
s_add_u32 s28, s43, 19456
buffer_load_dwordx4 v10, s[12:15], s28 offen lds
s_add_u32 s46, s23, 17039360
s_add_u32 s47, s46, 4096
s_add_u32 s24, s24, 1
s_cmp_eq_u32 s24, 3
s_cselect_b32 s24, 0, s24
s_mov_b32 s28, 33280
s_cselect_b32 s29, -2, 1
s_mul_i32 s28, s28, s29
v_add_u32 v11, s28, v11
s_add_u32 s19, s19, s25
s_mov_b32 s25, 2
s_add_u32 s20, s20, 1
s_cmp_eq_u32 s20, 1
s_cbranch_scc1 Lq_fl
s_cmp_lt_u32 s19, 64
s_cbranch_scc1 Lq_sg3
s_branch Lq_fl
Lq_fl:
s_nop 7
v_cvt_pk_bf16_f32 v112, v96, v97
v_cvt_pk_bf16_f32 v113, v98, v99
v_cvt_pk_bf16_f32 v114, v100, v101
v_cvt_pk_bf16_f32 v115, v102, v103
v_cvt_pk_bf16_f32 v116, v104, v105
v_cvt_pk_bf16_f32 v117, v106, v107
v_cvt_pk_bf16_f32 v118, v108, v109
v_cvt_pk_bf16_f32 v119, v110, v111
ds_write2_b32 v13, v112, v113 offset0:0 offset1:2
ds_write2_b32 v13, v114, v115 offset0:64 offset1:66
ds_write2_b32 v13, v116, v117 offset0:128 offset1:130
ds_write2_b32 v13, v118, v119 offset0:192 offset1:194
s_waitcnt lgkmcnt(0)
s_barrier
ds_read_b128 v[120:123], v14 offset:16384
ds_read_b128 v[124:127], v14 offset:20480
s_waitcnt lgkmcnt(0)
buffer_store_dwordx4 v[120:123], v17, s[8:11], s46 offen sc1
buffer_store_dwordx4 v[124:127], v17, s[8:11], s47 offen sc1
v_mov_b32 v24, 32
Lq_wc_13:
global_load_dword v25, v24, s[6:7] sc1
s_add_u32 s30, s30, 1
s_cmp_gt_u32 s30, 1000000
s_cbranch_scc1 L_fin
s_waitcnt vmcnt(0)
v_cmp_gt_u32 vcc, 64, v25
s_cbranch_vccz Lq_wd_14
s_sleep 16
s_branch Lq_wc_13
Lq_wd_14:
s_barrier
s_cmp_lt_u32 s19, 64
v_mov_b32 v19, s19
buffer_store_dword v19, v16, s[8:11], 0 offen sc1
s_mov_b32 s49, 0
s_cbranch_scc0 Lq_end
s_branch Lq_seg
Lq_end:
s_cmp_lt_u32 s41, 2
s_cbranch_scc1 L_fin
v_mbcnt_lo_u32_b32 v51, -1, 0
v_mbcnt_hi_u32_b32 v51, -1, v51
s_lshl_b32 s28, s17, 6
v_add_u32 v51, s28, v51
v_bfe_u32 v50, v51, 1, 3
v_bfe_u32 v49, v51, 4, 2
v_xor_b32 v50, v50, v49
v_lshlrev_b32 v50, 5, v50
v_and_b32 v49, 1, v51
v_lshl_add_u32 v48, v49, 4, v50
s_lshl_b32 s28, s16, 8
v_bfe_u32 v200, v51, 4, 1
v_lshlrev_b32 v200, 13, v200
v_bfe_u32 v50, v51, 5, 1
v_lshl_add_u32 v200, v50, 16, v200
v_bfe_u32 v50, v51, 6, 1
v_lshl_add_u32 v200, v50, 14, v200
v_bfe_u32 v50, v51, 7, 1
v_lshl_add_u32 v200, v50, 18, v200
v_add_u32 v200, s28, v200
v_add_u32 v200, v200, v48
v_xor_b32 v201, 128, v200
s_mul_i32 s36, s17, 36864
s_add_u32 s36, s36, 16384
s_mov_b32 s14, 0x400000
s_mov_b32 s15, 0x20000
s_mov_b32 s12, s76
s_mov_b32 s13, s77
s_add_u32 m0, s36, 0
s_mov_b32 s28, 0
buffer_load_dwordx4 v200, s[12:15], s28 offen  lds
s_add_u32 m0, s36, 1024
s_mov_b32 s28, 32768
buffer_load_dwordx4 v201, s[12:15], s28 offen  lds
s_add_u32 m0, s36, 2048
s_mov_b32 s28, 131072
buffer_load_dwordx4 v200, s[12:15], s28 offen  lds
s_add_u32 m0, s36, 3072
s_mov_b32 s28, 163840
buffer_load_dwordx4 v201, s[12:15], s28 offen  lds
s_add_u32 m0, s36, 4096
s_mov_b32 s28, 524288
buffer_load_dwordx4 v200, s[12:15], s28 offen  lds
s_add_u32 m0, s36, 5120
s_mov_b32 s28, 557056
buffer_load_dwordx4 v201, s[12:15], s28 offen  lds
s_add_u32 m0, s36, 6144
s_mov_b32 s28, 655360
buffer_load_dwordx4 v200, s[12:15], s28 offen  lds
s_add_u32 m0, s36, 7168
s_mov_b32 s28, 688128
buffer_load_dwordx4 v201, s[12:15], s28 offen  lds
s_add_u32 m0, s36, 8192
s_mov_b32 s28, 1048576
buffer_load_dwordx4 v200, s[12:15], s28 offen  lds
s_add_u32 m0, s36, 9216
s_mov_b32 s28, 1081344
buffer_load_dwordx4 v201, s[12:15], s28 offen  lds
s_add_u32 m0, s36, 10240
s_mov_b32 s28, 1179648
buffer_load_dwordx4 v200, s[12:15], s28 offen  lds
s_add_u32 m0, s36, 11264
s_mov_b32 s28, 1212416
buffer_load_dwordx4 v201, s[12:15], s28 offen  lds
s_add_u32 m0, s36, 12288
s_mov_b32 s28, 1572864
buffer_load_dwordx4 v200, s[12:15], s28 offen  lds
s_add_u32 m0, s36, 13312
s_mov_b32 s28, 1605632
buffer_load_dwordx4 v201, s[12:15], s28 offen  lds
s_add_u32 m0, s36, 14336
s_mov_b32 s28, 1703936
buffer_load_dwordx4 v200, s[12:15], s28 offen  lds
s_add_u32 m0, s36, 15360
s_mov_b32 s28, 1736704
buffer_load_dwordx4 v201, s[12:15], s28 offen  lds
s_add_u32 m0, s36, 16384
s_mov_b32 s28, 2097152
buffer_load_dwordx4 v200, s[12:15], s28 offen  lds
s_add_u32 m0, s36, 17408
s_mov_b32 s28, 2129920
buffer_load_dwordx4 v201, s[12:15], s28 offen  lds
s_add_u32 m0, s36, 18432
s_mov_b32 s28, 2228224
buffer_load_dwordx4 v200, s[12:15], s28 offen  lds
s_add_u32 m0, s36, 19456
s_mov_b32 s28, 2260992
buffer_load_dwordx4 v201, s[12:15], s28 offen  lds
s_add_u32 m0, s36, 20480
s_mov_b32 s28, 2621440
buffer_load_dwordx4 v200, s[12:15], s28 offen  lds
s_add_u32 m0, s36, 21504
s_mov_b32 s28, 2654208
buffer_load_dwordx4 v201, s[12:15], s28 offen  lds
s_add_u32 m0, s36, 22528
s_mov_b32 s28, 2752512
buffer_load_dwordx4 v200, s[12:15], s28 offen  lds
s_add_u32 m0, s36, 23552
s_mov_b32 s28, 2785280
buffer_load_dwordx4 v201, s[12:15], s28 offen  lds
s_add_u32 m0, s36, 24576
s_mov_b32 s28, 3145728
buffer_load_dwordx4 v200, s[12:15], s28 offen  lds
s_add_u32 m0, s36, 25600
s_mov_b32 s28, 3178496
buffer_load_dwordx4 v201, s[12:15], s28 offen  lds
s_add_u32 m0, s36, 26624
s_mov_b32 s28, 3276800
buffer_load_dwordx4 v200, s[12:15], s28 offen  lds
s_add_u32 m0, s36, 27648
s_mov_b32 s28, 3309568
buffer_load_dwordx4 v201, s[12:15], s28 offen  lds
s_add_u32 m0, s36, 28672
s_mov_b32 s28, 3670016
buffer_load_dwordx4 v200, s[12:15], s28 offen  lds
s_add_u32 m0, s36, 29696
s_mov_b32 s28, 3702784
buffer_load_dwordx4 v201, s[12:15], s28 offen  lds
s_add_u32 m0, s36, 30720
s_mov_b32 s28, 3801088
buffer_load_dwordx4 v200, s[12:15], s28 offen  lds
s_add_u32 m0, s36, 31744
s_mov_b32 s28, 3833856
buffer_load_dwordx4 v201, s[12:15], s28 offen  lds
s_mov_b32 s12, s78
s_mov_b32 s13, s79
s_add_u32 m0, s36, 32768
s_mov_b32 s28, 0
buffer_load_dwordx4 v200, s[12:15], s28 offen  lds
s_add_u32 m0, s36, 33792
s_mov_b32 s28, 32768
buffer_load_dwordx4 v201, s[12:15], s28 offen  lds
s_add_u32 m0, s36, 34816
s_mov_b32 s28, 131072
buffer_load_dwordx4 v200, s[12:15], s28 offen  lds
s_add_u32 m0, s36, 35840
s_mov_b32 s28, 163840
buffer_load_dwordx4 v201, s[12:15], s28 offen  lds
v_bfe_u32 v50, v51, 2, 3
v_bfe_u32 v49, v51, 6, 2
v_lshlrev_b32 v49, 1, v49
v_xor_b32 v48, v50, v49
v_bfe_u32 v49, v51, 2, 4
v_lshlrev_b32 v49, 8, v49
v_bfe_u32 v50, v51, 0, 2
v_lshl_add_u32 v49, v50, 3, v49
v_lshl_add_u32 v49, v48, 5, v49
v_add_u32 v204, 16384, v49
v_xor_b32 v205, 32, v204
v_add_u32 v206, 53248, v49
v_xor_b32 v207, 32, v206
v_add_u32 v208, 90112, v49
v_xor_b32 v209, 32, v208
v_add_u32 v210, 126976, v49
v_xor_b32 v211, 32, v210
v_bfe_u32 v0, v51, 0, 6
v_lshlrev_b32 v0, 4, v0
v_bfe_u32 v49, v51, 6, 1
v_lshlrev_b32 v49, 3, v49
v_bfe_u32 v50, v51, 4, 2
v_lshl_add_u32 v49, v50, 0, v49
v_and_b32 v50, 15, v51
v_xor_b32 v49, v49, v50
v_bfe_u32 v244, v51, 6, 2
v_lshlrev_b32 v244, 11, v244
v_bfe_u32 v50, v51, 4, 2
v_lshl_add_u32 v244, v50, 8, v244
v_lshl_add_u32 v244, v49, 4, v244
v_bfe_u32 v49, v51, 6, 1
v_lshlrev_b32 v49, 3, v49
v_bfe_u32 v50, v51, 4, 2
v_lshl_add_u32 v49, v50, 0, v49
v_add_u32 v49, 4, v49
v_and_b32 v50, 15, v51
v_xor_b32 v49, v49, v50
v_bfe_u32 v245, v51, 6, 2
v_lshlrev_b32 v245, 11, v245
v_bfe_u32 v50, v51, 4, 2
v_lshl_add_u32 v245, v50, 8, v245
v_add_u32 v245, 1024, v245
v_lshl_add_u32 v245, v49, 4, v245
v_bfe_u32 v246, v51, 6, 2
v_lshlrev_b32 v246, 11, v246
v_bfe_u32 v50, v51, 0, 6
v_lshl_add_u32 v246, v50, 4, v246
v_bfe_u32 v50, v51, 4, 2
v_and_b32 v49, 15, v51
v_xor_b32 v50, v50, v49
v_lshlrev_b32 v49, 8, v49
v_lshl_add_u32 v49, v50, 4, v49
v_add_u32 v49, 16384, v49
v_xor_b32 v248, 0, v49
v_xor_b32 v249, 64, v49
v_xor_b32 v250, 128, v49
v_xor_b32 v251, 192, v49
v_bfe_u32 v50, v51, 6, 1
v_lshlrev_b32 v50, 12, v50
v_add_u32 v50, 8192, v50
v_add_u32 v248, v50, v248
v_add_u32 v249, v50, v249
v_add_u32 v250, v50, v250
v_add_u32 v251, v50, v251
v_bfe_u32 v2, v51, 3, 1
v_lshlrev_b32 v2, 11, v2
v_bfe_u32 v50, v51, 4, 2
v_lshl_add_u32 v2, v50, 8, v2
v_bfe_u32 v50, v51, 1, 2
v_lshl_add_u32 v2, v50, 6, v2
v_bfe_u32 v50, v51, 0, 1
v_lshl_add_u32 v2, v50, 4, v2
v_add_u32 v2, 16384, v2
v_bfe_u32 v3, v51, 7, 1
v_lshlrev_b32 v3, 12, v3
v_bfe_u32 v50, v51, 0, 6
v_lshl_add_u32 v3, v50, 4, v3
v_add_u32 v3, 32768, v3
v_bfe_u32 v4, v51, 7, 1
v_lshlrev_b32 v4, 10, v4
v_bfe_u32 v50, v51, 2, 2
v_lshl_add_u32 v4, v50, 7, v4
v_bfe_u32 v50, v51, 6, 1
v_lshl_add_u32 v4, v50, 6, v4
v_bfe_u32 v50, v51, 0, 2
v_lshl_add_u32 v4, v50, 4, v4
v_bfe_u32 v50, v51, 4, 2
v_lshl_add_u32 v4, v50, 2, v4
v_add_u32 v4, 8192, v4
v_bfe_u32 v15, v51, 6, 2
v_lshlrev_b32 v15, 9, v15
v_bfe_u32 v50, v51, 0, 4
v_lshl_add_u32 v15, v50, 4, v15
v_bfe_u32 v50, v51, 4, 2
v_lshl_add_u32 v15, v50, 2, v15
v_add_u32 v15, 10240, v15
v_bfe_u32 v5, v51, 4, 2
v_lshlrev_b32 v5, 7, v5
v_bfe_u32 v50, v51, 2, 2
v_lshl_add_u32 v5, v50, 4, v5
v_bfe_u32 v50, v51, 0, 1
v_lshl_add_u32 v5, v50, 3, v5
v_add_u32 v5, 8192, v5
v_bfe_u32 v6, v51, 7, 1
v_lshlrev_b32 v6, 10, v6
v_bfe_u32 v50, v51, 0, 4
v_lshl_add_u32 v6, v50, 4, v6
v_bfe_u32 v50, v51, 4, 1
v_lshl_add_u32 v6, v50, 3, v6
v_add_u32 v6, 10240, v6
v_bfe_u32 v7, v51, 0, 6
v_lshlrev_b32 v7, 6, v7
v_bfe_u32 v50, v51, 1, 4
v_lshl_add_u32 v7, v50, 2, v7
v_and_b32 v9, 63, v51
v_min_u32 v9, 3, v9
s_lshl_b32 s28, s16, 7
s_add_u32 s28, s28, 1122304
v_lshl_add_u32 v8, v9, 2, s28
v_bfe_u32 v10, v51, 0, 4
v_bfe_u32 v50, v51, 6, 1
v_lshl_add_u32 v10, v50, 4, v10
v_bfe_u32 v49, v51, 4, 2
v_lshlrev_b32 v49, 2, v49
v_sub_u32 v10, v10, v49
s_lshl_b32 s28, s18, 5
s_add_u32 s28, s28, s16
s_lshl_b32 s28, s28, 7
v_bfe_u32 v11, v51, 0, 8
v_min_u32 v11, 1, v11
v_lshlrev_b32 v11, 30, v11
v_add_u32 v11, 1146880, v11
v_add_u32 v11, s28, v11
v_and_b32 v50, 2, v51
v_mul_u32_u24 v50, 0x5555, v50
v_add_u32 v14, 0x4444, v50
v_mov_b32 v236, 0
v_mov_b32 v237, 0xff800000
v_mov_b32 v238, 1
v_mov_b32 v239, 3467369582
v_mov_b32 v240, 0x3f803f80
v_mov_b32 v241, 0x3f803f80
v_mov_b32 v242, 0x3f803f80
v_mov_b32 v243, 0x3f803f80
s_mov_b32 s27, 2141552549
s_waitcnt vmcnt(32)
s_barrier
ds_read_b64_tr_b16 a[0:1], v204 offset:0
ds_read_b64_tr_b16 a[2:3], v206 offset:0
ds_read_b64_tr_b16 a[4:5], v208 offset:0
ds_read_b64_tr_b16 a[6:7], v210 offset:0
ds_read_b64_tr_b16 a[8:9], v205 offset:0
ds_read_b64_tr_b16 a[10:11], v207 offset:0
ds_read_b64_tr_b16 a[12:13], v209 offset:0
ds_read_b64_tr_b16 a[14:15], v211 offset:0
s_waitcnt lgkmcnt(0)
s_waitcnt vmcnt(28)
s_barrier
s_add_u32 m0, s36, 0
s_mov_b32 s28, 524288
buffer_load_dwordx4 v200, s[12:15], s28 offen  lds
s_add_u32 m0, s36, 1024
s_mov_b32 s28, 557056
buffer_load_dwordx4 v201, s[12:15], s28 offen  lds
s_add_u32 m0, s36, 2048
s_mov_b32 s28, 655360
buffer_load_dwordx4 v200, s[12:15], s28 offen  lds
s_add_u32 m0, s36, 3072
s_mov_b32 s28, 688128
buffer_load_dwordx4 v201, s[12:15], s28 offen  lds
ds_read_b64_tr_b16 a[16:17], v204 offset:4096
ds_read_b64_tr_b16 a[18:19], v206 offset:4096
ds_read_b64_tr_b16 a[20:21], v208 offset:4096
ds_read_b64_tr_b16 a[22:23], v210 offset:4096
ds_read_b64_tr_b16 a[24:25], v205 offset:4096
ds_read_b64_tr_b16 a[26:27], v207 offset:4096
ds_read_b64_tr_b16 a[28:29], v209 offset:4096
ds_read_b64_tr_b16 a[30:31], v211 offset:4096
s_waitcnt lgkmcnt(0)
s_waitcnt vmcnt(28)
s_barrier
s_add_u32 m0, s36, 4096
s_mov_b32 s28, 1048576
buffer_load_dwordx4 v200, s[12:15], s28 offen  lds
s_add_u32 m0, s36, 5120
s_mov_b32 s28, 1081344
buffer_load_dwordx4 v201, s[12:15], s28 offen  lds
s_add_u32 m0, s36, 6144
s_mov_b32 s28, 1179648
buffer_load_dwordx4 v200, s[12:15], s28 offen  lds
s_add_u32 m0, s36, 7168
s_mov_b32 s28, 1212416
buffer_load_dwordx4 v201, s[12:15], s28 offen  lds
ds_read_b64_tr_b16 a[32:33], v204 offset:8192
ds_read_b64_tr_b16 a[34:35], v206 offset:8192
ds_read_b64_tr_b16 a[36:37], v208 offset:8192
ds_read_b64_tr_b16 a[38:39], v210 offset:8192
ds_read_b64_tr_b16 a[40:41], v205 offset:8192
ds_read_b64_tr_b16 a[42:43], v207 offset:8192
ds_read_b64_tr_b16 a[44:45], v209 offset:8192
ds_read_b64_tr_b16 a[46:47], v211 offset:8192
s_waitcnt lgkmcnt(0)
s_waitcnt vmcnt(28)
s_barrier
s_add_u32 m0, s36, 8192
s_mov_b32 s28, 1572864
buffer_load_dwordx4 v200, s[12:15], s28 offen  lds
s_add_u32 m0, s36, 9216
s_mov_b32 s28, 1605632
buffer_load_dwordx4 v201, s[12:15], s28 offen  lds
s_add_u32 m0, s36, 10240
s_mov_b32 s28, 1703936
buffer_load_dwordx4 v200, s[12:15], s28 offen  lds
s_add_u32 m0, s36, 11264
s_mov_b32 s28, 1736704
buffer_load_dwordx4 v201, s[12:15], s28 offen  lds
ds_read_b64_tr_b16 a[48:49], v204 offset:12288
ds_read_b64_tr_b16 a[50:51], v206 offset:12288
ds_read_b64_tr_b16 a[52:53], v208 offset:12288
ds_read_b64_tr_b16 a[54:55], v210 offset:12288
ds_read_b64_tr_b16 a[56:57], v205 offset:12288
ds_read_b64_tr_b16 a[58:59], v207 offset:12288
ds_read_b64_tr_b16 a[60:61], v209 offset:12288
ds_read_b64_tr_b16 a[62:63], v211 offset:12288
s_waitcnt lgkmcnt(0)
s_waitcnt vmcnt(28)
s_barrier
s_add_u32 m0, s36, 12288
s_mov_b32 s28, 2097152
buffer_load_dwordx4 v200, s[12:15], s28 offen  lds
s_add_u32 m0, s36, 13312
s_mov_b32 s28, 2129920
buffer_load_dwordx4 v201, s[12:15], s28 offen  lds
s_add_u32 m0, s36, 14336
s_mov_b32 s28, 2228224
buffer_load_dwordx4 v200, s[12:15], s28 offen  lds
s_add_u32 m0, s36, 15360
s_mov_b32 s28, 2260992
buffer_load_dwordx4 v201, s[12:15], s28 offen  lds
ds_read_b64_tr_b16 a[64:65], v204 offset:16384
ds_read_b64_tr_b16 a[66:67], v206 offset:16384
ds_read_b64_tr_b16 a[68:69], v208 offset:16384
ds_read_b64_tr_b16 a[70:71], v210 offset:16384
ds_read_b64_tr_b16 a[72:73], v205 offset:16384
ds_read_b64_tr_b16 a[74:75], v207 offset:16384
ds_read_b64_tr_b16 a[76:77], v209 offset:16384
ds_read_b64_tr_b16 a[78:79], v211 offset:16384
s_waitcnt lgkmcnt(0)
s_waitcnt vmcnt(28)
s_barrier
s_add_u32 m0, s36, 16384
s_mov_b32 s28, 2621440
buffer_load_dwordx4 v200, s[12:15], s28 offen  lds
s_add_u32 m0, s36, 17408
s_mov_b32 s28, 2654208
buffer_load_dwordx4 v201, s[12:15], s28 offen  lds
s_add_u32 m0, s36, 18432
s_mov_b32 s28, 2752512
buffer_load_dwordx4 v200, s[12:15], s28 offen  lds
s_add_u32 m0, s36, 19456
s_mov_b32 s28, 2785280
buffer_load_dwordx4 v201, s[12:15], s28 offen  lds
ds_read_b64_tr_b16 a[80:81], v204 offset:20480
ds_read_b64_tr_b16 a[82:83], v206 offset:20480
ds_read_b64_tr_b16 a[84:85], v208 offset:20480
ds_read_b64_tr_b16 a[86:87], v210 offset:20480
ds_read_b64_tr_b16 a[88:89], v205 offset:20480
ds_read_b64_tr_b16 a[90:91], v207 offset:20480
ds_read_b64_tr_b16 a[92:93], v209 offset:20480
ds_read_b64_tr_b16 a[94:95], v211 offset:20480
s_waitcnt lgkmcnt(0)
s_waitcnt vmcnt(28)
s_barrier
s_add_u32 m0, s36, 20480
s_mov_b32 s28, 3145728
buffer_load_dwordx4 v200, s[12:15], s28 offen  lds
s_add_u32 m0, s36, 21504
s_mov_b32 s28, 3178496
buffer_load_dwordx4 v201, s[12:15], s28 offen  lds
s_add_u32 m0, s36, 22528
s_mov_b32 s28, 3276800
buffer_load_dwordx4 v200, s[12:15], s28 offen  lds
s_add_u32 m0, s36, 23552
s_mov_b32 s28, 3309568
buffer_load_dwordx4 v201, s[12:15], s28 offen  lds
ds_read_b64_tr_b16 a[96:97], v204 offset:24576
ds_read_b64_tr_b16 a[98:99], v206 offset:24576
ds_read_b64_tr_b16 a[100:101], v208 offset:24576
ds_read_b64_tr_b16 a[102:103], v210 offset:24576
ds_read_b64_tr_b16 a[104:105], v205 offset:24576
ds_read_b64_tr_b16 a[106:107], v207 offset:24576
ds_read_b64_tr_b16 a[108:109], v209 offset:24576
ds_read_b64_tr_b16 a[110:111], v211 offset:24576
s_waitcnt lgkmcnt(0)
s_waitcnt vmcnt(28)
s_barrier
s_add_u32 m0, s36, 24576
s_mov_b32 s28, 3670016
buffer_load_dwordx4 v200, s[12:15], s28 offen  lds
s_add_u32 m0, s36, 25600
s_mov_b32 s28, 3702784
buffer_load_dwordx4 v201, s[12:15], s28 offen  lds
s_add_u32 m0, s36, 26624
s_mov_b32 s28, 3801088
buffer_load_dwordx4 v200, s[12:15], s28 offen  lds
s_add_u32 m0, s36, 27648
s_mov_b32 s28, 3833856
buffer_load_dwordx4 v201, s[12:15], s28 offen  lds
ds_read_b64_tr_b16 a[112:113], v204 offset:28672
ds_read_b64_tr_b16 a[114:115], v206 offset:28672
ds_read_b64_tr_b16 a[116:117], v208 offset:28672
ds_read_b64_tr_b16 a[118:119], v210 offset:28672
ds_read_b64_tr_b16 a[120:121], v205 offset:28672
ds_read_b64_tr_b16 a[122:123], v207 offset:28672
ds_read_b64_tr_b16 a[124:125], v209 offset:28672
ds_read_b64_tr_b16 a[126:127], v211 offset:28672
s_waitcnt lgkmcnt(0)
s_waitcnt vmcnt(28)
s_barrier
ds_read_b64_tr_b16 a[128:129], v204 offset:32768
ds_read_b64_tr_b16 a[130:131], v206 offset:32768
ds_read_b64_tr_b16 a[132:133], v208 offset:32768
ds_read_b64_tr_b16 a[134:135], v210 offset:32768
ds_read_b64_tr_b16 a[136:137], v205 offset:32768
ds_read_b64_tr_b16 a[138:139], v207 offset:32768
ds_read_b64_tr_b16 a[140:141], v209 offset:32768
ds_read_b64_tr_b16 a[142:143], v211 offset:32768
s_waitcnt lgkmcnt(0)
s_waitcnt vmcnt(24)
s_barrier
ds_read_b64_tr_b16 a[144:145], v204 offset:0
ds_read_b64_tr_b16 a[146:147], v206 offset:0
ds_read_b64_tr_b16 a[148:149], v208 offset:0
ds_read_b64_tr_b16 a[150:151], v210 offset:0
ds_read_b64_tr_b16 a[152:153], v205 offset:0
ds_read_b64_tr_b16 a[154:155], v207 offset:0
ds_read_b64_tr_b16 a[156:157], v209 offset:0
ds_read_b64_tr_b16 a[158:159], v211 offset:0
s_waitcnt lgkmcnt(0)
s_waitcnt vmcnt(20)
s_barrier
ds_read_b64_tr_b16 a[160:161], v204 offset:4096
ds_read_b64_tr_b16 a[162:163], v206 offset:4096
ds_read_b64_tr_b16 a[164:165], v208 offset:4096
ds_read_b64_tr_b16 a[166:167], v210 offset:4096
ds_read_b64_tr_b16 a[168:169], v205 offset:4096
ds_read_b64_tr_b16 a[170:171], v207 offset:4096
ds_read_b64_tr_b16 a[172:173], v209 offset:4096
ds_read_b64_tr_b16 a[174:175], v211 offset:4096
s_waitcnt lgkmcnt(0)
s_waitcnt vmcnt(16)
s_barrier
ds_read_b64_tr_b16 a[176:177], v204 offset:8192
ds_read_b64_tr_b16 a[178:179], v206 offset:8192
ds_read_b64_tr_b16 a[180:181], v208 offset:8192
ds_read_b64_tr_b16 a[182:183], v210 offset:8192
ds_read_b64_tr_b16 a[184:185], v205 offset:8192
ds_read_b64_tr_b16 a[186:187], v207 offset:8192
ds_read_b64_tr_b16 a[188:189], v209 offset:8192
ds_read_b64_tr_b16 a[190:191], v211 offset:8192
s_waitcnt lgkmcnt(0)
s_waitcnt vmcnt(12)
s_barrier
ds_read_b64_tr_b16 a[192:193], v204 offset:12288
ds_read_b64_tr_b16 a[194:195], v206 offset:12288
ds_read_b64_tr_b16 a[196:197], v208 offset:12288
ds_read_b64_tr_b16 a[198:199], v210 offset:12288
ds_read_b64_tr_b16 a[200:201], v205 offset:12288
ds_read_b64_tr_b16 a[202:203], v207 offset:12288
ds_read_b64_tr_b16 a[204:205], v209 offset:12288
ds_read_b64_tr_b16 a[206:207], v211 offset:12288
s_waitcnt lgkmcnt(0)
s_waitcnt vmcnt(8)
s_barrier
ds_read_b64_tr_b16 a[208:209], v204 offset:16384
ds_read_b64_tr_b16 a[210:211], v206 offset:16384
ds_read_b64_tr_b16 a[212:213], v208 offset:16384
ds_read_b64_tr_b16 a[214:215], v210 offset:16384
ds_read_b64_tr_b16 a[216:217], v205 offset:16384
ds_read_b64_tr_b16 a[218:219], v207 offset:16384
ds_read_b64_tr_b16 a[220:221], v209 offset:16384
ds_read_b64_tr_b16 a[222:223], v211 offset:16384
s_waitcnt lgkmcnt(0)
s_waitcnt vmcnt(4)
s_barrier
ds_read_b64_tr_b16 a[224:225], v204 offset:20480
ds_read_b64_tr_b16 a[226:227], v206 offset:20480
ds_read_b64_tr_b16 a[228:229], v208 offset:20480
ds_read_b64_tr_b16 a[230:231], v210 offset:20480
ds_read_b64_tr_b16 a[232:233], v205 offset:20480
ds_read_b64_tr_b16 a[234:235], v207 offset:20480
ds_read_b64_tr_b16 a[236:237], v209 offset:20480
ds_read_b64_tr_b16 a[238:239], v211 offset:20480
s_waitcnt lgkmcnt(0)
s_waitcnt vmcnt(0)
s_barrier
ds_read_b64_tr_b16 a[240:241], v204 offset:24576
ds_read_b64_tr_b16 a[242:243], v206 offset:24576
ds_read_b64_tr_b16 a[244:245], v208 offset:24576
ds_read_b64_tr_b16 a[246:247], v210 offset:24576
ds_read_b64_tr_b16 a[248:249], v205 offset:24576
ds_read_b64_tr_b16 a[250:251], v207 offset:24576
ds_read_b64_tr_b16 a[252:253], v209 offset:24576
ds_read_b64_tr_b16 a[254:255], v211 offset:24576
s_waitcnt lgkmcnt(0)
s_barrier
s_waitcnt lgkmcnt(0)
s_mov_b32 s19, s18
s_lshl_b32 s28, s17, 11
v_add_u32 v16, s28, v0
s_mov_b32 s20, 0
s_mov_b32 s37, s19
s_mov_b32 s42, 0
s_cmp_lg_u32 s20, 0
s_cbranch_scc1 La_rka
La_rwa:
buffer_load_dword v12, v8, s[8:11], 0 offen sc1
s_add_u32 s30, s30, 1
s_cmp_gt_u32 s30, 1000000
s_cbranch_scc1 L_fin
s_waitcnt vmcnt(0)
v_cmp_ge_u32 vcc, 63, v12
s_cmp_eq_u64 vcc, 0
s_cselect_b32 s20, 1, 0
v_cmp_ge_u32 vcc, s37, v12
s_cbranch_vccnz La_rwa
La_rka:
s_mul_i32 s28, s37, 1048576
s_lshl_b32 s29, s16, 13
s_add_u32 s28, s28, s29
s_add_u32 s23, s28, 16777216
s_add_u32 s24, s28, 17301504
s_add_u32 s25, s28, 17039360
s_lshl_b32 s36, s17, 11
s_add_u32 s36, s36, s42
s_add_u32 m0, s36, 16384
s_nop 0
buffer_load_dwordx4 v246, s[8:11], s23 offen offset:0 sc1 lds
s_add_u32 m0, s36, 16384
s_nop 0
buffer_load_dwordx4 v246, s[8:11], s23 offen offset:1024 sc1 lds
s_add_u32 m0, s36, 24576
s_nop 0
buffer_load_dwordx4 v244, s[8:11], s24 offen offset:0 sc1 lds
s_add_u32 m0, s36, 25600
s_nop 0
buffer_load_dwordx4 v245, s[8:11], s24 offen offset:0 sc1 lds
s_add_u32 m0, s36, 32768
s_nop 0
buffer_load_dwordx4 v246, s[8:11], s25 offen offset:0 sc1 lds
s_add_u32 m0, s36, 32768
s_nop 0
buffer_load_dwordx4 v246, s[8:11], s25 offen offset:1024 sc1 lds
s_min_u32 s21, s19, 63
s_lshl_b32 s21, s21, 13
s_lshl_b32 s28, s17, 11
s_add_u32 s21, s21, s28
s_add_u32 s21, s21, 1572864
buffer_load_dwordx4 v[228:231], v0, s[8:11], s21 offen offset:0 sc1
buffer_load_dwordx4 v[232:235], v0, s[8:11], s21 offen offset:1024 sc1
s_waitcnt vmcnt(0)
s_barrier
La_seg:
ds_read_b128 v[68:71], v248
ds_read_b128 v[84:87], v2 offset:0
ds_read_b128 v[100:103], v2 offset:4096
ds_read_b128 v[72:75], v249
ds_read_b128 v[88:91], v2 offset:32
ds_read_b128 v[104:107], v2 offset:4128
ds_read_b128 v[76:79], v250
ds_read_b128 v[92:95], v2 offset:1024
ds_read_b128 v[108:111], v2 offset:5120
ds_read_b128 v[80:83], v251
ds_read_b128 v[96:99], v2 offset:1056
ds_read_b128 v[112:115], v2 offset:5152
v_mfma_f32_16x16x1_4b_f32 v[52:67], v236, v236, 0
s_waitcnt lgkmcnt(9)
ds_read_b128 v[212:215], v3 offset:0
v_mfma_f32_16x16x32_bf16 v[132:135], v[84:87], v[68:71], 0
v_mfma_f32_16x16x32_bf16 v[136:139], v[100:103], v[68:71], 0
s_waitcnt lgkmcnt(7)
ds_read_b128 v[216:219], v3 offset:1024
v_mfma_f32_16x16x32_bf16 v[132:135], v[88:91], v[72:75], v[132:135]
v_mfma_f32_16x16x32_bf16 v[136:139], v[104:107], v[72:75], v[136:139]
s_waitcnt lgkmcnt(5)
ds_read_b128 v[220:223], v3 offset:2048
v_mfma_f32_16x16x32_bf16 v[132:135], v[92:95], v[76:79], v[132:135]
v_mfma_f32_16x16x32_bf16 v[136:139], v[108:111], v[76:79], v[136:139]
s_waitcnt lgkmcnt(3)
ds_read_b128 v[224:227], v3 offset:3072
v_mfma_f32_16x16x32_bf16 v[132:135], v[96:99], v[80:83], v[132:135]
v_mfma_f32_16x16x32_bf16 v[136:139], v[112:115], v[80:83], v[136:139]
s_waitcnt lgkmcnt(0)
v_mov_b32 v116, v212
v_mov_b32 v117, v214
v_mov_b32 v118, v216
v_mov_b32 v119, v218
v_mov_b32 v120, v213
v_mov_b32 v121, v215
v_mov_b32 v122, v217
v_mov_b32 v123, v219
v_mov_b32 v124, v220
v_mov_b32 v125, v222
v_mov_b32 v126, v224
v_mov_b32 v127, v226
v_mov_b32 v128, v221
v_mov_b32 v129, v223
v_mov_b32 v130, v225
v_mov_b32 v131, v227
s_xor_b32 s42, s42, 0x8000
v_xor_b32 v248, 0x8000, v248
v_xor_b32 v249, 0x8000, v249
v_xor_b32 v250, 0x8000, v250
v_xor_b32 v251, 0x8000, v251
v_xor_b32 v2, 0x8000, v2
v_xor_b32 v3, 0x18000, v3
s_and_b32 s28, s17, 1
s_lshl1_add_u32 s28, s19, s28
s_lshl_b32 s28, s28, 5
s_add_u32 s28, s28, s16
s_lshl_b32 s28, s28, 12
s_lshr_b32 s29, s17, 1
s_lshl_b32 s29, s29, 11
s_add_u32 s22, s28, s29
s_add_u32 s22, s22, 83886080
s_add_u32 s26, s19, 1
v_mov_b32 v238, s26
v_cmp_le_i32 vcc, 0, v10
s_nop 1
v_cndmask_b32 v132, v239, v132, vcc
v_cmp_le_i32 vcc, 1, v10
s_nop 1
v_cndmask_b32 v133, v239, v133, vcc
v_cmp_le_i32 vcc, 2, v10
s_nop 1
v_cndmask_b32 v134, v239, v134, vcc
v_cmp_le_i32 vcc, 3, v10
s_nop 1
v_cndmask_b32 v135, v239, v135, vcc
v_cmp_le_i32 vcc, 16, v10
s_nop 1
v_cndmask_b32 v136, v239, v136, vcc
v_cmp_le_i32 vcc, 17, v10
s_nop 1
v_cndmask_b32 v137, v239, v137, vcc
v_cmp_le_i32 vcc, 18, v10
s_nop 1
v_cndmask_b32 v138, v239, v138, vcc
v_cmp_le_i32 vcc, 19, v10
s_nop 1
v_cndmask_b32 v139, v239, v139, vcc
v_max3_f32 v12, v132, v133, v134
v_max3_f32 v13, v135, v136, v137
v_max3_f32 v12, v12, v138, v139
v_max_f32 v17, v12, v13
s_add_u32 s19, s19, 2
s_min_u32 s37, s19, 63
s_cmp_lg_u32 s20, 0
s_cbranch_scc1 La_rkb
La_rwb:
buffer_load_dword v12, v8, s[8:11], 0 offen sc1
s_add_u32 s30, s30, 1
s_cmp_gt_u32 s30, 1000000
s_cbranch_scc1 L_fin
s_waitcnt vmcnt(0)
v_cmp_ge_u32 vcc, 63, v12
s_cmp_eq_u64 vcc, 0
s_cselect_b32 s20, 1, 0
v_cmp_ge_u32 vcc, s37, v12
s_cbranch_vccnz La_rwb
La_rkb:
s_mul_i32 s28, s37, 1048576
s_lshl_b32 s29, s16, 13
s_add_u32 s28, s28, s29
s_add_u32 s23, s28, 16777216
s_add_u32 s24, s28, 17301504
s_add_u32 s25, s28, 17039360
s_lshl_b32 s36, s17, 11
s_add_u32 s36, s36, s42
s_waitcnt vmcnt(1)
s_branch La_mq
La_mp:
s_cmp_ge_u32 s19, 64
s_cbranch_scc1 La_ms
s_sleep 2
La_ms:
buffer_load_dwordx4 v[228:231], v0, s[8:11], s21 offen offset:0 sc1
buffer_load_dwordx4 v[232:235], v0, s[8:11], s21 offen offset:1024 sc1
s_add_u32 s30, s30, 1
s_cmp_gt_u32 s30, 1000000
s_cbranch_scc1 L_fin
s_waitcnt vmcnt(0)
La_mq:
ds_write_b128 v16, v[228:231] offset:0
ds_write_b128 v16, v[232:235] offset:1024
v_maximum3_f32 v12, v228, v229, v230
v_maximum3_f32 v13, v231, v232, v233
v_maximum3_f32 v12, v12, v234, v235
v_cmp_u_f32 vcc, v12, v13
s_cbranch_vccnz La_mx
La_mo:
s_waitcnt lgkmcnt(0)
s_barrier
ds_read_b128 v[20:23], v0 offset:0
ds_read_b128 v[24:27], v0 offset:1024
ds_read_b128 v[28:31], v0 offset:2048
ds_read_b128 v[32:35], v0 offset:3072
ds_read_b128 v[36:39], v0 offset:4096
ds_read_b128 v[40:43], v0 offset:5120
ds_read_b128 v[44:47], v0 offset:6144
ds_read_b128 v[48:51], v0 offset:7168
s_waitcnt lgkmcnt(7)
v_smfmac_f32_16x16x64_bf16 v[52:55], v[20:23], a[0:7], v14
v_smfmac_f32_16x16x64_bf16 v[56:59], v[20:23], a[8:15], v14
s_add_u32 m0, s36, 16384
s_nop 0
buffer_load_dwordx4 v246, s[8:11], s23 offen offset:0 sc1 lds
s_waitcnt lgkmcnt(6)
v_smfmac_f32_16x16x64_bf16 v[52:55], v[24:27], a[16:23], v14
v_smfmac_f32_16x16x64_bf16 v[56:59], v[24:27], a[24:31], v14
s_add_u32 m0, s36, 16384
s_nop 0
buffer_load_dwordx4 v246, s[8:11], s23 offen offset:1024 sc1 lds
s_waitcnt lgkmcnt(5)
v_smfmac_f32_16x16x64_bf16 v[52:55], v[28:31], a[32:39], v14
v_smfmac_f32_16x16x64_bf16 v[56:59], v[28:31], a[40:47], v14
s_add_u32 m0, s36, 24576
s_nop 0
buffer_load_dwordx4 v244, s[8:11], s24 offen offset:0 sc1 lds
s_waitcnt lgkmcnt(4)
v_smfmac_f32_16x16x64_bf16 v[52:55], v[32:35], a[48:55], v14
v_smfmac_f32_16x16x64_bf16 v[56:59], v[32:35], a[56:63], v14
s_add_u32 m0, s36, 25600
s_nop 0
buffer_load_dwordx4 v245, s[8:11], s24 offen offset:0 sc1 lds
s_waitcnt lgkmcnt(3)
v_smfmac_f32_16x16x64_bf16 v[52:55], v[36:39], a[64:71], v14
v_smfmac_f32_16x16x64_bf16 v[56:59], v[36:39], a[72:79], v14
s_add_u32 m0, s36, 32768
s_nop 0
buffer_load_dwordx4 v246, s[8:11], s25 offen offset:0 sc1 lds
s_waitcnt lgkmcnt(2)
v_smfmac_f32_16x16x64_bf16 v[52:55], v[40:43], a[80:87], v14
v_smfmac_f32_16x16x64_bf16 v[56:59], v[40:43], a[88:95], v14
s_add_u32 m0, s36, 32768
s_nop 0
buffer_load_dwordx4 v246, s[8:11], s25 offen offset:1024 sc1 lds
s_waitcnt lgkmcnt(1)
v_smfmac_f32_16x16x64_bf16 v[52:55], v[44:47], a[96:103], v14
v_smfmac_f32_16x16x64_bf16 v[56:59], v[44:47], a[104:111], v14
s_waitcnt lgkmcnt(0)
v_smfmac_f32_16x16x64_bf16 v[52:55], v[48:51], a[112:119], v14
v_smfmac_f32_16x16x64_bf16 v[56:59], v[48:51], a[120:127], v14
v_smfmac_f32_16x16x64_bf16 v[60:63], v[20:23], a[128:135], v14
v_smfmac_f32_16x16x64_bf16 v[64:67], v[20:23], a[136:143], v14
v_add_f32 v52, v52, v54
v_add_f32 v53, v53, v55
v_cvt_pk_bf16_f32 v52, v52, v53
v_smfmac_f32_16x16x64_bf16 v[60:63], v[24:27], a[144:151], v14
v_smfmac_f32_16x16x64_bf16 v[64:67], v[24:27], a[152:159], v14
v_add_f32 v56, v56, v58
v_add_f32 v57, v57, v59
v_cvt_pk_bf16_f32 v56, v56, v57
ds_write_b32 v4, v52 offset:0
v_smfmac_f32_16x16x64_bf16 v[60:63], v[28:31], a[160:167], v14
v_smfmac_f32_16x16x64_bf16 v[64:67], v[28:31], a[168:175], v14
ds_write_b32 v4, v56 offset:512
v_smfmac_f32_16x16x64_bf16 v[60:63], v[32:35], a[176:183], v14
v_smfmac_f32_16x16x64_bf16 v[64:67], v[32:35], a[184:191], v14
v_smfmac_f32_16x16x64_bf16 v[60:63], v[36:39], a[192:199], v14
v_smfmac_f32_16x16x64_bf16 v[64:67], v[36:39], a[200:207], v14
s_waitcnt lgkmcnt(0)
s_barrier
ds_read_b64_tr_b16 v[144:145], v5 offset:0
ds_read_b64_tr_b16 v[146:147], v5 offset:64
v_smfmac_f32_16x16x64_bf16 v[60:63], v[40:43], a[208:215], v14
v_smfmac_f32_16x16x64_bf16 v[64:67], v[40:43], a[216:223], v14
ds_read_b64_tr_b16 v[148:149], v5 offset:512
ds_read_b64_tr_b16 v[150:151], v5 offset:576
v_smfmac_f32_16x16x64_bf16 v[60:63], v[44:47], a[224:231], v14
v_smfmac_f32_16x16x64_bf16 v[64:67], v[44:47], a[232:239], v14
ds_read_b64_tr_b16 v[152:153], v5 offset:1024
ds_read_b64_tr_b16 v[154:155], v5 offset:1088
v_smfmac_f32_16x16x64_bf16 v[60:63], v[48:51], a[240:247], v14
v_smfmac_f32_16x16x64_bf16 v[64:67], v[48:51], a[248:255], v14
ds_read_b64_tr_b16 v[156:157], v5 offset:1536
ds_read_b64_tr_b16 v[158:159], v5 offset:1600
s_waitcnt lgkmcnt(6)
v_mfma_f32_16x16x32_bf16 v[140:143], v[144:147], v[68:71], 0
s_waitcnt lgkmcnt(4)
v_mfma_f32_16x16x32_bf16 v[140:143], v[148:151], v[72:75], v[140:143]
s_waitcnt lgkmcnt(2)
v_mfma_f32_16x16x32_bf16 v[140:143], v[152:155], v[76:79], v[140:143]
v_add_f32 v60, v60, v62
v_add_f32 v61, v61, v63
v_cvt_pk_bf16_f32 v60, v60, v61
ds_write_b32 v15, v60 offset:0
s_waitcnt lgkmcnt(1)
v_mfma_f32_16x16x32_bf16 v[140:143], v[156:159], v[80:83], v[140:143]
v_add_f32 v64, v64, v66
v_add_f32 v65, v65, v67
v_cvt_pk_bf16_f32 v64, v64, v65
ds_write_b32 v15, v64 offset:256
s_nop 2
v_mul_f32 v140, 1040356334, v140
v_mul_f32 v141, 1040356334, v141
v_mul_f32 v142, 1040356334, v142
v_mul_f32 v143, 1040356334, v143
v_max3_f32 v12, v17, v140, v141
v_max3_f32 v12, v12, v142, v143
v_mov_b32 v13, v12
s_nop 1
v_permlane32_swap_b32 v13, v12
v_max_f32 v12, v12, v13
v_mov_b32 v13, v12
s_nop 1
v_permlane16_swap_b32 v13, v12
v_max_f32 v12, v12, v13
s_waitcnt lgkmcnt(0)
s_barrier
ds_read_b64 v[160:161], v6 offset:0
ds_read_b64 v[162:163], v6 offset:256
ds_read_b64 v[164:165], v6 offset:512
ds_read_b64 v[166:167], v6 offset:768
v_mov_b32_dpp v140, v237 quad_perm:[0,1,2,3] row_mask:0xc bank_mask:0xf
v_mov_b32_dpp v141, v237 quad_perm:[0,1,2,3] row_mask:0xc bank_mask:0xf
v_mov_b32_dpp v142, v237 quad_perm:[0,1,2,3] row_mask:0xc bank_mask:0xf
v_mov_b32_dpp v143, v237 quad_perm:[0,1,2,3] row_mask:0xc bank_mask:0xf
v_sub_f32 v132, v132, v12
v_exp_f32 v132, v132
v_sub_f32 v133, v133, v12
v_exp_f32 v133, v133
v_sub_f32 v134, v134, v12
v_exp_f32 v134, v134
v_sub_f32 v135, v135, v12
v_exp_f32 v135, v135
v_sub_f32 v136, v136, v12
v_exp_f32 v136, v136
v_sub_f32 v137, v137, v12
v_exp_f32 v137, v137
v_sub_f32 v138, v138, v12
v_exp_f32 v138, v138
v_sub_f32 v139, v139, v12
v_exp_f32 v139, v139
v_cvt_pk_bf16_f32 v168, v132, v133
v_cvt_pk_bf16_f32 v169, v134, v135
v_cvt_pk_bf16_f32 v170, v136, v137
v_cvt_pk_bf16_f32 v171, v138, v139
s_nop 1
v_mfma_f32_16x16x32_bf16 v[176:179], v[116:119], v[168:171], 0
v_sub_f32 v140, v140, v12
v_exp_f32 v140, v140
v_mfma_f32_16x16x32_bf16 v[180:183], v[120:123], v[168:171], 0
v_sub_f32 v141, v141, v12
v_exp_f32 v141, v141
v_mfma_f32_16x16x32_bf16 v[184:187], v[124:127], v[168:171], 0
v_sub_f32 v142, v142, v12
v_exp_f32 v142, v142
v_mfma_f32_16x16x32_bf16 v[188:191], v[128:131], v[168:171], 0
v_sub_f32 v143, v143, v12
v_exp_f32 v143, v143
v_mfma_f32_16x16x32_bf16 v[52:55], v[240:243], v[168:171], 0
v_cvt_pk_bf16_f32 v172, v140, v141
v_cvt_pk_bf16_f32 v173, v142, v143
s_waitcnt lgkmcnt(0)
s_nop 0
v_mfma_f32_16x16x16_bf16 v[52:55], v[240:241], v[172:173], v[52:55]
v_mfma_f32_16x16x16_bf16 v[176:179], v[160:161], v[172:173], v[176:179]
v_mfma_f32_16x16x16_bf16 v[180:183], v[162:163], v[172:173], v[180:183]
v_mfma_f32_16x16x16_bf16 v[184:187], v[164:165], v[172:173], v[184:187]
v_mfma_f32_16x16x16_bf16 v[188:191], v[166:167], v[172:173], v[188:191]
v_rcp_f32 v12, v52
s_nop 0
v_mul_f32 v176, v176, v12
v_mul_f32 v177, v177, v12
v_mul_f32 v178, v178, v12
v_mul_f32 v179, v179, v12
v_mul_f32 v180, v180, v12
v_mul_f32 v181, v181, v12
v_mul_f32 v182, v182, v12
v_mul_f32 v183, v183, v12
v_cvt_pk_bf16_f32 v176, v176, v177
v_cvt_pk_bf16_f32 v177, v178, v179
v_cvt_pk_bf16_f32 v178, v180, v181
v_cvt_pk_bf16_f32 v179, v182, v183
buffer_store_dwordx4 v[176:179], v0, s[8:11], s22 offen offset:0 sc1
v_mul_f32 v184, v184, v12
v_mul_f32 v185, v185, v12
v_mul_f32 v186, v186, v12
v_mul_f32 v187, v187, v12
v_mul_f32 v188, v188, v12
v_mul_f32 v189, v189, v12
v_mul_f32 v190, v190, v12
v_mul_f32 v191, v191, v12
v_cvt_pk_bf16_f32 v184, v184, v185
v_cvt_pk_bf16_f32 v185, v186, v187
v_cvt_pk_bf16_f32 v186, v188, v189
v_cvt_pk_bf16_f32 v187, v190, v191
buffer_store_dwordx4 v[184:187], v0, s[8:11], s22 offen offset:1024 sc1
s_min_u32 s21, s19, 63
s_lshl_b32 s21, s21, 13
s_lshl_b32 s28, s17, 11
s_add_u32 s21, s21, s28
s_add_u32 s21, s21, 1572864
buffer_load_dwordx4 v[228:231], v0, s[8:11], s21 offen offset:0 sc1
buffer_load_dwordx4 v[232:235], v0, s[8:11], s21 offen offset:1024 sc1
s_waitcnt vmcnt(2)
s_barrier
buffer_store_dword v238, v11, s[8:11], 0 offen sc1
s_cmp_lt_u32 s19, 64
s_cbranch_scc1 La_seg
s_branch La_end
La_mx:
s_mov_b64 s[38:39], 0
v_cmp_eq_u32 vcc, s27, v228
s_or_b64 s[38:39], s[38:39], vcc
v_cmp_eq_u32 vcc, s27, v229
s_or_b64 s[38:39], s[38:39], vcc
v_cmp_eq_u32 vcc, s27, v230
s_or_b64 s[38:39], s[38:39], vcc
v_cmp_eq_u32 vcc, s27, v231
s_or_b64 s[38:39], s[38:39], vcc
v_cmp_eq_u32 vcc, s27, v232
s_or_b64 s[38:39], s[38:39], vcc
v_cmp_eq_u32 vcc, s27, v233
s_or_b64 s[38:39], s[38:39], vcc
v_cmp_eq_u32 vcc, s27, v234
s_or_b64 s[38:39], s[38:39], vcc
v_cmp_eq_u32 vcc, s27, v235
s_or_b64 s[38:39], s[38:39], vcc
s_cbranch_scc0 La_mo
s_waitcnt lgkmcnt(0)
s_branch La_mp
La_end:
s_branch L_fin
L_fft:
s_cmp_lg_u32 s83, 0
s_cbranch_scc1 L_vf_15
v_mov_b32 v60, 15920
s_cmp_lg_u32 s17, 0
s_cbranch_scc1 L_vg_16
s_waitcnt lgkmcnt(0)
s_and_b32 s100, s100, s101
v_mov_b32 v61, s100
ds_write_b32 v60, v61
L_vg_16:
s_waitcnt lgkmcnt(0)
s_barrier
ds_read_b32 v61, v60
s_waitcnt lgkmcnt(0)
v_cmp_ne_u32 vcc, 0, v61
s_cbranch_vccnz L_redo
L_vf_15:
L_s2:
s_mov_b32 s22, s62
v_mbcnt_lo_u32_b32 v51, -1, 0
v_mbcnt_hi_u32_b32 v51, -1, v51
s_lshl_b32 s28, s17, 6
v_add_u32 v51, s28, v51
v_bfe_u32 v0, v51, 0, 8
v_lshlrev_b32 v0, 4, v0
s_waitcnt vmcnt(24)
s_mul_i32 s29, s22, 16448
s_lshl_b32 s36, s17, 10
s_mov_b32 s12, s66
s_mov_b32 s13, s67
s_mov_b32 s14, 1052672
s_mov_b32 s15, 0x20000
s_add_u32 m0, s36, 16384
s_add_u32 s28, s29, 0
buffer_load_dwordx4 v0, s[12:15], s28 offen lds
s_add_u32 m0, s36, 20480
s_add_u32 s28, s29, 4096
buffer_load_dwordx4 v0, s[12:15], s28 offen lds
s_add_u32 m0, s36, 24576
s_add_u32 s28, s29, 8192
buffer_load_dwordx4 v0, s[12:15], s28 offen lds
s_add_u32 m0, s36, 28672
s_add_u32 s28, s29, 12288
buffer_load_dwordx4 v0, s[12:15], s28 offen lds
s_add_u32 m0, s36, 32768
s_add_u32 s28, s29, 16384
buffer_load_dwordx4 v0, s[12:15], s28 offen lds
s_mov_b32 s12, s68
s_mov_b32 s13, s69
s_mov_b32 s14, 1052672
s_mov_b32 s15, 0x20000
s_add_u32 m0, s36, 36864
s_add_u32 s28, s29, 0
buffer_load_dwordx4 v0, s[12:15], s28 offen lds
s_add_u32 m0, s36, 40960
s_add_u32 s28, s29, 4096
buffer_load_dwordx4 v0, s[12:15], s28 offen lds
s_add_u32 m0, s36, 45056
s_add_u32 s28, s29, 8192
buffer_load_dwordx4 v0, s[12:15], s28 offen lds
s_add_u32 m0, s36, 49152
s_add_u32 s28, s29, 12288
buffer_load_dwordx4 v0, s[12:15], s28 offen lds
s_add_u32 m0, s36, 53248
s_add_u32 s28, s29, 16384
buffer_load_dwordx4 v0, s[12:15], s28 offen lds
v_bfe_u32 v1, v51, 0, 5
v_mul_u32_u24 v1, 514, v1
v_bfe_u32 v50, v51, 5, 3
v_lshl_add_u32 v1, v50, 1, v1
v_add_u32 v1, 16384, v1
s_lshl_b32 s28, s22, 7
v_bfe_u32 v2, v51, 0, 5
v_lshlrev_b32 v2, 2, v2
v_bfe_u32 v50, v51, 5, 3
v_mul_u32_u24 v50, 8320, v50
v_add_u32 v2, v50, v2
v_add_u32 v2, 109051904, v2
v_add_u32 v2, s28, v2
s_waitcnt vmcnt(0) lgkmcnt(0)
s_barrier
ds_read_u16 v8, v1 offset:0
ds_read_u16 v9, v1 offset:20480
ds_read_u16 v10, v1 offset:16
ds_read_u16 v11, v1 offset:20496
ds_read_u16 v12, v1 offset:32
ds_read_u16 v13, v1 offset:20512
ds_read_u16 v14, v1 offset:48
ds_read_u16 v15, v1 offset:20528
ds_read_u16 v16, v1 offset:64
ds_read_u16 v17, v1 offset:20544
ds_read_u16 v18, v1 offset:80
ds_read_u16 v19, v1 offset:20560
ds_read_u16 v20, v1 offset:96
ds_read_u16 v21, v1 offset:20576
s_waitcnt lgkmcnt(0)
v_lshl_or_b32 v64, v9, 16, v8
s_mov_b32 s28, 0
buffer_store_dword v64, v2, s[8:11], s28 offen
v_lshl_or_b32 v65, v11, 16, v10
s_mov_b32 s28, 66560
buffer_store_dword v65, v2, s[8:11], s28 offen
v_lshl_or_b32 v66, v13, 16, v12
s_mov_b32 s28, 133120
buffer_store_dword v66, v2, s[8:11], s28 offen
v_lshl_or_b32 v67, v15, 16, v14
s_mov_b32 s28, 199680
buffer_store_dword v67, v2, s[8:11], s28 offen
v_lshl_or_b32 v68, v17, 16, v16
s_mov_b32 s28, 266240
buffer_store_dword v68, v2, s[8:11], s28 offen
v_lshl_or_b32 v69, v19, 16, v18
s_mov_b32 s28, 332800
buffer_store_dword v69, v2, s[8:11], s28 offen
v_lshl_or_b32 v70, v21, 16, v20
s_mov_b32 s28, 399360
buffer_store_dword v70, v2, s[8:11], s28 offen
ds_read_u16 v8, v1 offset:112
ds_read_u16 v9, v1 offset:20592
ds_read_u16 v10, v1 offset:128
ds_read_u16 v11, v1 offset:20608
ds_read_u16 v12, v1 offset:144
ds_read_u16 v13, v1 offset:20624
ds_read_u16 v14, v1 offset:160
ds_read_u16 v15, v1 offset:20640
ds_read_u16 v16, v1 offset:176
ds_read_u16 v17, v1 offset:20656
ds_read_u16 v18, v1 offset:192
ds_read_u16 v19, v1 offset:20672
ds_read_u16 v20, v1 offset:208
ds_read_u16 v21, v1 offset:20688
s_waitcnt lgkmcnt(0)
v_lshl_or_b32 v71, v9, 16, v8
s_mov_b32 s28, 465920
buffer_store_dword v71, v2, s[8:11], s28 offen
v_lshl_or_b32 v72, v11, 16, v10
s_mov_b32 s28, 532480
buffer_store_dword v72, v2, s[8:11], s28 offen
v_lshl_or_b32 v73, v13, 16, v12
s_mov_b32 s28, 599040
buffer_store_dword v73, v2, s[8:11], s28 offen
v_lshl_or_b32 v74, v15, 16, v14
s_mov_b32 s28, 665600
buffer_store_dword v74, v2, s[8:11], s28 offen
v_lshl_or_b32 v75, v17, 16, v16
s_mov_b32 s28, 732160
buffer_store_dword v75, v2, s[8:11], s28 offen
v_lshl_or_b32 v76, v19, 16, v18
s_mov_b32 s28, 798720
buffer_store_dword v76, v2, s[8:11], s28 offen
v_lshl_or_b32 v77, v21, 16, v20
s_mov_b32 s28, 865280
buffer_store_dword v77, v2, s[8:11], s28 offen
ds_read_u16 v8, v1 offset:224
ds_read_u16 v9, v1 offset:20704
ds_read_u16 v10, v1 offset:240
ds_read_u16 v11, v1 offset:20720
ds_read_u16 v12, v1 offset:256
ds_read_u16 v13, v1 offset:20736
ds_read_u16 v14, v1 offset:272
ds_read_u16 v15, v1 offset:20752
ds_read_u16 v16, v1 offset:288
ds_read_u16 v17, v1 offset:20768
ds_read_u16 v18, v1 offset:304
ds_read_u16 v19, v1 offset:20784
ds_read_u16 v20, v1 offset:320
ds_read_u16 v21, v1 offset:20800
s_waitcnt lgkmcnt(0)
v_lshl_or_b32 v78, v9, 16, v8
s_mov_b32 s28, 931840
buffer_store_dword v78, v2, s[8:11], s28 offen
v_lshl_or_b32 v79, v11, 16, v10
s_mov_b32 s28, 998400
buffer_store_dword v79, v2, s[8:11], s28 offen
v_lshl_or_b32 v80, v13, 16, v12
s_mov_b32 s28, 1064960
buffer_store_dword v80, v2, s[8:11], s28 offen
v_lshl_or_b32 v81, v15, 16, v14
s_mov_b32 s28, 1131520
buffer_store_dword v81, v2, s[8:11], s28 offen
v_lshl_or_b32 v82, v17, 16, v16
s_mov_b32 s28, 1198080
buffer_store_dword v82, v2, s[8:11], s28 offen
v_lshl_or_b32 v83, v19, 16, v18
s_mov_b32 s28, 1264640
buffer_store_dword v83, v2, s[8:11], s28 offen
v_lshl_or_b32 v84, v21, 16, v20
s_mov_b32 s28, 1331200
buffer_store_dword v84, v2, s[8:11], s28 offen
ds_read_u16 v8, v1 offset:336
ds_read_u16 v9, v1 offset:20816
ds_read_u16 v10, v1 offset:352
ds_read_u16 v11, v1 offset:20832
ds_read_u16 v12, v1 offset:368
ds_read_u16 v13, v1 offset:20848
ds_read_u16 v14, v1 offset:384
ds_read_u16 v15, v1 offset:20864
ds_read_u16 v16, v1 offset:400
ds_read_u16 v17, v1 offset:20880
ds_read_u16 v18, v1 offset:416
ds_read_u16 v19, v1 offset:20896
ds_read_u16 v20, v1 offset:432
ds_read_u16 v21, v1 offset:20912
s_waitcnt lgkmcnt(0)
v_lshl_or_b32 v85, v9, 16, v8
s_mov_b32 s28, 1397760
buffer_store_dword v85, v2, s[8:11], s28 offen
v_lshl_or_b32 v86, v11, 16, v10
s_mov_b32 s28, 1464320
buffer_store_dword v86, v2, s[8:11], s28 offen
v_lshl_or_b32 v87, v13, 16, v12
s_mov_b32 s28, 1530880
buffer_store_dword v87, v2, s[8:11], s28 offen
v_lshl_or_b32 v88, v15, 16, v14
s_mov_b32 s28, 1597440
buffer_store_dword v88, v2, s[8:11], s28 offen
v_lshl_or_b32 v89, v17, 16, v16
s_mov_b32 s28, 1664000
buffer_store_dword v89, v2, s[8:11], s28 offen
v_lshl_or_b32 v90, v19, 16, v18
s_mov_b32 s28, 1730560
buffer_store_dword v90, v2, s[8:11], s28 offen
v_lshl_or_b32 v91, v21, 16, v20
s_mov_b32 s28, 1797120
buffer_store_dword v91, v2, s[8:11], s28 offen
ds_read_u16 v8, v1 offset:448
ds_read_u16 v9, v1 offset:20928
ds_read_u16 v10, v1 offset:464
ds_read_u16 v11, v1 offset:20944
ds_read_u16 v12, v1 offset:480
ds_read_u16 v13, v1 offset:20960
ds_read_u16 v14, v1 offset:496
ds_read_u16 v15, v1 offset:20976
ds_read_u16 v16, v1 offset:512
ds_read_u16 v17, v1 offset:20992
s_waitcnt lgkmcnt(0)
v_lshl_or_b32 v92, v9, 16, v8
s_mov_b32 s28, 1863680
buffer_store_dword v92, v2, s[8:11], s28 offen
v_lshl_or_b32 v93, v11, 16, v10
s_mov_b32 s28, 1930240
buffer_store_dword v93, v2, s[8:11], s28 offen
v_lshl_or_b32 v94, v13, 16, v12
s_mov_b32 s28, 1996800
buffer_store_dword v94, v2, s[8:11], s28 offen
v_lshl_or_b32 v95, v15, 16, v14
s_mov_b32 s28, 2063360
buffer_store_dword v95, v2, s[8:11], s28 offen
v_lshl_or_b32 v96, v17, 16, v16
s_mov_b32 s28, 2129920
buffer_store_dword v96, v2, s[8:11], s28 offen
s_barrier
s_xor_b32 s62, s62, 32
s_bitcmp1_b32 s62, 5
s_cbranch_scc1 L_s2
s_waitcnt vmcnt(0) lgkmcnt(0)
s_barrier
s_cmp_lg_u32 s17, 0
s_cbranch_scc1 L_pb_17
buffer_wbl2 sc1
s_waitcnt vmcnt(0)
v_mov_b32 v5, 36
v_mov_b32 v6, 1
s_mov_b64 exec, 1
global_atomic_add v5, v6, s[6:7]
s_mov_b64 exec, -1
L_pb_17:
s_branch L_fin
L_out:
s_cmp_lg_u32 s83, 0
s_cbranch_scc1 L_vf_18
v_mov_b32 v60, 15920
s_cmp_lg_u32 s17, 0
s_cbranch_scc1 L_vg_19
s_waitcnt lgkmcnt(0)
s_and_b32 s100, s100, s101
v_mov_b32 v61, s100
ds_write_b32 v60, v61
L_vg_19:
s_waitcnt lgkmcnt(0)
s_barrier
ds_read_b32 v61, v60
s_waitcnt lgkmcnt(0)
v_cmp_ne_u32 vcc, 0, v61
s_cbranch_vccnz L_redo
L_vf_18:
v_mbcnt_lo_u32_b32 v3, -1, 0
v_mbcnt_hi_u32_b32 v3, -1, v3
s_lshl_b32 s28, s17, 6
v_add_u32 v3, s28, v3
v_lshlrev_b32 v2, 4, v3
v_lshlrev_b32 v1, 2, v3
v_mov_b32 v8, 0
s_lshl_b32 s28, s62, 13
v_mov_b32 v4, 2141552549
v_mov_b32 v5, 2141552549
v_mov_b32 v6, 2141552549
v_mov_b32 v7, 2141552549
s_add_u32 s29, s28, 0
buffer_store_dwordx4 v[4:7], v2, s[8:11], s29 offen sc1
s_add_u32 s29, s28, 4096
buffer_store_dwordx4 v[4:7], v2, s[8:11], s29 offen sc1
s_add_u32 s29, s28, 1572864
buffer_store_dwordx4 v[4:7], v2, s[8:11], s29 offen sc1
s_add_u32 s29, s28, 1576960
buffer_store_dwordx4 v[4:7], v2, s[8:11], s29 offen sc1
s_lshl_b32 s28, s62, 10
s_add_u32 s29, s28, 1048576
buffer_store_dword v4, v1, s[8:11], s29 offen sc1
s_add_u32 s29, s28, 1114112
buffer_store_dword v8, v1, s[8:11], s29 offen sc1
s_waitcnt vmcnt(0) lgkmcnt(0)
s_barrier
s_cmp_lg_u32 s17, 0
s_cbranch_scc1 Ls_ar_20
v_mov_b32 v1, 32
v_mov_b32 v2, 1
s_mov_b64 exec, 1
global_atomic_add v3, v1, v2, s[6:7] sc0
s_waitcnt vmcnt(0)
v_readfirstlane_b32 s28, v3
s_mov_b64 exec, -1
s_cmp_lg_u32 s28, 63
s_cbranch_scc1 Ls_ar_20
v_mov_b32 v1, 164
v_mov_b32 v2, 64
global_store_dword v1, v2, s[6:7] sc1
Ls_ar_20:
v_mbcnt_lo_u32_b32 v3, -1, 0
v_mbcnt_hi_u32_b32 v3, -1, v3
s_lshl_b32 s28, s17, 6
v_add_u32 v3, s28, v3
v_lshlrev_b32 v3, 7, v3
s_lshl_b32 s28, s62, 15
s_add_u32 s29, s28, 0x200000
s_mov_b32 s12, s76
s_mov_b32 s13, s77
s_mov_b32 s14, 4194304
s_mov_b32 s15, 0x20000
buffer_load_dword v4, v3, s[12:15], s28 offen
buffer_load_dword v4, v3, s[12:15], s29 offen
s_mov_b32 s12, s78
s_mov_b32 s13, s79
s_mov_b32 s14, 4194304
s_mov_b32 s15, 0x20000
buffer_load_dword v4, v3, s[12:15], s28 offen
buffer_load_dword v4, v3, s[12:15], s29 offen
s_mov_b32 s12, s80
s_mov_b32 s13, s81
s_mov_b32 s14, 4194304
s_mov_b32 s15, 0x20000
buffer_load_dword v4, v3, s[12:15], s28 offen
buffer_load_dword v4, v3, s[12:15], s29 offen
v_mov_b32 v1, 32
s_cmp_lg_u32 s17, 0
s_cbranch_scc1 Lo_wd_22
s_sleep 64
Lo_wc_21:
global_load_dword v2, v1, s[6:7] sc1
s_add_u32 s30, s30, 1
s_cmp_gt_u32 s30, 1000000
s_cbranch_scc1 L_fin
s_waitcnt vmcnt(0)
v_cmp_gt_u32 vcc, 64, v2
s_cbranch_vccz Lo_wd_22
s_sleep 16
s_branch Lo_wc_21
Lo_wd_22:
s_barrier
s_and_b32 s28, s62, 31
s_lshl_b32 s28, s28, 7
s_add_u32 s28, s28, 1122304
v_mov_b32 v1, s28
Lo_wk_23:
s_sleep 16
buffer_load_dword v2, v1, s[8:11], 0 offen sc1
s_add_u32 s30, s30, 1
s_cmp_gt_u32 s30, 1000000
s_cbranch_scc1 L_fin
s_waitcnt vmcnt(0)
v_cmp_eq_u32 vcc, 0, v2
s_cbranch_vccnz Lo_wk_23
s_and_b32 s21, s62, 3
s_lshr_b32 s22, s62, 2
v_mbcnt_lo_u32_b32 v51, -1, 0
v_mbcnt_hi_u32_b32 v51, -1, v51
s_lshl_b32 s28, s17, 6
v_add_u32 v51, s28, v51
v_bfe_u32 v0, v51, 0, 6
v_lshlrev_b32 v0, 4, v0
s_mov_b32 s12, s64
s_mov_b32 s13, s65
s_mov_b32 s14, 2097152
s_mov_b32 s15, 0x20000
s_lshr_b32 s29, s17, 1
s_lshl_b32 s29, s29, 5
s_and_b32 s28, s17, 1
s_lshl_b32 s28, s28, 3
s_add_u32 s29, s29, s28
s_lshl_b32 s29, s29, 15
s_lshl_b32 s28, s22, 11
s_add_u32 s29, s29, s28
s_mul_i32 s36, s17, 16640
s_waitcnt vmcnt(24)
s_add_u32 m0, s36, 0
s_add_u32 s28, s29, 0
buffer_load_dwordx4 v0, s[12:15], s28 offen lds
s_add_u32 m0, s36, 1040
s_add_u32 s28, s29, 32768
buffer_load_dwordx4 v0, s[12:15], s28 offen lds
s_add_u32 m0, s36, 2080
s_add_u32 s28, s29, 65536
buffer_load_dwordx4 v0, s[12:15], s28 offen lds
s_add_u32 m0, s36, 3120
s_add_u32 s28, s29, 98304
buffer_load_dwordx4 v0, s[12:15], s28 offen lds
s_add_u32 m0, s36, 4160
s_add_u32 s28, s29, 524288
buffer_load_dwordx4 v0, s[12:15], s28 offen lds
s_add_u32 m0, s36, 5200
s_add_u32 s28, s29, 557056
buffer_load_dwordx4 v0, s[12:15], s28 offen lds
s_add_u32 m0, s36, 6240
s_add_u32 s28, s29, 589824
buffer_load_dwordx4 v0, s[12:15], s28 offen lds
s_add_u32 m0, s36, 7280
s_add_u32 s28, s29, 622592
buffer_load_dwordx4 v0, s[12:15], s28 offen lds
s_add_u32 m0, s36, 8320
s_add_u32 s28, s29, 131072
buffer_load_dwordx4 v0, s[12:15], s28 offen lds
s_add_u32 m0, s36, 9360
s_add_u32 s28, s29, 163840
buffer_load_dwordx4 v0, s[12:15], s28 offen lds
s_add_u32 m0, s36, 10400
s_add_u32 s28, s29, 196608
buffer_load_dwordx4 v0, s[12:15], s28 offen lds
s_add_u32 m0, s36, 11440
s_add_u32 s28, s29, 229376
buffer_load_dwordx4 v0, s[12:15], s28 offen lds
s_add_u32 m0, s36, 12480
s_add_u32 s28, s29, 655360
buffer_load_dwordx4 v0, s[12:15], s28 offen lds
s_add_u32 m0, s36, 13520
s_add_u32 s28, s29, 688128
buffer_load_dwordx4 v0, s[12:15], s28 offen lds
s_add_u32 m0, s36, 14560
s_add_u32 s28, s29, 720896
buffer_load_dwordx4 v0, s[12:15], s28 offen lds
s_add_u32 m0, s36, 15600
s_add_u32 s28, s29, 753664
buffer_load_dwordx4 v0, s[12:15], s28 offen lds
s_add_u32 m0, s36, 66560
s_add_u32 s28, s29, 1024
buffer_load_dwordx4 v0, s[12:15], s28 offen lds
s_add_u32 m0, s36, 67600
s_add_u32 s28, s29, 33792
buffer_load_dwordx4 v0, s[12:15], s28 offen lds
s_add_u32 m0, s36, 68640
s_add_u32 s28, s29, 66560
buffer_load_dwordx4 v0, s[12:15], s28 offen lds
s_add_u32 m0, s36, 69680
s_add_u32 s28, s29, 99328
buffer_load_dwordx4 v0, s[12:15], s28 offen lds
s_add_u32 m0, s36, 70720
s_add_u32 s28, s29, 525312
buffer_load_dwordx4 v0, s[12:15], s28 offen lds
s_add_u32 m0, s36, 71760
s_add_u32 s28, s29, 558080
buffer_load_dwordx4 v0, s[12:15], s28 offen lds
s_add_u32 m0, s36, 72800
s_add_u32 s28, s29, 590848
buffer_load_dwordx4 v0, s[12:15], s28 offen lds
s_add_u32 m0, s36, 73840
s_add_u32 s28, s29, 623616
buffer_load_dwordx4 v0, s[12:15], s28 offen lds
s_add_u32 m0, s36, 74880
s_add_u32 s28, s29, 132096
buffer_load_dwordx4 v0, s[12:15], s28 offen lds
s_add_u32 m0, s36, 75920
s_add_u32 s28, s29, 164864
buffer_load_dwordx4 v0, s[12:15], s28 offen lds
s_add_u32 m0, s36, 76960
s_add_u32 s28, s29, 197632
buffer_load_dwordx4 v0, s[12:15], s28 offen lds
s_add_u32 m0, s36, 78000
s_add_u32 s28, s29, 230400
buffer_load_dwordx4 v0, s[12:15], s28 offen lds
s_add_u32 m0, s36, 79040
s_add_u32 s28, s29, 656384
buffer_load_dwordx4 v0, s[12:15], s28 offen lds
s_add_u32 m0, s36, 80080
s_add_u32 s28, s29, 689152
buffer_load_dwordx4 v0, s[12:15], s28 offen lds
s_add_u32 m0, s36, 81120
s_add_u32 s28, s29, 721920
buffer_load_dwordx4 v0, s[12:15], s28 offen lds
s_add_u32 m0, s36, 82160
s_add_u32 s28, s29, 754688
buffer_load_dwordx4 v0, s[12:15], s28 offen lds
v_bfe_u32 v1, v51, 0, 5
v_mul_u32_u24 v1, 1040, v1
v_bfe_u32 v50, v51, 5, 1
v_lshl_add_u32 v1, v50, 4, v1
s_lshl_b32 s28, s21, 7
v_bfe_u32 v49, v51, 0, 5
v_bfe_u32 v50, v51, 6, 2
v_lshl_add_u32 v49, v50, 5, v49
v_add_u32 v49, s28, v49
s_lshl_b32 s28, s22, 8
s_add_u32 s28, s28, 100663296
v_bfe_u32 v2, v51, 5, 1
v_lshlrev_b32 v2, 5, v2
v_add_u32 v2, s28, v2
v_mul_u32_u24 v48, 4224, v49
v_add_u32 v2, v48, v2
v_cmp_lt_u32 vcc, 256, v49
v_subrev_u32 v48, 256, v49
s_nop 0
v_cndmask_b32 v49, v49, v48, vcc
v_mov_b32 v48, 1048576000
v_cndmask_b32 v4, 0, v48, vcc
v_cvt_f32_u32 v3, v49
v_mul_f32 v3, 989855744, v3
v_bfe_u32 v49, v51, 5, 1
v_lshlrev_b32 v49, 3, v49
v_cvt_f32_u32 v49, v49
v_fmac_f32 v4, v49, v3
v_fmamk_f32 v8, v3, 0, v4
v_fmamk_f32 v9, v3, 1065353216, v4
v_cos_f32 v8, v8
v_cos_f32 v9, v9
v_fmamk_f32 v5, v3, 1073741824, v4
v_fmamk_f32 v6, v3, 1077936128, v4
v_cos_f32 v5, v5
v_cos_f32 v6, v6
v_cvt_pk_bf16_f32 v128, v8, v9
v_fmamk_f32 v8, v3, 1082130432, v4
v_fmamk_f32 v9, v3, 1084227584, v4
v_cos_f32 v8, v8
v_cos_f32 v9, v9
v_cvt_pk_bf16_f32 v129, v5, v6
v_fmamk_f32 v5, v3, 1086324736, v4
v_fmamk_f32 v6, v3, 1088421888, v4
v_cos_f32 v5, v5
v_cos_f32 v6, v6
v_cvt_pk_bf16_f32 v130, v8, v9
v_fmamk_f32 v8, v3, 1098907648, v4
v_fmamk_f32 v9, v3, 1099431936, v4
v_cos_f32 v8, v8
v_cos_f32 v9, v9
v_cvt_pk_bf16_f32 v131, v5, v6
v_fmamk_f32 v5, v3, 1099956224, v4
v_fmamk_f32 v6, v3, 1100480512, v4
v_cos_f32 v5, v5
v_cos_f32 v6, v6
v_cvt_pk_bf16_f32 v132, v8, v9
v_fmamk_f32 v8, v3, 1101004800, v4
v_fmamk_f32 v9, v3, 1101529088, v4
v_cos_f32 v8, v8
v_cos_f32 v9, v9
v_cvt_pk_bf16_f32 v133, v5, v6
v_fmamk_f32 v5, v3, 1102053376, v4
v_fmamk_f32 v6, v3, 1102577664, v4
v_cos_f32 v5, v5
v_cos_f32 v6, v6
v_cvt_pk_bf16_f32 v134, v8, v9
v_fmamk_f32 v8, v3, 1107296256, v4
v_fmamk_f32 v9, v3, 1107558400, v4
v_cos_f32 v8, v8
v_cos_f32 v9, v9
v_cvt_pk_bf16_f32 v135, v5, v6
v_fmamk_f32 v5, v3, 1107820544, v4
v_fmamk_f32 v6, v3, 1108082688, v4
v_cos_f32 v5, v5
v_cos_f32 v6, v6
v_cvt_pk_bf16_f32 v136, v8, v9
v_fmamk_f32 v8, v3, 1108344832, v4
v_fmamk_f32 v9, v3, 1108606976, v4
v_cos_f32 v8, v8
v_cos_f32 v9, v9
v_cvt_pk_bf16_f32 v137, v5, v6
v_fmamk_f32 v5, v3, 1108869120, v4
v_fmamk_f32 v6, v3, 1109131264, v4
v_cos_f32 v5, v5
v_cos_f32 v6, v6
v_cvt_pk_bf16_f32 v138, v8, v9
v_fmamk_f32 v8, v3, 1111490560, v4
v_fmamk_f32 v9, v3, 1111752704, v4
v_cos_f32 v8, v8
v_cos_f32 v9, v9
v_cvt_pk_bf16_f32 v139, v5, v6
v_fmamk_f32 v5, v3, 1112014848, v4
v_fmamk_f32 v6, v3, 1112276992, v4
v_cos_f32 v5, v5
v_cos_f32 v6, v6
v_cvt_pk_bf16_f32 v140, v8, v9
v_fmamk_f32 v8, v3, 1112539136, v4
v_fmamk_f32 v9, v3, 1112801280, v4
v_cos_f32 v8, v8
v_cos_f32 v9, v9
v_cvt_pk_bf16_f32 v141, v5, v6
v_fmamk_f32 v5, v3, 1113063424, v4
v_fmamk_f32 v6, v3, 1113325568, v4
v_cos_f32 v5, v5
v_cos_f32 v6, v6
v_cvt_pk_bf16_f32 v142, v8, v9
v_fmamk_f32 v8, v3, 1115684864, v4
v_fmamk_f32 v9, v3, 1115815936, v4
v_cos_f32 v8, v8
v_cos_f32 v9, v9
v_cvt_pk_bf16_f32 v143, v5, v6
v_fmamk_f32 v5, v3, 1115947008, v4
v_fmamk_f32 v6, v3, 1116078080, v4
v_cos_f32 v5, v5
v_cos_f32 v6, v6
v_cvt_pk_bf16_f32 v144, v8, v9
v_fmamk_f32 v8, v3, 1116209152, v4
v_fmamk_f32 v9, v3, 1116340224, v4
v_cos_f32 v8, v8
v_cos_f32 v9, v9
v_cvt_pk_bf16_f32 v145, v5, v6
v_fmamk_f32 v5, v3, 1116471296, v4
v_fmamk_f32 v6, v3, 1116602368, v4
v_cos_f32 v5, v5
v_cos_f32 v6, v6
v_cvt_pk_bf16_f32 v146, v8, v9
v_fmamk_f32 v8, v3, 1117782016, v4
v_fmamk_f32 v9, v3, 1117913088, v4
v_cos_f32 v8, v8
v_cos_f32 v9, v9
v_cvt_pk_bf16_f32 v147, v5, v6
v_fmamk_f32 v5, v3, 1118044160, v4
v_fmamk_f32 v6, v3, 1118175232, v4
v_cos_f32 v5, v5
v_cos_f32 v6, v6
v_cvt_pk_bf16_f32 v148, v8, v9
v_fmamk_f32 v8, v3, 1118306304, v4
v_fmamk_f32 v9, v3, 1118437376, v4
v_cos_f32 v8, v8
v_cos_f32 v9, v9
v_cvt_pk_bf16_f32 v149, v5, v6
v_fmamk_f32 v5, v3, 1118568448, v4
v_fmamk_f32 v6, v3, 1118699520, v4
v_cos_f32 v5, v5
v_cos_f32 v6, v6
v_cvt_pk_bf16_f32 v150, v8, v9
v_fmamk_f32 v8, v3, 1119879168, v4
v_fmamk_f32 v9, v3, 1120010240, v4
v_cos_f32 v8, v8
v_cos_f32 v9, v9
v_cvt_pk_bf16_f32 v151, v5, v6
v_fmamk_f32 v5, v3, 1120141312, v4
v_fmamk_f32 v6, v3, 1120272384, v4
v_cos_f32 v5, v5
v_cos_f32 v6, v6
v_cvt_pk_bf16_f32 v152, v8, v9
v_fmamk_f32 v8, v3, 1120403456, v4
v_fmamk_f32 v9, v3, 1120534528, v4
v_cos_f32 v8, v8
v_cos_f32 v9, v9
v_cvt_pk_bf16_f32 v153, v5, v6
v_fmamk_f32 v5, v3, 1120665600, v4
v_fmamk_f32 v6, v3, 1120796672, v4
v_cos_f32 v5, v5
v_cos_f32 v6, v6
v_cvt_pk_bf16_f32 v154, v8, v9
v_fmamk_f32 v8, v3, 1121976320, v4
v_fmamk_f32 v9, v3, 1122107392, v4
v_cos_f32 v8, v8
v_cos_f32 v9, v9
v_cvt_pk_bf16_f32 v155, v5, v6
v_fmamk_f32 v5, v3, 1122238464, v4
v_fmamk_f32 v6, v3, 1122369536, v4
v_cos_f32 v5, v5
v_cos_f32 v6, v6
v_cvt_pk_bf16_f32 v156, v8, v9
v_fmamk_f32 v8, v3, 1122500608, v4
v_fmamk_f32 v9, v3, 1122631680, v4
v_cos_f32 v8, v8
v_cos_f32 v9, v9
v_cvt_pk_bf16_f32 v157, v5, v6
v_fmamk_f32 v5, v3, 1122762752, v4
v_fmamk_f32 v6, v3, 1122893824, v4
v_cos_f32 v5, v5
v_cos_f32 v6, v6
v_cvt_pk_bf16_f32 v158, v8, v9
v_fmamk_f32 v8, v3, 1124073472, v4
v_fmamk_f32 v9, v3, 1124139008, v4
v_cos_f32 v8, v8
v_cos_f32 v9, v9
v_cvt_pk_bf16_f32 v159, v5, v6
v_fmamk_f32 v5, v3, 1124204544, v4
v_fmamk_f32 v6, v3, 1124270080, v4
v_cos_f32 v5, v5
v_cos_f32 v6, v6
v_cvt_pk_bf16_f32 v160, v8, v9
v_fmamk_f32 v8, v3, 1124335616, v4
v_fmamk_f32 v9, v3, 1124401152, v4
v_cos_f32 v8, v8
v_cos_f32 v9, v9
v_cvt_pk_bf16_f32 v161, v5, v6
v_fmamk_f32 v5, v3, 1124466688, v4
v_fmamk_f32 v6, v3, 1124532224, v4
v_cos_f32 v5, v5
v_cos_f32 v6, v6
v_cvt_pk_bf16_f32 v162, v8, v9
v_fmamk_f32 v8, v3, 1125122048, v4
v_fmamk_f32 v9, v3, 1125187584, v4
v_cos_f32 v8, v8
v_cos_f32 v9, v9
v_cvt_pk_bf16_f32 v163, v5, v6
v_fmamk_f32 v5, v3, 1125253120, v4
v_fmamk_f32 v6, v3, 1125318656, v4
v_cos_f32 v5, v5
v_cos_f32 v6, v6
v_cvt_pk_bf16_f32 v164, v8, v9
v_fmamk_f32 v8, v3, 1125384192, v4
v_fmamk_f32 v9, v3, 1125449728, v4
v_cos_f32 v8, v8
v_cos_f32 v9, v9
v_cvt_pk_bf16_f32 v165, v5, v6
v_fmamk_f32 v5, v3, 1125515264, v4
v_fmamk_f32 v6, v3, 1125580800, v4
v_cos_f32 v5, v5
v_cos_f32 v6, v6
v_cvt_pk_bf16_f32 v166, v8, v9
v_fmamk_f32 v8, v3, 1126170624, v4
v_fmamk_f32 v9, v3, 1126236160, v4
v_cos_f32 v8, v8
v_cos_f32 v9, v9
v_cvt_pk_bf16_f32 v167, v5, v6
v_fmamk_f32 v5, v3, 1126301696, v4
v_fmamk_f32 v6, v3, 1126367232, v4
v_cos_f32 v5, v5
v_cos_f32 v6, v6
v_cvt_pk_bf16_f32 v168, v8, v9
v_fmamk_f32 v8, v3, 1126432768, v4
v_fmamk_f32 v9, v3, 1126498304, v4
v_cos_f32 v8, v8
v_cos_f32 v9, v9
v_cvt_pk_bf16_f32 v169, v5, v6
v_fmamk_f32 v5, v3, 1126563840, v4
v_fmamk_f32 v6, v3, 1126629376, v4
v_cos_f32 v5, v5
v_cos_f32 v6, v6
v_cvt_pk_bf16_f32 v170, v8, v9
v_fmamk_f32 v8, v3, 1127219200, v4
v_fmamk_f32 v9, v3, 1127284736, v4
v_cos_f32 v8, v8
v_cos_f32 v9, v9
v_cvt_pk_bf16_f32 v171, v5, v6
v_fmamk_f32 v5, v3, 1127350272, v4
v_fmamk_f32 v6, v3, 1127415808, v4
v_cos_f32 v5, v5
v_cos_f32 v6, v6
v_cvt_pk_bf16_f32 v172, v8, v9
v_fmamk_f32 v8, v3, 1127481344, v4
v_fmamk_f32 v9, v3, 1127546880, v4
v_cos_f32 v8, v8
v_cos_f32 v9, v9
v_cvt_pk_bf16_f32 v173, v5, v6
v_fmamk_f32 v5, v3, 1127612416, v4
v_fmamk_f32 v6, v3, 1127677952, v4
v_cos_f32 v5, v5
v_cos_f32 v6, v6
v_cvt_pk_bf16_f32 v174, v8, v9
v_fmamk_f32 v8, v3, 1128267776, v4
v_fmamk_f32 v9, v3, 1128333312, v4
v_cos_f32 v8, v8
v_cos_f32 v9, v9
v_cvt_pk_bf16_f32 v175, v5, v6
v_fmamk_f32 v5, v3, 1128398848, v4
v_fmamk_f32 v6, v3, 1128464384, v4
v_cos_f32 v5, v5
v_cos_f32 v6, v6
v_cvt_pk_bf16_f32 v176, v8, v9
v_fmamk_f32 v8, v3, 1128529920, v4
v_fmamk_f32 v9, v3, 1128595456, v4
v_cos_f32 v8, v8
v_cos_f32 v9, v9
v_cvt_pk_bf16_f32 v177, v5, v6
v_fmamk_f32 v5, v3, 1128660992, v4
v_fmamk_f32 v6, v3, 1128726528, v4
v_cos_f32 v5, v5
v_cos_f32 v6, v6
v_cvt_pk_bf16_f32 v178, v8, v9
v_fmamk_f32 v8, v3, 1129316352, v4
v_fmamk_f32 v9, v3, 1129381888, v4
v_cos_f32 v8, v8
v_cos_f32 v9, v9
v_cvt_pk_bf16_f32 v179, v5, v6
v_fmamk_f32 v5, v3, 1129447424, v4
v_fmamk_f32 v6, v3, 1129512960, v4
v_cos_f32 v5, v5
v_cos_f32 v6, v6
v_cvt_pk_bf16_f32 v180, v8, v9
v_fmamk_f32 v8, v3, 1129578496, v4
v_fmamk_f32 v9, v3, 1129644032, v4
v_cos_f32 v8, v8
v_cos_f32 v9, v9
v_cvt_pk_bf16_f32 v181, v5, v6
v_fmamk_f32 v5, v3, 1129709568, v4
v_fmamk_f32 v6, v3, 1129775104, v4
v_cos_f32 v5, v5
v_cos_f32 v6, v6
v_cvt_pk_bf16_f32 v182, v8, v9
v_fmamk_f32 v8, v3, 1130364928, v4
v_fmamk_f32 v9, v3, 1130430464, v4
v_cos_f32 v8, v8
v_cos_f32 v9, v9
v_cvt_pk_bf16_f32 v183, v5, v6
v_fmamk_f32 v5, v3, 1130496000, v4
v_fmamk_f32 v6, v3, 1130561536, v4
v_cos_f32 v5, v5
v_cos_f32 v6, v6
v_cvt_pk_bf16_f32 v184, v8, v9
v_fmamk_f32 v8, v3, 1130627072, v4
v_fmamk_f32 v9, v3, 1130692608, v4
v_cos_f32 v8, v8
v_cos_f32 v9, v9
v_cvt_pk_bf16_f32 v185, v5, v6
v_fmamk_f32 v5, v3, 1130758144, v4
v_fmamk_f32 v6, v3, 1130823680, v4
v_cos_f32 v5, v5
v_cos_f32 v6, v6
v_cvt_pk_bf16_f32 v186, v8, v9
v_fmamk_f32 v8, v3, 1131413504, v4
v_fmamk_f32 v9, v3, 1131479040, v4
v_cos_f32 v8, v8
v_cos_f32 v9, v9
v_cvt_pk_bf16_f32 v187, v5, v6
v_fmamk_f32 v5, v3, 1131544576, v4
v_fmamk_f32 v6, v3, 1131610112, v4
v_cos_f32 v5, v5
v_cos_f32 v6, v6
v_cvt_pk_bf16_f32 v188, v8, v9
v_fmamk_f32 v8, v3, 1131675648, v4
v_fmamk_f32 v9, v3, 1131741184, v4
v_cos_f32 v8, v8
v_cos_f32 v9, v9
v_cvt_pk_bf16_f32 v189, v5, v6
v_fmamk_f32 v5, v3, 1131806720, v4
v_fmamk_f32 v6, v3, 1131872256, v4
v_cos_f32 v5, v5
v_cos_f32 v6, v6
v_cvt_pk_bf16_f32 v190, v8, v9
v_fmamk_f32 v8, v3, 1132462080, v4
v_fmamk_f32 v9, v3, 1132494848, v4
v_cos_f32 v8, v8
v_cos_f32 v9, v9
v_cvt_pk_bf16_f32 v191, v5, v6
v_fmamk_f32 v5, v3, 1132527616, v4
v_fmamk_f32 v6, v3, 1132560384, v4
v_cos_f32 v5, v5
v_cos_f32 v6, v6
v_cvt_pk_bf16_f32 v192, v8, v9
v_fmamk_f32 v8, v3, 1132593152, v4
v_fmamk_f32 v9, v3, 1132625920, v4
v_cos_f32 v8, v8
v_cos_f32 v9, v9
v_cvt_pk_bf16_f32 v193, v5, v6
v_fmamk_f32 v5, v3, 1132658688, v4
v_fmamk_f32 v6, v3, 1132691456, v4
v_cos_f32 v5, v5
v_cos_f32 v6, v6
v_cvt_pk_bf16_f32 v194, v8, v9
v_fmamk_f32 v8, v3, 1132986368, v4
v_fmamk_f32 v9, v3, 1133019136, v4
v_cos_f32 v8, v8
v_cos_f32 v9, v9
v_cvt_pk_bf16_f32 v195, v5, v6
v_fmamk_f32 v5, v3, 1133051904, v4
v_fmamk_f32 v6, v3, 1133084672, v4
v_cos_f32 v5, v5
v_cos_f32 v6, v6
v_cvt_pk_bf16_f32 v196, v8, v9
v_fmamk_f32 v8, v3, 1133117440, v4
v_fmamk_f32 v9, v3, 1133150208, v4
v_cos_f32 v8, v8
v_cos_f32 v9, v9
v_cvt_pk_bf16_f32 v197, v5, v6
v_fmamk_f32 v5, v3, 1133182976, v4
v_fmamk_f32 v6, v3, 1133215744, v4
v_cos_f32 v5, v5
v_cos_f32 v6, v6
v_cvt_pk_bf16_f32 v198, v8, v9
v_fmamk_f32 v8, v3, 1133510656, v4
v_fmamk_f32 v9, v3, 1133543424, v4
v_cos_f32 v8, v8
v_cos_f32 v9, v9
v_cvt_pk_bf16_f32 v199, v5, v6
v_fmamk_f32 v5, v3, 1133576192, v4
v_fmamk_f32 v6, v3, 1133608960, v4
v_cos_f32 v5, v5
v_cos_f32 v6, v6
v_cvt_pk_bf16_f32 v200, v8, v9
v_fmamk_f32 v8, v3, 1133641728, v4
v_fmamk_f32 v9, v3, 1133674496, v4
v_cos_f32 v8, v8
v_cos_f32 v9, v9
v_cvt_pk_bf16_f32 v201, v5, v6
v_fmamk_f32 v5, v3, 1133707264, v4
v_fmamk_f32 v6, v3, 1133740032, v4
v_cos_f32 v5, v5
v_cos_f32 v6, v6
v_cvt_pk_bf16_f32 v202, v8, v9
v_fmamk_f32 v8, v3, 1134034944, v4
v_fmamk_f32 v9, v3, 1134067712, v4
v_cos_f32 v8, v8
v_cos_f32 v9, v9
v_cvt_pk_bf16_f32 v203, v5, v6
v_fmamk_f32 v5, v3, 1134100480, v4
v_fmamk_f32 v6, v3, 1134133248, v4
v_cos_f32 v5, v5
v_cos_f32 v6, v6
v_cvt_pk_bf16_f32 v204, v8, v9
v_fmamk_f32 v8, v3, 1134166016, v4
v_fmamk_f32 v9, v3, 1134198784, v4
v_cos_f32 v8, v8
v_cos_f32 v9, v9
v_cvt_pk_bf16_f32 v205, v5, v6
v_fmamk_f32 v5, v3, 1134231552, v4
v_fmamk_f32 v6, v3, 1134264320, v4
v_cos_f32 v5, v5
v_cos_f32 v6, v6
v_cvt_pk_bf16_f32 v206, v8, v9
v_fmamk_f32 v8, v3, 1134559232, v4
v_fmamk_f32 v9, v3, 1134592000, v4
v_cos_f32 v8, v8
v_cos_f32 v9, v9
v_cvt_pk_bf16_f32 v207, v5, v6
v_fmamk_f32 v5, v3, 1134624768, v4
v_fmamk_f32 v6, v3, 1134657536, v4
v_cos_f32 v5, v5
v_cos_f32 v6, v6
v_cvt_pk_bf16_f32 v208, v8, v9
v_fmamk_f32 v8, v3, 1134690304, v4
v_fmamk_f32 v9, v3, 1134723072, v4
v_cos_f32 v8, v8
v_cos_f32 v9, v9
v_cvt_pk_bf16_f32 v209, v5, v6
v_fmamk_f32 v5, v3, 1134755840, v4
v_fmamk_f32 v6, v3, 1134788608, v4
v_cos_f32 v5, v5
v_cos_f32 v6, v6
v_cvt_pk_bf16_f32 v210, v8, v9
v_fmamk_f32 v8, v3, 1135083520, v4
v_fmamk_f32 v9, v3, 1135116288, v4
v_cos_f32 v8, v8
v_cos_f32 v9, v9
v_cvt_pk_bf16_f32 v211, v5, v6
v_fmamk_f32 v5, v3, 1135149056, v4
v_fmamk_f32 v6, v3, 1135181824, v4
v_cos_f32 v5, v5
v_cos_f32 v6, v6
v_cvt_pk_bf16_f32 v212, v8, v9
v_fmamk_f32 v8, v3, 1135214592, v4
v_fmamk_f32 v9, v3, 1135247360, v4
v_cos_f32 v8, v8
v_cos_f32 v9, v9
v_cvt_pk_bf16_f32 v213, v5, v6
v_fmamk_f32 v5, v3, 1135280128, v4
v_fmamk_f32 v6, v3, 1135312896, v4
v_cos_f32 v5, v5
v_cos_f32 v6, v6
v_cvt_pk_bf16_f32 v214, v8, v9
v_fmamk_f32 v8, v3, 1135607808, v4
v_fmamk_f32 v9, v3, 1135640576, v4
v_cos_f32 v8, v8
v_cos_f32 v9, v9
v_cvt_pk_bf16_f32 v215, v5, v6
v_fmamk_f32 v5, v3, 1135673344, v4
v_fmamk_f32 v6, v3, 1135706112, v4
v_cos_f32 v5, v5
v_cos_f32 v6, v6
v_cvt_pk_bf16_f32 v216, v8, v9
v_fmamk_f32 v8, v3, 1135738880, v4
v_fmamk_f32 v9, v3, 1135771648, v4
v_cos_f32 v8, v8
v_cos_f32 v9, v9
v_cvt_pk_bf16_f32 v217, v5, v6
v_fmamk_f32 v5, v3, 1135804416, v4
v_fmamk_f32 v6, v3, 1135837184, v4
v_cos_f32 v5, v5
v_cos_f32 v6, v6
v_cvt_pk_bf16_f32 v218, v8, v9
v_fmamk_f32 v8, v3, 1136132096, v4
v_fmamk_f32 v9, v3, 1136164864, v4
v_cos_f32 v8, v8
v_cos_f32 v9, v9
v_cvt_pk_bf16_f32 v219, v5, v6
v_fmamk_f32 v5, v3, 1136197632, v4
v_fmamk_f32 v6, v3, 1136230400, v4
v_cos_f32 v5, v5
v_cos_f32 v6, v6
v_cvt_pk_bf16_f32 v220, v8, v9
v_fmamk_f32 v8, v3, 1136263168, v4
v_fmamk_f32 v9, v3, 1136295936, v4
v_cos_f32 v8, v8
v_cos_f32 v9, v9
v_cvt_pk_bf16_f32 v221, v5, v6
v_fmamk_f32 v5, v3, 1136328704, v4
v_fmamk_f32 v6, v3, 1136361472, v4
v_cos_f32 v5, v5
v_cos_f32 v6, v6
v_cvt_pk_bf16_f32 v222, v8, v9
v_fmamk_f32 v8, v3, 1136656384, v4
v_fmamk_f32 v9, v3, 1136689152, v4
v_cos_f32 v8, v8
v_cos_f32 v9, v9
v_cvt_pk_bf16_f32 v223, v5, v6
v_fmamk_f32 v5, v3, 1136721920, v4
v_fmamk_f32 v6, v3, 1136754688, v4
v_cos_f32 v5, v5
v_cos_f32 v6, v6
v_cvt_pk_bf16_f32 v224, v8, v9
v_fmamk_f32 v8, v3, 1136787456, v4
v_fmamk_f32 v9, v3, 1136820224, v4
v_cos_f32 v8, v8
v_cos_f32 v9, v9
v_cvt_pk_bf16_f32 v225, v5, v6
v_fmamk_f32 v5, v3, 1136852992, v4
v_fmamk_f32 v6, v3, 1136885760, v4
v_cos_f32 v5, v5
v_cos_f32 v6, v6
v_cvt_pk_bf16_f32 v226, v8, v9
v_fmamk_f32 v8, v3, 1137180672, v4
v_fmamk_f32 v9, v3, 1137213440, v4
v_cos_f32 v8, v8
v_cos_f32 v9, v9
v_cvt_pk_bf16_f32 v227, v5, v6
v_fmamk_f32 v5, v3, 1137246208, v4
v_fmamk_f32 v6, v3, 1137278976, v4
v_cos_f32 v5, v5
v_cos_f32 v6, v6
v_cvt_pk_bf16_f32 v228, v8, v9
v_fmamk_f32 v8, v3, 1137311744, v4
v_fmamk_f32 v9, v3, 1137344512, v4
v_cos_f32 v8, v8
v_cos_f32 v9, v9
v_cvt_pk_bf16_f32 v229, v5, v6
v_fmamk_f32 v5, v3, 1137377280, v4
v_fmamk_f32 v6, v3, 1137410048, v4
v_cos_f32 v5, v5
v_cos_f32 v6, v6
v_cvt_pk_bf16_f32 v230, v8, v9
v_fmamk_f32 v8, v3, 1137704960, v4
v_fmamk_f32 v9, v3, 1137737728, v4
v_cos_f32 v8, v8
v_cos_f32 v9, v9
v_cvt_pk_bf16_f32 v231, v5, v6
v_fmamk_f32 v5, v3, 1137770496, v4
v_fmamk_f32 v6, v3, 1137803264, v4
v_cos_f32 v5, v5
v_cos_f32 v6, v6
v_cvt_pk_bf16_f32 v232, v8, v9
v_fmamk_f32 v8, v3, 1137836032, v4
v_fmamk_f32 v9, v3, 1137868800, v4
v_cos_f32 v8, v8
v_cos_f32 v9, v9
v_cvt_pk_bf16_f32 v233, v5, v6
v_fmamk_f32 v5, v3, 1137901568, v4
v_fmamk_f32 v6, v3, 1137934336, v4
v_cos_f32 v5, v5
v_cos_f32 v6, v6
v_cvt_pk_bf16_f32 v234, v8, v9
v_fmamk_f32 v8, v3, 1138229248, v4
v_fmamk_f32 v9, v3, 1138262016, v4
v_cos_f32 v8, v8
v_cos_f32 v9, v9
v_cvt_pk_bf16_f32 v235, v5, v6
v_fmamk_f32 v5, v3, 1138294784, v4
v_fmamk_f32 v6, v3, 1138327552, v4
v_cos_f32 v5, v5
v_cos_f32 v6, v6
v_cvt_pk_bf16_f32 v236, v8, v9
v_fmamk_f32 v8, v3, 1138360320, v4
v_fmamk_f32 v9, v3, 1138393088, v4
v_cos_f32 v8, v8
v_cos_f32 v9, v9
v_cvt_pk_bf16_f32 v237, v5, v6
v_fmamk_f32 v5, v3, 1138425856, v4
v_fmamk_f32 v6, v3, 1138458624, v4
v_cos_f32 v5, v5
v_cos_f32 v6, v6
v_cvt_pk_bf16_f32 v238, v8, v9
v_fmamk_f32 v8, v3, 1138753536, v4
v_fmamk_f32 v9, v3, 1138786304, v4
v_cos_f32 v8, v8
v_cos_f32 v9, v9
v_cvt_pk_bf16_f32 v239, v5, v6
v_fmamk_f32 v5, v3, 1138819072, v4
v_fmamk_f32 v6, v3, 1138851840, v4
v_cos_f32 v5, v5
v_cos_f32 v6, v6
v_cvt_pk_bf16_f32 v240, v8, v9
v_fmamk_f32 v8, v3, 1138884608, v4
v_fmamk_f32 v9, v3, 1138917376, v4
v_cos_f32 v8, v8
v_cos_f32 v9, v9
v_cvt_pk_bf16_f32 v241, v5, v6
v_fmamk_f32 v5, v3, 1138950144, v4
v_fmamk_f32 v6, v3, 1138982912, v4
v_cos_f32 v5, v5
v_cos_f32 v6, v6
v_cvt_pk_bf16_f32 v242, v8, v9
v_fmamk_f32 v8, v3, 1139277824, v4
v_fmamk_f32 v9, v3, 1139310592, v4
v_cos_f32 v8, v8
v_cos_f32 v9, v9
v_cvt_pk_bf16_f32 v243, v5, v6
v_fmamk_f32 v5, v3, 1139343360, v4
v_fmamk_f32 v6, v3, 1139376128, v4
v_cos_f32 v5, v5
v_cos_f32 v6, v6
v_cvt_pk_bf16_f32 v244, v8, v9
v_fmamk_f32 v8, v3, 1139408896, v4
v_fmamk_f32 v9, v3, 1139441664, v4
v_cos_f32 v8, v8
v_cos_f32 v9, v9
v_cvt_pk_bf16_f32 v245, v5, v6
v_fmamk_f32 v5, v3, 1139474432, v4
v_fmamk_f32 v6, v3, 1139507200, v4
v_cos_f32 v5, v5
v_cos_f32 v6, v6
v_cvt_pk_bf16_f32 v246, v8, v9
v_fmamk_f32 v8, v3, 1139802112, v4
v_fmamk_f32 v9, v3, 1139834880, v4
v_cos_f32 v8, v8
v_cos_f32 v9, v9
v_cvt_pk_bf16_f32 v247, v5, v6
v_fmamk_f32 v5, v3, 1139867648, v4
v_fmamk_f32 v6, v3, 1139900416, v4
v_cos_f32 v5, v5
v_cos_f32 v6, v6
v_cvt_pk_bf16_f32 v248, v8, v9
v_fmamk_f32 v8, v3, 1139933184, v4
v_fmamk_f32 v9, v3, 1139965952, v4
v_cos_f32 v8, v8
v_cos_f32 v9, v9
v_cvt_pk_bf16_f32 v249, v5, v6
v_fmamk_f32 v5, v3, 1139998720, v4
v_fmamk_f32 v6, v3, 1140031488, v4
v_cos_f32 v5, v5
v_cos_f32 v6, v6
v_cvt_pk_bf16_f32 v250, v8, v9
v_fmamk_f32 v8, v3, 1140326400, v4
v_fmamk_f32 v9, v3, 1140359168, v4
v_cos_f32 v8, v8
v_cos_f32 v9, v9
v_cvt_pk_bf16_f32 v251, v5, v6
v_fmamk_f32 v5, v3, 1140391936, v4
v_fmamk_f32 v6, v3, 1140424704, v4
v_cos_f32 v5, v5
v_cos_f32 v6, v6
v_cvt_pk_bf16_f32 v252, v8, v9
v_fmamk_f32 v8, v3, 1140457472, v4
v_fmamk_f32 v9, v3, 1140490240, v4
v_cos_f32 v8, v8
v_cos_f32 v9, v9
v_cvt_pk_bf16_f32 v253, v5, v6
v_fmamk_f32 v5, v3, 1140523008, v4
v_fmamk_f32 v6, v3, 1140555776, v4
v_cos_f32 v5, v5
v_cos_f32 v6, v6
v_cvt_pk_bf16_f32 v254, v8, v9
v_cvt_pk_bf16_f32 v255, v5, v6
s_waitcnt vmcnt(0) lgkmcnt(0)
s_barrier
s_mov_b32 s20, 0
Lf_bl:
ds_read_b128 v[16:19], v1 offset:0
ds_read_b128 v[20:23], v1 offset:33280
ds_read_b128 v[24:27], v1 offset:32
ds_read_b128 v[28:31], v1 offset:33312
ds_read_b128 v[32:35], v1 offset:64
ds_read_b128 v[36:39], v1 offset:33344
s_waitcnt lgkmcnt(5)
v_mfma_f32_32x32x16_bf16 v[64:79], v[16:19], v[128:131], 0
ds_read_b128 v[40:43], v1 offset:96
s_waitcnt lgkmcnt(5)
v_mfma_f32_32x32x16_bf16 v[80:95], v[20:23], v[128:131], 0
ds_read_b128 v[44:47], v1 offset:33376
s_waitcnt lgkmcnt(5)
v_mfma_f32_32x32x16_bf16 v[64:79], v[24:27], v[132:135], v[64:79]
ds_read_b128 v[16:19], v1 offset:128
s_waitcnt lgkmcnt(5)
v_mfma_f32_32x32x16_bf16 v[80:95], v[28:31], v[132:135], v[80:95]
ds_read_b128 v[20:23], v1 offset:33408
s_waitcnt lgkmcnt(5)
v_mfma_f32_32x32x16_bf16 v[64:79], v[32:35], v[136:139], v[64:79]
ds_read_b128 v[24:27], v1 offset:160
s_waitcnt lgkmcnt(5)
v_mfma_f32_32x32x16_bf16 v[80:95], v[36:39], v[136:139], v[80:95]
ds_read_b128 v[28:31], v1 offset:33440
s_waitcnt lgkmcnt(5)
v_mfma_f32_32x32x16_bf16 v[64:79], v[40:43], v[140:143], v[64:79]
ds_read_b128 v[32:35], v1 offset:192
s_waitcnt lgkmcnt(5)
v_mfma_f32_32x32x16_bf16 v[80:95], v[44:47], v[140:143], v[80:95]
ds_read_b128 v[36:39], v1 offset:33472
s_waitcnt lgkmcnt(5)
v_mfma_f32_32x32x16_bf16 v[64:79], v[16:19], v[144:147], v[64:79]
ds_read_b128 v[40:43], v1 offset:224
s_waitcnt lgkmcnt(5)
v_mfma_f32_32x32x16_bf16 v[80:95], v[20:23], v[144:147], v[80:95]
ds_read_b128 v[44:47], v1 offset:33504
s_waitcnt lgkmcnt(5)
v_mfma_f32_32x32x16_bf16 v[64:79], v[24:27], v[148:151], v[64:79]
ds_read_b128 v[16:19], v1 offset:256
s_waitcnt lgkmcnt(5)
v_mfma_f32_32x32x16_bf16 v[80:95], v[28:31], v[148:151], v[80:95]
ds_read_b128 v[20:23], v1 offset:33536
s_waitcnt lgkmcnt(5)
v_mfma_f32_32x32x16_bf16 v[64:79], v[32:35], v[152:155], v[64:79]
ds_read_b128 v[24:27], v1 offset:288
s_waitcnt lgkmcnt(5)
v_mfma_f32_32x32x16_bf16 v[80:95], v[36:39], v[152:155], v[80:95]
ds_read_b128 v[28:31], v1 offset:33568
s_waitcnt lgkmcnt(5)
v_mfma_f32_32x32x16_bf16 v[64:79], v[40:43], v[156:159], v[64:79]
ds_read_b128 v[32:35], v1 offset:320
s_waitcnt lgkmcnt(5)
v_mfma_f32_32x32x16_bf16 v[80:95], v[44:47], v[156:159], v[80:95]
ds_read_b128 v[36:39], v1 offset:33600
s_waitcnt lgkmcnt(5)
v_mfma_f32_32x32x16_bf16 v[64:79], v[16:19], v[160:163], v[64:79]
ds_read_b128 v[40:43], v1 offset:352
s_waitcnt lgkmcnt(5)
v_mfma_f32_32x32x16_bf16 v[80:95], v[20:23], v[160:163], v[80:95]
ds_read_b128 v[44:47], v1 offset:33632
s_waitcnt lgkmcnt(5)
v_mfma_f32_32x32x16_bf16 v[64:79], v[24:27], v[164:167], v[64:79]
ds_read_b128 v[16:19], v1 offset:384
s_waitcnt lgkmcnt(5)
v_mfma_f32_32x32x16_bf16 v[80:95], v[28:31], v[164:167], v[80:95]
ds_read_b128 v[20:23], v1 offset:33664
s_waitcnt lgkmcnt(5)
v_mfma_f32_32x32x16_bf16 v[64:79], v[32:35], v[168:171], v[64:79]
ds_read_b128 v[24:27], v1 offset:416
s_waitcnt lgkmcnt(5)
v_mfma_f32_32x32x16_bf16 v[80:95], v[36:39], v[168:171], v[80:95]
ds_read_b128 v[28:31], v1 offset:33696
s_waitcnt lgkmcnt(5)
v_mfma_f32_32x32x16_bf16 v[64:79], v[40:43], v[172:175], v[64:79]
ds_read_b128 v[32:35], v1 offset:448
s_waitcnt lgkmcnt(5)
v_mfma_f32_32x32x16_bf16 v[80:95], v[44:47], v[172:175], v[80:95]
ds_read_b128 v[36:39], v1 offset:33728
s_waitcnt lgkmcnt(5)
v_mfma_f32_32x32x16_bf16 v[64:79], v[16:19], v[176:179], v[64:79]
ds_read_b128 v[40:43], v1 offset:480
s_waitcnt lgkmcnt(5)
v_mfma_f32_32x32x16_bf16 v[80:95], v[20:23], v[176:179], v[80:95]
ds_read_b128 v[44:47], v1 offset:33760
s_waitcnt lgkmcnt(5)
v_mfma_f32_32x32x16_bf16 v[64:79], v[24:27], v[180:183], v[64:79]
ds_read_b128 v[16:19], v1 offset:512
s_waitcnt lgkmcnt(5)
v_mfma_f32_32x32x16_bf16 v[80:95], v[28:31], v[180:183], v[80:95]
ds_read_b128 v[20:23], v1 offset:33792
s_waitcnt lgkmcnt(5)
v_mfma_f32_32x32x16_bf16 v[64:79], v[32:35], v[184:187], v[64:79]
ds_read_b128 v[24:27], v1 offset:544
s_waitcnt lgkmcnt(5)
v_mfma_f32_32x32x16_bf16 v[80:95], v[36:39], v[184:187], v[80:95]
ds_read_b128 v[28:31], v1 offset:33824
s_waitcnt lgkmcnt(5)
v_mfma_f32_32x32x16_bf16 v[64:79], v[40:43], v[188:191], v[64:79]
ds_read_b128 v[32:35], v1 offset:576
s_waitcnt lgkmcnt(5)
v_mfma_f32_32x32x16_bf16 v[80:95], v[44:47], v[188:191], v[80:95]
ds_read_b128 v[36:39], v1 offset:33856
s_waitcnt lgkmcnt(5)
v_mfma_f32_32x32x16_bf16 v[64:79], v[16:19], v[192:195], v[64:79]
ds_read_b128 v[40:43], v1 offset:608
s_waitcnt lgkmcnt(5)
v_mfma_f32_32x32x16_bf16 v[80:95], v[20:23], v[192:195], v[80:95]
ds_read_b128 v[44:47], v1 offset:33888
s_waitcnt lgkmcnt(5)
v_mfma_f32_32x32x16_bf16 v[64:79], v[24:27], v[196:199], v[64:79]
ds_read_b128 v[16:19], v1 offset:640
s_waitcnt lgkmcnt(5)
v_mfma_f32_32x32x16_bf16 v[80:95], v[28:31], v[196:199], v[80:95]
ds_read_b128 v[20:23], v1 offset:33920
s_waitcnt lgkmcnt(5)
v_mfma_f32_32x32x16_bf16 v[64:79], v[32:35], v[200:203], v[64:79]
ds_read_b128 v[24:27], v1 offset:672
s_waitcnt lgkmcnt(5)
v_mfma_f32_32x32x16_bf16 v[80:95], v[36:39], v[200:203], v[80:95]
ds_read_b128 v[28:31], v1 offset:33952
s_waitcnt lgkmcnt(5)
v_mfma_f32_32x32x16_bf16 v[64:79], v[40:43], v[204:207], v[64:79]
ds_read_b128 v[32:35], v1 offset:704
s_waitcnt lgkmcnt(5)
v_mfma_f32_32x32x16_bf16 v[80:95], v[44:47], v[204:207], v[80:95]
ds_read_b128 v[36:39], v1 offset:33984
s_waitcnt lgkmcnt(5)
v_mfma_f32_32x32x16_bf16 v[64:79], v[16:19], v[208:211], v[64:79]
ds_read_b128 v[40:43], v1 offset:736
s_waitcnt lgkmcnt(5)
v_mfma_f32_32x32x16_bf16 v[80:95], v[20:23], v[208:211], v[80:95]
ds_read_b128 v[44:47], v1 offset:34016
s_waitcnt lgkmcnt(5)
v_mfma_f32_32x32x16_bf16 v[64:79], v[24:27], v[212:215], v[64:79]
ds_read_b128 v[16:19], v1 offset:768
s_waitcnt lgkmcnt(5)
v_mfma_f32_32x32x16_bf16 v[80:95], v[28:31], v[212:215], v[80:95]
ds_read_b128 v[20:23], v1 offset:34048
s_waitcnt lgkmcnt(5)
v_mfma_f32_32x32x16_bf16 v[64:79], v[32:35], v[216:219], v[64:79]
ds_read_b128 v[24:27], v1 offset:800
s_waitcnt lgkmcnt(5)
v_mfma_f32_32x32x16_bf16 v[80:95], v[36:39], v[216:219], v[80:95]
ds_read_b128 v[28:31], v1 offset:34080
s_waitcnt lgkmcnt(5)
v_mfma_f32_32x32x16_bf16 v[64:79], v[40:43], v[220:223], v[64:79]
ds_read_b128 v[32:35], v1 offset:832
s_waitcnt lgkmcnt(5)
v_mfma_f32_32x32x16_bf16 v[80:95], v[44:47], v[220:223], v[80:95]
ds_read_b128 v[36:39], v1 offset:34112
s_waitcnt lgkmcnt(5)
v_mfma_f32_32x32x16_bf16 v[64:79], v[16:19], v[224:227], v[64:79]
ds_read_b128 v[40:43], v1 offset:864
s_waitcnt lgkmcnt(5)
v_mfma_f32_32x32x16_bf16 v[80:95], v[20:23], v[224:227], v[80:95]
ds_read_b128 v[44:47], v1 offset:34144
s_waitcnt lgkmcnt(5)
v_mfma_f32_32x32x16_bf16 v[64:79], v[24:27], v[228:231], v[64:79]
ds_read_b128 v[16:19], v1 offset:896
s_waitcnt lgkmcnt(5)
v_mfma_f32_32x32x16_bf16 v[80:95], v[28:31], v[228:231], v[80:95]
ds_read_b128 v[20:23], v1 offset:34176
s_waitcnt lgkmcnt(5)
v_mfma_f32_32x32x16_bf16 v[64:79], v[32:35], v[232:235], v[64:79]
ds_read_b128 v[24:27], v1 offset:928
s_waitcnt lgkmcnt(5)
v_mfma_f32_32x32x16_bf16 v[80:95], v[36:39], v[232:235], v[80:95]
ds_read_b128 v[28:31], v1 offset:34208
s_waitcnt lgkmcnt(5)
v_mfma_f32_32x32x16_bf16 v[64:79], v[40:43], v[236:239], v[64:79]
ds_read_b128 v[32:35], v1 offset:960
s_waitcnt lgkmcnt(5)
v_mfma_f32_32x32x16_bf16 v[80:95], v[44:47], v[236:239], v[80:95]
ds_read_b128 v[36:39], v1 offset:34240
s_waitcnt lgkmcnt(5)
v_mfma_f32_32x32x16_bf16 v[64:79], v[16:19], v[240:243], v[64:79]
ds_read_b128 v[40:43], v1 offset:992
s_waitcnt lgkmcnt(5)
v_mfma_f32_32x32x16_bf16 v[80:95], v[20:23], v[240:243], v[80:95]
ds_read_b128 v[44:47], v1 offset:34272
s_waitcnt lgkmcnt(5)
v_mfma_f32_32x32x16_bf16 v[64:79], v[24:27], v[244:247], v[64:79]
s_waitcnt lgkmcnt(4)
v_mfma_f32_32x32x16_bf16 v[80:95], v[28:31], v[244:247], v[80:95]
s_waitcnt lgkmcnt(3)
v_mfma_f32_32x32x16_bf16 v[64:79], v[32:35], v[248:251], v[64:79]
s_waitcnt lgkmcnt(2)
v_mfma_f32_32x32x16_bf16 v[80:95], v[36:39], v[248:251], v[80:95]
s_waitcnt lgkmcnt(1)
v_mfma_f32_32x32x16_bf16 v[64:79], v[40:43], v[252:255], v[64:79]
s_waitcnt lgkmcnt(0)
v_mfma_f32_32x32x16_bf16 v[80:95], v[44:47], v[252:255], v[80:95]
s_nop 2
s_nop 0
v_cvt_pk_bf16_f32 v96, v64, v65
v_cvt_pk_bf16_f32 v97, v66, v67
v_cvt_pk_bf16_f32 v98, v68, v69
v_cvt_pk_bf16_f32 v99, v70, v71
v_cvt_pk_bf16_f32 v100, v72, v73
v_cvt_pk_bf16_f32 v101, v74, v75
v_cvt_pk_bf16_f32 v102, v76, v77
v_cvt_pk_bf16_f32 v103, v78, v79
s_nop 0
v_cvt_pk_bf16_f32 v104, v80, v81
v_cvt_pk_bf16_f32 v105, v82, v83
v_cvt_pk_bf16_f32 v106, v84, v85
v_cvt_pk_bf16_f32 v107, v86, v87
v_cvt_pk_bf16_f32 v108, v88, v89
v_cvt_pk_bf16_f32 v109, v90, v91
v_cvt_pk_bf16_f32 v110, v92, v93
v_cvt_pk_bf16_f32 v111, v94, v95
buffer_store_dwordx4 v[96:99], v2, s[8:11], s20 offen offset:0
buffer_store_dwordx4 v[100:103], v2, s[8:11], s20 offen offset:16
buffer_store_dwordx4 v[104:107], v2, s[8:11], s20 offen offset:64
buffer_store_dwordx4 v[108:111], v2, s[8:11], s20 offen offset:80
v_add_u32 v1, 66560, v1
s_add_u32 s20, s20, 128
s_cmp_lt_u32 s20, 256
s_cbranch_scc1 Lf_bl
s_waitcnt lgkmcnt(0)
s_barrier
s_waitcnt vmcnt(0) lgkmcnt(0)
s_barrier
s_cmp_lg_u32 s17, 0
s_cbranch_scc1 L_pb_24
buffer_wbl2 sc1
s_waitcnt vmcnt(0)
v_mov_b32 v5, 36
v_mov_b32 v6, 1
s_mov_b64 exec, 1
global_atomic_add v5, v6, s[6:7]
s_mov_b64 exec, -1
L_pb_24:
s_lshl2_add_u32 s21, s62, s17
v_mbcnt_lo_u32_b32 v51, -1, 0
v_mbcnt_hi_u32_b32 v51, -1, v51
s_lshl_b32 s28, s17, 6
v_add_u32 v51, s28, v51
v_bfe_u32 v49, v51, 4, 1
v_lshlrev_b32 v49, 4, v49
v_bfe_u32 v50, v51, 2, 1
v_lshl_add_u32 v49, v50, 3, v49
v_bfe_u32 v50, v51, 3, 1
v_lshl_add_u32 v49, v50, 2, v49
v_bfe_u32 v50, v51, 0, 2
v_lshl_add_u32 v49, v50, 0, v49
v_cvt_f32_u32 v3, v49
v_bfe_u32 v49, v51, 5, 1
v_lshlrev_b32 v49, 3, v49
v_cvt_f32_u32 v4, v49
v_add_f32 v9, 0, v3
v_mul_f32 v9, 1015021568, v9
v_mul_f32 v10, v4, v9
v_fmamk_f32 v5, v9, 0, v10
v_fmamk_f32 v6, v9, 1065353216, v10
v_cos_f32 v7, v5
v_cos_f32 v8, v6
v_sin_f32 v5, v5
v_sin_f32 v6, v6
v_cvt_pk_bf16_f32 v7, v7, v8
v_cvt_pk_bf16_f32 v5, v5, v6
v_accvgpr_write_b32 a0, v7
v_accvgpr_write_b32 a32, v5
v_xor_b32 v5, 0x80008000, v5
v_accvgpr_write_b32 a64, v5
v_fmamk_f32 v5, v9, 1073741824, v10
v_fmamk_f32 v6, v9, 1077936128, v10
v_cos_f32 v7, v5
v_cos_f32 v8, v6
v_sin_f32 v5, v5
v_sin_f32 v6, v6
v_cvt_pk_bf16_f32 v7, v7, v8
v_cvt_pk_bf16_f32 v5, v5, v6
v_accvgpr_write_b32 a1, v7
v_accvgpr_write_b32 a33, v5
v_xor_b32 v5, 0x80008000, v5
v_accvgpr_write_b32 a65, v5
v_fmamk_f32 v5, v9, 1082130432, v10
v_fmamk_f32 v6, v9, 1084227584, v10
v_cos_f32 v7, v5
v_cos_f32 v8, v6
v_sin_f32 v5, v5
v_sin_f32 v6, v6
v_cvt_pk_bf16_f32 v7, v7, v8
v_cvt_pk_bf16_f32 v5, v5, v6
v_accvgpr_write_b32 a2, v7
v_accvgpr_write_b32 a34, v5
v_xor_b32 v5, 0x80008000, v5
v_accvgpr_write_b32 a66, v5
v_fmamk_f32 v5, v9, 1086324736, v10
v_fmamk_f32 v6, v9, 1088421888, v10
v_cos_f32 v7, v5
v_cos_f32 v8, v6
v_sin_f32 v5, v5
v_sin_f32 v6, v6
v_cvt_pk_bf16_f32 v7, v7, v8
v_cvt_pk_bf16_f32 v5, v5, v6
v_accvgpr_write_b32 a3, v7
v_accvgpr_write_b32 a35, v5
v_xor_b32 v5, 0x80008000, v5
v_accvgpr_write_b32 a67, v5
v_fmamk_f32 v5, v9, 1098907648, v10
v_fmamk_f32 v6, v9, 1099431936, v10
v_cos_f32 v7, v5
v_cos_f32 v8, v6
v_sin_f32 v5, v5
v_sin_f32 v6, v6
v_cvt_pk_bf16_f32 v7, v7, v8
v_cvt_pk_bf16_f32 v5, v5, v6
v_accvgpr_write_b32 a4, v7
v_accvgpr_write_b32 a36, v5
v_xor_b32 v5, 0x80008000, v5
v_accvgpr_write_b32 a68, v5
v_fmamk_f32 v5, v9, 1099956224, v10
v_fmamk_f32 v6, v9, 1100480512, v10
v_cos_f32 v7, v5
v_cos_f32 v8, v6
v_sin_f32 v5, v5
v_sin_f32 v6, v6
v_cvt_pk_bf16_f32 v7, v7, v8
v_cvt_pk_bf16_f32 v5, v5, v6
v_accvgpr_write_b32 a5, v7
v_accvgpr_write_b32 a37, v5
v_xor_b32 v5, 0x80008000, v5
v_accvgpr_write_b32 a69, v5
v_fmamk_f32 v5, v9, 1101004800, v10
v_fmamk_f32 v6, v9, 1101529088, v10
v_cos_f32 v7, v5
v_cos_f32 v8, v6
v_sin_f32 v5, v5
v_sin_f32 v6, v6
v_cvt_pk_bf16_f32 v7, v7, v8
v_cvt_pk_bf16_f32 v5, v5, v6
v_accvgpr_write_b32 a6, v7
v_accvgpr_write_b32 a38, v5
v_xor_b32 v5, 0x80008000, v5
v_accvgpr_write_b32 a70, v5
v_fmamk_f32 v5, v9, 1102053376, v10
v_fmamk_f32 v6, v9, 1102577664, v10
v_cos_f32 v7, v5
v_cos_f32 v8, v6
v_sin_f32 v5, v5
v_sin_f32 v6, v6
v_cvt_pk_bf16_f32 v7, v7, v8
v_cvt_pk_bf16_f32 v5, v5, v6
v_accvgpr_write_b32 a7, v7
v_accvgpr_write_b32 a39, v5
v_xor_b32 v5, 0x80008000, v5
v_accvgpr_write_b32 a71, v5
v_fmamk_f32 v5, v9, 1107296256, v10
v_fmamk_f32 v6, v9, 1107558400, v10
v_cos_f32 v7, v5
v_cos_f32 v8, v6
v_sin_f32 v5, v5
v_sin_f32 v6, v6
v_cvt_pk_bf16_f32 v7, v7, v8
v_cvt_pk_bf16_f32 v5, v5, v6
v_accvgpr_write_b32 a8, v7
v_accvgpr_write_b32 a40, v5
v_xor_b32 v5, 0x80008000, v5
v_accvgpr_write_b32 a72, v5
v_fmamk_f32 v5, v9, 1107820544, v10
v_fmamk_f32 v6, v9, 1108082688, v10
v_cos_f32 v7, v5
v_cos_f32 v8, v6
v_sin_f32 v5, v5
v_sin_f32 v6, v6
v_cvt_pk_bf16_f32 v7, v7, v8
v_cvt_pk_bf16_f32 v5, v5, v6
v_accvgpr_write_b32 a9, v7
v_accvgpr_write_b32 a41, v5
v_xor_b32 v5, 0x80008000, v5
v_accvgpr_write_b32 a73, v5
v_fmamk_f32 v5, v9, 1108344832, v10
v_fmamk_f32 v6, v9, 1108606976, v10
v_cos_f32 v7, v5
v_cos_f32 v8, v6
v_sin_f32 v5, v5
v_sin_f32 v6, v6
v_cvt_pk_bf16_f32 v7, v7, v8
v_cvt_pk_bf16_f32 v5, v5, v6
v_accvgpr_write_b32 a10, v7
v_accvgpr_write_b32 a42, v5
v_xor_b32 v5, 0x80008000, v5
v_accvgpr_write_b32 a74, v5
v_fmamk_f32 v5, v9, 1108869120, v10
v_fmamk_f32 v6, v9, 1109131264, v10
v_cos_f32 v7, v5
v_cos_f32 v8, v6
v_sin_f32 v5, v5
v_sin_f32 v6, v6
v_cvt_pk_bf16_f32 v7, v7, v8
v_cvt_pk_bf16_f32 v5, v5, v6
v_accvgpr_write_b32 a11, v7
v_accvgpr_write_b32 a43, v5
v_xor_b32 v5, 0x80008000, v5
v_accvgpr_write_b32 a75, v5
v_fmamk_f32 v5, v9, 1111490560, v10
v_fmamk_f32 v6, v9, 1111752704, v10
v_cos_f32 v7, v5
v_cos_f32 v8, v6
v_sin_f32 v5, v5
v_sin_f32 v6, v6
v_cvt_pk_bf16_f32 v7, v7, v8
v_cvt_pk_bf16_f32 v5, v5, v6
v_accvgpr_write_b32 a12, v7
v_accvgpr_write_b32 a44, v5
v_xor_b32 v5, 0x80008000, v5
v_accvgpr_write_b32 a76, v5
v_fmamk_f32 v5, v9, 1112014848, v10
v_fmamk_f32 v6, v9, 1112276992, v10
v_cos_f32 v7, v5
v_cos_f32 v8, v6
v_sin_f32 v5, v5
v_sin_f32 v6, v6
v_cvt_pk_bf16_f32 v7, v7, v8
v_cvt_pk_bf16_f32 v5, v5, v6
v_accvgpr_write_b32 a13, v7
v_accvgpr_write_b32 a45, v5
v_xor_b32 v5, 0x80008000, v5
v_accvgpr_write_b32 a77, v5
v_fmamk_f32 v5, v9, 1112539136, v10
v_fmamk_f32 v6, v9, 1112801280, v10
v_cos_f32 v7, v5
v_cos_f32 v8, v6
v_sin_f32 v5, v5
v_sin_f32 v6, v6
v_cvt_pk_bf16_f32 v7, v7, v8
v_cvt_pk_bf16_f32 v5, v5, v6
v_accvgpr_write_b32 a14, v7
v_accvgpr_write_b32 a46, v5
v_xor_b32 v5, 0x80008000, v5
v_accvgpr_write_b32 a78, v5
v_fmamk_f32 v5, v9, 1113063424, v10
v_fmamk_f32 v6, v9, 1113325568, v10
v_cos_f32 v7, v5
v_cos_f32 v8, v6
v_sin_f32 v5, v5
v_sin_f32 v6, v6
v_cvt_pk_bf16_f32 v7, v7, v8
v_cvt_pk_bf16_f32 v5, v5, v6
v_accvgpr_write_b32 a15, v7
v_accvgpr_write_b32 a47, v5
v_xor_b32 v5, 0x80008000, v5
v_accvgpr_write_b32 a79, v5
v_add_f32 v9, 1107296256, v3
v_mul_f32 v9, 1015021568, v9
v_mul_f32 v10, v4, v9
v_fmamk_f32 v5, v9, 0, v10
v_fmamk_f32 v6, v9, 1065353216, v10
v_cos_f32 v7, v5
v_cos_f32 v8, v6
v_sin_f32 v5, v5
v_sin_f32 v6, v6
v_cvt_pk_bf16_f32 v7, v7, v8
v_cvt_pk_bf16_f32 v5, v5, v6
v_accvgpr_write_b32 a16, v7
v_accvgpr_write_b32 a48, v5
v_xor_b32 v5, 0x80008000, v5
v_accvgpr_write_b32 a80, v5
v_fmamk_f32 v5, v9, 1073741824, v10
v_fmamk_f32 v6, v9, 1077936128, v10
v_cos_f32 v7, v5
v_cos_f32 v8, v6
v_sin_f32 v5, v5
v_sin_f32 v6, v6
v_cvt_pk_bf16_f32 v7, v7, v8
v_cvt_pk_bf16_f32 v5, v5, v6
v_accvgpr_write_b32 a17, v7
v_accvgpr_write_b32 a49, v5
v_xor_b32 v5, 0x80008000, v5
v_accvgpr_write_b32 a81, v5
v_fmamk_f32 v5, v9, 1082130432, v10
v_fmamk_f32 v6, v9, 1084227584, v10
v_cos_f32 v7, v5
v_cos_f32 v8, v6
v_sin_f32 v5, v5
v_sin_f32 v6, v6
v_cvt_pk_bf16_f32 v7, v7, v8
v_cvt_pk_bf16_f32 v5, v5, v6
v_accvgpr_write_b32 a18, v7
v_accvgpr_write_b32 a50, v5
v_xor_b32 v5, 0x80008000, v5
v_accvgpr_write_b32 a82, v5
v_fmamk_f32 v5, v9, 1086324736, v10
v_fmamk_f32 v6, v9, 1088421888, v10
v_cos_f32 v7, v5
v_cos_f32 v8, v6
v_sin_f32 v5, v5
v_sin_f32 v6, v6
v_cvt_pk_bf16_f32 v7, v7, v8
v_cvt_pk_bf16_f32 v5, v5, v6
v_accvgpr_write_b32 a19, v7
v_accvgpr_write_b32 a51, v5
v_xor_b32 v5, 0x80008000, v5
v_accvgpr_write_b32 a83, v5
v_fmamk_f32 v5, v9, 1098907648, v10
v_fmamk_f32 v6, v9, 1099431936, v10
v_cos_f32 v7, v5
v_cos_f32 v8, v6
v_sin_f32 v5, v5
v_sin_f32 v6, v6
v_cvt_pk_bf16_f32 v7, v7, v8
v_cvt_pk_bf16_f32 v5, v5, v6
v_accvgpr_write_b32 a20, v7
v_accvgpr_write_b32 a52, v5
v_xor_b32 v5, 0x80008000, v5
v_accvgpr_write_b32 a84, v5
v_fmamk_f32 v5, v9, 1099956224, v10
v_fmamk_f32 v6, v9, 1100480512, v10
v_cos_f32 v7, v5
v_cos_f32 v8, v6
v_sin_f32 v5, v5
v_sin_f32 v6, v6
v_cvt_pk_bf16_f32 v7, v7, v8
v_cvt_pk_bf16_f32 v5, v5, v6
v_accvgpr_write_b32 a21, v7
v_accvgpr_write_b32 a53, v5
v_xor_b32 v5, 0x80008000, v5
v_accvgpr_write_b32 a85, v5
v_fmamk_f32 v5, v9, 1101004800, v10
v_fmamk_f32 v6, v9, 1101529088, v10
v_cos_f32 v7, v5
v_cos_f32 v8, v6
v_sin_f32 v5, v5
v_sin_f32 v6, v6
v_cvt_pk_bf16_f32 v7, v7, v8
v_cvt_pk_bf16_f32 v5, v5, v6
v_accvgpr_write_b32 a22, v7
v_accvgpr_write_b32 a54, v5
v_xor_b32 v5, 0x80008000, v5
v_accvgpr_write_b32 a86, v5
v_fmamk_f32 v5, v9, 1102053376, v10
v_fmamk_f32 v6, v9, 1102577664, v10
v_cos_f32 v7, v5
v_cos_f32 v8, v6
v_sin_f32 v5, v5
v_sin_f32 v6, v6
v_cvt_pk_bf16_f32 v7, v7, v8
v_cvt_pk_bf16_f32 v5, v5, v6
v_accvgpr_write_b32 a23, v7
v_accvgpr_write_b32 a55, v5
v_xor_b32 v5, 0x80008000, v5
v_accvgpr_write_b32 a87, v5
v_fmamk_f32 v5, v9, 1107296256, v10
v_fmamk_f32 v6, v9, 1107558400, v10
v_cos_f32 v7, v5
v_cos_f32 v8, v6
v_sin_f32 v5, v5
v_sin_f32 v6, v6
v_cvt_pk_bf16_f32 v7, v7, v8
v_cvt_pk_bf16_f32 v5, v5, v6
v_accvgpr_write_b32 a24, v7
v_accvgpr_write_b32 a56, v5
v_xor_b32 v5, 0x80008000, v5
v_accvgpr_write_b32 a88, v5
v_fmamk_f32 v5, v9, 1107820544, v10
v_fmamk_f32 v6, v9, 1108082688, v10
v_cos_f32 v7, v5
v_cos_f32 v8, v6
v_sin_f32 v5, v5
v_sin_f32 v6, v6
v_cvt_pk_bf16_f32 v7, v7, v8
v_cvt_pk_bf16_f32 v5, v5, v6
v_accvgpr_write_b32 a25, v7
v_accvgpr_write_b32 a57, v5
v_xor_b32 v5, 0x80008000, v5
v_accvgpr_write_b32 a89, v5
v_fmamk_f32 v5, v9, 1108344832, v10
v_fmamk_f32 v6, v9, 1108606976, v10
v_cos_f32 v7, v5
v_cos_f32 v8, v6
v_sin_f32 v5, v5
v_sin_f32 v6, v6
v_cvt_pk_bf16_f32 v7, v7, v8
v_cvt_pk_bf16_f32 v5, v5, v6
v_accvgpr_write_b32 a26, v7
v_accvgpr_write_b32 a58, v5
v_xor_b32 v5, 0x80008000, v5
v_accvgpr_write_b32 a90, v5
v_fmamk_f32 v5, v9, 1108869120, v10
v_fmamk_f32 v6, v9, 1109131264, v10
v_cos_f32 v7, v5
v_cos_f32 v8, v6
v_sin_f32 v5, v5
v_sin_f32 v6, v6
v_cvt_pk_bf16_f32 v7, v7, v8
v_cvt_pk_bf16_f32 v5, v5, v6
v_accvgpr_write_b32 a27, v7
v_accvgpr_write_b32 a59, v5
v_xor_b32 v5, 0x80008000, v5
v_accvgpr_write_b32 a91, v5
v_fmamk_f32 v5, v9, 1111490560, v10
v_fmamk_f32 v6, v9, 1111752704, v10
v_cos_f32 v7, v5
v_cos_f32 v8, v6
v_sin_f32 v5, v5
v_sin_f32 v6, v6
v_cvt_pk_bf16_f32 v7, v7, v8
v_cvt_pk_bf16_f32 v5, v5, v6
v_accvgpr_write_b32 a28, v7
v_accvgpr_write_b32 a60, v5
v_xor_b32 v5, 0x80008000, v5
v_accvgpr_write_b32 a92, v5
v_fmamk_f32 v5, v9, 1112014848, v10
v_fmamk_f32 v6, v9, 1112276992, v10
v_cos_f32 v7, v5
v_cos_f32 v8, v6
v_sin_f32 v5, v5
v_sin_f32 v6, v6
v_cvt_pk_bf16_f32 v7, v7, v8
v_cvt_pk_bf16_f32 v5, v5, v6
v_accvgpr_write_b32 a29, v7
v_accvgpr_write_b32 a61, v5
v_xor_b32 v5, 0x80008000, v5
v_accvgpr_write_b32 a93, v5
v_fmamk_f32 v5, v9, 1112539136, v10
v_fmamk_f32 v6, v9, 1112801280, v10
v_cos_f32 v7, v5
v_cos_f32 v8, v6
v_sin_f32 v5, v5
v_sin_f32 v6, v6
v_cvt_pk_bf16_f32 v7, v7, v8
v_cvt_pk_bf16_f32 v5, v5, v6
v_accvgpr_write_b32 a30, v7
v_accvgpr_write_b32 a62, v5
v_xor_b32 v5, 0x80008000, v5
v_accvgpr_write_b32 a94, v5
v_fmamk_f32 v5, v9, 1113063424, v10
v_fmamk_f32 v6, v9, 1113325568, v10
v_cos_f32 v7, v5
v_cos_f32 v8, v6
v_sin_f32 v5, v5
v_sin_f32 v6, v6
v_cvt_pk_bf16_f32 v7, v7, v8
v_cvt_pk_bf16_f32 v5, v5, v6
v_accvgpr_write_b32 a31, v7
v_accvgpr_write_b32 a63, v5
v_xor_b32 v5, 0x80008000, v5
v_accvgpr_write_b32 a95, v5
v_add_f32 v9, 0, v3
v_mul_f32 v9, 1023410176, v9
v_mul_f32 v10, v4, v9
v_fmamk_f32 v5, v9, 0, v10
v_fmamk_f32 v6, v9, 1065353216, v10
v_cos_f32 v7, v5
v_cos_f32 v8, v6
v_sin_f32 v5, v5
v_sin_f32 v6, v6
v_cvt_pk_bf16_f32 v7, v7, v8
v_cvt_pk_bf16_f32 v5, v5, v6
v_accvgpr_write_b32 a96, v7
v_accvgpr_write_b32 a104, v5
v_xor_b32 v5, 0x80008000, v5
v_accvgpr_write_b32 a112, v5
v_fmamk_f32 v5, v9, 1073741824, v10
v_fmamk_f32 v6, v9, 1077936128, v10
v_cos_f32 v7, v5
v_cos_f32 v8, v6
v_sin_f32 v5, v5
v_sin_f32 v6, v6
v_cvt_pk_bf16_f32 v7, v7, v8
v_cvt_pk_bf16_f32 v5, v5, v6
v_accvgpr_write_b32 a97, v7
v_accvgpr_write_b32 a105, v5
v_xor_b32 v5, 0x80008000, v5
v_accvgpr_write_b32 a113, v5
v_fmamk_f32 v5, v9, 1082130432, v10
v_fmamk_f32 v6, v9, 1084227584, v10
v_cos_f32 v7, v5
v_cos_f32 v8, v6
v_sin_f32 v5, v5
v_sin_f32 v6, v6
v_cvt_pk_bf16_f32 v7, v7, v8
v_cvt_pk_bf16_f32 v5, v5, v6
v_accvgpr_write_b32 a98, v7
v_accvgpr_write_b32 a106, v5
v_xor_b32 v5, 0x80008000, v5
v_accvgpr_write_b32 a114, v5
v_fmamk_f32 v5, v9, 1086324736, v10
v_fmamk_f32 v6, v9, 1088421888, v10
v_cos_f32 v7, v5
v_cos_f32 v8, v6
v_sin_f32 v5, v5
v_sin_f32 v6, v6
v_cvt_pk_bf16_f32 v7, v7, v8
v_cvt_pk_bf16_f32 v5, v5, v6
v_accvgpr_write_b32 a99, v7
v_accvgpr_write_b32 a107, v5
v_xor_b32 v5, 0x80008000, v5
v_accvgpr_write_b32 a115, v5
v_fmamk_f32 v5, v9, 1098907648, v10
v_fmamk_f32 v6, v9, 1099431936, v10
v_cos_f32 v7, v5
v_cos_f32 v8, v6
v_sin_f32 v5, v5
v_sin_f32 v6, v6
v_cvt_pk_bf16_f32 v7, v7, v8
v_cvt_pk_bf16_f32 v5, v5, v6
v_accvgpr_write_b32 a100, v7
v_accvgpr_write_b32 a108, v5
v_xor_b32 v5, 0x80008000, v5
v_accvgpr_write_b32 a116, v5
v_fmamk_f32 v5, v9, 1099956224, v10
v_fmamk_f32 v6, v9, 1100480512, v10
v_cos_f32 v7, v5
v_cos_f32 v8, v6
v_sin_f32 v5, v5
v_sin_f32 v6, v6
v_cvt_pk_bf16_f32 v7, v7, v8
v_cvt_pk_bf16_f32 v5, v5, v6
v_accvgpr_write_b32 a101, v7
v_accvgpr_write_b32 a109, v5
v_xor_b32 v5, 0x80008000, v5
v_accvgpr_write_b32 a117, v5
v_fmamk_f32 v5, v9, 1101004800, v10
v_fmamk_f32 v6, v9, 1101529088, v10
v_cos_f32 v7, v5
v_cos_f32 v8, v6
v_sin_f32 v5, v5
v_sin_f32 v6, v6
v_cvt_pk_bf16_f32 v7, v7, v8
v_cvt_pk_bf16_f32 v5, v5, v6
v_accvgpr_write_b32 a102, v7
v_accvgpr_write_b32 a110, v5
v_xor_b32 v5, 0x80008000, v5
v_accvgpr_write_b32 a118, v5
v_fmamk_f32 v5, v9, 1102053376, v10
v_fmamk_f32 v6, v9, 1102577664, v10
v_cos_f32 v7, v5
v_cos_f32 v8, v6
v_sin_f32 v5, v5
v_sin_f32 v6, v6
v_cvt_pk_bf16_f32 v7, v7, v8
v_cvt_pk_bf16_f32 v5, v5, v6
v_accvgpr_write_b32 a103, v7
v_accvgpr_write_b32 a111, v5
v_xor_b32 v5, 0x80008000, v5
v_accvgpr_write_b32 a119, v5
v_bfe_u32 v0, v51, 4, 1
v_lshlrev_b32 v0, 11, v0
v_bfe_u32 v50, v51, 2, 1
v_lshl_add_u32 v0, v50, 10, v0
v_bfe_u32 v50, v51, 3, 1
v_lshl_add_u32 v0, v50, 9, v0
v_bfe_u32 v50, v51, 0, 2
v_lshl_add_u32 v0, v50, 7, v0
v_bfe_u32 v50, v51, 5, 1
v_lshl_add_u32 v0, v50, 4, v0
v_bfe_u32 v2, v51, 4, 1
v_mul_u32_u24 v2, 528384, v2
v_bfe_u32 v50, v51, 2, 1
v_mul_u32_u24 v50, 264192, v50
v_add_u32 v2, v50, v2
v_bfe_u32 v50, v51, 3, 1
v_mul_u32_u24 v50, 132096, v50
v_add_u32 v2, v50, v2
v_bfe_u32 v50, v51, 0, 2
v_mul_u32_u24 v50, 33024, v50
v_add_u32 v2, v50, v2
v_bfe_u32 v50, v51, 5, 1
v_lshl_add_u32 v2, v50, 4, v2
v_bfe_u32 v1, v51, 4, 1
v_lshlrev_b32 v1, 6, v1
v_bfe_u32 v50, v51, 2, 1
v_lshl_add_u32 v1, v50, 5, v1
v_bfe_u32 v50, v51, 3, 1
v_lshl_add_u32 v1, v50, 4, v1
v_bfe_u32 v50, v51, 0, 2
v_lshl_add_u32 v1, v50, 2, v1
v_bfe_u32 v50, v51, 5, 1
v_lshl_add_u32 v1, v50, 11, v1
v_add_u32 v1, 109051904, v1
v_mov_b32 v5, 36
Lg_wc_25:
global_load_dword v6, v5, s[6:7] sc1
s_add_u32 s30, s30, 1
s_cmp_gt_u32 s30, 1000000
s_cbranch_scc1 L_fin
s_waitcnt vmcnt(0)
v_cmp_gt_u32 vcc, 96, v6
s_cbranch_vccz Lg_wd_26
s_sleep 16
s_branch Lg_wc_25
Lg_wd_26:
Lg_k:
s_mul_i32 s23, s21, 4224
s_add_u32 s23, s23, 100663296
s_lshl_b32 s25, s21, 6
s_add_u32 s25, s25, 104857600
s_and_b32 s28, s21, 255
s_cmp_eq_u32 s28, 0
s_cselect_b32 s28, 0x40000000, 0
s_mov_b32 s20, 905969664
s_cselect_b32 s20, 897581056, s20
s_add_u32 s24, s23, 1081344
s_add_u32 s24, s24, s28
s_add_u32 s26, s25, 16384
s_add_u32 s26, s26, s28
buffer_load_dwordx4 v[16:19], v0, s[8:11], s23 offen offset:0 sc1
buffer_load_dwordx4 v[20:23], v0, s[8:11], s23 offen offset:32 sc1
buffer_load_dwordx4 v[24:27], v0, s[8:11], s23 offen offset:64 sc1
buffer_load_dwordx4 v[28:31], v0, s[8:11], s23 offen offset:96 sc1
buffer_load_dwordx4 v[32:35], v0, s[8:11], s24 offen offset:0 sc1
buffer_load_dwordx4 v[36:39], v0, s[8:11], s24 offen offset:32 sc1
buffer_load_dwordx4 v[40:43], v0, s[8:11], s24 offen offset:64 sc1
buffer_load_dwordx4 v[44:47], v0, s[8:11], s24 offen offset:96 sc1
s_mul_i32 s28, s21, 8320
s_add_u32 s29, s28, 4096
buffer_load_dword v160, v1, s[8:11], s28 offen offset:0 sc1
buffer_load_dword v161, v1, s[8:11], s28 offen offset:256 sc1
buffer_load_dword v162, v1, s[8:11], s28 offen offset:512 sc1
buffer_load_dword v163, v1, s[8:11], s28 offen offset:768 sc1
buffer_load_dword v164, v1, s[8:11], s28 offen offset:1024 sc1
buffer_load_dword v165, v1, s[8:11], s28 offen offset:1280 sc1
buffer_load_dword v166, v1, s[8:11], s28 offen offset:1536 sc1
buffer_load_dword v167, v1, s[8:11], s28 offen offset:1792 sc1
buffer_load_dword v168, v1, s[8:11], s29 offen offset:0 sc1
buffer_load_dword v169, v1, s[8:11], s29 offen offset:256 sc1
buffer_load_dword v170, v1, s[8:11], s29 offen offset:512 sc1
buffer_load_dword v171, v1, s[8:11], s29 offen offset:768 sc1
buffer_load_dword v172, v1, s[8:11], s29 offen offset:1024 sc1
buffer_load_dword v173, v1, s[8:11], s29 offen offset:1280 sc1
buffer_load_dword v174, v1, s[8:11], s29 offen offset:1536 sc1
buffer_load_dword v175, v1, s[8:11], s29 offen offset:1792 sc1
buffer_load_dword v176, v1, s[8:11], s28 offen offset:128 sc1
buffer_load_dword v177, v1, s[8:11], s28 offen offset:384 sc1
buffer_load_dword v178, v1, s[8:11], s28 offen offset:640 sc1
buffer_load_dword v179, v1, s[8:11], s28 offen offset:896 sc1
buffer_load_dword v180, v1, s[8:11], s28 offen offset:1152 sc1
buffer_load_dword v181, v1, s[8:11], s28 offen offset:1408 sc1
buffer_load_dword v182, v1, s[8:11], s28 offen offset:1664 sc1
buffer_load_dword v183, v1, s[8:11], s28 offen offset:1920 sc1
buffer_load_dword v184, v1, s[8:11], s29 offen offset:128 sc1
buffer_load_dword v185, v1, s[8:11], s29 offen offset:384 sc1
buffer_load_dword v186, v1, s[8:11], s29 offen offset:640 sc1
buffer_load_dword v187, v1, s[8:11], s29 offen offset:896 sc1
buffer_load_dword v188, v1, s[8:11], s29 offen offset:1152 sc1
buffer_load_dword v189, v1, s[8:11], s29 offen offset:1408 sc1
buffer_load_dword v190, v1, s[8:11], s29 offen offset:1664 sc1
buffer_load_dword v191, v1, s[8:11], s29 offen offset:1920 sc1
s_waitcnt vmcnt(32)
v_mfma_f32_32x32x16_bf16 v[64:79], v[16:19], a[0:3], 0
v_mfma_f32_32x32x16_bf16 v[80:95], v[32:35], a[0:3], 0
v_mfma_f32_32x32x16_bf16 v[64:79], v[32:35], a[32:35], v[64:79]
v_mfma_f32_32x32x16_bf16 v[80:95], v[16:19], a[64:67], v[80:95]
v_mfma_f32_32x32x16_bf16 v[64:79], v[20:23], a[4:7], v[64:79]
v_mfma_f32_32x32x16_bf16 v[80:95], v[36:39], a[4:7], v[80:95]
v_mfma_f32_32x32x16_bf16 v[64:79], v[36:39], a[36:39], v[64:79]
v_mfma_f32_32x32x16_bf16 v[80:95], v[20:23], a[68:71], v[80:95]
v_mfma_f32_32x32x16_bf16 v[64:79], v[24:27], a[8:11], v[64:79]
v_mfma_f32_32x32x16_bf16 v[80:95], v[40:43], a[8:11], v[80:95]
v_mfma_f32_32x32x16_bf16 v[64:79], v[40:43], a[40:43], v[64:79]
v_mfma_f32_32x32x16_bf16 v[80:95], v[24:27], a[72:75], v[80:95]
v_mfma_f32_32x32x16_bf16 v[64:79], v[28:31], a[12:15], v[64:79]
v_mfma_f32_32x32x16_bf16 v[80:95], v[44:47], a[12:15], v[80:95]
v_mfma_f32_32x32x16_bf16 v[64:79], v[44:47], a[44:47], v[64:79]
v_mfma_f32_32x32x16_bf16 v[80:95], v[28:31], a[76:79], v[80:95]
v_mfma_f32_32x32x16_bf16 v[96:111], v[16:19], a[16:19], 0
v_mfma_f32_32x32x16_bf16 v[112:127], v[32:35], a[16:19], 0
v_mfma_f32_32x32x16_bf16 v[96:111], v[32:35], a[48:51], v[96:111]
v_mfma_f32_32x32x16_bf16 v[112:127], v[16:19], a[80:83], v[112:127]
v_mfma_f32_32x32x16_bf16 v[96:111], v[20:23], a[20:23], v[96:111]
v_mfma_f32_32x32x16_bf16 v[112:127], v[36:39], a[20:23], v[112:127]
v_mfma_f32_32x32x16_bf16 v[96:111], v[36:39], a[52:55], v[96:111]
v_mfma_f32_32x32x16_bf16 v[112:127], v[20:23], a[84:87], v[112:127]
v_mfma_f32_32x32x16_bf16 v[96:111], v[24:27], a[24:27], v[96:111]
v_mfma_f32_32x32x16_bf16 v[112:127], v[40:43], a[24:27], v[112:127]
v_mfma_f32_32x32x16_bf16 v[96:111], v[40:43], a[56:59], v[96:111]
v_mfma_f32_32x32x16_bf16 v[112:127], v[24:27], a[88:91], v[112:127]
v_mfma_f32_32x32x16_bf16 v[96:111], v[28:31], a[28:31], v[96:111]
v_mfma_f32_32x32x16_bf16 v[112:127], v[44:47], a[28:31], v[112:127]
v_mfma_f32_32x32x16_bf16 v[96:111], v[44:47], a[60:63], v[96:111]
v_mfma_f32_32x32x16_bf16 v[112:127], v[28:31], a[92:95], v[112:127]
v_add_f32 v9, 0, v3
v_mul_f32 v9, 3120562176, v9
v_mul_f32 v10, v4, v9
v_fmamk_f32 v6, v9, 0, v10
v_cos_f32 v5, v6
v_sin_f32 v6, v6
s_nop 0
v_mul_f32 v7, v80, v6
v_mul_f32 v8, v64, v6
v_fma_f32 v64, v64, v5, -v7
v_fma_f32 v80, v80, v5, v8
v_fmamk_f32 v6, v9, 1065353216, v10
v_cos_f32 v5, v6
v_sin_f32 v6, v6
s_nop 0
v_mul_f32 v7, v81, v6
v_mul_f32 v8, v65, v6
v_fma_f32 v65, v65, v5, -v7
v_fma_f32 v81, v81, v5, v8
v_cvt_pk_bf16_f32 v16, v64, v65
v_cvt_pk_bf16_f32 v32, v80, v81
v_fmamk_f32 v6, v9, 1073741824, v10
v_cos_f32 v5, v6
v_sin_f32 v6, v6
s_nop 0
v_mul_f32 v7, v82, v6
v_mul_f32 v8, v66, v6
v_fma_f32 v66, v66, v5, -v7
v_fma_f32 v82, v82, v5, v8
v_fmamk_f32 v6, v9, 1077936128, v10
v_cos_f32 v5, v6
v_sin_f32 v6, v6
s_nop 0
v_mul_f32 v7, v83, v6
v_mul_f32 v8, v67, v6
v_fma_f32 v67, v67, v5, -v7
v_fma_f32 v83, v83, v5, v8
v_cvt_pk_bf16_f32 v17, v66, v67
v_cvt_pk_bf16_f32 v33, v82, v83
v_fmamk_f32 v6, v9, 1082130432, v10
v_cos_f32 v5, v6
v_sin_f32 v6, v6
s_nop 0
v_mul_f32 v7, v84, v6
v_mul_f32 v8, v68, v6
v_fma_f32 v68, v68, v5, -v7
v_fma_f32 v84, v84, v5, v8
v_fmamk_f32 v6, v9, 1084227584, v10
v_cos_f32 v5, v6
v_sin_f32 v6, v6
s_nop 0
v_mul_f32 v7, v85, v6
v_mul_f32 v8, v69, v6
v_fma_f32 v69, v69, v5, -v7
v_fma_f32 v85, v85, v5, v8
v_cvt_pk_bf16_f32 v18, v68, v69
v_cvt_pk_bf16_f32 v34, v84, v85
v_fmamk_f32 v6, v9, 1086324736, v10
v_cos_f32 v5, v6
v_sin_f32 v6, v6
s_nop 0
v_mul_f32 v7, v86, v6
v_mul_f32 v8, v70, v6
v_fma_f32 v70, v70, v5, -v7
v_fma_f32 v86, v86, v5, v8
v_fmamk_f32 v6, v9, 1088421888, v10
v_cos_f32 v5, v6
v_sin_f32 v6, v6
s_nop 0
v_mul_f32 v7, v87, v6
v_mul_f32 v8, v71, v6
v_fma_f32 v71, v71, v5, -v7
v_fma_f32 v87, v87, v5, v8
v_cvt_pk_bf16_f32 v19, v70, v71
v_cvt_pk_bf16_f32 v35, v86, v87
v_fmamk_f32 v6, v9, 1098907648, v10
v_cos_f32 v5, v6
v_sin_f32 v6, v6
s_nop 0
v_mul_f32 v7, v88, v6
v_mul_f32 v8, v72, v6
v_fma_f32 v72, v72, v5, -v7
v_fma_f32 v88, v88, v5, v8
v_fmamk_f32 v6, v9, 1099431936, v10
v_cos_f32 v5, v6
v_sin_f32 v6, v6
s_nop 0
v_mul_f32 v7, v89, v6
v_mul_f32 v8, v73, v6
v_fma_f32 v73, v73, v5, -v7
v_fma_f32 v89, v89, v5, v8
v_cvt_pk_bf16_f32 v20, v72, v73
v_cvt_pk_bf16_f32 v36, v88, v89
v_fmamk_f32 v6, v9, 1099956224, v10
v_cos_f32 v5, v6
v_sin_f32 v6, v6
s_nop 0
v_mul_f32 v7, v90, v6
v_mul_f32 v8, v74, v6
v_fma_f32 v74, v74, v5, -v7
v_fma_f32 v90, v90, v5, v8
v_fmamk_f32 v6, v9, 1100480512, v10
v_cos_f32 v5, v6
v_sin_f32 v6, v6
s_nop 0
v_mul_f32 v7, v91, v6
v_mul_f32 v8, v75, v6
v_fma_f32 v75, v75, v5, -v7
v_fma_f32 v91, v91, v5, v8
v_cvt_pk_bf16_f32 v21, v74, v75
v_cvt_pk_bf16_f32 v37, v90, v91
v_fmamk_f32 v6, v9, 1101004800, v10
v_cos_f32 v5, v6
v_sin_f32 v6, v6
s_nop 0
v_mul_f32 v7, v92, v6
v_mul_f32 v8, v76, v6
v_fma_f32 v76, v76, v5, -v7
v_fma_f32 v92, v92, v5, v8
v_fmamk_f32 v6, v9, 1101529088, v10
v_cos_f32 v5, v6
v_sin_f32 v6, v6
s_nop 0
v_mul_f32 v7, v93, v6
v_mul_f32 v8, v77, v6
v_fma_f32 v77, v77, v5, -v7
v_fma_f32 v93, v93, v5, v8
v_cvt_pk_bf16_f32 v22, v76, v77
v_cvt_pk_bf16_f32 v38, v92, v93
v_fmamk_f32 v6, v9, 1102053376, v10
v_cos_f32 v5, v6
v_sin_f32 v6, v6
s_nop 0
v_mul_f32 v7, v94, v6
v_mul_f32 v8, v78, v6
v_fma_f32 v78, v78, v5, -v7
v_fma_f32 v94, v94, v5, v8
v_fmamk_f32 v6, v9, 1102577664, v10
v_cos_f32 v5, v6
v_sin_f32 v6, v6
s_nop 0
v_mul_f32 v7, v95, v6
v_mul_f32 v8, v79, v6
v_fma_f32 v79, v79, v5, -v7
v_fma_f32 v95, v95, v5, v8
v_cvt_pk_bf16_f32 v23, v78, v79
v_cvt_pk_bf16_f32 v39, v94, v95
v_add_f32 v9, 1107296256, v3
v_mul_f32 v9, 3120562176, v9
v_mul_f32 v10, v4, v9
v_fmamk_f32 v6, v9, 0, v10
v_cos_f32 v5, v6
v_sin_f32 v6, v6
s_nop 0
v_mul_f32 v7, v112, v6
v_mul_f32 v8, v96, v6
v_fma_f32 v96, v96, v5, -v7
v_fma_f32 v112, v112, v5, v8
v_fmamk_f32 v6, v9, 1065353216, v10
v_cos_f32 v5, v6
v_sin_f32 v6, v6
s_nop 0
v_mul_f32 v7, v113, v6
v_mul_f32 v8, v97, v6
v_fma_f32 v97, v97, v5, -v7
v_fma_f32 v113, v113, v5, v8
v_cvt_pk_bf16_f32 v24, v96, v97
v_cvt_pk_bf16_f32 v40, v112, v113
v_fmamk_f32 v6, v9, 1073741824, v10
v_cos_f32 v5, v6
v_sin_f32 v6, v6
s_nop 0
v_mul_f32 v7, v114, v6
v_mul_f32 v8, v98, v6
v_fma_f32 v98, v98, v5, -v7
v_fma_f32 v114, v114, v5, v8
v_fmamk_f32 v6, v9, 1077936128, v10
v_cos_f32 v5, v6
v_sin_f32 v6, v6
s_nop 0
v_mul_f32 v7, v115, v6
v_mul_f32 v8, v99, v6
v_fma_f32 v99, v99, v5, -v7
v_fma_f32 v115, v115, v5, v8
v_cvt_pk_bf16_f32 v25, v98, v99
v_cvt_pk_bf16_f32 v41, v114, v115
v_fmamk_f32 v6, v9, 1082130432, v10
v_cos_f32 v5, v6
v_sin_f32 v6, v6
s_nop 0
v_mul_f32 v7, v116, v6
v_mul_f32 v8, v100, v6
v_fma_f32 v100, v100, v5, -v7
v_fma_f32 v116, v116, v5, v8
v_fmamk_f32 v6, v9, 1084227584, v10
v_cos_f32 v5, v6
v_sin_f32 v6, v6
s_nop 0
v_mul_f32 v7, v117, v6
v_mul_f32 v8, v101, v6
v_fma_f32 v101, v101, v5, -v7
v_fma_f32 v117, v117, v5, v8
v_cvt_pk_bf16_f32 v26, v100, v101
v_cvt_pk_bf16_f32 v42, v116, v117
v_fmamk_f32 v6, v9, 1086324736, v10
v_cos_f32 v5, v6
v_sin_f32 v6, v6
s_nop 0
v_mul_f32 v7, v118, v6
v_mul_f32 v8, v102, v6
v_fma_f32 v102, v102, v5, -v7
v_fma_f32 v118, v118, v5, v8
v_fmamk_f32 v6, v9, 1088421888, v10
v_cos_f32 v5, v6
v_sin_f32 v6, v6
s_nop 0
v_mul_f32 v7, v119, v6
v_mul_f32 v8, v103, v6
v_fma_f32 v103, v103, v5, -v7
v_fma_f32 v119, v119, v5, v8
v_cvt_pk_bf16_f32 v27, v102, v103
v_cvt_pk_bf16_f32 v43, v118, v119
v_fmamk_f32 v6, v9, 1098907648, v10
v_cos_f32 v5, v6
v_sin_f32 v6, v6
s_nop 0
v_mul_f32 v7, v120, v6
v_mul_f32 v8, v104, v6
v_fma_f32 v104, v104, v5, -v7
v_fma_f32 v120, v120, v5, v8
v_fmamk_f32 v6, v9, 1099431936, v10
v_cos_f32 v5, v6
v_sin_f32 v6, v6
s_nop 0
v_mul_f32 v7, v121, v6
v_mul_f32 v8, v105, v6
v_fma_f32 v105, v105, v5, -v7
v_fma_f32 v121, v121, v5, v8
v_cvt_pk_bf16_f32 v28, v104, v105
v_cvt_pk_bf16_f32 v44, v120, v121
v_fmamk_f32 v6, v9, 1099956224, v10
v_cos_f32 v5, v6
v_sin_f32 v6, v6
s_nop 0
v_mul_f32 v7, v122, v6
v_mul_f32 v8, v106, v6
v_fma_f32 v106, v106, v5, -v7
v_fma_f32 v122, v122, v5, v8
v_fmamk_f32 v6, v9, 1100480512, v10
v_cos_f32 v5, v6
v_sin_f32 v6, v6
s_nop 0
v_mul_f32 v7, v123, v6
v_mul_f32 v8, v107, v6
v_fma_f32 v107, v107, v5, -v7
v_fma_f32 v123, v123, v5, v8
v_cvt_pk_bf16_f32 v29, v106, v107
v_cvt_pk_bf16_f32 v45, v122, v123
v_fmamk_f32 v6, v9, 1101004800, v10
v_cos_f32 v5, v6
v_sin_f32 v6, v6
s_nop 0
v_mul_f32 v7, v124, v6
v_mul_f32 v8, v108, v6
v_fma_f32 v108, v108, v5, -v7
v_fma_f32 v124, v124, v5, v8
v_fmamk_f32 v6, v9, 1101529088, v10
v_cos_f32 v5, v6
v_sin_f32 v6, v6
s_nop 0
v_mul_f32 v7, v125, v6
v_mul_f32 v8, v109, v6
v_fma_f32 v109, v109, v5, -v7
v_fma_f32 v125, v125, v5, v8
v_cvt_pk_bf16_f32 v30, v108, v109
v_cvt_pk_bf16_f32 v46, v124, v125
v_fmamk_f32 v6, v9, 1102053376, v10
v_cos_f32 v5, v6
v_sin_f32 v6, v6
s_nop 0
v_mul_f32 v7, v126, v6
v_mul_f32 v8, v110, v6
v_fma_f32 v110, v110, v5, -v7
v_fma_f32 v126, v126, v5, v8
v_fmamk_f32 v6, v9, 1102577664, v10
v_cos_f32 v5, v6
v_sin_f32 v6, v6
s_nop 0
v_mul_f32 v7, v127, v6
v_mul_f32 v8, v111, v6
v_fma_f32 v111, v111, v5, -v7
v_fma_f32 v127, v127, v5, v8
v_cvt_pk_bf16_f32 v31, v110, v111
v_cvt_pk_bf16_f32 v47, v126, v127
v_mfma_f32_32x32x16_bf16 v[64:79], a[96:99], v[16:19], 0
v_mfma_f32_32x32x16_bf16 v[80:95], a[96:99], v[32:35], 0
v_mfma_f32_32x32x16_bf16 v[64:79], a[104:107], v[32:35], v[64:79]
v_mfma_f32_32x32x16_bf16 v[80:95], a[112:115], v[16:19], v[80:95]
v_mfma_f32_32x32x16_bf16 v[64:79], a[100:103], v[20:23], v[64:79]
v_mfma_f32_32x32x16_bf16 v[80:95], a[100:103], v[36:39], v[80:95]
v_mfma_f32_32x32x16_bf16 v[64:79], a[108:111], v[36:39], v[64:79]
v_mfma_f32_32x32x16_bf16 v[80:95], a[116:119], v[20:23], v[80:95]
v_mfma_f32_32x32x16_bf16 v[96:111], a[96:99], v[24:27], 0
v_mfma_f32_32x32x16_bf16 v[112:127], a[96:99], v[40:43], 0
v_mfma_f32_32x32x16_bf16 v[96:111], a[104:107], v[40:43], v[96:111]
v_mfma_f32_32x32x16_bf16 v[112:127], a[112:115], v[24:27], v[112:127]
v_mfma_f32_32x32x16_bf16 v[96:111], a[100:103], v[28:31], v[96:111]
v_mfma_f32_32x32x16_bf16 v[112:127], a[100:103], v[44:47], v[112:127]
v_mfma_f32_32x32x16_bf16 v[96:111], a[108:111], v[44:47], v[96:111]
v_mfma_f32_32x32x16_bf16 v[112:127], a[116:119], v[28:31], v[112:127]
s_waitcnt vmcnt(0)
v_lshlrev_b32 v128, 16, v160
v_and_b32 v160, 0xffff0000, v160
v_lshlrev_b32 v129, 16, v161
v_and_b32 v161, 0xffff0000, v161
v_lshlrev_b32 v130, 16, v162
v_and_b32 v162, 0xffff0000, v162
v_lshlrev_b32 v131, 16, v163
v_and_b32 v163, 0xffff0000, v163
v_lshlrev_b32 v132, 16, v164
v_and_b32 v164, 0xffff0000, v164
v_lshlrev_b32 v133, 16, v165
v_and_b32 v165, 0xffff0000, v165
v_lshlrev_b32 v134, 16, v166
v_and_b32 v166, 0xffff0000, v166
v_lshlrev_b32 v135, 16, v167
v_and_b32 v167, 0xffff0000, v167
v_lshlrev_b32 v136, 16, v168
v_and_b32 v168, 0xffff0000, v168
v_lshlrev_b32 v137, 16, v169
v_and_b32 v169, 0xffff0000, v169
v_lshlrev_b32 v138, 16, v170
v_and_b32 v170, 0xffff0000, v170
v_lshlrev_b32 v139, 16, v171
v_and_b32 v171, 0xffff0000, v171
v_lshlrev_b32 v140, 16, v172
v_and_b32 v172, 0xffff0000, v172
v_lshlrev_b32 v141, 16, v173
v_and_b32 v173, 0xffff0000, v173
v_lshlrev_b32 v142, 16, v174
v_and_b32 v174, 0xffff0000, v174
v_lshlrev_b32 v143, 16, v175
v_and_b32 v175, 0xffff0000, v175
v_lshlrev_b32 v144, 16, v176
v_and_b32 v176, 0xffff0000, v176
v_lshlrev_b32 v145, 16, v177
v_and_b32 v177, 0xffff0000, v177
v_lshlrev_b32 v146, 16, v178
v_and_b32 v178, 0xffff0000, v178
v_lshlrev_b32 v147, 16, v179
v_and_b32 v179, 0xffff0000, v179
v_lshlrev_b32 v148, 16, v180
v_and_b32 v180, 0xffff0000, v180
v_lshlrev_b32 v149, 16, v181
v_and_b32 v181, 0xffff0000, v181
v_lshlrev_b32 v150, 16, v182
v_and_b32 v182, 0xffff0000, v182
v_lshlrev_b32 v151, 16, v183
v_and_b32 v183, 0xffff0000, v183
v_lshlrev_b32 v152, 16, v184
v_and_b32 v184, 0xffff0000, v184
v_lshlrev_b32 v153, 16, v185
v_and_b32 v185, 0xffff0000, v185
v_lshlrev_b32 v154, 16, v186
v_and_b32 v186, 0xffff0000, v186
v_lshlrev_b32 v155, 16, v187
v_and_b32 v187, 0xffff0000, v187
v_lshlrev_b32 v156, 16, v188
v_and_b32 v188, 0xffff0000, v188
v_lshlrev_b32 v157, 16, v189
v_and_b32 v189, 0xffff0000, v189
v_lshlrev_b32 v158, 16, v190
v_and_b32 v190, 0xffff0000, v190
v_lshlrev_b32 v159, 16, v191
v_and_b32 v191, 0xffff0000, v191
v_mul_f32 v7, v80, v160
v_mul_f32 v8, v64, v160
v_fma_f32 v64, v64, v128, -v7
v_fma_f32 v80, v80, v128, v8
v_mul_f32 v7, v81, v161
v_mul_f32 v8, v65, v161
v_fma_f32 v65, v65, v129, -v7
v_fma_f32 v81, v81, v129, v8
v_cvt_pk_bf16_f32 v16, v64, v65
v_cvt_pk_bf16_f32 v32, v80, v81
v_mul_f32 v7, v82, v162
v_mul_f32 v8, v66, v162
v_fma_f32 v66, v66, v130, -v7
v_fma_f32 v82, v82, v130, v8
v_mul_f32 v7, v83, v163
v_mul_f32 v8, v67, v163
v_fma_f32 v67, v67, v131, -v7
v_fma_f32 v83, v83, v131, v8
v_cvt_pk_bf16_f32 v17, v66, v67
v_cvt_pk_bf16_f32 v33, v82, v83
v_mul_f32 v7, v84, v164
v_mul_f32 v8, v68, v164
v_fma_f32 v68, v68, v132, -v7
v_fma_f32 v84, v84, v132, v8
v_mul_f32 v7, v85, v165
v_mul_f32 v8, v69, v165
v_fma_f32 v69, v69, v133, -v7
v_fma_f32 v85, v85, v133, v8
v_cvt_pk_bf16_f32 v18, v68, v69
v_cvt_pk_bf16_f32 v34, v84, v85
v_mul_f32 v7, v86, v166
v_mul_f32 v8, v70, v166
v_fma_f32 v70, v70, v134, -v7
v_fma_f32 v86, v86, v134, v8
v_mul_f32 v7, v87, v167
v_mul_f32 v8, v71, v167
v_fma_f32 v71, v71, v135, -v7
v_fma_f32 v87, v87, v135, v8
v_cvt_pk_bf16_f32 v19, v70, v71
v_cvt_pk_bf16_f32 v35, v86, v87
v_mul_f32 v7, v88, v168
v_mul_f32 v8, v72, v168
v_fma_f32 v72, v72, v136, -v7
v_fma_f32 v88, v88, v136, v8
v_mul_f32 v7, v89, v169
v_mul_f32 v8, v73, v169
v_fma_f32 v73, v73, v137, -v7
v_fma_f32 v89, v89, v137, v8
v_cvt_pk_bf16_f32 v20, v72, v73
v_cvt_pk_bf16_f32 v36, v88, v89
v_mul_f32 v7, v90, v170
v_mul_f32 v8, v74, v170
v_fma_f32 v74, v74, v138, -v7
v_fma_f32 v90, v90, v138, v8
v_mul_f32 v7, v91, v171
v_mul_f32 v8, v75, v171
v_fma_f32 v75, v75, v139, -v7
v_fma_f32 v91, v91, v139, v8
v_cvt_pk_bf16_f32 v21, v74, v75
v_cvt_pk_bf16_f32 v37, v90, v91
v_mul_f32 v7, v92, v172
v_mul_f32 v8, v76, v172
v_fma_f32 v76, v76, v140, -v7
v_fma_f32 v92, v92, v140, v8
v_mul_f32 v7, v93, v173
v_mul_f32 v8, v77, v173
v_fma_f32 v77, v77, v141, -v7
v_fma_f32 v93, v93, v141, v8
v_cvt_pk_bf16_f32 v22, v76, v77
v_cvt_pk_bf16_f32 v38, v92, v93
v_mul_f32 v7, v94, v174
v_mul_f32 v8, v78, v174
v_fma_f32 v78, v78, v142, -v7
v_fma_f32 v94, v94, v142, v8
v_mul_f32 v7, v95, v175
v_mul_f32 v8, v79, v175
v_fma_f32 v79, v79, v143, -v7
v_fma_f32 v95, v95, v143, v8
v_cvt_pk_bf16_f32 v23, v78, v79
v_cvt_pk_bf16_f32 v39, v94, v95
v_mul_f32 v7, v112, v176
v_mul_f32 v8, v96, v176
v_fma_f32 v96, v96, v144, -v7
v_fma_f32 v112, v112, v144, v8
v_mul_f32 v7, v113, v177
v_mul_f32 v8, v97, v177
v_fma_f32 v97, v97, v145, -v7
v_fma_f32 v113, v113, v145, v8
v_cvt_pk_bf16_f32 v24, v96, v97
v_cvt_pk_bf16_f32 v40, v112, v113
v_mul_f32 v7, v114, v178
v_mul_f32 v8, v98, v178
v_fma_f32 v98, v98, v146, -v7
v_fma_f32 v114, v114, v146, v8
v_mul_f32 v7, v115, v179
v_mul_f32 v8, v99, v179
v_fma_f32 v99, v99, v147, -v7
v_fma_f32 v115, v115, v147, v8
v_cvt_pk_bf16_f32 v25, v98, v99
v_cvt_pk_bf16_f32 v41, v114, v115
v_mul_f32 v7, v116, v180
v_mul_f32 v8, v100, v180
v_fma_f32 v100, v100, v148, -v7
v_fma_f32 v116, v116, v148, v8
v_mul_f32 v7, v117, v181
v_mul_f32 v8, v101, v181
v_fma_f32 v101, v101, v149, -v7
v_fma_f32 v117, v117, v149, v8
v_cvt_pk_bf16_f32 v26, v100, v101
v_cvt_pk_bf16_f32 v42, v116, v117
v_mul_f32 v7, v118, v182
v_mul_f32 v8, v102, v182
v_fma_f32 v102, v102, v150, -v7
v_fma_f32 v118, v118, v150, v8
v_mul_f32 v7, v119, v183
v_mul_f32 v8, v103, v183
v_fma_f32 v103, v103, v151, -v7
v_fma_f32 v119, v119, v151, v8
v_cvt_pk_bf16_f32 v27, v102, v103
v_cvt_pk_bf16_f32 v43, v118, v119
v_mul_f32 v7, v120, v184
v_mul_f32 v8, v104, v184
v_fma_f32 v104, v104, v152, -v7
v_fma_f32 v120, v120, v152, v8
v_mul_f32 v7, v121, v185
v_mul_f32 v8, v105, v185
v_fma_f32 v105, v105, v153, -v7
v_fma_f32 v121, v121, v153, v8
v_cvt_pk_bf16_f32 v28, v104, v105
v_cvt_pk_bf16_f32 v44, v120, v121
v_mul_f32 v7, v122, v186
v_mul_f32 v8, v106, v186
v_fma_f32 v106, v106, v154, -v7
v_fma_f32 v122, v122, v154, v8
v_mul_f32 v7, v123, v187
v_mul_f32 v8, v107, v187
v_fma_f32 v107, v107, v155, -v7
v_fma_f32 v123, v123, v155, v8
v_cvt_pk_bf16_f32 v29, v106, v107
v_cvt_pk_bf16_f32 v45, v122, v123
v_mul_f32 v7, v124, v188
v_mul_f32 v8, v108, v188
v_fma_f32 v108, v108, v156, -v7
v_fma_f32 v124, v124, v156, v8
v_mul_f32 v7, v125, v189
v_mul_f32 v8, v109, v189
v_fma_f32 v109, v109, v157, -v7
v_fma_f32 v125, v125, v157, v8
v_cvt_pk_bf16_f32 v30, v108, v109
v_cvt_pk_bf16_f32 v46, v124, v125
v_mul_f32 v7, v126, v190
v_mul_f32 v8, v110, v190
v_fma_f32 v110, v110, v158, -v7
v_fma_f32 v126, v126, v158, v8
v_mul_f32 v7, v127, v191
v_mul_f32 v8, v111, v191
v_fma_f32 v111, v111, v159, -v7
v_fma_f32 v127, v127, v159, v8
v_cvt_pk_bf16_f32 v31, v110, v111
v_cvt_pk_bf16_f32 v47, v126, v127
v_mfma_f32_32x32x16_bf16 v[64:79], v[16:19], a[96:99], 0
v_mfma_f32_32x32x16_bf16 v[80:95], v[32:35], a[96:99], 0
v_mfma_f32_32x32x16_bf16 v[64:79], v[32:35], a[112:115], v[64:79]
v_mfma_f32_32x32x16_bf16 v[80:95], v[16:19], a[104:107], v[80:95]
v_mfma_f32_32x32x16_bf16 v[64:79], v[20:23], a[100:103], v[64:79]
v_mfma_f32_32x32x16_bf16 v[80:95], v[36:39], a[100:103], v[80:95]
v_mfma_f32_32x32x16_bf16 v[64:79], v[36:39], a[116:119], v[64:79]
v_mfma_f32_32x32x16_bf16 v[80:95], v[20:23], a[108:111], v[80:95]
v_mfma_f32_32x32x16_bf16 v[96:111], v[24:27], a[96:99], 0
v_mfma_f32_32x32x16_bf16 v[112:127], v[40:43], a[96:99], 0
v_mfma_f32_32x32x16_bf16 v[96:111], v[40:43], a[112:115], v[96:111]
v_mfma_f32_32x32x16_bf16 v[112:127], v[24:27], a[104:107], v[112:127]
v_mfma_f32_32x32x16_bf16 v[96:111], v[28:31], a[100:103], v[96:111]
v_mfma_f32_32x32x16_bf16 v[112:127], v[44:47], a[100:103], v[112:127]
v_mfma_f32_32x32x16_bf16 v[96:111], v[44:47], a[116:119], v[96:111]
v_mfma_f32_32x32x16_bf16 v[112:127], v[28:31], a[108:111], v[112:127]
v_mul_f32 v9, 973078528, v3
v_mul_f32 v10, v4, v9
v_fmamk_f32 v6, v9, 0, v10
v_cos_f32 v5, v6
v_sin_f32 v6, v6
s_nop 0
v_mul_f32 v7, v80, v6
v_mul_f32 v8, v64, v6
v_fma_f32 v64, v64, v5, -v7
v_fma_f32 v80, v80, v5, v8
v_fmamk_f32 v6, v9, 1065353216, v10
v_cos_f32 v5, v6
v_sin_f32 v6, v6
s_nop 0
v_mul_f32 v7, v81, v6
v_mul_f32 v8, v65, v6
v_fma_f32 v65, v65, v5, -v7
v_fma_f32 v81, v81, v5, v8
v_cvt_pk_bf16_f32 v16, v64, v65
v_cvt_pk_bf16_f32 v32, v80, v81
v_fmamk_f32 v6, v9, 1073741824, v10
v_cos_f32 v5, v6
v_sin_f32 v6, v6
s_nop 0
v_mul_f32 v7, v82, v6
v_mul_f32 v8, v66, v6
v_fma_f32 v66, v66, v5, -v7
v_fma_f32 v82, v82, v5, v8
v_fmamk_f32 v6, v9, 1077936128, v10
v_cos_f32 v5, v6
v_sin_f32 v6, v6
s_nop 0
v_mul_f32 v7, v83, v6
v_mul_f32 v8, v67, v6
v_fma_f32 v67, v67, v5, -v7
v_fma_f32 v83, v83, v5, v8
v_cvt_pk_bf16_f32 v17, v66, v67
v_cvt_pk_bf16_f32 v33, v82, v83
v_fmamk_f32 v6, v9, 1082130432, v10
v_cos_f32 v5, v6
v_sin_f32 v6, v6
s_nop 0
v_mul_f32 v7, v84, v6
v_mul_f32 v8, v68, v6
v_fma_f32 v68, v68, v5, -v7
v_fma_f32 v84, v84, v5, v8
v_fmamk_f32 v6, v9, 1084227584, v10
v_cos_f32 v5, v6
v_sin_f32 v6, v6
s_nop 0
v_mul_f32 v7, v85, v6
v_mul_f32 v8, v69, v6
v_fma_f32 v69, v69, v5, -v7
v_fma_f32 v85, v85, v5, v8
v_cvt_pk_bf16_f32 v18, v68, v69
v_cvt_pk_bf16_f32 v34, v84, v85
v_fmamk_f32 v6, v9, 1086324736, v10
v_cos_f32 v5, v6
v_sin_f32 v6, v6
s_nop 0
v_mul_f32 v7, v86, v6
v_mul_f32 v8, v70, v6
v_fma_f32 v70, v70, v5, -v7
v_fma_f32 v86, v86, v5, v8
v_fmamk_f32 v6, v9, 1088421888, v10
v_cos_f32 v5, v6
v_sin_f32 v6, v6
s_nop 0
v_mul_f32 v7, v87, v6
v_mul_f32 v8, v71, v6
v_fma_f32 v71, v71, v5, -v7
v_fma_f32 v87, v87, v5, v8
v_cvt_pk_bf16_f32 v19, v70, v71
v_cvt_pk_bf16_f32 v35, v86, v87
v_fmamk_f32 v6, v9, 1098907648, v10
v_cos_f32 v5, v6
v_sin_f32 v6, v6
s_nop 0
v_mul_f32 v7, v88, v6
v_mul_f32 v8, v72, v6
v_fma_f32 v72, v72, v5, -v7
v_fma_f32 v88, v88, v5, v8
v_fmamk_f32 v6, v9, 1099431936, v10
v_cos_f32 v5, v6
v_sin_f32 v6, v6
s_nop 0
v_mul_f32 v7, v89, v6
v_mul_f32 v8, v73, v6
v_fma_f32 v73, v73, v5, -v7
v_fma_f32 v89, v89, v5, v8
v_cvt_pk_bf16_f32 v20, v72, v73
v_cvt_pk_bf16_f32 v36, v88, v89
v_fmamk_f32 v6, v9, 1099956224, v10
v_cos_f32 v5, v6
v_sin_f32 v6, v6
s_nop 0
v_mul_f32 v7, v90, v6
v_mul_f32 v8, v74, v6
v_fma_f32 v74, v74, v5, -v7
v_fma_f32 v90, v90, v5, v8
v_fmamk_f32 v6, v9, 1100480512, v10
v_cos_f32 v5, v6
v_sin_f32 v6, v6
s_nop 0
v_mul_f32 v7, v91, v6
v_mul_f32 v8, v75, v6
v_fma_f32 v75, v75, v5, -v7
v_fma_f32 v91, v91, v5, v8
v_cvt_pk_bf16_f32 v21, v74, v75
v_cvt_pk_bf16_f32 v37, v90, v91
v_fmamk_f32 v6, v9, 1101004800, v10
v_cos_f32 v5, v6
v_sin_f32 v6, v6
s_nop 0
v_mul_f32 v7, v92, v6
v_mul_f32 v8, v76, v6
v_fma_f32 v76, v76, v5, -v7
v_fma_f32 v92, v92, v5, v8
v_fmamk_f32 v6, v9, 1101529088, v10
v_cos_f32 v5, v6
v_sin_f32 v6, v6
s_nop 0
v_mul_f32 v7, v93, v6
v_mul_f32 v8, v77, v6
v_fma_f32 v77, v77, v5, -v7
v_fma_f32 v93, v93, v5, v8
v_cvt_pk_bf16_f32 v22, v76, v77
v_cvt_pk_bf16_f32 v38, v92, v93
v_fmamk_f32 v6, v9, 1102053376, v10
v_cos_f32 v5, v6
v_sin_f32 v6, v6
s_nop 0
v_mul_f32 v7, v94, v6
v_mul_f32 v8, v78, v6
v_fma_f32 v78, v78, v5, -v7
v_fma_f32 v94, v94, v5, v8
v_fmamk_f32 v6, v9, 1102577664, v10
v_cos_f32 v5, v6
v_sin_f32 v6, v6
s_nop 0
v_mul_f32 v7, v95, v6
v_mul_f32 v8, v79, v6
v_fma_f32 v79, v79, v5, -v7
v_fma_f32 v95, v95, v5, v8
v_cvt_pk_bf16_f32 v23, v78, v79
v_cvt_pk_bf16_f32 v39, v94, v95
v_fmamk_f32 v6, v9, 1107296256, v10
v_cos_f32 v5, v6
v_sin_f32 v6, v6
s_nop 0
v_mul_f32 v7, v112, v6
v_mul_f32 v8, v96, v6
v_fma_f32 v96, v96, v5, -v7
v_fma_f32 v112, v112, v5, v8
v_fmamk_f32 v6, v9, 1107558400, v10
v_cos_f32 v5, v6
v_sin_f32 v6, v6
s_nop 0
v_mul_f32 v7, v113, v6
v_mul_f32 v8, v97, v6
v_fma_f32 v97, v97, v5, -v7
v_fma_f32 v113, v113, v5, v8
v_cvt_pk_bf16_f32 v24, v96, v97
v_cvt_pk_bf16_f32 v40, v112, v113
v_fmamk_f32 v6, v9, 1107820544, v10
v_cos_f32 v5, v6
v_sin_f32 v6, v6
s_nop 0
v_mul_f32 v7, v114, v6
v_mul_f32 v8, v98, v6
v_fma_f32 v98, v98, v5, -v7
v_fma_f32 v114, v114, v5, v8
v_fmamk_f32 v6, v9, 1108082688, v10
v_cos_f32 v5, v6
v_sin_f32 v6, v6
s_nop 0
v_mul_f32 v7, v115, v6
v_mul_f32 v8, v99, v6
v_fma_f32 v99, v99, v5, -v7
v_fma_f32 v115, v115, v5, v8
v_cvt_pk_bf16_f32 v25, v98, v99
v_cvt_pk_bf16_f32 v41, v114, v115
v_fmamk_f32 v6, v9, 1108344832, v10
v_cos_f32 v5, v6
v_sin_f32 v6, v6
s_nop 0
v_mul_f32 v7, v116, v6
v_mul_f32 v8, v100, v6
v_fma_f32 v100, v100, v5, -v7
v_fma_f32 v116, v116, v5, v8
v_fmamk_f32 v6, v9, 1108606976, v10
v_cos_f32 v5, v6
v_sin_f32 v6, v6
s_nop 0
v_mul_f32 v7, v117, v6
v_mul_f32 v8, v101, v6
v_fma_f32 v101, v101, v5, -v7
v_fma_f32 v117, v117, v5, v8
v_cvt_pk_bf16_f32 v26, v100, v101
v_cvt_pk_bf16_f32 v42, v116, v117
v_fmamk_f32 v6, v9, 1108869120, v10
v_cos_f32 v5, v6
v_sin_f32 v6, v6
s_nop 0
v_mul_f32 v7, v118, v6
v_mul_f32 v8, v102, v6
v_fma_f32 v102, v102, v5, -v7
v_fma_f32 v118, v118, v5, v8
v_fmamk_f32 v6, v9, 1109131264, v10
v_cos_f32 v5, v6
v_sin_f32 v6, v6
s_nop 0
v_mul_f32 v7, v119, v6
v_mul_f32 v8, v103, v6
v_fma_f32 v103, v103, v5, -v7
v_fma_f32 v119, v119, v5, v8
v_cvt_pk_bf16_f32 v27, v102, v103
v_cvt_pk_bf16_f32 v43, v118, v119
v_fmamk_f32 v6, v9, 1111490560, v10
v_cos_f32 v5, v6
v_sin_f32 v6, v6
s_nop 0
v_mul_f32 v7, v120, v6
v_mul_f32 v8, v104, v6
v_fma_f32 v104, v104, v5, -v7
v_fma_f32 v120, v120, v5, v8
v_fmamk_f32 v6, v9, 1111752704, v10
v_cos_f32 v5, v6
v_sin_f32 v6, v6
s_nop 0
v_mul_f32 v7, v121, v6
v_mul_f32 v8, v105, v6
v_fma_f32 v105, v105, v5, -v7
v_fma_f32 v121, v121, v5, v8
v_cvt_pk_bf16_f32 v28, v104, v105
v_cvt_pk_bf16_f32 v44, v120, v121
v_fmamk_f32 v6, v9, 1112014848, v10
v_cos_f32 v5, v6
v_sin_f32 v6, v6
s_nop 0
v_mul_f32 v7, v122, v6
v_mul_f32 v8, v106, v6
v_fma_f32 v106, v106, v5, -v7
v_fma_f32 v122, v122, v5, v8
v_fmamk_f32 v6, v9, 1112276992, v10
v_cos_f32 v5, v6
v_sin_f32 v6, v6
s_nop 0
v_mul_f32 v7, v123, v6
v_mul_f32 v8, v107, v6
v_fma_f32 v107, v107, v5, -v7
v_fma_f32 v123, v123, v5, v8
v_cvt_pk_bf16_f32 v29, v106, v107
v_cvt_pk_bf16_f32 v45, v122, v123
v_fmamk_f32 v6, v9, 1112539136, v10
v_cos_f32 v5, v6
v_sin_f32 v6, v6
s_nop 0
v_mul_f32 v7, v124, v6
v_mul_f32 v8, v108, v6
v_fma_f32 v108, v108, v5, -v7
v_fma_f32 v124, v124, v5, v8
v_fmamk_f32 v6, v9, 1112801280, v10
v_cos_f32 v5, v6
v_sin_f32 v6, v6
s_nop 0
v_mul_f32 v7, v125, v6
v_mul_f32 v8, v109, v6
v_fma_f32 v109, v109, v5, -v7
v_fma_f32 v125, v125, v5, v8
v_cvt_pk_bf16_f32 v30, v108, v109
v_cvt_pk_bf16_f32 v46, v124, v125
v_fmamk_f32 v6, v9, 1113063424, v10
v_cos_f32 v5, v6
v_sin_f32 v6, v6
s_nop 0
v_mul_f32 v7, v126, v6
v_mul_f32 v8, v110, v6
v_fma_f32 v110, v110, v5, -v7
v_fma_f32 v126, v126, v5, v8
v_fmamk_f32 v6, v9, 1113325568, v10
v_cos_f32 v5, v6
v_sin_f32 v6, v6
s_nop 0
v_mul_f32 v7, v127, v6
v_mul_f32 v8, v111, v6
v_fma_f32 v111, v111, v5, -v7
v_fma_f32 v127, v127, v5, v8
v_cvt_pk_bf16_f32 v31, v110, v111
v_cvt_pk_bf16_f32 v47, v126, v127
v_mfma_f32_32x32x16_bf16 v[64:79], v[16:19], a[0:3], 0
v_mfma_f32_32x32x16_bf16 v[80:95], v[32:35], a[0:3], 0
v_mfma_f32_32x32x16_bf16 v[64:79], v[32:35], a[64:67], v[64:79]
v_mfma_f32_32x32x16_bf16 v[80:95], v[16:19], a[32:35], v[80:95]
v_mfma_f32_32x32x16_bf16 v[64:79], v[20:23], a[4:7], v[64:79]
v_mfma_f32_32x32x16_bf16 v[80:95], v[36:39], a[4:7], v[80:95]
v_mfma_f32_32x32x16_bf16 v[64:79], v[36:39], a[68:71], v[64:79]
v_mfma_f32_32x32x16_bf16 v[80:95], v[20:23], a[36:39], v[80:95]
v_mfma_f32_32x32x16_bf16 v[64:79], v[24:27], a[8:11], v[64:79]
v_mfma_f32_32x32x16_bf16 v[80:95], v[40:43], a[8:11], v[80:95]
v_mfma_f32_32x32x16_bf16 v[64:79], v[40:43], a[72:75], v[64:79]
v_mfma_f32_32x32x16_bf16 v[80:95], v[24:27], a[40:43], v[80:95]
v_mfma_f32_32x32x16_bf16 v[64:79], v[28:31], a[12:15], v[64:79]
v_mfma_f32_32x32x16_bf16 v[80:95], v[44:47], a[12:15], v[80:95]
v_mfma_f32_32x32x16_bf16 v[64:79], v[44:47], a[76:79], v[64:79]
v_mfma_f32_32x32x16_bf16 v[80:95], v[28:31], a[44:47], v[80:95]
v_mfma_f32_32x32x16_bf16 v[96:111], v[16:19], a[16:19], 0
v_mfma_f32_32x32x16_bf16 v[112:127], v[32:35], a[16:19], 0
v_mfma_f32_32x32x16_bf16 v[96:111], v[32:35], a[80:83], v[96:111]
v_mfma_f32_32x32x16_bf16 v[112:127], v[16:19], a[48:51], v[112:127]
v_mfma_f32_32x32x16_bf16 v[96:111], v[20:23], a[20:23], v[96:111]
v_mfma_f32_32x32x16_bf16 v[112:127], v[36:39], a[20:23], v[112:127]
v_mfma_f32_32x32x16_bf16 v[96:111], v[36:39], a[84:87], v[96:111]
v_mfma_f32_32x32x16_bf16 v[112:127], v[20:23], a[52:55], v[112:127]
v_mfma_f32_32x32x16_bf16 v[96:111], v[24:27], a[24:27], v[96:111]
v_mfma_f32_32x32x16_bf16 v[112:127], v[40:43], a[24:27], v[112:127]
v_mfma_f32_32x32x16_bf16 v[96:111], v[40:43], a[88:91], v[96:111]
v_mfma_f32_32x32x16_bf16 v[112:127], v[24:27], a[56:59], v[112:127]
v_mfma_f32_32x32x16_bf16 v[96:111], v[28:31], a[28:31], v[96:111]
v_mfma_f32_32x32x16_bf16 v[112:127], v[44:47], a[28:31], v[112:127]
v_mfma_f32_32x32x16_bf16 v[96:111], v[44:47], a[92:95], v[96:111]
v_mfma_f32_32x32x16_bf16 v[112:127], v[28:31], a[60:63], v[112:127]
v_mul_f32 v64, s20, v64
v_mul_f32 v65, s20, v65
v_mul_f32 v66, s20, v66
v_mul_f32 v67, s20, v67
v_mul_f32 v68, s20, v68
v_mul_f32 v69, s20, v69
v_mul_f32 v70, s20, v70
v_mul_f32 v71, s20, v71
v_mul_f32 v72, s20, v72
v_mul_f32 v73, s20, v73
v_mul_f32 v74, s20, v74
v_mul_f32 v75, s20, v75
v_mul_f32 v76, s20, v76
v_mul_f32 v77, s20, v77
v_mul_f32 v78, s20, v78
v_mul_f32 v79, s20, v79
v_mul_f32 v80, s20, v80
v_mul_f32 v81, s20, v81
v_mul_f32 v82, s20, v82
v_mul_f32 v83, s20, v83
v_mul_f32 v84, s20, v84
v_mul_f32 v85, s20, v85
v_mul_f32 v86, s20, v86
v_mul_f32 v87, s20, v87
v_mul_f32 v88, s20, v88
v_mul_f32 v89, s20, v89
v_mul_f32 v90, s20, v90
v_mul_f32 v91, s20, v91
v_mul_f32 v92, s20, v92
v_mul_f32 v93, s20, v93
v_mul_f32 v94, s20, v94
v_mul_f32 v95, s20, v95
v_mul_f32 v96, s20, v96
v_mul_f32 v97, s20, v97
v_mul_f32 v98, s20, v98
v_mul_f32 v99, s20, v99
v_mul_f32 v100, s20, v100
v_mul_f32 v101, s20, v101
v_mul_f32 v102, s20, v102
v_mul_f32 v103, s20, v103
v_mul_f32 v104, s20, v104
v_mul_f32 v105, s20, v105
v_mul_f32 v106, s20, v106
v_mul_f32 v107, s20, v107
v_mul_f32 v108, s20, v108
v_mul_f32 v109, s20, v109
v_mul_f32 v110, s20, v110
v_mul_f32 v111, s20, v111
v_mul_f32 v112, s20, v112
v_mul_f32 v113, s20, v113
v_mul_f32 v114, s20, v114
v_mul_f32 v115, s20, v115
v_mul_f32 v116, s20, v116
v_mul_f32 v117, s20, v117
v_mul_f32 v118, s20, v118
v_mul_f32 v119, s20, v119
v_mul_f32 v120, s20, v120
v_mul_f32 v121, s20, v121
v_mul_f32 v122, s20, v122
v_mul_f32 v123, s20, v123
v_mul_f32 v124, s20, v124
v_mul_f32 v125, s20, v125
v_mul_f32 v126, s20, v126
v_mul_f32 v127, s20, v127
v_cvt_pk_bf16_f32 v16, v64, v65
v_cvt_pk_bf16_f32 v17, v66, v67
v_cvt_pk_bf16_f32 v18, v68, v69
v_cvt_pk_bf16_f32 v19, v70, v71
v_cvt_pk_bf16_f32 v20, v72, v73
v_cvt_pk_bf16_f32 v21, v74, v75
v_cvt_pk_bf16_f32 v22, v76, v77
v_cvt_pk_bf16_f32 v23, v78, v79
v_cvt_pk_bf16_f32 v24, v80, v81
v_cvt_pk_bf16_f32 v25, v82, v83
v_cvt_pk_bf16_f32 v26, v84, v85
v_cvt_pk_bf16_f32 v27, v86, v87
v_cvt_pk_bf16_f32 v28, v88, v89
v_cvt_pk_bf16_f32 v29, v90, v91
v_cvt_pk_bf16_f32 v30, v92, v93
v_cvt_pk_bf16_f32 v31, v94, v95
v_cvt_pk_bf16_f32 v32, v96, v97
v_cvt_pk_bf16_f32 v33, v98, v99
v_cvt_pk_bf16_f32 v34, v100, v101
v_cvt_pk_bf16_f32 v35, v102, v103
v_cvt_pk_bf16_f32 v36, v104, v105
v_cvt_pk_bf16_f32 v37, v106, v107
v_cvt_pk_bf16_f32 v38, v108, v109
v_cvt_pk_bf16_f32 v39, v110, v111
v_cvt_pk_bf16_f32 v40, v112, v113
v_cvt_pk_bf16_f32 v41, v114, v115
v_cvt_pk_bf16_f32 v42, v116, v117
v_cvt_pk_bf16_f32 v43, v118, v119
v_cvt_pk_bf16_f32 v44, v120, v121
v_cvt_pk_bf16_f32 v45, v122, v123
v_cvt_pk_bf16_f32 v46, v124, v125
v_cvt_pk_bf16_f32 v47, v126, v127
s_add_u32 s28, s25, 0
buffer_store_dwordx4 v[16:19], v2, s[8:11], s28 offen offset:0
buffer_store_dwordx4 v[20:23], v2, s[8:11], s28 offen offset:32
s_add_u32 s28, s26, 0
buffer_store_dwordx4 v[24:27], v2, s[8:11], s28 offen offset:0
buffer_store_dwordx4 v[28:31], v2, s[8:11], s28 offen offset:32
s_add_u32 s28, s25, 1056768
buffer_store_dwordx4 v[32:35], v2, s[8:11], s28 offen offset:0
buffer_store_dwordx4 v[36:39], v2, s[8:11], s28 offen offset:32
s_add_u32 s28, s26, 1056768
buffer_store_dwordx4 v[40:43], v2, s[8:11], s28 offen offset:0
buffer_store_dwordx4 v[44:47], v2, s[8:11], s28 offen offset:32
s_add_u32 s21, s21, 256
s_cmp_le_u32 s21, 256
s_cbranch_scc1 Lg_k
s_waitcnt vmcnt(0) lgkmcnt(0)
s_barrier
s_cmp_lg_u32 s17, 0
s_cbranch_scc1 L_pb_27
buffer_wbl2 sc1
s_waitcnt vmcnt(0)
v_mov_b32 v5, 40
v_mov_b32 v6, 1
s_mov_b64 exec, 1
global_atomic_add v5, v6, s[6:7]
s_mov_b64 exec, -1
L_pb_27:
s_and_b32 s21, s62, 3
s_lshr_b32 s22, s62, 2
v_mbcnt_lo_u32_b32 v51, -1, 0
v_mbcnt_hi_u32_b32 v51, -1, v51
s_lshl_b32 s28, s17, 6
v_add_u32 v51, s28, v51
v_bfe_u32 v0, v51, 0, 6
v_lshlrev_b32 v0, 4, v0
v_bfe_u32 v1, v51, 5, 1
v_lshlrev_b32 v1, 9, v1
v_bfe_u32 v50, v51, 2, 2
v_lshl_add_u32 v1, v50, 6, v1
v_bfe_u32 v50, v51, 4, 1
v_lshl_add_u32 v1, v50, 5, v1
v_bfe_u32 v50, v51, 0, 2
v_lshl_add_u32 v1, v50, 3, v1
s_lshl_b32 s28, s21, 7
v_bfe_u32 v49, v51, 2, 1
v_lshlrev_b32 v49, 4, v49
v_bfe_u32 v50, v51, 3, 2
v_lshl_add_u32 v49, v50, 2, v49
v_bfe_u32 v50, v51, 0, 2
v_lshl_add_u32 v49, v50, 0, v49
v_bfe_u32 v50, v51, 6, 2
v_lshl_add_u32 v49, v50, 5, v49
v_add_u32 v49, s28, v49
v_cvt_f32_u32 v3, v49
v_mul_f32 v3, 989855744, v3
v_bfe_u32 v49, v51, 5, 1
v_lshlrev_b32 v49, 3, v49
v_cvt_f32_u32 v48, v49
v_mul_f32 v4, v48, v3
v_add_f32 v5, 1048576000, v4
v_cmp_eq_u32 vcc, 0, v49
s_lshl_b32 s28, s21, 8
s_lshl_b32 s29, s22, 18
s_add_u32 s28, s28, s29
v_bfe_u32 v2, v51, 0, 5
v_lshlrev_b32 v2, 11, v2
v_bfe_u32 v50, v51, 6, 2
v_lshl_add_u32 v2, v50, 6, v2
v_bfe_u32 v50, v51, 5, 1
v_lshl_add_u32 v2, v50, 5, v2
v_add_u32 v2, s28, v2
v_fmamk_f32 v8, v3, 0, v4
v_fmamk_f32 v9, v3, 1065353216, v4
v_cos_f32 v8, v8
v_cos_f32 v9, v9
v_fmamk_f32 v6, v3, 1073741824, v4
v_fmamk_f32 v7, v3, 1077936128, v4
v_cos_f32 v6, v6
v_cos_f32 v7, v7
v_cvt_pk_bf16_f32 v128, v8, v9
v_fmamk_f32 v8, v3, 1082130432, v4
v_fmamk_f32 v9, v3, 1084227584, v4
v_cos_f32 v8, v8
v_cos_f32 v9, v9
v_cvt_pk_bf16_f32 v129, v6, v7
v_fmamk_f32 v6, v3, 1086324736, v4
v_fmamk_f32 v7, v3, 1088421888, v4
v_cos_f32 v6, v6
v_cos_f32 v7, v7
v_cvt_pk_bf16_f32 v130, v8, v9
v_fmamk_f32 v8, v3, 1098907648, v4
v_fmamk_f32 v9, v3, 1099431936, v4
v_cos_f32 v8, v8
v_cos_f32 v9, v9
v_cvt_pk_bf16_f32 v131, v6, v7
v_fmamk_f32 v6, v3, 1099956224, v4
v_fmamk_f32 v7, v3, 1100480512, v4
v_cos_f32 v6, v6
v_cos_f32 v7, v7
v_cvt_pk_bf16_f32 v132, v8, v9
v_fmamk_f32 v8, v3, 1101004800, v4
v_fmamk_f32 v9, v3, 1101529088, v4
v_cos_f32 v8, v8
v_cos_f32 v9, v9
v_cvt_pk_bf16_f32 v133, v6, v7
v_fmamk_f32 v6, v3, 1102053376, v4
v_fmamk_f32 v7, v3, 1102577664, v4
v_cos_f32 v6, v6
v_cos_f32 v7, v7
v_cvt_pk_bf16_f32 v134, v8, v9
v_fmamk_f32 v8, v3, 1107296256, v4
v_fmamk_f32 v9, v3, 1107558400, v4
v_cos_f32 v8, v8
v_cos_f32 v9, v9
v_cvt_pk_bf16_f32 v135, v6, v7
v_fmamk_f32 v6, v3, 1107820544, v4
v_fmamk_f32 v7, v3, 1108082688, v4
v_cos_f32 v6, v6
v_cos_f32 v7, v7
v_cvt_pk_bf16_f32 v136, v8, v9
v_fmamk_f32 v8, v3, 1108344832, v4
v_fmamk_f32 v9, v3, 1108606976, v4
v_cos_f32 v8, v8
v_cos_f32 v9, v9
v_cvt_pk_bf16_f32 v137, v6, v7
v_fmamk_f32 v6, v3, 1108869120, v4
v_fmamk_f32 v7, v3, 1109131264, v4
v_cos_f32 v6, v6
v_cos_f32 v7, v7
v_cvt_pk_bf16_f32 v138, v8, v9
v_fmamk_f32 v8, v3, 1111490560, v4
v_fmamk_f32 v9, v3, 1111752704, v4
v_cos_f32 v8, v8
v_cos_f32 v9, v9
v_cvt_pk_bf16_f32 v139, v6, v7
v_fmamk_f32 v6, v3, 1112014848, v4
v_fmamk_f32 v7, v3, 1112276992, v4
v_cos_f32 v6, v6
v_cos_f32 v7, v7
v_cvt_pk_bf16_f32 v140, v8, v9
v_fmamk_f32 v8, v3, 1112539136, v4
v_fmamk_f32 v9, v3, 1112801280, v4
v_cos_f32 v8, v8
v_cos_f32 v9, v9
v_cvt_pk_bf16_f32 v141, v6, v7
v_fmamk_f32 v6, v3, 1113063424, v4
v_fmamk_f32 v7, v3, 1113325568, v4
v_cos_f32 v6, v6
v_cos_f32 v7, v7
v_cvt_pk_bf16_f32 v142, v8, v9
v_fmamk_f32 v8, v3, 1115684864, v4
v_fmamk_f32 v9, v3, 1115815936, v4
v_cos_f32 v8, v8
v_cos_f32 v9, v9
v_cvt_pk_bf16_f32 v143, v6, v7
v_fmamk_f32 v6, v3, 1115947008, v4
v_fmamk_f32 v7, v3, 1116078080, v4
v_cos_f32 v6, v6
v_cos_f32 v7, v7
v_cvt_pk_bf16_f32 v144, v8, v9
v_fmamk_f32 v8, v3, 1116209152, v4
v_fmamk_f32 v9, v3, 1116340224, v4
v_cos_f32 v8, v8
v_cos_f32 v9, v9
v_cvt_pk_bf16_f32 v145, v6, v7
v_fmamk_f32 v6, v3, 1116471296, v4
v_fmamk_f32 v7, v3, 1116602368, v4
v_cos_f32 v6, v6
v_cos_f32 v7, v7
v_cvt_pk_bf16_f32 v146, v8, v9
v_fmamk_f32 v8, v3, 1117782016, v4
v_fmamk_f32 v9, v3, 1117913088, v4
v_cos_f32 v8, v8
v_cos_f32 v9, v9
v_cvt_pk_bf16_f32 v147, v6, v7
v_fmamk_f32 v6, v3, 1118044160, v4
v_fmamk_f32 v7, v3, 1118175232, v4
v_cos_f32 v6, v6
v_cos_f32 v7, v7
v_cvt_pk_bf16_f32 v148, v8, v9
v_fmamk_f32 v8, v3, 1118306304, v4
v_fmamk_f32 v9, v3, 1118437376, v4
v_cos_f32 v8, v8
v_cos_f32 v9, v9
v_cvt_pk_bf16_f32 v149, v6, v7
v_fmamk_f32 v6, v3, 1118568448, v4
v_fmamk_f32 v7, v3, 1118699520, v4
v_cos_f32 v6, v6
v_cos_f32 v7, v7
v_cvt_pk_bf16_f32 v150, v8, v9
v_fmamk_f32 v8, v3, 1119879168, v4
v_fmamk_f32 v9, v3, 1120010240, v4
v_cos_f32 v8, v8
v_cos_f32 v9, v9
v_cvt_pk_bf16_f32 v151, v6, v7
v_fmamk_f32 v6, v3, 1120141312, v4
v_fmamk_f32 v7, v3, 1120272384, v4
v_cos_f32 v6, v6
v_cos_f32 v7, v7
v_cvt_pk_bf16_f32 v152, v8, v9
v_fmamk_f32 v8, v3, 1120403456, v4
v_fmamk_f32 v9, v3, 1120534528, v4
v_cos_f32 v8, v8
v_cos_f32 v9, v9
v_cvt_pk_bf16_f32 v153, v6, v7
v_fmamk_f32 v6, v3, 1120665600, v4
v_fmamk_f32 v7, v3, 1120796672, v4
v_cos_f32 v6, v6
v_cos_f32 v7, v7
v_cvt_pk_bf16_f32 v154, v8, v9
v_fmamk_f32 v8, v3, 1121976320, v4
v_fmamk_f32 v9, v3, 1122107392, v4
v_cos_f32 v8, v8
v_cos_f32 v9, v9
v_cvt_pk_bf16_f32 v155, v6, v7
v_fmamk_f32 v6, v3, 1122238464, v4
v_fmamk_f32 v7, v3, 1122369536, v4
v_cos_f32 v6, v6
v_cos_f32 v7, v7
v_cvt_pk_bf16_f32 v156, v8, v9
v_fmamk_f32 v8, v3, 1122500608, v4
v_fmamk_f32 v9, v3, 1122631680, v4
v_cos_f32 v8, v8
v_cos_f32 v9, v9
v_cvt_pk_bf16_f32 v157, v6, v7
v_fmamk_f32 v6, v3, 1122762752, v4
v_fmamk_f32 v7, v3, 1122893824, v4
v_cos_f32 v6, v6
v_cos_f32 v7, v7
v_cvt_pk_bf16_f32 v158, v8, v9
v_fmamk_f32 v8, v3, 1124073472, v4
v_fmamk_f32 v9, v3, 1124139008, v4
v_cos_f32 v8, v8
v_cos_f32 v9, v9
v_cvt_pk_bf16_f32 v159, v6, v7
v_fmamk_f32 v6, v3, 1124204544, v4
v_fmamk_f32 v7, v3, 1124270080, v4
v_cos_f32 v6, v6
v_cos_f32 v7, v7
v_cvt_pk_bf16_f32 v160, v8, v9
v_fmamk_f32 v8, v3, 1124335616, v4
v_fmamk_f32 v9, v3, 1124401152, v4
v_cos_f32 v8, v8
v_cos_f32 v9, v9
v_cvt_pk_bf16_f32 v161, v6, v7
v_fmamk_f32 v6, v3, 1124466688, v4
v_fmamk_f32 v7, v3, 1124532224, v4
v_cos_f32 v6, v6
v_cos_f32 v7, v7
v_cvt_pk_bf16_f32 v162, v8, v9
v_fmamk_f32 v8, v3, 1125122048, v4
v_fmamk_f32 v9, v3, 1125187584, v4
v_cos_f32 v8, v8
v_cos_f32 v9, v9
v_cvt_pk_bf16_f32 v163, v6, v7
v_fmamk_f32 v6, v3, 1125253120, v4
v_fmamk_f32 v7, v3, 1125318656, v4
v_cos_f32 v6, v6
v_cos_f32 v7, v7
v_cvt_pk_bf16_f32 v164, v8, v9
v_fmamk_f32 v8, v3, 1125384192, v4
v_fmamk_f32 v9, v3, 1125449728, v4
v_cos_f32 v8, v8
v_cos_f32 v9, v9
v_cvt_pk_bf16_f32 v165, v6, v7
v_fmamk_f32 v6, v3, 1125515264, v4
v_fmamk_f32 v7, v3, 1125580800, v4
v_cos_f32 v6, v6
v_cos_f32 v7, v7
v_cvt_pk_bf16_f32 v166, v8, v9
v_fmamk_f32 v8, v3, 1126170624, v4
v_fmamk_f32 v9, v3, 1126236160, v4
v_cos_f32 v8, v8
v_cos_f32 v9, v9
v_cvt_pk_bf16_f32 v167, v6, v7
v_fmamk_f32 v6, v3, 1126301696, v4
v_fmamk_f32 v7, v3, 1126367232, v4
v_cos_f32 v6, v6
v_cos_f32 v7, v7
v_cvt_pk_bf16_f32 v168, v8, v9
v_fmamk_f32 v8, v3, 1126432768, v4
v_fmamk_f32 v9, v3, 1126498304, v4
v_cos_f32 v8, v8
v_cos_f32 v9, v9
v_cvt_pk_bf16_f32 v169, v6, v7
v_fmamk_f32 v6, v3, 1126563840, v4
v_fmamk_f32 v7, v3, 1126629376, v4
v_cos_f32 v6, v6
v_cos_f32 v7, v7
v_cvt_pk_bf16_f32 v170, v8, v9
v_fmamk_f32 v8, v3, 1127219200, v4
v_fmamk_f32 v9, v3, 1127284736, v4
v_cos_f32 v8, v8
v_cos_f32 v9, v9
v_cvt_pk_bf16_f32 v171, v6, v7
v_fmamk_f32 v6, v3, 1127350272, v4
v_fmamk_f32 v7, v3, 1127415808, v4
v_cos_f32 v6, v6
v_cos_f32 v7, v7
v_cvt_pk_bf16_f32 v172, v8, v9
v_fmamk_f32 v8, v3, 1127481344, v4
v_fmamk_f32 v9, v3, 1127546880, v4
v_cos_f32 v8, v8
v_cos_f32 v9, v9
v_cvt_pk_bf16_f32 v173, v6, v7
v_fmamk_f32 v6, v3, 1127612416, v4
v_fmamk_f32 v7, v3, 1127677952, v4
v_cos_f32 v6, v6
v_cos_f32 v7, v7
v_cvt_pk_bf16_f32 v174, v8, v9
v_fmamk_f32 v8, v3, 1128267776, v4
v_fmamk_f32 v9, v3, 1128333312, v4
v_cos_f32 v8, v8
v_cos_f32 v9, v9
v_cvt_pk_bf16_f32 v175, v6, v7
v_fmamk_f32 v6, v3, 1128398848, v4
v_fmamk_f32 v7, v3, 1128464384, v4
v_cos_f32 v6, v6
v_cos_f32 v7, v7
v_cvt_pk_bf16_f32 v176, v8, v9
v_fmamk_f32 v8, v3, 1128529920, v4
v_fmamk_f32 v9, v3, 1128595456, v4
v_cos_f32 v8, v8
v_cos_f32 v9, v9
v_cvt_pk_bf16_f32 v177, v6, v7
v_fmamk_f32 v6, v3, 1128660992, v4
v_fmamk_f32 v7, v3, 1128726528, v4
v_cos_f32 v6, v6
v_cos_f32 v7, v7
v_cvt_pk_bf16_f32 v178, v8, v9
v_fmamk_f32 v8, v3, 1129316352, v4
v_fmamk_f32 v9, v3, 1129381888, v4
v_cos_f32 v8, v8
v_cos_f32 v9, v9
v_cvt_pk_bf16_f32 v179, v6, v7
v_fmamk_f32 v6, v3, 1129447424, v4
v_fmamk_f32 v7, v3, 1129512960, v4
v_cos_f32 v6, v6
v_cos_f32 v7, v7
v_cvt_pk_bf16_f32 v180, v8, v9
v_fmamk_f32 v8, v3, 1129578496, v4
v_fmamk_f32 v9, v3, 1129644032, v4
v_cos_f32 v8, v8
v_cos_f32 v9, v9
v_cvt_pk_bf16_f32 v181, v6, v7
v_fmamk_f32 v6, v3, 1129709568, v4
v_fmamk_f32 v7, v3, 1129775104, v4
v_cos_f32 v6, v6
v_cos_f32 v7, v7
v_cvt_pk_bf16_f32 v182, v8, v9
v_fmamk_f32 v8, v3, 1130364928, v4
v_fmamk_f32 v9, v3, 1130430464, v4
v_cos_f32 v8, v8
v_cos_f32 v9, v9
v_cvt_pk_bf16_f32 v183, v6, v7
v_fmamk_f32 v6, v3, 1130496000, v4
v_fmamk_f32 v7, v3, 1130561536, v4
v_cos_f32 v6, v6
v_cos_f32 v7, v7
v_cvt_pk_bf16_f32 v184, v8, v9
v_fmamk_f32 v8, v3, 1130627072, v4
v_fmamk_f32 v9, v3, 1130692608, v4
v_cos_f32 v8, v8
v_cos_f32 v9, v9
v_cvt_pk_bf16_f32 v185, v6, v7
v_fmamk_f32 v6, v3, 1130758144, v4
v_fmamk_f32 v7, v3, 1130823680, v4
v_cos_f32 v6, v6
v_cos_f32 v7, v7
v_cvt_pk_bf16_f32 v186, v8, v9
v_fmamk_f32 v8, v3, 1131413504, v4
v_fmamk_f32 v9, v3, 1131479040, v4
v_cos_f32 v8, v8
v_cos_f32 v9, v9
v_cvt_pk_bf16_f32 v187, v6, v7
v_fmamk_f32 v6, v3, 1131544576, v4
v_fmamk_f32 v7, v3, 1131610112, v4
v_cos_f32 v6, v6
v_cos_f32 v7, v7
v_cvt_pk_bf16_f32 v188, v8, v9
v_fmamk_f32 v8, v3, 1131675648, v4
v_fmamk_f32 v9, v3, 1131741184, v4
v_cos_f32 v8, v8
v_cos_f32 v9, v9
v_cvt_pk_bf16_f32 v189, v6, v7
v_fmamk_f32 v6, v3, 1131806720, v4
v_fmamk_f32 v7, v3, 1131872256, v4
v_cos_f32 v6, v6
v_cos_f32 v7, v7
v_cvt_pk_bf16_f32 v190, v8, v9
v_mul_f32 v8, 1132462080, v3
v_cndmask_b32 v8, v5, v8, vcc
v_fmamk_f32 v9, v3, 1065353216, v5
v_cos_f32 v8, v8
v_cos_f32 v9, v9
v_cvt_pk_bf16_f32 v191, v6, v7
v_fmamk_f32 v6, v3, 1073741824, v5
v_fmamk_f32 v7, v3, 1077936128, v5
v_cos_f32 v6, v6
v_cos_f32 v7, v7
v_cvt_pk_bf16_f32 v192, v8, v9
v_fmamk_f32 v8, v3, 1082130432, v5
v_fmamk_f32 v9, v3, 1084227584, v5
v_cos_f32 v8, v8
v_cos_f32 v9, v9
v_cvt_pk_bf16_f32 v193, v6, v7
v_fmamk_f32 v6, v3, 1086324736, v5
v_fmamk_f32 v7, v3, 1088421888, v5
v_cos_f32 v6, v6
v_cos_f32 v7, v7
v_cvt_pk_bf16_f32 v194, v8, v9
v_fmamk_f32 v8, v3, 1098907648, v5
v_fmamk_f32 v9, v3, 1099431936, v5
v_cos_f32 v8, v8
v_cos_f32 v9, v9
v_cvt_pk_bf16_f32 v195, v6, v7
v_fmamk_f32 v6, v3, 1099956224, v5
v_fmamk_f32 v7, v3, 1100480512, v5
v_cos_f32 v6, v6
v_cos_f32 v7, v7
v_cvt_pk_bf16_f32 v196, v8, v9
v_fmamk_f32 v8, v3, 1101004800, v5
v_fmamk_f32 v9, v3, 1101529088, v5
v_cos_f32 v8, v8
v_cos_f32 v9, v9
v_cvt_pk_bf16_f32 v197, v6, v7
v_fmamk_f32 v6, v3, 1102053376, v5
v_fmamk_f32 v7, v3, 1102577664, v5
v_cos_f32 v6, v6
v_cos_f32 v7, v7
v_cvt_pk_bf16_f32 v198, v8, v9
v_fmamk_f32 v8, v3, 1107296256, v5
v_fmamk_f32 v9, v3, 1107558400, v5
v_cos_f32 v8, v8
v_cos_f32 v9, v9
v_cvt_pk_bf16_f32 v199, v6, v7
v_fmamk_f32 v6, v3, 1107820544, v5
v_fmamk_f32 v7, v3, 1108082688, v5
v_cos_f32 v6, v6
v_cos_f32 v7, v7
v_cvt_pk_bf16_f32 v200, v8, v9
v_fmamk_f32 v8, v3, 1108344832, v5
v_fmamk_f32 v9, v3, 1108606976, v5
v_cos_f32 v8, v8
v_cos_f32 v9, v9
v_cvt_pk_bf16_f32 v201, v6, v7
v_fmamk_f32 v6, v3, 1108869120, v5
v_fmamk_f32 v7, v3, 1109131264, v5
v_cos_f32 v6, v6
v_cos_f32 v7, v7
v_cvt_pk_bf16_f32 v202, v8, v9
v_fmamk_f32 v8, v3, 1111490560, v5
v_fmamk_f32 v9, v3, 1111752704, v5
v_cos_f32 v8, v8
v_cos_f32 v9, v9
v_cvt_pk_bf16_f32 v203, v6, v7
v_fmamk_f32 v6, v3, 1112014848, v5
v_fmamk_f32 v7, v3, 1112276992, v5
v_cos_f32 v6, v6
v_cos_f32 v7, v7
v_cvt_pk_bf16_f32 v204, v8, v9
v_fmamk_f32 v8, v3, 1112539136, v5
v_fmamk_f32 v9, v3, 1112801280, v5
v_cos_f32 v8, v8
v_cos_f32 v9, v9
v_cvt_pk_bf16_f32 v205, v6, v7
v_fmamk_f32 v6, v3, 1113063424, v5
v_fmamk_f32 v7, v3, 1113325568, v5
v_cos_f32 v6, v6
v_cos_f32 v7, v7
v_cvt_pk_bf16_f32 v206, v8, v9
v_fmamk_f32 v8, v3, 1115684864, v5
v_fmamk_f32 v9, v3, 1115815936, v5
v_cos_f32 v8, v8
v_cos_f32 v9, v9
v_cvt_pk_bf16_f32 v207, v6, v7
v_fmamk_f32 v6, v3, 1115947008, v5
v_fmamk_f32 v7, v3, 1116078080, v5
v_cos_f32 v6, v6
v_cos_f32 v7, v7
v_cvt_pk_bf16_f32 v208, v8, v9
v_fmamk_f32 v8, v3, 1116209152, v5
v_fmamk_f32 v9, v3, 1116340224, v5
v_cos_f32 v8, v8
v_cos_f32 v9, v9
v_cvt_pk_bf16_f32 v209, v6, v7
v_fmamk_f32 v6, v3, 1116471296, v5
v_fmamk_f32 v7, v3, 1116602368, v5
v_cos_f32 v6, v6
v_cos_f32 v7, v7
v_cvt_pk_bf16_f32 v210, v8, v9
v_fmamk_f32 v8, v3, 1117782016, v5
v_fmamk_f32 v9, v3, 1117913088, v5
v_cos_f32 v8, v8
v_cos_f32 v9, v9
v_cvt_pk_bf16_f32 v211, v6, v7
v_fmamk_f32 v6, v3, 1118044160, v5
v_fmamk_f32 v7, v3, 1118175232, v5
v_cos_f32 v6, v6
v_cos_f32 v7, v7
v_cvt_pk_bf16_f32 v212, v8, v9
v_fmamk_f32 v8, v3, 1118306304, v5
v_fmamk_f32 v9, v3, 1118437376, v5
v_cos_f32 v8, v8
v_cos_f32 v9, v9
v_cvt_pk_bf16_f32 v213, v6, v7
v_fmamk_f32 v6, v3, 1118568448, v5
v_fmamk_f32 v7, v3, 1118699520, v5
v_cos_f32 v6, v6
v_cos_f32 v7, v7
v_cvt_pk_bf16_f32 v214, v8, v9
v_fmamk_f32 v8, v3, 1119879168, v5
v_fmamk_f32 v9, v3, 1120010240, v5
v_cos_f32 v8, v8
v_cos_f32 v9, v9
v_cvt_pk_bf16_f32 v215, v6, v7
v_fmamk_f32 v6, v3, 1120141312, v5
v_fmamk_f32 v7, v3, 1120272384, v5
v_cos_f32 v6, v6
v_cos_f32 v7, v7
v_cvt_pk_bf16_f32 v216, v8, v9
v_fmamk_f32 v8, v3, 1120403456, v5
v_fmamk_f32 v9, v3, 1120534528, v5
v_cos_f32 v8, v8
v_cos_f32 v9, v9
v_cvt_pk_bf16_f32 v217, v6, v7
v_fmamk_f32 v6, v3, 1120665600, v5
v_fmamk_f32 v7, v3, 1120796672, v5
v_cos_f32 v6, v6
v_cos_f32 v7, v7
v_cvt_pk_bf16_f32 v218, v8, v9
v_fmamk_f32 v8, v3, 1121976320, v5
v_fmamk_f32 v9, v3, 1122107392, v5
v_cos_f32 v8, v8
v_cos_f32 v9, v9
v_cvt_pk_bf16_f32 v219, v6, v7
v_fmamk_f32 v6, v3, 1122238464, v5
v_fmamk_f32 v7, v3, 1122369536, v5
v_cos_f32 v6, v6
v_cos_f32 v7, v7
v_cvt_pk_bf16_f32 v220, v8, v9
v_fmamk_f32 v8, v3, 1122500608, v5
v_fmamk_f32 v9, v3, 1122631680, v5
v_cos_f32 v8, v8
v_cos_f32 v9, v9
v_cvt_pk_bf16_f32 v221, v6, v7
v_fmamk_f32 v6, v3, 1122762752, v5
v_fmamk_f32 v7, v3, 1122893824, v5
v_cos_f32 v6, v6
v_cos_f32 v7, v7
v_cvt_pk_bf16_f32 v222, v8, v9
v_fmamk_f32 v8, v3, 1124073472, v5
v_fmamk_f32 v9, v3, 1124139008, v5
v_cos_f32 v8, v8
v_cos_f32 v9, v9
v_cvt_pk_bf16_f32 v223, v6, v7
v_fmamk_f32 v6, v3, 1124204544, v5
v_fmamk_f32 v7, v3, 1124270080, v5
v_cos_f32 v6, v6
v_cos_f32 v7, v7
v_cvt_pk_bf16_f32 v224, v8, v9
v_fmamk_f32 v8, v3, 1124335616, v5
v_fmamk_f32 v9, v3, 1124401152, v5
v_cos_f32 v8, v8
v_cos_f32 v9, v9
v_cvt_pk_bf16_f32 v225, v6, v7
v_fmamk_f32 v6, v3, 1124466688, v5
v_fmamk_f32 v7, v3, 1124532224, v5
v_cos_f32 v6, v6
v_cos_f32 v7, v7
v_cvt_pk_bf16_f32 v226, v8, v9
v_fmamk_f32 v8, v3, 1125122048, v5
v_fmamk_f32 v9, v3, 1125187584, v5
v_cos_f32 v8, v8
v_cos_f32 v9, v9
v_cvt_pk_bf16_f32 v227, v6, v7
v_fmamk_f32 v6, v3, 1125253120, v5
v_fmamk_f32 v7, v3, 1125318656, v5
v_cos_f32 v6, v6
v_cos_f32 v7, v7
v_cvt_pk_bf16_f32 v228, v8, v9
v_fmamk_f32 v8, v3, 1125384192, v5
v_fmamk_f32 v9, v3, 1125449728, v5
v_cos_f32 v8, v8
v_cos_f32 v9, v9
v_cvt_pk_bf16_f32 v229, v6, v7
v_fmamk_f32 v6, v3, 1125515264, v5
v_fmamk_f32 v7, v3, 1125580800, v5
v_cos_f32 v6, v6
v_cos_f32 v7, v7
v_cvt_pk_bf16_f32 v230, v8, v9
v_fmamk_f32 v8, v3, 1126170624, v5
v_fmamk_f32 v9, v3, 1126236160, v5
v_cos_f32 v8, v8
v_cos_f32 v9, v9
v_cvt_pk_bf16_f32 v231, v6, v7
v_fmamk_f32 v6, v3, 1126301696, v5
v_fmamk_f32 v7, v3, 1126367232, v5
v_cos_f32 v6, v6
v_cos_f32 v7, v7
v_cvt_pk_bf16_f32 v232, v8, v9
v_fmamk_f32 v8, v3, 1126432768, v5
v_fmamk_f32 v9, v3, 1126498304, v5
v_cos_f32 v8, v8
v_cos_f32 v9, v9
v_cvt_pk_bf16_f32 v233, v6, v7
v_fmamk_f32 v6, v3, 1126563840, v5
v_fmamk_f32 v7, v3, 1126629376, v5
v_cos_f32 v6, v6
v_cos_f32 v7, v7
v_cvt_pk_bf16_f32 v234, v8, v9
v_fmamk_f32 v8, v3, 1127219200, v5
v_fmamk_f32 v9, v3, 1127284736, v5
v_cos_f32 v8, v8
v_cos_f32 v9, v9
v_cvt_pk_bf16_f32 v235, v6, v7
v_fmamk_f32 v6, v3, 1127350272, v5
v_fmamk_f32 v7, v3, 1127415808, v5
v_cos_f32 v6, v6
v_cos_f32 v7, v7
v_cvt_pk_bf16_f32 v236, v8, v9
v_fmamk_f32 v8, v3, 1127481344, v5
v_fmamk_f32 v9, v3, 1127546880, v5
v_cos_f32 v8, v8
v_cos_f32 v9, v9
v_cvt_pk_bf16_f32 v237, v6, v7
v_fmamk_f32 v6, v3, 1127612416, v5
v_fmamk_f32 v7, v3, 1127677952, v5
v_cos_f32 v6, v6
v_cos_f32 v7, v7
v_cvt_pk_bf16_f32 v238, v8, v9
v_fmamk_f32 v8, v3, 1128267776, v5
v_fmamk_f32 v9, v3, 1128333312, v5
v_cos_f32 v8, v8
v_cos_f32 v9, v9
v_cvt_pk_bf16_f32 v239, v6, v7
v_fmamk_f32 v6, v3, 1128398848, v5
v_fmamk_f32 v7, v3, 1128464384, v5
v_cos_f32 v6, v6
v_cos_f32 v7, v7
v_cvt_pk_bf16_f32 v240, v8, v9
v_fmamk_f32 v8, v3, 1128529920, v5
v_fmamk_f32 v9, v3, 1128595456, v5
v_cos_f32 v8, v8
v_cos_f32 v9, v9
v_cvt_pk_bf16_f32 v241, v6, v7
v_fmamk_f32 v6, v3, 1128660992, v5
v_fmamk_f32 v7, v3, 1128726528, v5
v_cos_f32 v6, v6
v_cos_f32 v7, v7
v_cvt_pk_bf16_f32 v242, v8, v9
v_fmamk_f32 v8, v3, 1129316352, v5
v_fmamk_f32 v9, v3, 1129381888, v5
v_cos_f32 v8, v8
v_cos_f32 v9, v9
v_cvt_pk_bf16_f32 v243, v6, v7
v_fmamk_f32 v6, v3, 1129447424, v5
v_fmamk_f32 v7, v3, 1129512960, v5
v_cos_f32 v6, v6
v_cos_f32 v7, v7
v_cvt_pk_bf16_f32 v244, v8, v9
v_fmamk_f32 v8, v3, 1129578496, v5
v_fmamk_f32 v9, v3, 1129644032, v5
v_cos_f32 v8, v8
v_cos_f32 v9, v9
v_cvt_pk_bf16_f32 v245, v6, v7
v_fmamk_f32 v6, v3, 1129709568, v5
v_fmamk_f32 v7, v3, 1129775104, v5
v_cos_f32 v6, v6
v_cos_f32 v7, v7
v_cvt_pk_bf16_f32 v246, v8, v9
v_fmamk_f32 v8, v3, 1130364928, v5
v_fmamk_f32 v9, v3, 1130430464, v5
v_cos_f32 v8, v8
v_cos_f32 v9, v9
v_cvt_pk_bf16_f32 v247, v6, v7
v_fmamk_f32 v6, v3, 1130496000, v5
v_fmamk_f32 v7, v3, 1130561536, v5
v_cos_f32 v6, v6
v_cos_f32 v7, v7
v_cvt_pk_bf16_f32 v248, v8, v9
v_fmamk_f32 v8, v3, 1130627072, v5
v_fmamk_f32 v9, v3, 1130692608, v5
v_cos_f32 v8, v8
v_cos_f32 v9, v9
v_cvt_pk_bf16_f32 v249, v6, v7
v_fmamk_f32 v6, v3, 1130758144, v5
v_fmamk_f32 v7, v3, 1130823680, v5
v_cos_f32 v6, v6
v_cos_f32 v7, v7
v_cvt_pk_bf16_f32 v250, v8, v9
v_fmamk_f32 v8, v3, 1131413504, v5
v_fmamk_f32 v9, v3, 1131479040, v5
v_cos_f32 v8, v8
v_cos_f32 v9, v9
v_cvt_pk_bf16_f32 v251, v6, v7
v_fmamk_f32 v6, v3, 1131544576, v5
v_fmamk_f32 v7, v3, 1131610112, v5
v_cos_f32 v6, v6
v_cos_f32 v7, v7
v_cvt_pk_bf16_f32 v252, v8, v9
v_fmamk_f32 v8, v3, 1131675648, v5
v_fmamk_f32 v9, v3, 1131741184, v5
v_cos_f32 v8, v8
v_cos_f32 v9, v9
v_cvt_pk_bf16_f32 v253, v6, v7
v_fmamk_f32 v6, v3, 1131806720, v5
v_fmamk_f32 v7, v3, 1131872256, v5
v_cos_f32 v6, v6
v_cos_f32 v7, v7
v_cvt_pk_bf16_f32 v254, v8, v9
v_cvt_pk_bf16_f32 v255, v6, v7
v_mov_b32 v6, 40
Lh_wc_28:
global_load_dword v7, v6, s[6:7] sc1
s_add_u32 s30, s30, 1
s_cmp_gt_u32 s30, 1000000
s_cbranch_scc1 L_fin
s_waitcnt vmcnt(0)
v_cmp_gt_u32 vcc, 64, v7
s_cbranch_vccz Lh_wd_29
s_sleep 16
s_branch Lh_wc_28
Lh_wd_29:
s_barrier
s_lshl2_add_u32 s28, s22, s17
s_mul_i32 s29, s28, 33024
s_add_u32 s29, s29, 104857600
s_lshl_b32 s36, s17, 15
s_add_u32 m0, s36, 0
s_add_u32 s28, s29, 0
buffer_load_dwordx4 v0, s[8:11], s28 offen offset:0 sc1 lds
buffer_load_dwordx4 v0, s[8:11], s28 offen offset:1024 sc1 lds
buffer_load_dwordx4 v0, s[8:11], s28 offen offset:2048 sc1 lds
buffer_load_dwordx4 v0, s[8:11], s28 offen offset:3072 sc1 lds
s_add_u32 m0, s36, 4096
s_add_u32 s28, s29, 4096
buffer_load_dwordx4 v0, s[8:11], s28 offen offset:0 sc1 lds
buffer_load_dwordx4 v0, s[8:11], s28 offen offset:1024 sc1 lds
buffer_load_dwordx4 v0, s[8:11], s28 offen offset:2048 sc1 lds
buffer_load_dwordx4 v0, s[8:11], s28 offen offset:3072 sc1 lds
s_add_u32 m0, s36, 8192
s_add_u32 s28, s29, 8192
buffer_load_dwordx4 v0, s[8:11], s28 offen offset:0 sc1 lds
buffer_load_dwordx4 v0, s[8:11], s28 offen offset:1024 sc1 lds
buffer_load_dwordx4 v0, s[8:11], s28 offen offset:2048 sc1 lds
buffer_load_dwordx4 v0, s[8:11], s28 offen offset:3072 sc1 lds
s_add_u32 m0, s36, 12288
s_add_u32 s28, s29, 12288
buffer_load_dwordx4 v0, s[8:11], s28 offen offset:0 sc1 lds
buffer_load_dwordx4 v0, s[8:11], s28 offen offset:1024 sc1 lds
buffer_load_dwordx4 v0, s[8:11], s28 offen offset:2048 sc1 lds
buffer_load_dwordx4 v0, s[8:11], s28 offen offset:3072 sc1 lds
s_add_u32 m0, s36, 16384
s_add_u32 s28, s29, 16384
buffer_load_dwordx4 v0, s[8:11], s28 offen offset:0 sc1 lds
buffer_load_dwordx4 v0, s[8:11], s28 offen offset:1024 sc1 lds
buffer_load_dwordx4 v0, s[8:11], s28 offen offset:2048 sc1 lds
buffer_load_dwordx4 v0, s[8:11], s28 offen offset:3072 sc1 lds
s_add_u32 m0, s36, 20480
s_add_u32 s28, s29, 20480
buffer_load_dwordx4 v0, s[8:11], s28 offen offset:0 sc1 lds
buffer_load_dwordx4 v0, s[8:11], s28 offen offset:1024 sc1 lds
buffer_load_dwordx4 v0, s[8:11], s28 offen offset:2048 sc1 lds
buffer_load_dwordx4 v0, s[8:11], s28 offen offset:3072 sc1 lds
s_add_u32 m0, s36, 24576
s_add_u32 s28, s29, 24576
buffer_load_dwordx4 v0, s[8:11], s28 offen offset:0 sc1 lds
buffer_load_dwordx4 v0, s[8:11], s28 offen offset:1024 sc1 lds
buffer_load_dwordx4 v0, s[8:11], s28 offen offset:2048 sc1 lds
buffer_load_dwordx4 v0, s[8:11], s28 offen offset:3072 sc1 lds
s_add_u32 m0, s36, 28672
s_add_u32 s28, s29, 28672
buffer_load_dwordx4 v0, s[8:11], s28 offen offset:0 sc1 lds
buffer_load_dwordx4 v0, s[8:11], s28 offen offset:1024 sc1 lds
buffer_load_dwordx4 v0, s[8:11], s28 offen offset:2048 sc1 lds
buffer_load_dwordx4 v0, s[8:11], s28 offen offset:3072 sc1 lds
s_mov_b32 s12, s4
s_mov_b32 s13, s5
s_mov_b32 s14, 4194304
s_mov_b32 s15, 0x20000
s_waitcnt vmcnt(0) lgkmcnt(0)
s_barrier
s_mov_b32 s20, 0
Lh_bl:
ds_read_b64_tr_b16 v[16:17], v1 offset:0
ds_read_b64_tr_b16 v[18:19], v1 offset:256
ds_read_b64_tr_b16 v[20:21], v1 offset:32768
ds_read_b64_tr_b16 v[22:23], v1 offset:33024
ds_read_b64_tr_b16 v[24:25], v1 offset:1024
ds_read_b64_tr_b16 v[26:27], v1 offset:1280
ds_read_b64_tr_b16 v[28:29], v1 offset:33792
ds_read_b64_tr_b16 v[30:31], v1 offset:34048
ds_read_b64_tr_b16 v[32:33], v1 offset:2048
ds_read_b64_tr_b16 v[34:35], v1 offset:2304
ds_read_b64_tr_b16 v[36:37], v1 offset:34816
ds_read_b64_tr_b16 v[38:39], v1 offset:35072
s_waitcnt lgkmcnt(10)
v_mfma_f32_32x32x16_bf16 v[64:79], v[128:131], v[16:19], 0
ds_read_b64_tr_b16 v[40:41], v1 offset:3072
ds_read_b64_tr_b16 v[42:43], v1 offset:3328
s_waitcnt lgkmcnt(10)
v_mfma_f32_32x32x16_bf16 v[80:95], v[128:131], v[20:23], 0
ds_read_b64_tr_b16 v[44:45], v1 offset:35840
ds_read_b64_tr_b16 v[46:47], v1 offset:36096
s_waitcnt lgkmcnt(10)
v_mfma_f32_32x32x16_bf16 v[64:79], v[132:135], v[24:27], v[64:79]
ds_read_b64_tr_b16 v[16:17], v1 offset:4096
ds_read_b64_tr_b16 v[18:19], v1 offset:4352
s_waitcnt lgkmcnt(10)
v_mfma_f32_32x32x16_bf16 v[80:95], v[132:135], v[28:31], v[80:95]
ds_read_b64_tr_b16 v[20:21], v1 offset:36864
ds_read_b64_tr_b16 v[22:23], v1 offset:37120
s_waitcnt lgkmcnt(10)
v_mfma_f32_32x32x16_bf16 v[64:79], v[136:139], v[32:35], v[64:79]
ds_read_b64_tr_b16 v[24:25], v1 offset:5120
ds_read_b64_tr_b16 v[26:27], v1 offset:5376
s_waitcnt lgkmcnt(10)
v_mfma_f32_32x32x16_bf16 v[80:95], v[136:139], v[36:39], v[80:95]
ds_read_b64_tr_b16 v[28:29], v1 offset:37888
ds_read_b64_tr_b16 v[30:31], v1 offset:38144
s_waitcnt lgkmcnt(10)
v_mfma_f32_32x32x16_bf16 v[64:79], v[140:143], v[40:43], v[64:79]
ds_read_b64_tr_b16 v[32:33], v1 offset:6144
ds_read_b64_tr_b16 v[34:35], v1 offset:6400
s_waitcnt lgkmcnt(10)
v_mfma_f32_32x32x16_bf16 v[80:95], v[140:143], v[44:47], v[80:95]
ds_read_b64_tr_b16 v[36:37], v1 offset:38912
ds_read_b64_tr_b16 v[38:39], v1 offset:39168
s_waitcnt lgkmcnt(10)
v_mfma_f32_32x32x16_bf16 v[64:79], v[144:147], v[16:19], v[64:79]
ds_read_b64_tr_b16 v[40:41], v1 offset:7168
ds_read_b64_tr_b16 v[42:43], v1 offset:7424
s_waitcnt lgkmcnt(10)
v_mfma_f32_32x32x16_bf16 v[80:95], v[144:147], v[20:23], v[80:95]
ds_read_b64_tr_b16 v[44:45], v1 offset:39936
ds_read_b64_tr_b16 v[46:47], v1 offset:40192
s_waitcnt lgkmcnt(10)
v_mfma_f32_32x32x16_bf16 v[64:79], v[148:151], v[24:27], v[64:79]
ds_read_b64_tr_b16 v[16:17], v1 offset:8192
ds_read_b64_tr_b16 v[18:19], v1 offset:8448
s_waitcnt lgkmcnt(10)
v_mfma_f32_32x32x16_bf16 v[80:95], v[148:151], v[28:31], v[80:95]
ds_read_b64_tr_b16 v[20:21], v1 offset:40960
ds_read_b64_tr_b16 v[22:23], v1 offset:41216
s_waitcnt lgkmcnt(10)
v_mfma_f32_32x32x16_bf16 v[64:79], v[152:155], v[32:35], v[64:79]
ds_read_b64_tr_b16 v[24:25], v1 offset:9216
ds_read_b64_tr_b16 v[26:27], v1 offset:9472
s_waitcnt lgkmcnt(10)
v_mfma_f32_32x32x16_bf16 v[80:95], v[152:155], v[36:39], v[80:95]
ds_read_b64_tr_b16 v[28:29], v1 offset:41984
ds_read_b64_tr_b16 v[30:31], v1 offset:42240
s_waitcnt lgkmcnt(10)
v_mfma_f32_32x32x16_bf16 v[64:79], v[156:159], v[40:43], v[64:79]
ds_read_b64_tr_b16 v[32:33], v1 offset:10240
ds_read_b64_tr_b16 v[34:35], v1 offset:10496
s_waitcnt lgkmcnt(10)
v_mfma_f32_32x32x16_bf16 v[80:95], v[156:159], v[44:47], v[80:95]
ds_read_b64_tr_b16 v[36:37], v1 offset:43008
ds_read_b64_tr_b16 v[38:39], v1 offset:43264
s_waitcnt lgkmcnt(10)
v_mfma_f32_32x32x16_bf16 v[64:79], v[160:163], v[16:19], v[64:79]
ds_read_b64_tr_b16 v[40:41], v1 offset:11264
ds_read_b64_tr_b16 v[42:43], v1 offset:11520
s_waitcnt lgkmcnt(10)
v_mfma_f32_32x32x16_bf16 v[80:95], v[160:163], v[20:23], v[80:95]
ds_read_b64_tr_b16 v[44:45], v1 offset:44032
ds_read_b64_tr_b16 v[46:47], v1 offset:44288
s_waitcnt lgkmcnt(10)
v_mfma_f32_32x32x16_bf16 v[64:79], v[164:167], v[24:27], v[64:79]
ds_read_b64_tr_b16 v[16:17], v1 offset:12288
ds_read_b64_tr_b16 v[18:19], v1 offset:12544
s_waitcnt lgkmcnt(10)
v_mfma_f32_32x32x16_bf16 v[80:95], v[164:167], v[28:31], v[80:95]
ds_read_b64_tr_b16 v[20:21], v1 offset:45056
ds_read_b64_tr_b16 v[22:23], v1 offset:45312
s_waitcnt lgkmcnt(10)
v_mfma_f32_32x32x16_bf16 v[64:79], v[168:171], v[32:35], v[64:79]
ds_read_b64_tr_b16 v[24:25], v1 offset:13312
ds_read_b64_tr_b16 v[26:27], v1 offset:13568
s_waitcnt lgkmcnt(10)
v_mfma_f32_32x32x16_bf16 v[80:95], v[168:171], v[36:39], v[80:95]
ds_read_b64_tr_b16 v[28:29], v1 offset:46080
ds_read_b64_tr_b16 v[30:31], v1 offset:46336
s_waitcnt lgkmcnt(10)
v_mfma_f32_32x32x16_bf16 v[64:79], v[172:175], v[40:43], v[64:79]
ds_read_b64_tr_b16 v[32:33], v1 offset:14336
ds_read_b64_tr_b16 v[34:35], v1 offset:14592
s_waitcnt lgkmcnt(10)
v_mfma_f32_32x32x16_bf16 v[80:95], v[172:175], v[44:47], v[80:95]
ds_read_b64_tr_b16 v[36:37], v1 offset:47104
ds_read_b64_tr_b16 v[38:39], v1 offset:47360
s_waitcnt lgkmcnt(10)
v_mfma_f32_32x32x16_bf16 v[64:79], v[176:179], v[16:19], v[64:79]
ds_read_b64_tr_b16 v[40:41], v1 offset:15360
ds_read_b64_tr_b16 v[42:43], v1 offset:15616
s_waitcnt lgkmcnt(10)
v_mfma_f32_32x32x16_bf16 v[80:95], v[176:179], v[20:23], v[80:95]
ds_read_b64_tr_b16 v[44:45], v1 offset:48128
ds_read_b64_tr_b16 v[46:47], v1 offset:48384
s_waitcnt lgkmcnt(10)
v_mfma_f32_32x32x16_bf16 v[64:79], v[180:183], v[24:27], v[64:79]
ds_read_b64_tr_b16 v[16:17], v1 offset:16384
ds_read_b64_tr_b16 v[18:19], v1 offset:16640
s_waitcnt lgkmcnt(10)
v_mfma_f32_32x32x16_bf16 v[80:95], v[180:183], v[28:31], v[80:95]
ds_read_b64_tr_b16 v[20:21], v1 offset:49152
ds_read_b64_tr_b16 v[22:23], v1 offset:49408
s_waitcnt lgkmcnt(10)
v_mfma_f32_32x32x16_bf16 v[64:79], v[184:187], v[32:35], v[64:79]
ds_read_b64_tr_b16 v[24:25], v1 offset:17408
ds_read_b64_tr_b16 v[26:27], v1 offset:17664
s_waitcnt lgkmcnt(10)
v_mfma_f32_32x32x16_bf16 v[80:95], v[184:187], v[36:39], v[80:95]
ds_read_b64_tr_b16 v[28:29], v1 offset:50176
ds_read_b64_tr_b16 v[30:31], v1 offset:50432
s_waitcnt lgkmcnt(10)
v_mfma_f32_32x32x16_bf16 v[64:79], v[188:191], v[40:43], v[64:79]
ds_read_b64_tr_b16 v[32:33], v1 offset:18432
ds_read_b64_tr_b16 v[34:35], v1 offset:18688
s_waitcnt lgkmcnt(10)
v_mfma_f32_32x32x16_bf16 v[80:95], v[188:191], v[44:47], v[80:95]
ds_read_b64_tr_b16 v[36:37], v1 offset:51200
ds_read_b64_tr_b16 v[38:39], v1 offset:51456
s_waitcnt lgkmcnt(10)
v_mfma_f32_32x32x16_bf16 v[64:79], v[192:195], v[16:19], v[64:79]
ds_read_b64_tr_b16 v[40:41], v1 offset:19456
ds_read_b64_tr_b16 v[42:43], v1 offset:19712
s_waitcnt lgkmcnt(10)
v_mfma_f32_32x32x16_bf16 v[80:95], v[192:195], v[20:23], v[80:95]
ds_read_b64_tr_b16 v[44:45], v1 offset:52224
ds_read_b64_tr_b16 v[46:47], v1 offset:52480
s_waitcnt lgkmcnt(10)
v_mfma_f32_32x32x16_bf16 v[64:79], v[196:199], v[24:27], v[64:79]
ds_read_b64_tr_b16 v[16:17], v1 offset:20480
ds_read_b64_tr_b16 v[18:19], v1 offset:20736
s_waitcnt lgkmcnt(10)
v_mfma_f32_32x32x16_bf16 v[80:95], v[196:199], v[28:31], v[80:95]
ds_read_b64_tr_b16 v[20:21], v1 offset:53248
ds_read_b64_tr_b16 v[22:23], v1 offset:53504
s_waitcnt lgkmcnt(10)
v_mfma_f32_32x32x16_bf16 v[64:79], v[200:203], v[32:35], v[64:79]
ds_read_b64_tr_b16 v[24:25], v1 offset:21504
ds_read_b64_tr_b16 v[26:27], v1 offset:21760
s_waitcnt lgkmcnt(10)
v_mfma_f32_32x32x16_bf16 v[80:95], v[200:203], v[36:39], v[80:95]
ds_read_b64_tr_b16 v[28:29], v1 offset:54272
ds_read_b64_tr_b16 v[30:31], v1 offset:54528
s_waitcnt lgkmcnt(10)
v_mfma_f32_32x32x16_bf16 v[64:79], v[204:207], v[40:43], v[64:79]
ds_read_b64_tr_b16 v[32:33], v1 offset:22528
ds_read_b64_tr_b16 v[34:35], v1 offset:22784
s_waitcnt lgkmcnt(10)
v_mfma_f32_32x32x16_bf16 v[80:95], v[204:207], v[44:47], v[80:95]
ds_read_b64_tr_b16 v[36:37], v1 offset:55296
ds_read_b64_tr_b16 v[38:39], v1 offset:55552
s_waitcnt lgkmcnt(10)
v_mfma_f32_32x32x16_bf16 v[64:79], v[208:211], v[16:19], v[64:79]
ds_read_b64_tr_b16 v[40:41], v1 offset:23552
ds_read_b64_tr_b16 v[42:43], v1 offset:23808
s_waitcnt lgkmcnt(10)
v_mfma_f32_32x32x16_bf16 v[80:95], v[208:211], v[20:23], v[80:95]
ds_read_b64_tr_b16 v[44:45], v1 offset:56320
ds_read_b64_tr_b16 v[46:47], v1 offset:56576
s_waitcnt lgkmcnt(10)
v_mfma_f32_32x32x16_bf16 v[64:79], v[212:215], v[24:27], v[64:79]
ds_read_b64_tr_b16 v[16:17], v1 offset:24576
ds_read_b64_tr_b16 v[18:19], v1 offset:24832
s_waitcnt lgkmcnt(10)
v_mfma_f32_32x32x16_bf16 v[80:95], v[212:215], v[28:31], v[80:95]
ds_read_b64_tr_b16 v[20:21], v1 offset:57344
ds_read_b64_tr_b16 v[22:23], v1 offset:57600
s_waitcnt lgkmcnt(10)
v_mfma_f32_32x32x16_bf16 v[64:79], v[216:219], v[32:35], v[64:79]
ds_read_b64_tr_b16 v[24:25], v1 offset:25600
ds_read_b64_tr_b16 v[26:27], v1 offset:25856
s_waitcnt lgkmcnt(10)
v_mfma_f32_32x32x16_bf16 v[80:95], v[216:219], v[36:39], v[80:95]
ds_read_b64_tr_b16 v[28:29], v1 offset:58368
ds_read_b64_tr_b16 v[30:31], v1 offset:58624
s_waitcnt lgkmcnt(10)
v_mfma_f32_32x32x16_bf16 v[64:79], v[220:223], v[40:43], v[64:79]
ds_read_b64_tr_b16 v[32:33], v1 offset:26624
ds_read_b64_tr_b16 v[34:35], v1 offset:26880
s_waitcnt lgkmcnt(10)
v_mfma_f32_32x32x16_bf16 v[80:95], v[220:223], v[44:47], v[80:95]
ds_read_b64_tr_b16 v[36:37], v1 offset:59392
ds_read_b64_tr_b16 v[38:39], v1 offset:59648
s_waitcnt lgkmcnt(10)
v_mfma_f32_32x32x16_bf16 v[64:79], v[224:227], v[16:19], v[64:79]
ds_read_b64_tr_b16 v[40:41], v1 offset:27648
ds_read_b64_tr_b16 v[42:43], v1 offset:27904
s_waitcnt lgkmcnt(10)
v_mfma_f32_32x32x16_bf16 v[80:95], v[224:227], v[20:23], v[80:95]
ds_read_b64_tr_b16 v[44:45], v1 offset:60416
ds_read_b64_tr_b16 v[46:47], v1 offset:60672
s_waitcnt lgkmcnt(10)
v_mfma_f32_32x32x16_bf16 v[64:79], v[228:231], v[24:27], v[64:79]
ds_read_b64_tr_b16 v[16:17], v1 offset:28672
ds_read_b64_tr_b16 v[18:19], v1 offset:28928
s_waitcnt lgkmcnt(10)
v_mfma_f32_32x32x16_bf16 v[80:95], v[228:231], v[28:31], v[80:95]
ds_read_b64_tr_b16 v[20:21], v1 offset:61440
ds_read_b64_tr_b16 v[22:23], v1 offset:61696
s_waitcnt lgkmcnt(10)
v_mfma_f32_32x32x16_bf16 v[64:79], v[232:235], v[32:35], v[64:79]
ds_read_b64_tr_b16 v[24:25], v1 offset:29696
ds_read_b64_tr_b16 v[26:27], v1 offset:29952
s_waitcnt lgkmcnt(10)
v_mfma_f32_32x32x16_bf16 v[80:95], v[232:235], v[36:39], v[80:95]
ds_read_b64_tr_b16 v[28:29], v1 offset:62464
ds_read_b64_tr_b16 v[30:31], v1 offset:62720
s_waitcnt lgkmcnt(10)
v_mfma_f32_32x32x16_bf16 v[64:79], v[236:239], v[40:43], v[64:79]
ds_read_b64_tr_b16 v[32:33], v1 offset:30720
ds_read_b64_tr_b16 v[34:35], v1 offset:30976
s_waitcnt lgkmcnt(10)
v_mfma_f32_32x32x16_bf16 v[80:95], v[236:239], v[44:47], v[80:95]
ds_read_b64_tr_b16 v[36:37], v1 offset:63488
ds_read_b64_tr_b16 v[38:39], v1 offset:63744
s_waitcnt lgkmcnt(10)
v_mfma_f32_32x32x16_bf16 v[64:79], v[240:243], v[16:19], v[64:79]
ds_read_b64_tr_b16 v[40:41], v1 offset:31744
ds_read_b64_tr_b16 v[42:43], v1 offset:32000
s_waitcnt lgkmcnt(10)
v_mfma_f32_32x32x16_bf16 v[80:95], v[240:243], v[20:23], v[80:95]
ds_read_b64_tr_b16 v[44:45], v1 offset:64512
ds_read_b64_tr_b16 v[46:47], v1 offset:64768
s_waitcnt lgkmcnt(10)
v_mfma_f32_32x32x16_bf16 v[64:79], v[244:247], v[24:27], v[64:79]
s_waitcnt lgkmcnt(8)
v_mfma_f32_32x32x16_bf16 v[80:95], v[244:247], v[28:31], v[80:95]
s_waitcnt lgkmcnt(6)
v_mfma_f32_32x32x16_bf16 v[64:79], v[248:251], v[32:35], v[64:79]
s_waitcnt lgkmcnt(4)
v_mfma_f32_32x32x16_bf16 v[80:95], v[248:251], v[36:39], v[80:95]
s_waitcnt lgkmcnt(2)
v_mfma_f32_32x32x16_bf16 v[64:79], v[252:255], v[40:43], v[64:79]
s_waitcnt lgkmcnt(0)
v_mfma_f32_32x32x16_bf16 v[80:95], v[252:255], v[44:47], v[80:95]
s_nop 2
s_nop 0
v_cvt_pk_bf16_f32 v96, v64, v65
v_cvt_pk_bf16_f32 v97, v66, v67
v_cvt_pk_bf16_f32 v98, v68, v69
v_cvt_pk_bf16_f32 v99, v70, v71
v_cvt_pk_bf16_f32 v100, v72, v73
v_cvt_pk_bf16_f32 v101, v74, v75
v_cvt_pk_bf16_f32 v102, v76, v77
v_cvt_pk_bf16_f32 v103, v78, v79
s_nop 0
v_cvt_pk_bf16_f32 v104, v80, v81
v_cvt_pk_bf16_f32 v105, v82, v83
v_cvt_pk_bf16_f32 v106, v84, v85
v_cvt_pk_bf16_f32 v107, v86, v87
v_cvt_pk_bf16_f32 v108, v88, v89
v_cvt_pk_bf16_f32 v109, v90, v91
v_cvt_pk_bf16_f32 v110, v92, v93
v_cvt_pk_bf16_f32 v111, v94, v95
s_add_u32 s28, s20, 65536
buffer_store_dwordx4 v[96:99], v2, s[12:15], s20 offen offset:0
buffer_store_dwordx4 v[100:103], v2, s[12:15], s20 offen offset:16
buffer_store_dwordx4 v[104:107], v2, s[12:15], s28 offen offset:0
buffer_store_dwordx4 v[108:111], v2, s[12:15], s28 offen offset:16
v_add_u32 v1, 65536, v1
s_add_u32 s20, s20, 131072
s_cmp_lt_u32 s20, 262144
s_cbranch_scc1 Lh_bl
s_waitcnt vmcnt(0) lgkmcnt(0)
s_barrier
s_and_b32 s21, s62, 15
s_lshr_b32 s19, s62, 4
v_mbcnt_lo_u32_b32 v51, -1, 0
v_mbcnt_hi_u32_b32 v51, -1, v51
s_lshl_b32 s28, s17, 6
v_add_u32 v51, s28, v51
s_lshl_b32 s28, s21, 6
v_bfe_u32 v1, v51, 2, 4
v_lshlrev_b32 v1, 10, v1
v_bfe_u32 v50, v51, 0, 2
v_lshl_add_u32 v1, v50, 4, v1
v_bfe_u32 v50, v51, 6, 2
v_lshl_add_u32 v1, v50, 20, v1
v_add_u32 v1, s28, v1
v_bfe_u32 v2, v51, 2, 4
v_lshlrev_b32 v2, 6, v2
v_bfe_u32 v50, v51, 0, 2
v_lshl_add_u32 v2, v50, 4, v2
v_bfe_u32 v50, v51, 6, 2
v_lshl_add_u32 v2, v50, 15, v2
s_mov_b32 s12, s80
s_mov_b32 s13, s81
s_mov_b32 s14, 4194304
s_mov_b32 s15, 0x20000
s_lshl_b32 s36, s17, 15
s_add_u32 m0, s36, 0
s_mov_b32 s28, 0
buffer_load_dwordx4 v1, s[12:15], s28 offen lds
s_add_u32 m0, s36, 1024
s_mov_b32 s28, 16384
buffer_load_dwordx4 v1, s[12:15], s28 offen lds
s_add_u32 m0, s36, 2048
s_mov_b32 s28, 32768
buffer_load_dwordx4 v1, s[12:15], s28 offen lds
s_add_u32 m0, s36, 3072
s_mov_b32 s28, 49152
buffer_load_dwordx4 v1, s[12:15], s28 offen lds
s_add_u32 m0, s36, 4096
s_mov_b32 s28, 65536
buffer_load_dwordx4 v1, s[12:15], s28 offen lds
s_add_u32 m0, s36, 5120
s_mov_b32 s28, 81920
buffer_load_dwordx4 v1, s[12:15], s28 offen lds
s_add_u32 m0, s36, 6144
s_mov_b32 s28, 98304
buffer_load_dwordx4 v1, s[12:15], s28 offen lds
s_add_u32 m0, s36, 7168
s_mov_b32 s28, 114688
buffer_load_dwordx4 v1, s[12:15], s28 offen lds
s_add_u32 m0, s36, 8192
s_mov_b32 s28, 131072
buffer_load_dwordx4 v1, s[12:15], s28 offen lds
s_add_u32 m0, s36, 9216
s_mov_b32 s28, 147456
buffer_load_dwordx4 v1, s[12:15], s28 offen lds
s_add_u32 m0, s36, 10240
s_mov_b32 s28, 163840
buffer_load_dwordx4 v1, s[12:15], s28 offen lds
s_add_u32 m0, s36, 11264
s_mov_b32 s28, 180224
buffer_load_dwordx4 v1, s[12:15], s28 offen lds
s_add_u32 m0, s36, 12288
s_mov_b32 s28, 196608
buffer_load_dwordx4 v1, s[12:15], s28 offen lds
s_add_u32 m0, s36, 13312
s_mov_b32 s28, 212992
buffer_load_dwordx4 v1, s[12:15], s28 offen lds
s_add_u32 m0, s36, 14336
s_mov_b32 s28, 229376
buffer_load_dwordx4 v1, s[12:15], s28 offen lds
s_add_u32 m0, s36, 15360
s_mov_b32 s28, 245760
buffer_load_dwordx4 v1, s[12:15], s28 offen lds
s_add_u32 m0, s36, 16384
s_mov_b32 s28, 262144
buffer_load_dwordx4 v1, s[12:15], s28 offen lds
s_add_u32 m0, s36, 17408
s_mov_b32 s28, 278528
buffer_load_dwordx4 v1, s[12:15], s28 offen lds
s_add_u32 m0, s36, 18432
s_mov_b32 s28, 294912
buffer_load_dwordx4 v1, s[12:15], s28 offen lds
s_add_u32 m0, s36, 19456
s_mov_b32 s28, 311296
buffer_load_dwordx4 v1, s[12:15], s28 offen lds
s_add_u32 m0, s36, 20480
s_mov_b32 s28, 327680
buffer_load_dwordx4 v1, s[12:15], s28 offen lds
s_add_u32 m0, s36, 21504
s_mov_b32 s28, 344064
buffer_load_dwordx4 v1, s[12:15], s28 offen lds
s_add_u32 m0, s36, 22528
s_mov_b32 s28, 360448
buffer_load_dwordx4 v1, s[12:15], s28 offen lds
s_add_u32 m0, s36, 23552
s_mov_b32 s28, 376832
buffer_load_dwordx4 v1, s[12:15], s28 offen lds
s_add_u32 m0, s36, 24576
s_mov_b32 s28, 393216
buffer_load_dwordx4 v1, s[12:15], s28 offen lds
s_add_u32 m0, s36, 25600
s_mov_b32 s28, 409600
buffer_load_dwordx4 v1, s[12:15], s28 offen lds
s_add_u32 m0, s36, 26624
s_mov_b32 s28, 425984
buffer_load_dwordx4 v1, s[12:15], s28 offen lds
s_add_u32 m0, s36, 27648
s_mov_b32 s28, 442368
buffer_load_dwordx4 v1, s[12:15], s28 offen lds
s_add_u32 m0, s36, 28672
s_mov_b32 s28, 458752
buffer_load_dwordx4 v1, s[12:15], s28 offen lds
s_add_u32 m0, s36, 29696
s_mov_b32 s28, 475136
buffer_load_dwordx4 v1, s[12:15], s28 offen lds
s_add_u32 m0, s36, 30720
s_mov_b32 s28, 491520
buffer_load_dwordx4 v1, s[12:15], s28 offen lds
s_add_u32 m0, s36, 31744
s_mov_b32 s28, 507904
buffer_load_dwordx4 v1, s[12:15], s28 offen lds
v_bfe_u32 v0, v51, 0, 6
v_lshlrev_b32 v0, 4, v0
s_and_b32 s28, s19, 2
s_lshl_b32 s28, s28, 11
v_bfe_u32 v3, v51, 0, 3
v_lshlrev_b32 v3, 7, v3
v_bfe_u32 v50, v51, 6, 2
v_lshl_add_u32 v3, v50, 10, v3
v_add_u32 v3, 1146880, v3
v_add_u32 v3, s28, v3
v_bfe_u32 v4, v51, 0, 6
v_lshlrev_b32 v4, 4, v4
v_bfe_u32 v50, v51, 6, 2
v_lshl_add_u32 v4, v50, 11, v4
v_add_u32 v4, 131072, v4
s_lshl_b32 s28, s21, 6
s_add_u32 s28, s28, 1024
v_bfe_u32 v5, v51, 0, 4
v_lshlrev_b32 v5, 11, v5
v_bfe_u32 v50, v51, 4, 2
v_lshl_add_u32 v5, v50, 4, v5
v_add_u32 v5, s28, v5
s_waitcnt vmcnt(28)
ds_read_b64_tr_b16 a[0:1], v2 offset:0
ds_read_b64_tr_b16 a[2:3], v2 offset:1024
ds_read_b64_tr_b16 a[4:5], v2 offset:8
ds_read_b64_tr_b16 a[6:7], v2 offset:1032
ds_read_b64_tr_b16 a[8:9], v2 offset:2048
ds_read_b64_tr_b16 a[10:11], v2 offset:3072
ds_read_b64_tr_b16 a[12:13], v2 offset:2056
ds_read_b64_tr_b16 a[14:15], v2 offset:3080
s_waitcnt lgkmcnt(0)
s_add_u32 m0, s36, 0
s_mov_b32 s28, 524288
buffer_load_dwordx4 v1, s[12:15], s28 offen lds
s_add_u32 m0, s36, 1024
s_mov_b32 s28, 540672
buffer_load_dwordx4 v1, s[12:15], s28 offen lds
s_add_u32 m0, s36, 2048
s_mov_b32 s28, 557056
buffer_load_dwordx4 v1, s[12:15], s28 offen lds
s_add_u32 m0, s36, 3072
s_mov_b32 s28, 573440
buffer_load_dwordx4 v1, s[12:15], s28 offen lds
s_waitcnt vmcnt(28)
ds_read_b64_tr_b16 a[16:17], v2 offset:4096
ds_read_b64_tr_b16 a[18:19], v2 offset:5120
ds_read_b64_tr_b16 a[20:21], v2 offset:4104
ds_read_b64_tr_b16 a[22:23], v2 offset:5128
ds_read_b64_tr_b16 a[24:25], v2 offset:6144
ds_read_b64_tr_b16 a[26:27], v2 offset:7168
ds_read_b64_tr_b16 a[28:29], v2 offset:6152
ds_read_b64_tr_b16 a[30:31], v2 offset:7176
s_waitcnt lgkmcnt(0)
s_add_u32 m0, s36, 4096
s_mov_b32 s28, 589824
buffer_load_dwordx4 v1, s[12:15], s28 offen lds
s_add_u32 m0, s36, 5120
s_mov_b32 s28, 606208
buffer_load_dwordx4 v1, s[12:15], s28 offen lds
s_add_u32 m0, s36, 6144
s_mov_b32 s28, 622592
buffer_load_dwordx4 v1, s[12:15], s28 offen lds
s_add_u32 m0, s36, 7168
s_mov_b32 s28, 638976
buffer_load_dwordx4 v1, s[12:15], s28 offen lds
s_waitcnt vmcnt(28)
ds_read_b64_tr_b16 a[32:33], v2 offset:8192
ds_read_b64_tr_b16 a[34:35], v2 offset:9216
ds_read_b64_tr_b16 a[36:37], v2 offset:8200
ds_read_b64_tr_b16 a[38:39], v2 offset:9224
ds_read_b64_tr_b16 a[40:41], v2 offset:10240
ds_read_b64_tr_b16 a[42:43], v2 offset:11264
ds_read_b64_tr_b16 a[44:45], v2 offset:10248
ds_read_b64_tr_b16 a[46:47], v2 offset:11272
s_waitcnt lgkmcnt(0)
s_add_u32 m0, s36, 8192
s_mov_b32 s28, 655360
buffer_load_dwordx4 v1, s[12:15], s28 offen lds
s_add_u32 m0, s36, 9216
s_mov_b32 s28, 671744
buffer_load_dwordx4 v1, s[12:15], s28 offen lds
s_add_u32 m0, s36, 10240
s_mov_b32 s28, 688128
buffer_load_dwordx4 v1, s[12:15], s28 offen lds
s_add_u32 m0, s36, 11264
s_mov_b32 s28, 704512
buffer_load_dwordx4 v1, s[12:15], s28 offen lds
s_waitcnt vmcnt(28)
ds_read_b64_tr_b16 a[48:49], v2 offset:12288
ds_read_b64_tr_b16 a[50:51], v2 offset:13312
ds_read_b64_tr_b16 a[52:53], v2 offset:12296
ds_read_b64_tr_b16 a[54:55], v2 offset:13320
ds_read_b64_tr_b16 a[56:57], v2 offset:14336
ds_read_b64_tr_b16 a[58:59], v2 offset:15360
ds_read_b64_tr_b16 a[60:61], v2 offset:14344
ds_read_b64_tr_b16 a[62:63], v2 offset:15368
s_waitcnt lgkmcnt(0)
s_add_u32 m0, s36, 12288
s_mov_b32 s28, 720896
buffer_load_dwordx4 v1, s[12:15], s28 offen lds
s_add_u32 m0, s36, 13312
s_mov_b32 s28, 737280
buffer_load_dwordx4 v1, s[12:15], s28 offen lds
s_add_u32 m0, s36, 14336
s_mov_b32 s28, 753664
buffer_load_dwordx4 v1, s[12:15], s28 offen lds
s_add_u32 m0, s36, 15360
s_mov_b32 s28, 770048
buffer_load_dwordx4 v1, s[12:15], s28 offen lds
s_waitcnt vmcnt(28)
ds_read_b64_tr_b16 a[64:65], v2 offset:16384
ds_read_b64_tr_b16 a[66:67], v2 offset:17408
ds_read_b64_tr_b16 a[68:69], v2 offset:16392
ds_read_b64_tr_b16 a[70:71], v2 offset:17416
ds_read_b64_tr_b16 a[72:73], v2 offset:18432
ds_read_b64_tr_b16 a[74:75], v2 offset:19456
ds_read_b64_tr_b16 a[76:77], v2 offset:18440
ds_read_b64_tr_b16 a[78:79], v2 offset:19464
s_waitcnt lgkmcnt(0)
s_add_u32 m0, s36, 16384
s_mov_b32 s28, 786432
buffer_load_dwordx4 v1, s[12:15], s28 offen lds
s_add_u32 m0, s36, 17408
s_mov_b32 s28, 802816
buffer_load_dwordx4 v1, s[12:15], s28 offen lds
s_add_u32 m0, s36, 18432
s_mov_b32 s28, 819200
buffer_load_dwordx4 v1, s[12:15], s28 offen lds
s_add_u32 m0, s36, 19456
s_mov_b32 s28, 835584
buffer_load_dwordx4 v1, s[12:15], s28 offen lds
s_waitcnt vmcnt(28)
ds_read_b64_tr_b16 a[80:81], v2 offset:20480
ds_read_b64_tr_b16 a[82:83], v2 offset:21504
ds_read_b64_tr_b16 a[84:85], v2 offset:20488
ds_read_b64_tr_b16 a[86:87], v2 offset:21512
ds_read_b64_tr_b16 a[88:89], v2 offset:22528
ds_read_b64_tr_b16 a[90:91], v2 offset:23552
ds_read_b64_tr_b16 a[92:93], v2 offset:22536
ds_read_b64_tr_b16 a[94:95], v2 offset:23560
s_waitcnt lgkmcnt(0)
s_add_u32 m0, s36, 20480
s_mov_b32 s28, 851968
buffer_load_dwordx4 v1, s[12:15], s28 offen lds
s_add_u32 m0, s36, 21504
s_mov_b32 s28, 868352
buffer_load_dwordx4 v1, s[12:15], s28 offen lds
s_add_u32 m0, s36, 22528
s_mov_b32 s28, 884736
buffer_load_dwordx4 v1, s[12:15], s28 offen lds
s_add_u32 m0, s36, 23552
s_mov_b32 s28, 901120
buffer_load_dwordx4 v1, s[12:15], s28 offen lds
s_waitcnt vmcnt(28)
ds_read_b64_tr_b16 a[96:97], v2 offset:24576
ds_read_b64_tr_b16 a[98:99], v2 offset:25600
ds_read_b64_tr_b16 a[100:101], v2 offset:24584
ds_read_b64_tr_b16 a[102:103], v2 offset:25608
ds_read_b64_tr_b16 a[104:105], v2 offset:26624
ds_read_b64_tr_b16 a[106:107], v2 offset:27648
ds_read_b64_tr_b16 a[108:109], v2 offset:26632
ds_read_b64_tr_b16 a[110:111], v2 offset:27656
s_waitcnt lgkmcnt(0)
s_add_u32 m0, s36, 24576
s_mov_b32 s28, 917504
buffer_load_dwordx4 v1, s[12:15], s28 offen lds
s_add_u32 m0, s36, 25600
s_mov_b32 s28, 933888
buffer_load_dwordx4 v1, s[12:15], s28 offen lds
s_add_u32 m0, s36, 26624
s_mov_b32 s28, 950272
buffer_load_dwordx4 v1, s[12:15], s28 offen lds
s_add_u32 m0, s36, 27648
s_mov_b32 s28, 966656
buffer_load_dwordx4 v1, s[12:15], s28 offen lds
s_waitcnt vmcnt(28)
ds_read_b64_tr_b16 a[112:113], v2 offset:28672
ds_read_b64_tr_b16 a[114:115], v2 offset:29696
ds_read_b64_tr_b16 a[116:117], v2 offset:28680
ds_read_b64_tr_b16 a[118:119], v2 offset:29704
ds_read_b64_tr_b16 a[120:121], v2 offset:30720
ds_read_b64_tr_b16 a[122:123], v2 offset:31744
ds_read_b64_tr_b16 a[124:125], v2 offset:30728
ds_read_b64_tr_b16 a[126:127], v2 offset:31752
s_waitcnt lgkmcnt(0)
s_add_u32 m0, s36, 28672
s_mov_b32 s28, 983040
buffer_load_dwordx4 v1, s[12:15], s28 offen lds
s_add_u32 m0, s36, 29696
s_mov_b32 s28, 999424
buffer_load_dwordx4 v1, s[12:15], s28 offen lds
s_add_u32 m0, s36, 30720
s_mov_b32 s28, 1015808
buffer_load_dwordx4 v1, s[12:15], s28 offen lds
s_add_u32 m0, s36, 31744
s_mov_b32 s28, 1032192
buffer_load_dwordx4 v1, s[12:15], s28 offen lds
s_waitcnt vmcnt(28)
ds_read_b64_tr_b16 a[128:129], v2 offset:0
ds_read_b64_tr_b16 a[130:131], v2 offset:1024
ds_read_b64_tr_b16 a[132:133], v2 offset:8
ds_read_b64_tr_b16 a[134:135], v2 offset:1032
ds_read_b64_tr_b16 a[136:137], v2 offset:2048
ds_read_b64_tr_b16 a[138:139], v2 offset:3072
ds_read_b64_tr_b16 a[140:141], v2 offset:2056
ds_read_b64_tr_b16 a[142:143], v2 offset:3080
s_waitcnt lgkmcnt(0)
s_waitcnt vmcnt(24)
ds_read_b64_tr_b16 a[144:145], v2 offset:4096
ds_read_b64_tr_b16 a[146:147], v2 offset:5120
ds_read_b64_tr_b16 a[148:149], v2 offset:4104
ds_read_b64_tr_b16 a[150:151], v2 offset:5128
ds_read_b64_tr_b16 a[152:153], v2 offset:6144
ds_read_b64_tr_b16 a[154:155], v2 offset:7168
ds_read_b64_tr_b16 a[156:157], v2 offset:6152
ds_read_b64_tr_b16 a[158:159], v2 offset:7176
s_waitcnt lgkmcnt(0)
s_waitcnt vmcnt(20)
ds_read_b64_tr_b16 a[160:161], v2 offset:8192
ds_read_b64_tr_b16 a[162:163], v2 offset:9216
ds_read_b64_tr_b16 a[164:165], v2 offset:8200
ds_read_b64_tr_b16 a[166:167], v2 offset:9224
ds_read_b64_tr_b16 a[168:169], v2 offset:10240
ds_read_b64_tr_b16 a[170:171], v2 offset:11264
ds_read_b64_tr_b16 a[172:173], v2 offset:10248
ds_read_b64_tr_b16 a[174:175], v2 offset:11272
s_waitcnt lgkmcnt(0)
s_waitcnt vmcnt(16)
ds_read_b64_tr_b16 a[176:177], v2 offset:12288
ds_read_b64_tr_b16 a[178:179], v2 offset:13312
ds_read_b64_tr_b16 a[180:181], v2 offset:12296
ds_read_b64_tr_b16 a[182:183], v2 offset:13320
ds_read_b64_tr_b16 a[184:185], v2 offset:14336
ds_read_b64_tr_b16 a[186:187], v2 offset:15360
ds_read_b64_tr_b16 a[188:189], v2 offset:14344
ds_read_b64_tr_b16 a[190:191], v2 offset:15368
s_waitcnt lgkmcnt(0)
s_waitcnt vmcnt(12)
ds_read_b64_tr_b16 a[192:193], v2 offset:16384
ds_read_b64_tr_b16 a[194:195], v2 offset:17408
ds_read_b64_tr_b16 a[196:197], v2 offset:16392
ds_read_b64_tr_b16 a[198:199], v2 offset:17416
ds_read_b64_tr_b16 a[200:201], v2 offset:18432
ds_read_b64_tr_b16 a[202:203], v2 offset:19456
ds_read_b64_tr_b16 a[204:205], v2 offset:18440
ds_read_b64_tr_b16 a[206:207], v2 offset:19464
s_waitcnt lgkmcnt(0)
s_waitcnt vmcnt(8)
ds_read_b64_tr_b16 a[208:209], v2 offset:20480
ds_read_b64_tr_b16 a[210:211], v2 offset:21504
ds_read_b64_tr_b16 a[212:213], v2 offset:20488
ds_read_b64_tr_b16 a[214:215], v2 offset:21512
ds_read_b64_tr_b16 a[216:217], v2 offset:22528
ds_read_b64_tr_b16 a[218:219], v2 offset:23552
ds_read_b64_tr_b16 a[220:221], v2 offset:22536
ds_read_b64_tr_b16 a[222:223], v2 offset:23560
s_waitcnt lgkmcnt(0)
s_waitcnt vmcnt(4)
ds_read_b64_tr_b16 a[224:225], v2 offset:24576
ds_read_b64_tr_b16 a[226:227], v2 offset:25600
ds_read_b64_tr_b16 a[228:229], v2 offset:24584
ds_read_b64_tr_b16 a[230:231], v2 offset:25608
ds_read_b64_tr_b16 a[232:233], v2 offset:26624
ds_read_b64_tr_b16 a[234:235], v2 offset:27648
ds_read_b64_tr_b16 a[236:237], v2 offset:26632
ds_read_b64_tr_b16 a[238:239], v2 offset:27656
s_waitcnt lgkmcnt(0)
s_waitcnt vmcnt(0)
ds_read_b64_tr_b16 a[240:241], v2 offset:28672
ds_read_b64_tr_b16 a[242:243], v2 offset:29696
ds_read_b64_tr_b16 a[244:245], v2 offset:28680
ds_read_b64_tr_b16 a[246:247], v2 offset:29704
ds_read_b64_tr_b16 a[248:249], v2 offset:30720
ds_read_b64_tr_b16 a[250:251], v2 offset:31744
ds_read_b64_tr_b16 a[252:253], v2 offset:30728
ds_read_b64_tr_b16 a[254:255], v2 offset:31752
s_waitcnt lgkmcnt(0)
s_mov_b32 s12, s4
s_mov_b32 s13, s5
s_mov_b32 s14, 4194304
s_mov_b32 s15, 0x20000
s_lshr_b32 s26, s19, 1
s_lshl_b32 s22, s19, 17
s_lshl_b32 s28, s17, 15
s_add_u32 s22, s22, s28
s_add_u32 s22, s22, 83886080
Lo_fw:
buffer_load_dword v6, v3, s[8:11], 0 offen sc1
s_add_u32 s30, s30, 1
s_cmp_gt_u32 s30, 1000000
s_cbranch_scc1 L_fin
s_waitcnt vmcnt(0)
v_cmp_ge_u32 vcc, s26, v6
s_cbranch_vccz Lo_fo
s_cmp_ge_u32 s19, 124
s_cbranch_scc1 Lo_fw
s_sleep 2
s_branch Lo_fw
Lo_fo:
buffer_load_dwordx4 v[64:67], v0, s[8:11], s22 offen offset:0 sc1
buffer_load_dwordx4 v[68:71], v0, s[8:11], s22 offen offset:1024 sc1
buffer_load_dwordx4 v[72:75], v0, s[8:11], s22 offen offset:2048 sc1
buffer_load_dwordx4 v[76:79], v0, s[8:11], s22 offen offset:3072 sc1
s_add_u32 s22, s22, 4096
buffer_load_dwordx4 v[80:83], v0, s[8:11], s22 offen offset:0 sc1
buffer_load_dwordx4 v[84:87], v0, s[8:11], s22 offen offset:1024 sc1
buffer_load_dwordx4 v[88:91], v0, s[8:11], s22 offen offset:2048 sc1
buffer_load_dwordx4 v[92:95], v0, s[8:11], s22 offen offset:3072 sc1
s_add_u32 s22, s22, 4096
buffer_load_dwordx4 v[96:99], v0, s[8:11], s22 offen offset:0 sc1
buffer_load_dwordx4 v[100:103], v0, s[8:11], s22 offen offset:1024 sc1
buffer_load_dwordx4 v[104:107], v0, s[8:11], s22 offen offset:2048 sc1
buffer_load_dwordx4 v[108:111], v0, s[8:11], s22 offen offset:3072 sc1
s_add_u32 s22, s22, 4096
buffer_load_dwordx4 v[112:115], v0, s[8:11], s22 offen offset:0 sc1
buffer_load_dwordx4 v[116:119], v0, s[8:11], s22 offen offset:1024 sc1
buffer_load_dwordx4 v[120:123], v0, s[8:11], s22 offen offset:2048 sc1
buffer_load_dwordx4 v[124:127], v0, s[8:11], s22 offen offset:3072 sc1
s_add_u32 s22, s22, 4096
buffer_load_dwordx4 v[128:131], v0, s[8:11], s22 offen offset:0 sc1
buffer_load_dwordx4 v[132:135], v0, s[8:11], s22 offen offset:1024 sc1
buffer_load_dwordx4 v[136:139], v0, s[8:11], s22 offen offset:2048 sc1
buffer_load_dwordx4 v[140:143], v0, s[8:11], s22 offen offset:3072 sc1
s_add_u32 s22, s22, 4096
buffer_load_dwordx4 v[144:147], v0, s[8:11], s22 offen offset:0 sc1
buffer_load_dwordx4 v[148:151], v0, s[8:11], s22 offen offset:1024 sc1
buffer_load_dwordx4 v[152:155], v0, s[8:11], s22 offen offset:2048 sc1
buffer_load_dwordx4 v[156:159], v0, s[8:11], s22 offen offset:3072 sc1
s_add_u32 s22, s22, 4096
buffer_load_dwordx4 v[160:163], v0, s[8:11], s22 offen offset:0 sc1
buffer_load_dwordx4 v[164:167], v0, s[8:11], s22 offen offset:1024 sc1
buffer_load_dwordx4 v[168:171], v0, s[8:11], s22 offen offset:2048 sc1
buffer_load_dwordx4 v[172:175], v0, s[8:11], s22 offen offset:3072 sc1
s_add_u32 s22, s22, 4096
buffer_load_dwordx4 v[176:179], v0, s[8:11], s22 offen offset:0 sc1
buffer_load_dwordx4 v[180:183], v0, s[8:11], s22 offen offset:1024 sc1
buffer_load_dwordx4 v[184:187], v0, s[8:11], s22 offen offset:2048 sc1
buffer_load_dwordx4 v[188:191], v0, s[8:11], s22 offen offset:3072 sc1
Lo_seg:
s_lshl_b32 s23, s19, 15
s_add_u32 s19, s19, 4
s_lshr_b32 s26, s19, 1
s_lshl_b32 s22, s19, 17
s_lshl_b32 s28, s17, 15
s_add_u32 s22, s22, s28
s_add_u32 s22, s22, 83886080
s_waitcnt vmcnt(32)
v_cmp_ge_u32 vcc, s26, v6
s_mov_b32 s20, 1
s_cbranch_vccnz Lo_pl
s_mov_b32 s20, 0
buffer_load_dword v6, v3, s[8:11], 0 offen sc1
s_waitcnt vmcnt(32)
v_mfma_f32_16x16x32_bf16 v[8:11], a[0:3], v[64:67], 0
v_mfma_f32_16x16x32_bf16 v[12:15], a[4:7], v[64:67], 0
buffer_load_dwordx4 v[64:67], v0, s[8:11], s22 offen offset:0 sc1
s_waitcnt vmcnt(32)
v_mfma_f32_16x16x32_bf16 v[8:11], a[8:11], v[68:71], v[8:11]
v_mfma_f32_16x16x32_bf16 v[12:15], a[12:15], v[68:71], v[12:15]
buffer_load_dwordx4 v[68:71], v0, s[8:11], s22 offen offset:1024 sc1
s_waitcnt vmcnt(32)
v_mfma_f32_16x16x32_bf16 v[8:11], a[16:19], v[72:75], v[8:11]
v_mfma_f32_16x16x32_bf16 v[12:15], a[20:23], v[72:75], v[12:15]
buffer_load_dwordx4 v[72:75], v0, s[8:11], s22 offen offset:2048 sc1
s_waitcnt vmcnt(32)
v_mfma_f32_16x16x32_bf16 v[8:11], a[24:27], v[76:79], v[8:11]
v_mfma_f32_16x16x32_bf16 v[12:15], a[28:31], v[76:79], v[12:15]
buffer_load_dwordx4 v[76:79], v0, s[8:11], s22 offen offset:3072 sc1
s_waitcnt vmcnt(32)
v_mfma_f32_16x16x32_bf16 v[8:11], a[32:35], v[80:83], v[8:11]
v_mfma_f32_16x16x32_bf16 v[12:15], a[36:39], v[80:83], v[12:15]
s_add_u32 s22, s22, 4096
buffer_load_dwordx4 v[80:83], v0, s[8:11], s22 offen offset:0 sc1
s_waitcnt vmcnt(32)
v_mfma_f32_16x16x32_bf16 v[8:11], a[40:43], v[84:87], v[8:11]
v_mfma_f32_16x16x32_bf16 v[12:15], a[44:47], v[84:87], v[12:15]
buffer_load_dwordx4 v[84:87], v0, s[8:11], s22 offen offset:1024 sc1
s_waitcnt vmcnt(32)
v_mfma_f32_16x16x32_bf16 v[8:11], a[48:51], v[88:91], v[8:11]
v_mfma_f32_16x16x32_bf16 v[12:15], a[52:55], v[88:91], v[12:15]
buffer_load_dwordx4 v[88:91], v0, s[8:11], s22 offen offset:2048 sc1
s_waitcnt vmcnt(32)
v_mfma_f32_16x16x32_bf16 v[8:11], a[56:59], v[92:95], v[8:11]
v_mfma_f32_16x16x32_bf16 v[12:15], a[60:63], v[92:95], v[12:15]
buffer_load_dwordx4 v[92:95], v0, s[8:11], s22 offen offset:3072 sc1
s_waitcnt vmcnt(32)
v_mfma_f32_16x16x32_bf16 v[8:11], a[64:67], v[96:99], v[8:11]
v_mfma_f32_16x16x32_bf16 v[12:15], a[68:71], v[96:99], v[12:15]
s_add_u32 s22, s22, 4096
buffer_load_dwordx4 v[96:99], v0, s[8:11], s22 offen offset:0 sc1
s_waitcnt vmcnt(32)
v_mfma_f32_16x16x32_bf16 v[8:11], a[72:75], v[100:103], v[8:11]
v_mfma_f32_16x16x32_bf16 v[12:15], a[76:79], v[100:103], v[12:15]
buffer_load_dwordx4 v[100:103], v0, s[8:11], s22 offen offset:1024 sc1
s_waitcnt vmcnt(32)
v_mfma_f32_16x16x32_bf16 v[8:11], a[80:83], v[104:107], v[8:11]
v_mfma_f32_16x16x32_bf16 v[12:15], a[84:87], v[104:107], v[12:15]
buffer_load_dwordx4 v[104:107], v0, s[8:11], s22 offen offset:2048 sc1
s_waitcnt vmcnt(32)
v_mfma_f32_16x16x32_bf16 v[8:11], a[88:91], v[108:111], v[8:11]
v_mfma_f32_16x16x32_bf16 v[12:15], a[92:95], v[108:111], v[12:15]
buffer_load_dwordx4 v[108:111], v0, s[8:11], s22 offen offset:3072 sc1
s_waitcnt vmcnt(32)
v_mfma_f32_16x16x32_bf16 v[8:11], a[96:99], v[112:115], v[8:11]
v_mfma_f32_16x16x32_bf16 v[12:15], a[100:103], v[112:115], v[12:15]
s_add_u32 s22, s22, 4096
buffer_load_dwordx4 v[112:115], v0, s[8:11], s22 offen offset:0 sc1
s_waitcnt vmcnt(32)
v_mfma_f32_16x16x32_bf16 v[8:11], a[104:107], v[116:119], v[8:11]
v_mfma_f32_16x16x32_bf16 v[12:15], a[108:111], v[116:119], v[12:15]
buffer_load_dwordx4 v[116:119], v0, s[8:11], s22 offen offset:1024 sc1
s_waitcnt vmcnt(32)
v_mfma_f32_16x16x32_bf16 v[8:11], a[112:115], v[120:123], v[8:11]
v_mfma_f32_16x16x32_bf16 v[12:15], a[116:119], v[120:123], v[12:15]
buffer_load_dwordx4 v[120:123], v0, s[8:11], s22 offen offset:2048 sc1
s_waitcnt vmcnt(32)
v_mfma_f32_16x16x32_bf16 v[8:11], a[120:123], v[124:127], v[8:11]
v_mfma_f32_16x16x32_bf16 v[12:15], a[124:127], v[124:127], v[12:15]
buffer_load_dwordx4 v[124:127], v0, s[8:11], s22 offen offset:3072 sc1
s_waitcnt vmcnt(32)
v_mfma_f32_16x16x32_bf16 v[8:11], a[128:131], v[128:131], v[8:11]
v_mfma_f32_16x16x32_bf16 v[12:15], a[132:135], v[128:131], v[12:15]
s_add_u32 s22, s22, 4096
buffer_load_dwordx4 v[128:131], v0, s[8:11], s22 offen offset:0 sc1
s_waitcnt vmcnt(32)
v_mfma_f32_16x16x32_bf16 v[8:11], a[136:139], v[132:135], v[8:11]
v_mfma_f32_16x16x32_bf16 v[12:15], a[140:143], v[132:135], v[12:15]
buffer_load_dwordx4 v[132:135], v0, s[8:11], s22 offen offset:1024 sc1
s_waitcnt vmcnt(32)
v_mfma_f32_16x16x32_bf16 v[8:11], a[144:147], v[136:139], v[8:11]
v_mfma_f32_16x16x32_bf16 v[12:15], a[148:151], v[136:139], v[12:15]
buffer_load_dwordx4 v[136:139], v0, s[8:11], s22 offen offset:2048 sc1
s_waitcnt vmcnt(32)
v_mfma_f32_16x16x32_bf16 v[8:11], a[152:155], v[140:143], v[8:11]
v_mfma_f32_16x16x32_bf16 v[12:15], a[156:159], v[140:143], v[12:15]
buffer_load_dwordx4 v[140:143], v0, s[8:11], s22 offen offset:3072 sc1
s_waitcnt vmcnt(32)
v_mfma_f32_16x16x32_bf16 v[8:11], a[160:163], v[144:147], v[8:11]
v_mfma_f32_16x16x32_bf16 v[12:15], a[164:167], v[144:147], v[12:15]
s_add_u32 s22, s22, 4096
buffer_load_dwordx4 v[144:147], v0, s[8:11], s22 offen offset:0 sc1
s_waitcnt vmcnt(32)
v_mfma_f32_16x16x32_bf16 v[8:11], a[168:171], v[148:151], v[8:11]
v_mfma_f32_16x16x32_bf16 v[12:15], a[172:175], v[148:151], v[12:15]
buffer_load_dwordx4 v[148:151], v0, s[8:11], s22 offen offset:1024 sc1
s_waitcnt vmcnt(32)
v_mfma_f32_16x16x32_bf16 v[8:11], a[176:179], v[152:155], v[8:11]
v_mfma_f32_16x16x32_bf16 v[12:15], a[180:183], v[152:155], v[12:15]
buffer_load_dwordx4 v[152:155], v0, s[8:11], s22 offen offset:2048 sc1
s_waitcnt vmcnt(32)
v_mfma_f32_16x16x32_bf16 v[8:11], a[184:187], v[156:159], v[8:11]
v_mfma_f32_16x16x32_bf16 v[12:15], a[188:191], v[156:159], v[12:15]
buffer_load_dwordx4 v[156:159], v0, s[8:11], s22 offen offset:3072 sc1
s_waitcnt vmcnt(32)
v_mfma_f32_16x16x32_bf16 v[8:11], a[192:195], v[160:163], v[8:11]
v_mfma_f32_16x16x32_bf16 v[12:15], a[196:199], v[160:163], v[12:15]
s_add_u32 s22, s22, 4096
buffer_load_dwordx4 v[160:163], v0, s[8:11], s22 offen offset:0 sc1
s_waitcnt vmcnt(32)
v_mfma_f32_16x16x32_bf16 v[8:11], a[200:203], v[164:167], v[8:11]
v_mfma_f32_16x16x32_bf16 v[12:15], a[204:207], v[164:167], v[12:15]
buffer_load_dwordx4 v[164:167], v0, s[8:11], s22 offen offset:1024 sc1
s_waitcnt vmcnt(32)
v_mfma_f32_16x16x32_bf16 v[8:11], a[208:211], v[168:171], v[8:11]
v_mfma_f32_16x16x32_bf16 v[12:15], a[212:215], v[168:171], v[12:15]
buffer_load_dwordx4 v[168:171], v0, s[8:11], s22 offen offset:2048 sc1
s_waitcnt vmcnt(32)
v_mfma_f32_16x16x32_bf16 v[8:11], a[216:219], v[172:175], v[8:11]
v_mfma_f32_16x16x32_bf16 v[12:15], a[220:223], v[172:175], v[12:15]
buffer_load_dwordx4 v[172:175], v0, s[8:11], s22 offen offset:3072 sc1
s_waitcnt vmcnt(32)
v_mfma_f32_16x16x32_bf16 v[8:11], a[224:227], v[176:179], v[8:11]
v_mfma_f32_16x16x32_bf16 v[12:15], a[228:231], v[176:179], v[12:15]
s_add_u32 s22, s22, 4096
buffer_load_dwordx4 v[176:179], v0, s[8:11], s22 offen offset:0 sc1
s_waitcnt vmcnt(32)
v_mfma_f32_16x16x32_bf16 v[8:11], a[232:235], v[180:183], v[8:11]
v_mfma_f32_16x16x32_bf16 v[12:15], a[236:239], v[180:183], v[12:15]
buffer_load_dwordx4 v[180:183], v0, s[8:11], s22 offen offset:1024 sc1
s_waitcnt vmcnt(32)
v_mfma_f32_16x16x32_bf16 v[8:11], a[240:243], v[184:187], v[8:11]
v_mfma_f32_16x16x32_bf16 v[12:15], a[244:247], v[184:187], v[12:15]
buffer_load_dwordx4 v[184:187], v0, s[8:11], s22 offen offset:2048 sc1
s_waitcnt vmcnt(32)
v_mfma_f32_16x16x32_bf16 v[8:11], a[248:251], v[188:191], v[8:11]
v_mfma_f32_16x16x32_bf16 v[12:15], a[252:255], v[188:191], v[12:15]
buffer_load_dwordx4 v[188:191], v0, s[8:11], s22 offen offset:3072 sc1
s_branch Lo_rd
Lo_pl:
s_waitcnt vmcnt(31)
v_mfma_f32_16x16x32_bf16 v[8:11], a[0:3], v[64:67], 0
v_mfma_f32_16x16x32_bf16 v[12:15], a[4:7], v[64:67], 0
s_waitcnt vmcnt(30)
v_mfma_f32_16x16x32_bf16 v[8:11], a[8:11], v[68:71], v[8:11]
v_mfma_f32_16x16x32_bf16 v[12:15], a[12:15], v[68:71], v[12:15]
s_waitcnt vmcnt(29)
v_mfma_f32_16x16x32_bf16 v[8:11], a[16:19], v[72:75], v[8:11]
v_mfma_f32_16x16x32_bf16 v[12:15], a[20:23], v[72:75], v[12:15]
s_waitcnt vmcnt(28)
v_mfma_f32_16x16x32_bf16 v[8:11], a[24:27], v[76:79], v[8:11]
v_mfma_f32_16x16x32_bf16 v[12:15], a[28:31], v[76:79], v[12:15]
s_waitcnt vmcnt(27)
v_mfma_f32_16x16x32_bf16 v[8:11], a[32:35], v[80:83], v[8:11]
v_mfma_f32_16x16x32_bf16 v[12:15], a[36:39], v[80:83], v[12:15]
s_waitcnt vmcnt(26)
v_mfma_f32_16x16x32_bf16 v[8:11], a[40:43], v[84:87], v[8:11]
v_mfma_f32_16x16x32_bf16 v[12:15], a[44:47], v[84:87], v[12:15]
s_waitcnt vmcnt(25)
v_mfma_f32_16x16x32_bf16 v[8:11], a[48:51], v[88:91], v[8:11]
v_mfma_f32_16x16x32_bf16 v[12:15], a[52:55], v[88:91], v[12:15]
s_waitcnt vmcnt(24)
v_mfma_f32_16x16x32_bf16 v[8:11], a[56:59], v[92:95], v[8:11]
v_mfma_f32_16x16x32_bf16 v[12:15], a[60:63], v[92:95], v[12:15]
s_waitcnt vmcnt(23)
v_mfma_f32_16x16x32_bf16 v[8:11], a[64:67], v[96:99], v[8:11]
v_mfma_f32_16x16x32_bf16 v[12:15], a[68:71], v[96:99], v[12:15]
s_waitcnt vmcnt(22)
v_mfma_f32_16x16x32_bf16 v[8:11], a[72:75], v[100:103], v[8:11]
v_mfma_f32_16x16x32_bf16 v[12:15], a[76:79], v[100:103], v[12:15]
s_waitcnt vmcnt(21)
v_mfma_f32_16x16x32_bf16 v[8:11], a[80:83], v[104:107], v[8:11]
v_mfma_f32_16x16x32_bf16 v[12:15], a[84:87], v[104:107], v[12:15]
s_waitcnt vmcnt(20)
v_mfma_f32_16x16x32_bf16 v[8:11], a[88:91], v[108:111], v[8:11]
v_mfma_f32_16x16x32_bf16 v[12:15], a[92:95], v[108:111], v[12:15]
s_waitcnt vmcnt(19)
v_mfma_f32_16x16x32_bf16 v[8:11], a[96:99], v[112:115], v[8:11]
v_mfma_f32_16x16x32_bf16 v[12:15], a[100:103], v[112:115], v[12:15]
s_waitcnt vmcnt(18)
v_mfma_f32_16x16x32_bf16 v[8:11], a[104:107], v[116:119], v[8:11]
v_mfma_f32_16x16x32_bf16 v[12:15], a[108:111], v[116:119], v[12:15]
s_waitcnt vmcnt(17)
v_mfma_f32_16x16x32_bf16 v[8:11], a[112:115], v[120:123], v[8:11]
v_mfma_f32_16x16x32_bf16 v[12:15], a[116:119], v[120:123], v[12:15]
s_waitcnt vmcnt(16)
v_mfma_f32_16x16x32_bf16 v[8:11], a[120:123], v[124:127], v[8:11]
v_mfma_f32_16x16x32_bf16 v[12:15], a[124:127], v[124:127], v[12:15]
s_waitcnt vmcnt(15)
v_mfma_f32_16x16x32_bf16 v[8:11], a[128:131], v[128:131], v[8:11]
v_mfma_f32_16x16x32_bf16 v[12:15], a[132:135], v[128:131], v[12:15]
s_waitcnt vmcnt(14)
v_mfma_f32_16x16x32_bf16 v[8:11], a[136:139], v[132:135], v[8:11]
v_mfma_f32_16x16x32_bf16 v[12:15], a[140:143], v[132:135], v[12:15]
s_waitcnt vmcnt(13)
v_mfma_f32_16x16x32_bf16 v[8:11], a[144:147], v[136:139], v[8:11]
v_mfma_f32_16x16x32_bf16 v[12:15], a[148:151], v[136:139], v[12:15]
s_waitcnt vmcnt(12)
v_mfma_f32_16x16x32_bf16 v[8:11], a[152:155], v[140:143], v[8:11]
v_mfma_f32_16x16x32_bf16 v[12:15], a[156:159], v[140:143], v[12:15]
s_waitcnt vmcnt(11)
v_mfma_f32_16x16x32_bf16 v[8:11], a[160:163], v[144:147], v[8:11]
v_mfma_f32_16x16x32_bf16 v[12:15], a[164:167], v[144:147], v[12:15]
s_waitcnt vmcnt(10)
v_mfma_f32_16x16x32_bf16 v[8:11], a[168:171], v[148:151], v[8:11]
v_mfma_f32_16x16x32_bf16 v[12:15], a[172:175], v[148:151], v[12:15]
s_waitcnt vmcnt(9)
v_mfma_f32_16x16x32_bf16 v[8:11], a[176:179], v[152:155], v[8:11]
v_mfma_f32_16x16x32_bf16 v[12:15], a[180:183], v[152:155], v[12:15]
s_waitcnt vmcnt(8)
v_mfma_f32_16x16x32_bf16 v[8:11], a[184:187], v[156:159], v[8:11]
v_mfma_f32_16x16x32_bf16 v[12:15], a[188:191], v[156:159], v[12:15]
s_waitcnt vmcnt(7)
v_mfma_f32_16x16x32_bf16 v[8:11], a[192:195], v[160:163], v[8:11]
v_mfma_f32_16x16x32_bf16 v[12:15], a[196:199], v[160:163], v[12:15]
s_waitcnt vmcnt(6)
v_mfma_f32_16x16x32_bf16 v[8:11], a[200:203], v[164:167], v[8:11]
v_mfma_f32_16x16x32_bf16 v[12:15], a[204:207], v[164:167], v[12:15]
s_waitcnt vmcnt(5)
v_mfma_f32_16x16x32_bf16 v[8:11], a[208:211], v[168:171], v[8:11]
v_mfma_f32_16x16x32_bf16 v[12:15], a[212:215], v[168:171], v[12:15]
s_waitcnt vmcnt(4)
v_mfma_f32_16x16x32_bf16 v[8:11], a[216:219], v[172:175], v[8:11]
v_mfma_f32_16x16x32_bf16 v[12:15], a[220:223], v[172:175], v[12:15]
s_waitcnt vmcnt(3)
v_mfma_f32_16x16x32_bf16 v[8:11], a[224:227], v[176:179], v[8:11]
v_mfma_f32_16x16x32_bf16 v[12:15], a[228:231], v[176:179], v[12:15]
s_waitcnt vmcnt(2)
v_mfma_f32_16x16x32_bf16 v[8:11], a[232:235], v[180:183], v[8:11]
v_mfma_f32_16x16x32_bf16 v[12:15], a[236:239], v[180:183], v[12:15]
s_waitcnt vmcnt(1)
v_mfma_f32_16x16x32_bf16 v[8:11], a[240:243], v[184:187], v[8:11]
v_mfma_f32_16x16x32_bf16 v[12:15], a[244:247], v[184:187], v[12:15]
s_waitcnt vmcnt(0)
v_mfma_f32_16x16x32_bf16 v[8:11], a[248:251], v[188:191], v[8:11]
v_mfma_f32_16x16x32_bf16 v[12:15], a[252:255], v[188:191], v[12:15]
Lo_rd:
s_nop 7
ds_write_b128 v4, v[8:11] offset:0
ds_write_b128 v4, v[12:15] offset:1024
s_waitcnt lgkmcnt(0)
s_barrier
s_cmp_lg_u32 s17, 0
s_cbranch_scc1 Lo_nx
ds_read_b128 v[16:19], v4 offset:2048
ds_read_b128 v[20:23], v4 offset:3072
ds_read_b128 v[24:27], v4 offset:4096
ds_read_b128 v[28:31], v4 offset:5120
ds_read_b128 v[32:35], v4 offset:6144
ds_read_b128 v[36:39], v4 offset:7168
s_waitcnt lgkmcnt(0)
v_add_f32 v8, v8, v16
v_add_f32 v9, v9, v17
v_add_f32 v10, v10, v18
v_add_f32 v11, v11, v19
v_add_f32 v12, v12, v20
v_add_f32 v13, v13, v21
v_add_f32 v14, v14, v22
v_add_f32 v15, v15, v23
v_add_f32 v8, v8, v24
v_add_f32 v9, v9, v25
v_add_f32 v10, v10, v26
v_add_f32 v11, v11, v27
v_add_f32 v12, v12, v28
v_add_f32 v13, v13, v29
v_add_f32 v14, v14, v30
v_add_f32 v15, v15, v31
v_add_f32 v8, v8, v32
v_add_f32 v9, v9, v33
v_add_f32 v10, v10, v34
v_add_f32 v11, v11, v35
v_add_f32 v12, v12, v36
v_add_f32 v13, v13, v37
v_add_f32 v14, v14, v38
v_add_f32 v15, v15, v39
v_cvt_pk_bf16_f32 v16, v8, v9
v_cvt_pk_bf16_f32 v17, v10, v11
v_cvt_pk_bf16_f32 v18, v12, v13
v_cvt_pk_bf16_f32 v19, v14, v15
buffer_store_dwordx4 v[16:19], v5, s[12:15], s23 offen
Lo_nx:
v_xor_b32 v4, 8192, v4
s_cmp_eq_u32 s20, 0
s_cbranch_scc1 Lo_seg
s_cmp_lt_u32 s19, 128
s_cbranch_scc1 Lo_fw
L_fin:
L_end:
s_endpgm

.section .rodata,"a"
.p2align 6
.amdhsa_kernel concat_heads__spectral_gfnet__memory_aug_recurrent_mem_tr__prompt_kernel
  .amdhsa_next_free_vgpr 512
  .amdhsa_next_free_sgpr 102
  .amdhsa_accum_offset 256
  .amdhsa_group_segment_fixed_size 0
  .amdhsa_kernarg_size 104
  .amdhsa_user_sgpr_count 2
  .amdhsa_user_sgpr_kernarg_segment_ptr 1
  .amdhsa_system_sgpr_workgroup_id_x 1
.end_amdhsa_kernel
.text
```
